```python
import torch

def _softmax(x, axis=-1):
    return torch.softmax(x, dim=axis)
def _gelu(x):
    return torch.nn.functional.gelu(x, approximate="tanh")
def _silu(x):
    return torch.nn.functional.silu(x)
def _sigmoid(x):
    return torch.sigmoid(x)
def _layernorm(x, axis=-1, eps=1e-5):
    m = x.mean(dim=axis, keepdim=True)
    v = x.var(dim=axis, keepdim=True, unbiased=False)
    return (x - m) / torch.sqrt(v + eps)
def _scatter_add(tgt, idx, src, axis=0):
    return tgt.clone().index_add_(axis, idx, src)
def _segment_sum(src, seg, n):
    out = torch.zeros((n,) + src.shape[1:], dtype=src.dtype)
    return out.index_add_(0, seg, src)
def _pad(x, pw):
    flat = tuple(v for pair in reversed(pw) for v in pair)
    return torch.nn.functional.pad(x, flat)

kernel_name = 'recurrent_scan__spectral_gfnet__geglu_ffn__prompt'

def setup_inputs():

    _w = (lambda a: (lambda t: t.to(torch.bfloat16) if t.is_floating_point() else t)(torch.as_tensor(a)))
    def _A_setup():
        B, S, D = 1, 2048, 1024
        Df = D // 2 + 1
        return {
            "x": _w((lambda *s: torch.randn(*s, dtype=torch.bfloat16) * 0.05)(B, S, D)),
            "w_r": _w((lambda *s: torch.randn(*s, dtype=torch.bfloat16) * 0.05)(S, Df) * 0.02),
            "w_i": _w((lambda *s: torch.randn(*s, dtype=torch.bfloat16) * 0.05)(S, Df) * 0.02),
        }
    _A_in = _A_setup()

    def _B_setup():
        B, S, D, F = 1, 2048, 1024, 3584
        return {
            "x": _w((lambda *s: torch.randn(*s, dtype=torch.bfloat16) * 0.05)(B, S, D)),
            "w_gate": _w((lambda *s: torch.randn(*s, dtype=torch.bfloat16) * 0.05)(D, F)),
            "w_up": _w((lambda *s: torch.randn(*s, dtype=torch.bfloat16) * 0.05)(D, F)),
            "w_down": _w((lambda *s: torch.randn(*s, dtype=torch.bfloat16) * 0.05)(F, D)),
        }
    _B_in = _B_setup()

    return {
        "A_x": _A_in["x"],
        "A_w_r": _A_in["w_r"],
        "A_w_i": _A_in["w_i"],
        "B_x": _B_in["x"],
        "B_w_gate": _B_in["w_gate"],
        "B_w_up": _B_in["w_up"],
        "B_w_down": _B_in["w_down"],
    }

def reference(A_x, A_w_r, A_w_i, B_x, B_w_gate, B_w_up, B_w_down):
    def _A_ref(x, w_r, w_i):
        B, S, D = x.shape
        X = (lambda x, axes=(-2,-1): torch.fft.rfft2(x.float(), dim=axes))(x, axes=(-2, -1))
        W = w_r + 1j * w_i
        X = X * W
        y = (lambda x, s, axes=(-2,-1): torch.fft.irfft2(x, s=s, dim=axes).to(torch.bfloat16))(X, (S, D), axes=(-2, -1))
        return y

    def _B_ref(x, w_gate, w_up, w_down):
        return (_gelu(x @ w_gate) * (x @ w_up)) @ w_down

    x = A_x
    xn = _layernorm(x, axis=-1)
    s = _A_ref(xn, A_w_r, A_w_i)
    g = _silu(_B_ref(xn, B_w_gate, B_w_up, B_w_down))
    return x + s * g
```

```asm
; @launch grid=(256,1,1) block=(256,1,1) lds=152576
.amdgcn_target "amdgcn-amd-amdhsa--gfx950"
.text
.globl recurrent_scan__spectral_gfnet__geglu_ffn__prompt_kernel
.p2align 8
.type recurrent_scan__spectral_gfnet__geglu_ffn__prompt_kernel,@function
recurrent_scan__spectral_gfnet__geglu_ffn__prompt_kernel:
    s_cmp_ge_u32 s2, 256
    s_cbranch_scc1 k_done
    s_load_dwordx16 s[4:19], s[0:1], 0
    s_load_dwordx4 s[20:23], s[0:1], 64
    s_memrealtime s[66:67]
    s_getpc_b64 s[36:37]
cs_a_start:
    s_add_u32 s36, s36, a_start-cs_a_start
    s_addc_u32 s37, s37, 0
    s_and_b32 s37, s37, 0xffff
    s_mov_b32 s38, k_done-a_start
    s_mov_b32 s39, 0x20000
    s_bfe_u32 s40, s2, 0x30003
    s_lshl_b32 s40, s40, 13
    v_and_b32 v5, 15, v0
    v_lshlrev_b32 v5, 7, v5
    v_lshrrev_b32 v6, 6, v0
    v_lshl_add_u32 v5, v6, 11, v5
    s_mov_b64 exec, 0xffff
    buffer_load_dword v243, v5, s[36:39], s40 offen
    s_mov_b64 exec, -1
a_start:
    s_getpc_b64 s[28:29]
    s_add_u32 s28, s28, gf_tab@rel32@lo+4
    s_addc_u32 s29, s29, gf_tab@rel32@hi+12
    s_and_b32 s29, s29, 0xffff
    s_mov_b32 s30, 0xa800
    s_mov_b32 s31, 0x20000
    v_and_b32 v1, 63, v0
    v_lshrrev_b32 v2, 6, v0
    s_nop 0
    v_readfirstlane_b32 s3, v2
    v_lshlrev_b32 v3, 4, v1
    s_and_b32 s36, s2, 7
    s_bfe_u32 s37, s2, 0x10003
    s_lshr_b32 s38, s2, 4
    s_lshl_b32 s39, s38, 3
    s_add_u32 s39, s39, s36
    s_lshl_b32 s44, s37, 21
    s_lshl_b32 s45, s39, 11
    s_add_u32 s63, s44, s45
    s_add_u32 s69, s63, 0x40000
    v_lshl_add_u32 v4, v2, 19, v3
    s_and_b32 s40, s2, 7
    s_lshr_b32 s41, s2, 3
    s_sub_u32 s41, s41, 4
    s_and_b32 s42, s40, 1
    s_lshl_b32 s42, s42, 2
    s_and_b32 s43, s41, 3
    s_add_u32 s42, s42, s43
    s_lshr_b32 s43, s40, 1
    s_mul_i32 s43, s43, 7
    s_lshr_b32 s44, s41, 2
    s_add_u32 s43, s43, s44
    s_and_b32 s46, s3, 1
    s_lshr_b32 s47, s3, 1
    v_lshrrev_b32 v5, 4, v1
    s_lshl_b32 s48, s46, 2
    v_add_u32 v5, s48, v5
    v_lshlrev_b32 v6, 1, v5
    v_and_b32 v7, 15, v1
    v_xor_b32 v6, v6, v7
    s_lshl_b32 s48, s47, 4
    v_add_u32 v5, s48, v5
    v_mul_u32_u24 v5, 7168, v5
    v_lshl_add_u32 v244, v6, 4, v5
    s_lshl_b32 s61, s43, 8
    s_add_u32 s62, s61, 56320
    s_lshl_b32 s64, s3, 12
    s_add_u32 s65, s64, 0x4000
    s_lshl_b32 s60, s42, 19
    s_add_u32 s60, s60, s64
    s_waitcnt lgkmcnt(0)
    s_add_u32 s48, s4, 0x0
    s_addc_u32 s49, s5, 0
    s_and_b32 s49, s49, 0xffff
    s_mov_b32 s50, 0x400000
    s_mov_b32 s51, 0x20000
    buffer_load_dwordx4 v[8:11], v4, s[48:51], s63 offen
    buffer_load_dwordx4 v[12:15], v4, s[48:51], s63 offen offset:1024
    buffer_load_dwordx4 v[16:19], v4, s[48:51], s69 offen
    buffer_load_dwordx4 v[20:23], v4, s[48:51], s69 offen offset:1024
    s_add_u32 s32, s20, 0x0
    s_addc_u32 s33, s21, 0
    s_and_b32 s33, s33, 0xffff
    s_mov_b32 s34, 0x100
    s_mov_b32 s35, 0x20000
    s_add_u32 s24, s22, 0x2300000
    s_addc_u32 s25, s23, 0
    s_and_b32 s25, s25, 0xffff
    s_mov_b32 s26, 0xe0000
    s_mov_b32 s27, 0x20000
    v_mov_b32 v245, 0
    s_or_b32 s44, s2, s3
    s_cmp_lg_u32 s44, 0
    s_cbranch_scc1 a_notok
    s_or_b32 s66, s66, 1
    v_mov_b32 v246, s66
    s_mov_b64 exec, 1
    buffer_store_dword v246, v245, s[32:35], 0 offen sc1
    s_mov_b64 exec, -1
a_notok:
    v_lshrrev_b32 v7, 2, v1
    v_lshlrev_b32 v7, 6, v7
    v_and_b32 v142, 3, v1
    v_lshl_add_u32 v7, v142, 3, v7
    v_mul_u32_u24 v142, 4160, v2
    v_add_u32 v142, v142, v7
    v_add_u32 v142, 0x20000, v142
    v_and_b32 v7, 7, v1
    v_mul_u32_u24 v143, 2080, v7
    v_lshlrev_b32 v144, 4, v7
    v_bfe_u32 v7, v1, 3, 2
    v_lshl_add_u32 v143, v7, 3, v143
    v_lshl_add_u32 v144, v7, 8, v144
    v_lshrrev_b32 v7, 5, v0
    v_lshl_add_u32 v143, v7, 6, v143
    v_lshl_add_u32 v144, v7, 14, v144
    v_add_u32 v143, 0x20000, v143
    s_lshr_b32 s10, s39, 4
    s_lshl_b32 s10, s10, 19
    s_and_b32 s11, s39, 15
    s_lshl_b32 s11, s11, 10
    s_add_u32 s10, s10, s11
    s_lshl_b32 s11, s37, 7
    s_add_u32 s10, s10, s11
    v_mul_u32_u24 v141, 4160, v2
    v_add_u32 v141, v141, v3
    v_add_u32 v141, 0x20000, v141
    s_lshl_b32 s71, s3, 12
    s_add_u32 m0, s71, 0x1c000
    s_add_u32 s71, s71, 0x0
    buffer_load_dwordx4 v3, s[28:31], s71 offen lds
    buffer_load_dwordx4 v3, s[28:31], s71 offen offset:1024 lds
    buffer_load_dwordx4 v3, s[28:31], s71 offen offset:2048 lds
    buffer_load_dwordx4 v3, s[28:31], s71 offen offset:3072 lds
    s_lshl_b32 s71, s3, 10
    s_add_u32 m0, s71, 0x24400
    s_add_u32 s71, s71, 0x4000
    buffer_load_dwordx4 v3, s[28:31], s71 offen lds
    v_and_b32 v5, 15, v1
    v_cmp_eq_u32 vcc, 0, v5
    v_mov_b32 v7, 0xffff
    s_nop 0
    v_cndmask_b32 v136, -1, 0, vcc
    v_cndmask_b32 v137, 0, v7, vcc
    v_lshlrev_b32 v138, 16, v137
    v_and_b32 v7, 3, v1
    v_lshlrev_b32 v7, 5, v7
    v_lshl_add_u32 v139, v1, 7, v7
    v_lshl_add_u32 v139, v2, 3, v139
    v_add_u32 v139, 0x18000, v139
    v_xor_b32 v197, 32, v139
    v_xor_b32 v198, 64, v139
    v_xor_b32 v199, 96, v139
    v_lshlrev_b32 v146, 4, v0
    v_add_u32 v146, 0x18000, v146
    v_lshrrev_b32 v7, 3, v0
    v_lshlrev_b32 v145, 15, v7
    v_and_b32 v7, 3, v7
    v_lshlrev_b32 v7, 1, v7
    v_and_b32 v6, 7, v0
    v_xor_b32 v7, v7, v6
    v_lshl_add_u32 v145, v7, 4, v145
    s_waitcnt vmcnt(5)
    s_mov_b32 s45, 0xffff0000
    v_lshlrev_b32 v24, 16, v8
    v_and_b32 v25, s45, v8
    v_lshlrev_b32 v26, 16, v9
    v_and_b32 v27, s45, v9
    v_lshlrev_b32 v28, 16, v10
    v_and_b32 v29, s45, v10
    v_lshlrev_b32 v30, 16, v11
    v_and_b32 v31, s45, v11
    v_lshlrev_b32 v32, 16, v12
    v_and_b32 v33, s45, v12
    v_lshlrev_b32 v34, 16, v13
    v_and_b32 v35, s45, v13
    v_lshlrev_b32 v36, 16, v14
    v_and_b32 v37, s45, v14
    v_lshlrev_b32 v38, 16, v15
    v_and_b32 v39, s45, v15
    v_lshlrev_b32 v40, 16, v16
    v_and_b32 v41, s45, v16
    v_lshlrev_b32 v42, 16, v17
    v_and_b32 v43, s45, v17
    v_lshlrev_b32 v44, 16, v18
    v_and_b32 v45, s45, v18
    v_lshlrev_b32 v46, 16, v19
    v_and_b32 v47, s45, v19
    v_lshlrev_b32 v48, 16, v20
    v_and_b32 v49, s45, v20
    v_lshlrev_b32 v50, 16, v21
    v_and_b32 v51, s45, v21
    v_lshlrev_b32 v52, 16, v22
    v_and_b32 v53, s45, v22
    v_lshlrev_b32 v54, 16, v23
    v_and_b32 v55, s45, v23
    s_add_u32 s52, s12, 0x0
    s_addc_u32 s53, s13, 0
    s_and_b32 s53, s53, 0xffff
    s_mov_b32 s54, 0x700000
    s_mov_b32 s55, 0x20000
    s_sub_u32 s56, s14, 0x800
    s_subb_u32 s57, s15, 0
    s_and_b32 s57, s57, 0xffff
    s_mov_b32 s58, 0x700800
    s_mov_b32 s59, 0x20000
    s_cmp_lt_u32 s2, 32
    s_cselect_b32 s54, 0, s54
    s_cselect_b32 s58, 0, s58
    v_pk_add_f32 v[8:9], v[24:25], v[32:33]
    s_add_u32 m0, s65, 0x0
    s_nop 0
    buffer_load_dwordx4 v244, s[52:55], s61 offen lds
    v_pk_add_f32 v[10:11], v[26:27], v[34:35]
    v_pk_add_f32 v[12:13], v[28:29], v[36:37]
    v_pk_add_f32 v[14:15], v[30:31], v[38:39]
    v_pk_add_f32 v[16:17], v[40:41], v[48:49]
    v_pk_add_f32 v[18:19], v[42:43], v[50:51]
    v_pk_add_f32 v[20:21], v[44:45], v[52:53]
    v_pk_add_f32 v[22:23], v[46:47], v[54:55]
    v_pk_add_f32 v[8:9], v[8:9], v[12:13]
    v_pk_add_f32 v[10:11], v[10:11], v[14:15]
    buffer_load_dwordx4 v244, s[52:55], s62 offen offset:1024 lds
    v_pk_add_f32 v[16:17], v[16:17], v[20:21]
    v_pk_add_f32 v[18:19], v[18:19], v[22:23]
    v_pk_add_f32 v[8:9], v[8:9], v[10:11]
    v_pk_add_f32 v[16:17], v[16:17], v[18:19]
    v_add_f32 v56, v8, v9
    v_add_f32 v57, v16, v17
    s_nop 0
    v_add_f32_dpp v56, v56, v56 quad_perm:[1,0,3,2] row_mask:0xf bank_mask:0xf
    v_add_f32_dpp v57, v57, v57 quad_perm:[1,0,3,2] row_mask:0xf bank_mask:0xf
    s_nop 0
    v_add_f32_dpp v56, v56, v56 quad_perm:[2,3,0,1] row_mask:0xf bank_mask:0xf
    buffer_load_dwordx4 v244, s[56:59], s61 offen offset:2048 lds
    s_add_u32 s61, s61, 229376
    v_add_f32_dpp v57, v57, v57 quad_perm:[2,3,0,1] row_mask:0xf bank_mask:0xf
    v_add_f32_dpp v56, v56, v56 row_half_mirror row_mask:0xf bank_mask:0xf
    s_nop 0
    v_add_f32_dpp v57, v57, v57 row_half_mirror row_mask:0xf bank_mask:0xf
    v_add_f32_dpp v56, v56, v56 row_mirror row_mask:0xf bank_mask:0xf
    s_nop 0
    v_add_f32_dpp v57, v57, v57 row_mirror row_mask:0xf bank_mask:0xf
    v_mov_b32 v58, v56
    v_mov_b32 v59, v57
    s_nop 0
    v_permlane16_swap_b32 v56, v58
    v_permlane16_swap_b32 v57, v59
    buffer_load_dwordx4 v244, s[56:59], s62 offen offset:3072 lds
    s_add_u32 s62, s62, 229376
    v_add_f32 v56, v56, v58
    v_add_f32 v57, v57, v59
    v_mov_b32 v58, v56
    v_mov_b32 v59, v57
    s_nop 0
    v_permlane32_swap_b32 v56, v58
    v_permlane32_swap_b32 v57, v59
    v_add_f32 v56, v56, v58
    v_add_f32 v57, v57, v59
    s_mov_b32 s44, 0x3a800000
    s_add_u32 m0, s65, 0x8000
    s_nop 0
    buffer_load_dwordx4 v244, s[52:55], s61 offen lds
    v_mul_f32 v56, s44, v56
    v_mul_f32 v57, s44, v57
    v_pk_add_f32 v[164:165], v[24:25], v[56:57] op_sel:[0,0] op_sel_hi:[1,0] neg_lo:[0,1] neg_hi:[0,1]
    v_pk_add_f32 v[166:167], v[26:27], v[56:57] op_sel:[0,0] op_sel_hi:[1,0] neg_lo:[0,1] neg_hi:[0,1]
    v_pk_add_f32 v[168:169], v[28:29], v[56:57] op_sel:[0,0] op_sel_hi:[1,0] neg_lo:[0,1] neg_hi:[0,1]
    v_pk_add_f32 v[170:171], v[30:31], v[56:57] op_sel:[0,0] op_sel_hi:[1,0] neg_lo:[0,1] neg_hi:[0,1]
    v_pk_add_f32 v[172:173], v[32:33], v[56:57] op_sel:[0,0] op_sel_hi:[1,0] neg_lo:[0,1] neg_hi:[0,1]
    v_pk_add_f32 v[174:175], v[34:35], v[56:57] op_sel:[0,0] op_sel_hi:[1,0] neg_lo:[0,1] neg_hi:[0,1]
    v_pk_add_f32 v[176:177], v[36:37], v[56:57] op_sel:[0,0] op_sel_hi:[1,0] neg_lo:[0,1] neg_hi:[0,1]
    buffer_load_dwordx4 v244, s[52:55], s62 offen offset:1024 lds
    v_pk_add_f32 v[178:179], v[38:39], v[56:57] op_sel:[0,0] op_sel_hi:[1,0] neg_lo:[0,1] neg_hi:[0,1]
    v_pk_add_f32 v[180:181], v[40:41], v[56:57] op_sel:[0,1] op_sel_hi:[1,1] neg_lo:[0,1] neg_hi:[0,1]
    v_pk_add_f32 v[182:183], v[42:43], v[56:57] op_sel:[0,1] op_sel_hi:[1,1] neg_lo:[0,1] neg_hi:[0,1]
    v_pk_add_f32 v[184:185], v[44:45], v[56:57] op_sel:[0,1] op_sel_hi:[1,1] neg_lo:[0,1] neg_hi:[0,1]
    v_pk_add_f32 v[186:187], v[46:47], v[56:57] op_sel:[0,1] op_sel_hi:[1,1] neg_lo:[0,1] neg_hi:[0,1]
    v_pk_add_f32 v[188:189], v[48:49], v[56:57] op_sel:[0,1] op_sel_hi:[1,1] neg_lo:[0,1] neg_hi:[0,1]
    v_pk_add_f32 v[190:191], v[50:51], v[56:57] op_sel:[0,1] op_sel_hi:[1,1] neg_lo:[0,1] neg_hi:[0,1]
    v_pk_add_f32 v[192:193], v[52:53], v[56:57] op_sel:[0,1] op_sel_hi:[1,1] neg_lo:[0,1] neg_hi:[0,1]
    v_pk_add_f32 v[194:195], v[54:55], v[56:57] op_sel:[0,1] op_sel_hi:[1,1] neg_lo:[0,1] neg_hi:[0,1]
    buffer_load_dwordx4 v244, s[56:59], s61 offen offset:2048 lds
    s_add_u32 s61, s61, 229376
    v_pk_mul_f32 v[8:9], v[164:165], v[164:165]
    v_pk_mul_f32 v[10:11], v[166:167], v[166:167]
    v_pk_mul_f32 v[12:13], v[168:169], v[168:169]
    v_pk_mul_f32 v[14:15], v[170:171], v[170:171]
    v_pk_mul_f32 v[16:17], v[180:181], v[180:181]
    v_pk_mul_f32 v[18:19], v[182:183], v[182:183]
    v_pk_mul_f32 v[20:21], v[184:185], v[184:185]
    v_pk_mul_f32 v[22:23], v[186:187], v[186:187]
    v_pk_fma_f32 v[8:9], v[172:173], v[172:173], v[8:9]
    buffer_load_dwordx4 v244, s[56:59], s62 offen offset:3072 lds
    s_add_u32 s62, s62, 229376
    v_pk_fma_f32 v[10:11], v[174:175], v[174:175], v[10:11]
    v_pk_fma_f32 v[12:13], v[176:177], v[176:177], v[12:13]
    v_pk_fma_f32 v[14:15], v[178:179], v[178:179], v[14:15]
    v_pk_fma_f32 v[16:17], v[188:189], v[188:189], v[16:17]
    v_pk_fma_f32 v[18:19], v[190:191], v[190:191], v[18:19]
    v_pk_fma_f32 v[20:21], v[192:193], v[192:193], v[20:21]
    v_pk_fma_f32 v[22:23], v[194:195], v[194:195], v[22:23]
    v_pk_add_f32 v[8:9], v[8:9], v[12:13]
    v_pk_add_f32 v[10:11], v[10:11], v[14:15]
    s_add_u32 m0, s65, 0x10000
    s_nop 0
    buffer_load_dwordx4 v244, s[52:55], s61 offen lds
    v_pk_add_f32 v[16:17], v[16:17], v[20:21]
    v_pk_add_f32 v[18:19], v[18:19], v[22:23]
    v_pk_add_f32 v[8:9], v[8:9], v[10:11]
    v_pk_add_f32 v[16:17], v[16:17], v[18:19]
    v_add_f32 v60, v8, v9
    v_add_f32 v61, v16, v17
    v_cvt_pk_bf16_f32 v62, v56, v57
    v_add_f32_dpp v60, v60, v60 quad_perm:[1,0,3,2] row_mask:0xf bank_mask:0xf
    v_add_f32_dpp v61, v61, v61 quad_perm:[1,0,3,2] row_mask:0xf bank_mask:0xf
    buffer_load_dwordx4 v244, s[52:55], s62 offen offset:1024 lds
    v_add_f32_dpp v60, v60, v60 quad_perm:[2,3,0,1] row_mask:0xf bank_mask:0xf
    v_add_f32_dpp v61, v61, v61 quad_perm:[2,3,0,1] row_mask:0xf bank_mask:0xf
    s_nop 0
    v_add_f32_dpp v60, v60, v60 row_half_mirror row_mask:0xf bank_mask:0xf
    v_add_f32_dpp v61, v61, v61 row_half_mirror row_mask:0xf bank_mask:0xf
    s_nop 0
    v_add_f32_dpp v60, v60, v60 row_mirror row_mask:0xf bank_mask:0xf
    v_add_f32_dpp v61, v61, v61 row_mirror row_mask:0xf bank_mask:0xf
    v_mov_b32 v58, v60
    v_mov_b32 v59, v61
    s_nop 0
    v_permlane16_swap_b32 v60, v58
    buffer_load_dwordx4 v244, s[56:59], s61 offen offset:2048 lds
    s_add_u32 s61, s61, 229376
    v_permlane16_swap_b32 v61, v59
    v_add_f32 v60, v60, v58
    v_add_f32 v61, v61, v59
    v_mov_b32 v58, v60
    v_mov_b32 v59, v61
    s_nop 0
    v_permlane32_swap_b32 v60, v58
    v_permlane32_swap_b32 v61, v59
    v_add_f32 v60, v60, v58
    v_add_f32 v61, v61, v59
    buffer_load_dwordx4 v244, s[56:59], s62 offen offset:3072 lds
    s_add_u32 s62, s62, 229376
    v_lshlrev_b32 v56, 16, v62
    v_and_b32 v57, s45, v62
    v_mul_f32 v60, s44, v60
    v_mul_f32 v61, s44, v61
    v_cvt_pk_bf16_f32 v58, v60, v61
    v_lshlrev_b32 v60, 16, v58
    v_and_b32 v61, s45, v58
    v_add_f32 v60, 0x3727c5ac, v60
    v_add_f32 v61, 0x3727c5ac, v61
    v_cvt_pk_bf16_f32 v58, v60, v61
    v_lshlrev_b32 v60, 16, v58
    v_and_b32 v61, s45, v58
    v_sqrt_f32 v60, v60
    v_sqrt_f32 v61, v61
    s_nop 0
    v_cvt_pk_bf16_f32 v58, v60, v61
    v_lshlrev_b32 v60, 16, v58
    v_and_b32 v61, s45, v58
    v_rcp_f32 v60, v60
    v_rcp_f32 v61, v61
    buffer_load_dword v247, v245, s[32:35], 0 offen sc1
    v_pk_add_f32 v[24:25], v[24:25], v[56:57] op_sel:[0,0] op_sel_hi:[1,0] neg_lo:[0,1] neg_hi:[0,1]
    v_pk_add_f32 v[26:27], v[26:27], v[56:57] op_sel:[0,0] op_sel_hi:[1,0] neg_lo:[0,1] neg_hi:[0,1]
    v_pk_add_f32 v[28:29], v[28:29], v[56:57] op_sel:[0,0] op_sel_hi:[1,0] neg_lo:[0,1] neg_hi:[0,1]
    v_pk_add_f32 v[30:31], v[30:31], v[56:57] op_sel:[0,0] op_sel_hi:[1,0] neg_lo:[0,1] neg_hi:[0,1]
    v_pk_add_f32 v[32:33], v[32:33], v[56:57] op_sel:[0,0] op_sel_hi:[1,0] neg_lo:[0,1] neg_hi:[0,1]
    v_pk_add_f32 v[34:35], v[34:35], v[56:57] op_sel:[0,0] op_sel_hi:[1,0] neg_lo:[0,1] neg_hi:[0,1]
    v_pk_add_f32 v[36:37], v[36:37], v[56:57] op_sel:[0,0] op_sel_hi:[1,0] neg_lo:[0,1] neg_hi:[0,1]
    v_pk_add_f32 v[38:39], v[38:39], v[56:57] op_sel:[0,0] op_sel_hi:[1,0] neg_lo:[0,1] neg_hi:[0,1]
    v_cvt_pk_bf16_f32 v8, v24, v25
    v_cvt_pk_bf16_f32 v9, v26, v27
    v_cvt_pk_bf16_f32 v10, v28, v29
    v_cvt_pk_bf16_f32 v11, v30, v31
    v_cvt_pk_bf16_f32 v12, v32, v33
    v_cvt_pk_bf16_f32 v13, v34, v35
    v_cvt_pk_bf16_f32 v14, v36, v37
    v_cvt_pk_bf16_f32 v15, v38, v39
    v_lshlrev_b32 v24, 16, v8
    v_and_b32 v25, s45, v8
    v_lshlrev_b32 v26, 16, v9
    v_and_b32 v27, s45, v9
    v_lshlrev_b32 v28, 16, v10
    v_and_b32 v29, s45, v10
    v_lshlrev_b32 v30, 16, v11
    v_and_b32 v31, s45, v11
    v_lshlrev_b32 v32, 16, v12
    v_and_b32 v33, s45, v12
    v_lshlrev_b32 v34, 16, v13
    v_and_b32 v35, s45, v13
    v_lshlrev_b32 v36, 16, v14
    v_and_b32 v37, s45, v14
    v_lshlrev_b32 v38, 16, v15
    v_and_b32 v39, s45, v15
    v_pk_mul_f32 v[24:25], v[24:25], v[60:61] op_sel:[0,0] op_sel_hi:[1,0]
    v_pk_mul_f32 v[26:27], v[26:27], v[60:61] op_sel:[0,0] op_sel_hi:[1,0]
    v_pk_mul_f32 v[28:29], v[28:29], v[60:61] op_sel:[0,0] op_sel_hi:[1,0]
    v_pk_mul_f32 v[30:31], v[30:31], v[60:61] op_sel:[0,0] op_sel_hi:[1,0]
    v_pk_mul_f32 v[32:33], v[32:33], v[60:61] op_sel:[0,0] op_sel_hi:[1,0]
    v_pk_mul_f32 v[34:35], v[34:35], v[60:61] op_sel:[0,0] op_sel_hi:[1,0]
    v_pk_mul_f32 v[36:37], v[36:37], v[60:61] op_sel:[0,0] op_sel_hi:[1,0]
    v_pk_mul_f32 v[38:39], v[38:39], v[60:61] op_sel:[0,0] op_sel_hi:[1,0]
    v_cvt_pk_bf16_f32 v8, v24, v25
    v_cvt_pk_bf16_f32 v9, v26, v27
    v_cvt_pk_bf16_f32 v10, v28, v29
    v_cvt_pk_bf16_f32 v11, v30, v31
    v_cvt_pk_bf16_f32 v12, v32, v33
    v_cvt_pk_bf16_f32 v13, v34, v35
    v_cvt_pk_bf16_f32 v14, v36, v37
    v_cvt_pk_bf16_f32 v15, v38, v39
    ds_write_b128 v141, v[8:11] offset:0
    ds_write_b128 v141, v[12:15] offset:1024
    v_pk_add_f32 v[40:41], v[40:41], v[56:57] op_sel:[0,1] op_sel_hi:[1,1] neg_lo:[0,1] neg_hi:[0,1]
    v_pk_add_f32 v[42:43], v[42:43], v[56:57] op_sel:[0,1] op_sel_hi:[1,1] neg_lo:[0,1] neg_hi:[0,1]
    v_pk_add_f32 v[44:45], v[44:45], v[56:57] op_sel:[0,1] op_sel_hi:[1,1] neg_lo:[0,1] neg_hi:[0,1]
    v_pk_add_f32 v[46:47], v[46:47], v[56:57] op_sel:[0,1] op_sel_hi:[1,1] neg_lo:[0,1] neg_hi:[0,1]
    v_pk_add_f32 v[48:49], v[48:49], v[56:57] op_sel:[0,1] op_sel_hi:[1,1] neg_lo:[0,1] neg_hi:[0,1]
    v_pk_add_f32 v[50:51], v[50:51], v[56:57] op_sel:[0,1] op_sel_hi:[1,1] neg_lo:[0,1] neg_hi:[0,1]
    v_pk_add_f32 v[52:53], v[52:53], v[56:57] op_sel:[0,1] op_sel_hi:[1,1] neg_lo:[0,1] neg_hi:[0,1]
    v_pk_add_f32 v[54:55], v[54:55], v[56:57] op_sel:[0,1] op_sel_hi:[1,1] neg_lo:[0,1] neg_hi:[0,1]
    v_cvt_pk_bf16_f32 v16, v40, v41
    v_cvt_pk_bf16_f32 v17, v42, v43
    v_cvt_pk_bf16_f32 v18, v44, v45
    v_cvt_pk_bf16_f32 v19, v46, v47
    v_cvt_pk_bf16_f32 v20, v48, v49
    v_cvt_pk_bf16_f32 v21, v50, v51
    v_cvt_pk_bf16_f32 v22, v52, v53
    v_cvt_pk_bf16_f32 v23, v54, v55
    v_lshlrev_b32 v40, 16, v16
    v_and_b32 v41, s45, v16
    v_lshlrev_b32 v42, 16, v17
    v_and_b32 v43, s45, v17
    v_lshlrev_b32 v44, 16, v18
    v_and_b32 v45, s45, v18
    v_lshlrev_b32 v46, 16, v19
    v_and_b32 v47, s45, v19
    v_lshlrev_b32 v48, 16, v20
    v_and_b32 v49, s45, v20
    v_lshlrev_b32 v50, 16, v21
    v_and_b32 v51, s45, v21
    v_lshlrev_b32 v52, 16, v22
    v_and_b32 v53, s45, v22
    v_lshlrev_b32 v54, 16, v23
    v_and_b32 v55, s45, v23
    v_pk_mul_f32 v[40:41], v[40:41], v[60:61] op_sel:[0,1] op_sel_hi:[1,1]
    v_pk_mul_f32 v[42:43], v[42:43], v[60:61] op_sel:[0,1] op_sel_hi:[1,1]
    v_pk_mul_f32 v[44:45], v[44:45], v[60:61] op_sel:[0,1] op_sel_hi:[1,1]
    v_pk_mul_f32 v[46:47], v[46:47], v[60:61] op_sel:[0,1] op_sel_hi:[1,1]
    v_pk_mul_f32 v[48:49], v[48:49], v[60:61] op_sel:[0,1] op_sel_hi:[1,1]
    v_pk_mul_f32 v[50:51], v[50:51], v[60:61] op_sel:[0,1] op_sel_hi:[1,1]
    v_pk_mul_f32 v[52:53], v[52:53], v[60:61] op_sel:[0,1] op_sel_hi:[1,1]
    v_pk_mul_f32 v[54:55], v[54:55], v[60:61] op_sel:[0,1] op_sel_hi:[1,1]
    v_cvt_pk_bf16_f32 v16, v40, v41
    v_cvt_pk_bf16_f32 v17, v42, v43
    v_cvt_pk_bf16_f32 v18, v44, v45
    v_cvt_pk_bf16_f32 v19, v46, v47
    v_cvt_pk_bf16_f32 v20, v48, v49
    v_cvt_pk_bf16_f32 v21, v50, v51
    v_cvt_pk_bf16_f32 v22, v52, v53
    v_cvt_pk_bf16_f32 v23, v54, v55
    ds_write_b128 v141, v[16:19] offset:2080
    ds_write_b128 v141, v[20:23] offset:3104
    s_add_u32 s48, s22, 0x0
    s_addc_u32 s49, s23, 0
    s_and_b32 s49, s49, 0xffff
    s_mov_b32 s50, 0x400000
    s_mov_b32 s51, 0x20000
    s_waitcnt lgkmcnt(0)
    ds_read_b64_tr_b16 v[8:9], v142 offset:0
    ds_read_b64_tr_b16 v[10:11], v142 offset:1024
    ds_read_b64_tr_b16 v[12:13], v142 offset:32
    ds_read_b64_tr_b16 v[14:15], v142 offset:1056
    ds_read_b64_tr_b16 v[16:17], v142 offset:2080
    ds_read_b64_tr_b16 v[18:19], v142 offset:3104
    ds_read_b64_tr_b16 v[20:21], v142 offset:2112
    ds_read_b64_tr_b16 v[22:23], v142 offset:3136
    s_waitcnt vmcnt(13)
    s_barrier
    ds_read_b64 v[148:149], v143 offset:0
    ds_read_b64 v[150:151], v143 offset:32
    ds_read_b64 v[152:153], v143 offset:512
    ds_read_b64 v[154:155], v143 offset:544
    ds_read_b64 v[156:157], v143 offset:1024
    ds_read_b64 v[158:159], v143 offset:1056
    ds_read_b64 v[160:161], v143 offset:1536
    ds_read_b64 v[162:163], v143 offset:1568
    s_add_u32 s41, s10, 0x0
    s_waitcnt lgkmcnt(6)
    buffer_store_dwordx4 v[148:151], v144, s[48:51], s41 offen sc1
    s_add_u32 s41, s10, 0x20000
    s_waitcnt lgkmcnt(4)
    buffer_store_dwordx4 v[152:155], v144, s[48:51], s41 offen sc1
    s_add_u32 s41, s10, 0x40000
    s_waitcnt lgkmcnt(2)
    buffer_store_dwordx4 v[156:159], v144, s[48:51], s41 offen sc1
    s_add_u32 s41, s10, 0x60000
    s_waitcnt lgkmcnt(0)
    buffer_store_dwordx4 v[160:163], v144, s[48:51], s41 offen sc1
    v_add_u32 v7, 0x1c000, v3
    ds_read_b128 v[64:67], v7 offset:0
    ds_read_b128 v[68:71], v7 offset:1024
    ds_read_b128 v[72:75], v7 offset:2048
    ds_read_b128 v[76:79], v7 offset:3072
    ds_read_b128 v[80:83], v7 offset:4096
    ds_read_b128 v[84:87], v7 offset:5120
    ds_read_b128 v[88:91], v7 offset:6144
    ds_read_b128 v[92:95], v7 offset:7168
    ds_read_b128 v[96:99], v7 offset:8192
    ds_read_b128 v[100:103], v7 offset:9216
    ds_read_b128 v[104:107], v7 offset:10240
    ds_read_b128 v[108:111], v7 offset:11264
    ds_read_b128 v[112:115], v7 offset:12288
    ds_read_b128 v[116:119], v7 offset:13312
    ds_read_b128 v[120:123], v7 offset:14336
    ds_read_b128 v[124:127], v7 offset:15360
    ds_read_b128 v[128:131], v7 offset:33792
    ds_read_b128 v[132:135], v7 offset:34816
    s_waitcnt lgkmcnt(12)
    v_mfma_f32_16x16x32_bf16 v[24:27], v[8:11], v[64:67], 0
    v_mfma_f32_16x16x32_bf16 v[28:31], v[8:11], v[68:71], 0
    v_mfma_f32_16x16x32_bf16 v[32:35], v[12:15], v[64:67], 0
    v_mfma_f32_16x16x32_bf16 v[36:39], v[12:15], v[68:71], 0
    v_mfma_f32_16x16x32_bf16 v[40:43], v[16:19], v[64:67], 0
    v_mfma_f32_16x16x32_bf16 v[44:47], v[16:19], v[68:71], 0
    v_mfma_f32_16x16x32_bf16 v[48:51], v[20:23], v[64:67], 0
    v_mfma_f32_16x16x32_bf16 v[52:55], v[20:23], v[68:71], 0
    s_nop 0
    v_pk_mul_f32 v[56:57], v[24:25], v[72:73]
    v_pk_mul_f32 v[58:59], v[26:27], v[74:75]
    v_pk_mul_f32 v[60:61], v[28:29], v[72:73]
    v_pk_mul_f32 v[62:63], v[30:31], v[74:75]
    v_pk_fma_f32 v[56:57], v[28:29], v[76:77], v[56:57]
    v_pk_fma_f32 v[58:59], v[30:31], v[78:79], v[58:59]
    v_pk_fma_f32 v[60:61], v[24:25], v[76:77], v[60:61] neg_lo:[1,0,0] neg_hi:[1,0,0]
    v_pk_fma_f32 v[62:63], v[26:27], v[78:79], v[62:63] neg_lo:[1,0,0] neg_hi:[1,0,0]
    v_cvt_pk_bf16_f32 v24, v56, v60
    v_cvt_pk_bf16_f32 v25, v57, v61
    v_cvt_pk_bf16_f32 v26, v58, v62
    v_cvt_pk_bf16_f32 v27, v59, v63
    v_and_b32 v8, v24, v136
    v_and_b32 v164, v24, v137
    v_and_b32 v180, v24, v138
    v_and_b32 v9, v25, v136
    v_and_b32 v165, v25, v137
    v_and_b32 v181, v25, v138
    v_and_b32 v10, v26, v136
    v_and_b32 v166, v26, v137
    v_and_b32 v182, v26, v138
    v_and_b32 v11, v27, v136
    v_and_b32 v167, v27, v137
    v_and_b32 v183, v27, v138
    v_pk_mul_f32 v[56:57], v[32:33], v[80:81]
    v_pk_mul_f32 v[58:59], v[34:35], v[82:83]
    v_pk_mul_f32 v[60:61], v[36:37], v[80:81]
    v_pk_mul_f32 v[62:63], v[38:39], v[82:83]
    v_pk_fma_f32 v[56:57], v[36:37], v[84:85], v[56:57]
    v_pk_fma_f32 v[58:59], v[38:39], v[86:87], v[58:59]
    v_pk_fma_f32 v[60:61], v[32:33], v[84:85], v[60:61] neg_lo:[1,0,0] neg_hi:[1,0,0]
    v_pk_fma_f32 v[62:63], v[34:35], v[86:87], v[62:63] neg_lo:[1,0,0] neg_hi:[1,0,0]
    v_cvt_pk_bf16_f32 v32, v56, v60
    v_cvt_pk_bf16_f32 v33, v57, v61
    v_cvt_pk_bf16_f32 v34, v58, v62
    v_cvt_pk_bf16_f32 v35, v59, v63
    v_and_b32 v12, v32, v136
    v_and_b32 v168, v32, v137
    v_and_b32 v184, v32, v138
    v_and_b32 v13, v33, v136
    v_and_b32 v169, v33, v137
    v_and_b32 v185, v33, v138
    v_and_b32 v14, v34, v136
    v_and_b32 v170, v34, v137
    v_and_b32 v186, v34, v138
    v_and_b32 v15, v35, v136
    v_and_b32 v171, v35, v137
    v_and_b32 v187, v35, v138
    v_pk_mul_f32 v[56:57], v[40:41], v[72:73]
    v_pk_mul_f32 v[58:59], v[42:43], v[74:75]
    v_pk_mul_f32 v[60:61], v[44:45], v[72:73]
    v_pk_mul_f32 v[62:63], v[46:47], v[74:75]
    v_pk_fma_f32 v[56:57], v[44:45], v[76:77], v[56:57]
    v_pk_fma_f32 v[58:59], v[46:47], v[78:79], v[58:59]
    v_pk_fma_f32 v[60:61], v[40:41], v[76:77], v[60:61] neg_lo:[1,0,0] neg_hi:[1,0,0]
    v_pk_fma_f32 v[62:63], v[42:43], v[78:79], v[62:63] neg_lo:[1,0,0] neg_hi:[1,0,0]
    v_cvt_pk_bf16_f32 v40, v56, v60
    v_cvt_pk_bf16_f32 v41, v57, v61
    v_cvt_pk_bf16_f32 v42, v58, v62
    v_cvt_pk_bf16_f32 v43, v59, v63
    v_and_b32 v16, v40, v136
    v_and_b32 v172, v40, v137
    v_and_b32 v188, v40, v138
    v_and_b32 v17, v41, v136
    v_and_b32 v173, v41, v137
    v_and_b32 v189, v41, v138
    v_and_b32 v18, v42, v136
    v_and_b32 v174, v42, v137
    v_and_b32 v190, v42, v138
    v_and_b32 v19, v43, v136
    v_and_b32 v175, v43, v137
    v_and_b32 v191, v43, v138
    v_pk_mul_f32 v[56:57], v[48:49], v[80:81]
    v_pk_mul_f32 v[58:59], v[50:51], v[82:83]
    v_pk_mul_f32 v[60:61], v[52:53], v[80:81]
    v_pk_mul_f32 v[62:63], v[54:55], v[82:83]
    v_pk_fma_f32 v[56:57], v[52:53], v[84:85], v[56:57]
    v_pk_fma_f32 v[58:59], v[54:55], v[86:87], v[58:59]
    v_pk_fma_f32 v[60:61], v[48:49], v[84:85], v[60:61] neg_lo:[1,0,0] neg_hi:[1,0,0]
    v_pk_fma_f32 v[62:63], v[50:51], v[86:87], v[62:63] neg_lo:[1,0,0] neg_hi:[1,0,0]
    v_cvt_pk_bf16_f32 v48, v56, v60
    v_cvt_pk_bf16_f32 v49, v57, v61
    v_cvt_pk_bf16_f32 v50, v58, v62
    v_cvt_pk_bf16_f32 v51, v59, v63
    v_and_b32 v20, v48, v136
    v_and_b32 v176, v48, v137
    v_and_b32 v192, v48, v138
    v_and_b32 v21, v49, v136
    v_and_b32 v177, v49, v137
    v_and_b32 v193, v49, v138
    v_and_b32 v22, v50, v136
    v_and_b32 v178, v50, v137
    v_and_b32 v194, v50, v138
    v_and_b32 v23, v51, v136
    v_and_b32 v179, v51, v137
    v_and_b32 v195, v51, v138
    s_waitcnt vmcnt(0)
    v_readfirstlane_b32 s70, v247
    s_barrier
    s_cmp_lg_u32 s70, 0
    s_cbranch_scc1 a_tok
    s_mov_b32 s68, 0x20000
a_tokl:
    buffer_load_dword v247, v245, s[32:35], 0 offen sc1
    s_waitcnt vmcnt(0)
    v_readfirstlane_b32 s70, v247
    s_sub_u32 s68, s68, 1
    s_cmp_eq_u32 s68, 0
    s_cbranch_scc1 a_tok
    s_cmp_eq_u32 s70, 0
    s_cbranch_scc1 a_tokl
a_tok:
    s_cmp_lg_u32 s3, 0
    s_cbranch_scc1 a_nof1
    s_lshl_b32 s41, s2, 7
    v_mov_b32 v246, s70
    s_mov_b64 exec, 1
    buffer_store_dword v246, v245, s[24:27], s41 offen sc1
    s_mov_b64 exec, -1
a_nof1:
    s_cmp_lt_u32 s2, 32
    s_cbranch_scc0 a_nfil
    s_add_u32 s52, s6, 0x0
    s_addc_u32 s53, s7, 0
    s_and_b32 s53, s53, 0xffff
    s_mov_b32 s54, 0x201000
    s_mov_b32 s55, 0x20000
    s_add_u32 s56, s8, 0x0
    s_addc_u32 s57, s9, 0
    s_and_b32 s57, s57, 0xffff
    s_mov_b32 s58, 0x201000
    s_mov_b32 s59, 0x20000
    s_mul_i32 s96, s2, 65664
    s_mul_i32 s97, s3, 16384
    s_add_u32 s99, s96, s97
    s_add_u32 m0, s97, 0x0
    s_add_u32 s98, s99, 0
    buffer_load_dwordx4 v3, s[52:55], s98 offen lds
    buffer_load_dwordx4 v3, s[52:55], s98 offen offset:1024 lds
    buffer_load_dwordx4 v3, s[52:55], s98 offen offset:2048 lds
    buffer_load_dwordx4 v3, s[52:55], s98 offen offset:3072 lds
    s_add_u32 m0, s97, 0x1000
    s_add_u32 s98, s99, 4096
    buffer_load_dwordx4 v3, s[52:55], s98 offen lds
    buffer_load_dwordx4 v3, s[52:55], s98 offen offset:1024 lds
    buffer_load_dwordx4 v3, s[52:55], s98 offen offset:2048 lds
    buffer_load_dwordx4 v3, s[52:55], s98 offen offset:3072 lds
    s_add_u32 m0, s97, 0x2000
    s_add_u32 s98, s99, 8192
    buffer_load_dwordx4 v3, s[52:55], s98 offen lds
    buffer_load_dwordx4 v3, s[52:55], s98 offen offset:1024 lds
    buffer_load_dwordx4 v3, s[52:55], s98 offen offset:2048 lds
    buffer_load_dwordx4 v3, s[52:55], s98 offen offset:3072 lds
    s_add_u32 m0, s97, 0x3000
    s_add_u32 s98, s99, 12288
    buffer_load_dwordx4 v3, s[52:55], s98 offen lds
    buffer_load_dwordx4 v3, s[52:55], s98 offen offset:1024 lds
    buffer_load_dwordx4 v3, s[52:55], s98 offen offset:2048 lds
    buffer_load_dwordx4 v3, s[52:55], s98 offen offset:3072 lds
    s_mul_i32 s97, s3, 7168
    s_add_u32 s99, s96, s97
    s_add_u32 m0, s97, 0x10400
    s_add_u32 s98, s99, 0
    buffer_load_dwordx4 v3, s[56:59], s98 offen lds
    buffer_load_dwordx4 v3, s[56:59], s98 offen offset:1024 lds
    buffer_load_dwordx4 v3, s[56:59], s98 offen offset:2048 lds
    buffer_load_dwordx4 v3, s[56:59], s98 offen offset:3072 lds
    s_add_u32 m0, s97, 0x11400
    s_add_u32 s98, s99, 4096
    buffer_load_dwordx4 v3, s[56:59], s98 offen lds
    buffer_load_dwordx4 v3, s[56:59], s98 offen offset:1024 lds
    buffer_load_dwordx4 v3, s[56:59], s98 offen offset:2048 lds
a_nfil:
    s_waitcnt lgkmcnt(0)
    v_mfma_f32_16x16x32_bf16 v[24:27], v[88:91], v[8:11], 0
    v_mfma_f32_16x16x32_bf16 v[28:31], v[96:99], v[8:11], 0
    v_mfma_f32_16x16x32_bf16 v[32:35], v[104:107], v[8:11], 0
    v_mfma_f32_16x16x32_bf16 v[36:39], v[112:115], v[8:11], 0
    v_mfma_f32_16x16x32_bf16 v[24:27], v[92:95], v[12:15], v[24:27]
    v_mfma_f32_16x16x32_bf16 v[28:31], v[100:103], v[12:15], v[28:31]
    v_mfma_f32_16x16x32_bf16 v[32:35], v[108:111], v[12:15], v[32:35]
    v_mfma_f32_16x16x32_bf16 v[36:39], v[116:119], v[12:15], v[36:39]
    v_mfma_f32_16x16x32_bf16 v[24:27], v[120:123], v[164:167], v[24:27]
    v_mfma_f32_16x16x32_bf16 v[28:31], v[128:131], v[164:167], v[28:31]
    v_mov_b32 v4, v244
    v_lshlrev_b32 v243, 7, v1
    v_mfma_f32_16x16x32_bf16 v[32:35], v[120:123], v[180:183], v[32:35]
    s_lshl_b32 s40, s47, 13
    v_mfma_f32_16x16x32_bf16 v[36:39], v[128:131], v[180:183], v[36:39]
    v_add_u32 v5, s40, v3
    v_mfma_f32_16x16x32_bf16 v[24:27], v[124:127], v[168:171], v[24:27]
    v_add_u32 v6, 0x10000, v5
    v_bfe_u32 v7, v1, 4, 1
    v_mfma_f32_16x16x32_bf16 v[28:31], v[132:135], v[168:171], v[28:31]
    v_lshlrev_b32 v140, 12, v7
    v_mfma_f32_16x16x32_bf16 v[32:35], v[124:127], v[184:187], v[32:35]
    v_bfe_u32 v7, v1, 5, 1
    v_mfma_f32_16x16x32_bf16 v[36:39], v[132:135], v[184:187], v[36:39]
    v_lshl_add_u32 v140, v7, 10, v140
    v_mfma_f32_16x16x32_bf16 v[40:43], v[88:91], v[16:19], 0
    v_bfe_u32 v7, v1, 2, 2
    v_lshl_add_u32 v140, v7, 8, v140
    v_mfma_f32_16x16x32_bf16 v[44:47], v[96:99], v[16:19], 0
    v_and_b32 v7, 3, v1
    v_mfma_f32_16x16x32_bf16 v[48:51], v[104:107], v[16:19], 0
    v_lshl_add_u32 v140, v7, 3, v140
    v_mfma_f32_16x16x32_bf16 v[52:55], v[112:115], v[16:19], 0
    v_add_u32 v140, 0x4000, v140
    v_mfma_f32_16x16x32_bf16 v[40:43], v[92:95], v[20:23], v[40:43]
    v_bfe_u32 v7, v1, 2, 3
    s_lshl_b32 s40, s46, 2
    v_mfma_f32_16x16x32_bf16 v[44:47], v[100:103], v[20:23], v[44:47]
    v_xor_b32 v7, s40, v7
    v_mfma_f32_16x16x32_bf16 v[48:51], v[108:111], v[20:23], v[48:51]
    v_xor_b32 v141, 0, v7
    v_mfma_f32_16x16x32_bf16 v[52:55], v[116:119], v[20:23], v[52:55]
    v_lshl_add_u32 v8, v141, 5, v140
    v_mfma_f32_16x16x32_bf16 v[40:43], v[120:123], v[172:175], v[40:43]
    v_add_u32 v12, 0x10000, v8
    v_xor_b32 v141, 1, v7
    v_mfma_f32_16x16x32_bf16 v[44:47], v[128:131], v[172:175], v[44:47]
    v_lshl_add_u32 v9, v141, 5, v140
    v_mfma_f32_16x16x32_bf16 v[48:51], v[120:123], v[188:191], v[48:51]
    v_add_u32 v13, 0x10000, v9
    v_mfma_f32_16x16x32_bf16 v[52:55], v[128:131], v[188:191], v[52:55]
    v_xor_b32 v141, 2, v7
    v_mfma_f32_16x16x32_bf16 v[40:43], v[124:127], v[176:179], v[40:43]
    v_lshl_add_u32 v10, v141, 5, v140
    v_add_u32 v14, 0x10000, v10
    v_mfma_f32_16x16x32_bf16 v[44:47], v[132:135], v[176:179], v[44:47]
    v_xor_b32 v141, 3, v7
    v_mfma_f32_16x16x32_bf16 v[48:51], v[124:127], v[192:195], v[48:51]
    v_lshl_add_u32 v11, v141, 5, v140
    v_mfma_f32_16x16x32_bf16 v[52:55], v[132:135], v[192:195], v[52:55]
    v_add_u32 v15, 0x10000, v11
    s_lshl_b32 s10, s36, 12
    s_lshl_b32 s41, s38, 8
    s_add_u32 s10, s10, s41
    s_lshl_b32 s41, s37, 7
    s_add_u32 s10, s10, s41
    s_cmp_lt_u32 s3, 2
    s_cselect_b32 s36, s12, s14
    s_cselect_b32 s37, s13, s15
    s_and_b32 s37, s37, 0xffff
    s_mov_b32 s38, 7340032
    s_mov_b32 s39, 0x20000
    s_cmp_lt_u32 s2, 32
    s_cselect_b32 s38, 0, s38
    s_mul_i32 s69, s42, 114688
    s_lshl_b32 s41, s43, 8
    s_add_u32 s69, s69, s41
    s_lshl_b32 s41, s46, 7
    s_add_u32 s69, s69, s41
    s_add_u32 s69, s69, 917504
    v_mul_u32_u24 v17, 7168, v1
    v_lshrrev_b32 v16, 4, v1
    v_lshl_add_u32 v17, v16, 24, v17
    s_add_u32 s32, s22, 0x400000
    s_addc_u32 s33, s23, 0
    s_and_b32 s33, s33, 0xffff
    s_mov_b32 s34, 0x400000
    s_mov_b32 s35, 0x20000
    s_nop 4
    v_cvt_pk_bf16_f32 v64, v24, v28
    v_cvt_pk_bf16_f32 v66, v25, v29
    v_cvt_pk_bf16_f32 v68, v26, v30
    v_cvt_pk_bf16_f32 v70, v27, v31
    v_cvt_pk_bf16_f32 v72, v32, v36
    v_cvt_pk_bf16_f32 v74, v33, v37
    v_cvt_pk_bf16_f32 v76, v34, v38
    v_cvt_pk_bf16_f32 v78, v35, v39
    v_cvt_pk_bf16_f32 v65, v40, v44
    v_cvt_pk_bf16_f32 v67, v41, v45
    v_cvt_pk_bf16_f32 v69, v42, v46
    v_cvt_pk_bf16_f32 v71, v43, v47
    v_cvt_pk_bf16_f32 v73, v48, v52
    v_cvt_pk_bf16_f32 v75, v49, v53
    v_cvt_pk_bf16_f32 v77, v50, v54
    v_cvt_pk_bf16_f32 v79, v51, v55
    ds_write_b64 v139, v[64:65] offset:0
    ds_write_b64 v197, v[66:67] offset:0
    ds_write_b64 v198, v[68:69] offset:0
    ds_write_b64 v199, v[70:71] offset:0
    ds_write_b64 v139, v[72:73] offset:8192
    ds_write_b64 v197, v[74:75] offset:8192
    ds_write_b64 v198, v[76:77] offset:8192
    ds_write_b64 v199, v[78:79] offset:8192
    s_lshl_b32 s63, s2, 7
    s_add_u32 s63, s63, 32768
    v_mov_b32 v18, v145
    v_mov_b32 v28, v243
    v_mov_b32 v29, 0
    s_waitcnt lgkmcnt(0)
    s_barrier
    ds_read_b128 a[160:163], v146 offset:0
    ds_read_b128 a[164:167], v146 offset:4096
    ds_read_b128 a[168:171], v146 offset:8192
    ds_read_b128 a[172:175], v146 offset:12288
    s_cmp_lt_u32 s2, 32
    s_cbranch_scc1 a_nox
    s_lshl_b32 s44, s42, 12
    s_mov_b32 s68, 0x20000
pl_f1:
    s_bfm_b64 exec, 32, 0
    buffer_load_dword v246, v243, s[24:27], s44 offen sc1
    s_mov_b64 exec, -1
    s_waitcnt vmcnt(0)
    v_cmp_ne_u32 vcc, s70, v246
    s_nop 1
    s_bfm_b64 s[66:67], 32, 0
    s_and_b64 vcc, vcc, s[66:67]
    s_nop 3
    s_cbranch_vccz pd_f1
    s_sleep 2
    s_sub_u32 s68, s68, 1
    s_cmp_lg_u32 s68, 0
    s_cbranch_scc1 pl_f1
pd_f1:
    s_add_u32 m0, s64, 0x0
    s_nop 0
    buffer_load_dwordx4 v3, s[48:51], s60 offen sc1 lds
    buffer_load_dwordx4 v3, s[48:51], s60 offen offset:1024 sc1 lds
    buffer_load_dwordx4 v3, s[48:51], s60 offen offset:2048 sc1 lds
    buffer_load_dwordx4 v3, s[48:51], s60 offen offset:3072 sc1 lds
    s_add_u32 s60, s60, 0x4000
    s_add_u32 m0, s64, 0x8000
    s_nop 0
    buffer_load_dwordx4 v3, s[48:51], s60 offen sc1 lds
    buffer_load_dwordx4 v3, s[48:51], s60 offen offset:1024 sc1 lds
    buffer_load_dwordx4 v3, s[48:51], s60 offen offset:2048 sc1 lds
    buffer_load_dwordx4 v3, s[48:51], s60 offen offset:3072 sc1 lds
    s_add_u32 s60, s60, 0x4000
    s_add_u32 m0, s64, 0x10000
    s_nop 0
    buffer_load_dwordx4 v3, s[48:51], s60 offen sc1 lds
    buffer_load_dwordx4 v3, s[48:51], s60 offen offset:1024 sc1 lds
    buffer_load_dwordx4 v3, s[48:51], s60 offen offset:2048 sc1 lds
    buffer_load_dwordx4 v3, s[48:51], s60 offen offset:3072 sc1 lds
    s_add_u32 s60, s60, 0x4000
    buffer_load_dword v16, v17, s[36:39], s69 offen
    s_add_u32 s69, s69, 917504
    buffer_load_dword v16, v17, s[36:39], s69 offen
    s_add_u32 s69, s69, 917504
    s_waitcnt vmcnt(10)
    s_barrier
a_nox:
    s_cmp_lt_u32 s2, 32
    s_cbranch_scc1 k_fft
    ds_read_b128 a[32:35], v5 offset:0
    ds_read_b64_tr_b16 a[0:1], v8 offset:0
    ds_read_b64_tr_b16 a[2:3], v8 offset:8192
    ds_read_b128 a[36:39], v5 offset:1024
    ds_read_b64_tr_b16 a[4:5], v9 offset:0
    ds_read_b64_tr_b16 a[6:7], v9 offset:8192
    ds_read_b128 a[40:43], v5 offset:2048
    ds_read_b64_tr_b16 a[8:9], v10 offset:0
    ds_read_b64_tr_b16 a[10:11], v10 offset:8192
    ds_read_b128 a[44:47], v5 offset:3072
    ds_read_b64_tr_b16 a[12:13], v11 offset:0
    ds_read_b64_tr_b16 a[14:15], v11 offset:8192
    ds_read_b128 a[48:51], v5 offset:4096
    ds_read_b64_tr_b16 a[16:17], v8 offset:2048
    ds_read_b64_tr_b16 a[18:19], v8 offset:10240
    ds_read_b128 a[52:55], v5 offset:5120
    ds_read_b64_tr_b16 a[20:21], v9 offset:2048
    ds_read_b64_tr_b16 a[22:23], v9 offset:10240
    ds_read_b128 a[56:59], v5 offset:6144
    ds_read_b64_tr_b16 a[24:25], v10 offset:2048
    ds_read_b64_tr_b16 a[26:27], v10 offset:10240
    ds_read_b128 a[60:63], v5 offset:7168
    ds_read_b64_tr_b16 a[28:29], v11 offset:2048
    ds_read_b64_tr_b16 a[30:31], v11 offset:10240
    s_waitcnt lgkmcnt(0)
    v_mfma_f32_16x16x32_bf16 v[32:35], a[0:3], a[32:35], 0
    v_mfma_f32_16x16x32_bf16 v[36:39], a[4:7], a[32:35], 0
    v_mfma_f32_16x16x32_bf16 v[40:43], a[8:11], a[32:35], 0
    v_mfma_f32_16x16x32_bf16 v[44:47], a[12:15], a[32:35], 0
    v_mfma_f32_16x16x32_bf16 v[48:51], a[16:19], a[32:35], 0
    v_mfma_f32_16x16x32_bf16 v[52:55], a[20:23], a[32:35], 0
    v_mfma_f32_16x16x32_bf16 v[56:59], a[24:27], a[32:35], 0
    v_mfma_f32_16x16x32_bf16 v[60:63], a[28:31], a[32:35], 0
    s_waitcnt vmcnt(6)
    s_barrier
    v_mfma_f32_16x16x32_bf16 v[64:67], a[0:3], a[36:39], 0
    ds_read_b128 a[96:99], v5 offset:32768
    v_mfma_f32_16x16x32_bf16 v[68:71], a[4:7], a[36:39], 0
    s_add_u32 m0, s64, 0x18000
    v_mfma_f32_16x16x32_bf16 v[72:75], a[8:11], a[36:39], 0
    ds_read_b64_tr_b16 a[64:65], v8 offset:32768
    v_mfma_f32_16x16x32_bf16 v[76:79], a[12:15], a[36:39], 0
    buffer_load_dwordx4 v3, s[48:51], s60 offen sc1 lds
    v_mfma_f32_16x16x32_bf16 v[80:83], a[16:19], a[36:39], 0
    ds_read_b64_tr_b16 a[66:67], v8 offset:40960
    v_mfma_f32_16x16x32_bf16 v[84:87], a[20:23], a[36:39], 0
    v_mfma_f32_16x16x32_bf16 v[88:91], a[24:27], a[36:39], 0
    ds_read_b128 a[100:103], v5 offset:33792
    v_mfma_f32_16x16x32_bf16 v[92:95], a[28:31], a[36:39], 0
    buffer_load_dwordx4 v3, s[48:51], s60 offen offset:1024 sc1 lds
    v_mfma_f32_16x16x32_bf16 v[96:99], a[0:3], a[40:43], 0
    ds_read_b64_tr_b16 a[68:69], v9 offset:32768
    v_mfma_f32_16x16x32_bf16 v[100:103], a[4:7], a[40:43], 0
    v_mfma_f32_16x16x32_bf16 v[104:107], a[8:11], a[40:43], 0
    ds_read_b64_tr_b16 a[70:71], v9 offset:40960
    v_mfma_f32_16x16x32_bf16 v[108:111], a[12:15], a[40:43], 0
    buffer_load_dwordx4 v3, s[48:51], s60 offen offset:2048 sc1 lds
    v_mfma_f32_16x16x32_bf16 v[112:115], a[16:19], a[40:43], 0
    ds_read_b128 a[104:107], v5 offset:34816
    v_mfma_f32_16x16x32_bf16 v[116:119], a[20:23], a[40:43], 0
    v_mfma_f32_16x16x32_bf16 v[120:123], a[24:27], a[40:43], 0
    ds_read_b64_tr_b16 a[72:73], v10 offset:32768
    v_mfma_f32_16x16x32_bf16 v[124:127], a[28:31], a[40:43], 0
    v_mfma_f32_16x16x32_bf16 v[128:131], a[0:3], a[44:47], 0
    ds_read_b64_tr_b16 a[74:75], v10 offset:40960
    v_mfma_f32_16x16x32_bf16 v[132:135], a[4:7], a[44:47], 0
    buffer_load_dwordx4 v3, s[48:51], s60 offen offset:3072 sc1 lds
    v_mfma_f32_16x16x32_bf16 v[136:139], a[8:11], a[44:47], 0
    ds_read_b128 a[108:111], v5 offset:35840
    v_mfma_f32_16x16x32_bf16 v[140:143], a[12:15], a[44:47], 0
    s_add_u32 s60, s60, 0x4000
    v_mfma_f32_16x16x32_bf16 v[144:147], a[16:19], a[44:47], 0
    ds_read_b64_tr_b16 a[76:77], v11 offset:32768
    v_mfma_f32_16x16x32_bf16 v[148:151], a[20:23], a[44:47], 0
    s_add_u32 m0, s65, 0x18000
    v_mfma_f32_16x16x32_bf16 v[152:155], a[24:27], a[44:47], 0
    ds_read_b64_tr_b16 a[78:79], v11 offset:40960
    v_mfma_f32_16x16x32_bf16 v[156:159], a[28:31], a[44:47], 0
    buffer_load_dwordx4 v4, s[52:55], s61 offen lds
    v_mfma_f32_16x16x32_bf16 v[160:163], a[0:3], a[48:51], 0
    ds_read_b128 a[112:115], v5 offset:36864
    v_mfma_f32_16x16x32_bf16 v[164:167], a[4:7], a[48:51], 0
    buffer_load_dwordx4 v4, s[52:55], s62 offen offset:1024 lds
    v_mfma_f32_16x16x32_bf16 v[168:171], a[8:11], a[48:51], 0
    ds_read_b64_tr_b16 a[80:81], v8 offset:34816
    v_mfma_f32_16x16x32_bf16 v[172:175], a[12:15], a[48:51], 0
    v_mfma_f32_16x16x32_bf16 v[176:179], a[16:19], a[48:51], 0
    ds_read_b64_tr_b16 a[82:83], v8 offset:43008
    v_mfma_f32_16x16x32_bf16 v[180:183], a[20:23], a[48:51], 0
    buffer_load_dwordx4 v4, s[56:59], s61 offen offset:2048 lds
    v_mfma_f32_16x16x32_bf16 v[184:187], a[24:27], a[48:51], 0
    ds_read_b128 a[116:119], v5 offset:37888
    v_mfma_f32_16x16x32_bf16 v[188:191], a[28:31], a[48:51], 0
    s_add_u32 s61, s61, 229376
    v_mfma_f32_16x16x32_bf16 v[192:195], a[0:3], a[52:55], 0
    ds_read_b64_tr_b16 a[84:85], v9 offset:34816
    v_mfma_f32_16x16x32_bf16 v[196:199], a[4:7], a[52:55], 0
    buffer_load_dwordx4 v4, s[56:59], s62 offen offset:3072 lds
    v_mfma_f32_16x16x32_bf16 v[200:203], a[8:11], a[52:55], 0
    ds_read_b64_tr_b16 a[86:87], v9 offset:43008
    v_mfma_f32_16x16x32_bf16 v[204:207], a[12:15], a[52:55], 0
    s_add_u32 s62, s62, 229376
    v_mfma_f32_16x16x32_bf16 v[208:211], a[16:19], a[52:55], 0
    ds_read_b128 a[120:123], v5 offset:38912
    v_mfma_f32_16x16x32_bf16 v[212:215], a[20:23], a[52:55], 0
    buffer_store_dwordx4 a[160:163], v18, s[32:35], s10 offen sc1
    v_mfma_f32_16x16x32_bf16 v[216:219], a[24:27], a[52:55], 0
    ds_read_b64_tr_b16 a[88:89], v10 offset:34816
    v_mfma_f32_16x16x32_bf16 v[220:223], a[28:31], a[52:55], 0
    s_add_u32 s10, s10, 0x100000
    v_mfma_f32_16x16x32_bf16 v[224:227], a[0:3], a[56:59], 0
    ds_read_b64_tr_b16 a[90:91], v10 offset:43008
    v_mfma_f32_16x16x32_bf16 v[228:231], a[4:7], a[56:59], 0
    v_mfma_f32_16x16x32_bf16 v[232:235], a[8:11], a[56:59], 0
    ds_read_b128 a[124:127], v5 offset:39936
    v_mfma_f32_16x16x32_bf16 v[236:239], a[12:15], a[56:59], 0
    buffer_store_dwordx4 a[164:167], v18, s[32:35], s10 offen sc1
    v_mfma_f32_16x16x32_bf16 v[240:243], a[16:19], a[56:59], 0
    ds_read_b64_tr_b16 a[92:93], v11 offset:34816
    v_mfma_f32_16x16x32_bf16 v[244:247], a[20:23], a[56:59], 0
    s_add_u32 s10, s10, 0x100000
    v_mfma_f32_16x16x32_bf16 v[248:251], a[24:27], a[56:59], 0
    ds_read_b64_tr_b16 a[94:95], v11 offset:43008
    v_mfma_f32_16x16x32_bf16 v[252:255], a[28:31], a[56:59], 0
    buffer_store_dwordx4 a[168:171], v18, s[32:35], s10 offen sc1
    v_mfma_f32_16x16x32_bf16 a[128:131], a[0:3], a[60:63], 0
    s_add_u32 s10, s10, 0x100000
    v_mfma_f32_16x16x32_bf16 a[132:135], a[4:7], a[60:63], 0
    v_mfma_f32_16x16x32_bf16 a[136:139], a[8:11], a[60:63], 0
    buffer_store_dwordx4 a[172:175], v18, s[32:35], s10 offen sc1
    v_mfma_f32_16x16x32_bf16 a[140:143], a[12:15], a[60:63], 0
    s_add_u32 s10, s10, 0x100000
    v_mfma_f32_16x16x32_bf16 a[144:147], a[16:19], a[60:63], 0
    v_mfma_f32_16x16x32_bf16 a[148:151], a[20:23], a[60:63], 0
    v_mfma_f32_16x16x32_bf16 a[152:155], a[24:27], a[60:63], 0
    v_mfma_f32_16x16x32_bf16 a[156:159], a[28:31], a[60:63], 0
    s_waitcnt vmcnt(14) lgkmcnt(0)
    s_barrier
    v_mfma_f32_16x16x32_bf16 v[32:35], a[64:67], a[96:99], v[32:35]
    ds_read_b128 a[32:35], v6 offset:0
    v_mfma_f32_16x16x32_bf16 v[36:39], a[68:71], a[96:99], v[36:39]
    s_add_u32 m0, s64, 0x0
    v_mfma_f32_16x16x32_bf16 v[40:43], a[72:75], a[96:99], v[40:43]
    ds_read_b64_tr_b16 a[0:1], v12 offset:0
    v_mfma_f32_16x16x32_bf16 v[44:47], a[76:79], a[96:99], v[44:47]
    buffer_load_dwordx4 v3, s[48:51], s60 offen sc1 lds
    v_mfma_f32_16x16x32_bf16 v[48:51], a[80:83], a[96:99], v[48:51]
    ds_read_b64_tr_b16 a[2:3], v12 offset:8192
    v_mfma_f32_16x16x32_bf16 v[52:55], a[84:87], a[96:99], v[52:55]
    v_mfma_f32_16x16x32_bf16 v[56:59], a[88:91], a[96:99], v[56:59]
    ds_read_b128 a[36:39], v6 offset:1024
    v_mfma_f32_16x16x32_bf16 v[60:63], a[92:95], a[96:99], v[60:63]
    buffer_load_dwordx4 v3, s[48:51], s60 offen offset:1024 sc1 lds
    v_mfma_f32_16x16x32_bf16 v[64:67], a[64:67], a[100:103], v[64:67]
    ds_read_b64_tr_b16 a[4:5], v13 offset:0
    v_mfma_f32_16x16x32_bf16 v[68:71], a[68:71], a[100:103], v[68:71]
    buffer_load_dwordx4 v3, s[48:51], s60 offen offset:2048 sc1 lds
    v_mfma_f32_16x16x32_bf16 v[72:75], a[72:75], a[100:103], v[72:75]
    ds_read_b64_tr_b16 a[6:7], v13 offset:8192
    v_mfma_f32_16x16x32_bf16 v[76:79], a[76:79], a[100:103], v[76:79]
    v_mfma_f32_16x16x32_bf16 v[80:83], a[80:83], a[100:103], v[80:83]
    ds_read_b128 a[40:43], v6 offset:2048
    v_mfma_f32_16x16x32_bf16 v[84:87], a[84:87], a[100:103], v[84:87]
    buffer_load_dwordx4 v3, s[48:51], s60 offen offset:3072 sc1 lds
    v_mfma_f32_16x16x32_bf16 v[88:91], a[88:91], a[100:103], v[88:91]
    ds_read_b64_tr_b16 a[8:9], v14 offset:0
    v_mfma_f32_16x16x32_bf16 v[92:95], a[92:95], a[100:103], v[92:95]
    s_add_u32 s60, s60, 0x4000
    v_mfma_f32_16x16x32_bf16 v[96:99], a[64:67], a[104:107], v[96:99]
    ds_read_b64_tr_b16 a[10:11], v14 offset:8192
    v_mfma_f32_16x16x32_bf16 v[100:103], a[68:71], a[104:107], v[100:103]
    v_mfma_f32_16x16x32_bf16 v[104:107], a[72:75], a[104:107], v[104:107]
    ds_read_b128 a[44:47], v6 offset:3072
    v_mfma_f32_16x16x32_bf16 v[108:111], a[76:79], a[104:107], v[108:111]
    s_add_u32 m0, s65, 0x0
    v_mfma_f32_16x16x32_bf16 v[112:115], a[80:83], a[104:107], v[112:115]
    ds_read_b64_tr_b16 a[12:13], v15 offset:0
    v_mfma_f32_16x16x32_bf16 v[116:119], a[84:87], a[104:107], v[116:119]
    buffer_load_dwordx4 v4, s[52:55], s61 offen lds
    v_mfma_f32_16x16x32_bf16 v[120:123], a[88:91], a[104:107], v[120:123]
    ds_read_b64_tr_b16 a[14:15], v15 offset:8192
    v_mfma_f32_16x16x32_bf16 v[124:127], a[92:95], a[104:107], v[124:127]
    v_mfma_f32_16x16x32_bf16 v[128:131], a[64:67], a[108:111], v[128:131]
    ds_read_b128 a[48:51], v6 offset:4096
    v_mfma_f32_16x16x32_bf16 v[132:135], a[68:71], a[108:111], v[132:135]
    buffer_load_dwordx4 v4, s[52:55], s62 offen offset:1024 lds
    v_mfma_f32_16x16x32_bf16 v[136:139], a[72:75], a[108:111], v[136:139]
    ds_read_b64_tr_b16 a[16:17], v12 offset:2048
    v_mfma_f32_16x16x32_bf16 v[140:143], a[76:79], a[108:111], v[140:143]
    buffer_load_dwordx4 v4, s[56:59], s61 offen offset:2048 lds
    v_mfma_f32_16x16x32_bf16 v[144:147], a[80:83], a[108:111], v[144:147]
    ds_read_b64_tr_b16 a[18:19], v12 offset:10240
    v_mfma_f32_16x16x32_bf16 v[148:151], a[84:87], a[108:111], v[148:151]
    v_mfma_f32_16x16x32_bf16 v[152:155], a[88:91], a[108:111], v[152:155]
    ds_read_b128 a[52:55], v6 offset:5120
    v_mfma_f32_16x16x32_bf16 v[156:159], a[92:95], a[108:111], v[156:159]
    s_add_u32 s61, s61, 229376
    v_mfma_f32_16x16x32_bf16 v[160:163], a[64:67], a[112:115], v[160:163]
    ds_read_b64_tr_b16 a[20:21], v13 offset:2048
    v_mfma_f32_16x16x32_bf16 v[164:167], a[68:71], a[112:115], v[164:167]
    buffer_load_dwordx4 v4, s[56:59], s62 offen offset:3072 lds
    v_mfma_f32_16x16x32_bf16 v[168:171], a[72:75], a[112:115], v[168:171]
    ds_read_b64_tr_b16 a[22:23], v13 offset:10240
    v_mfma_f32_16x16x32_bf16 v[172:175], a[76:79], a[112:115], v[172:175]
    v_mfma_f32_16x16x32_bf16 v[176:179], a[80:83], a[112:115], v[176:179]
    ds_read_b128 a[56:59], v6 offset:6144
    v_mfma_f32_16x16x32_bf16 v[180:183], a[84:87], a[112:115], v[180:183]
    s_add_u32 s62, s62, 229376
    v_mfma_f32_16x16x32_bf16 v[184:187], a[88:91], a[112:115], v[184:187]
    ds_read_b64_tr_b16 a[24:25], v14 offset:2048
    v_mfma_f32_16x16x32_bf16 v[188:191], a[92:95], a[112:115], v[188:191]
    v_mfma_f32_16x16x32_bf16 v[192:195], a[64:67], a[116:119], v[192:195]
    ds_read_b64_tr_b16 a[26:27], v14 offset:10240
    v_mfma_f32_16x16x32_bf16 v[196:199], a[68:71], a[116:119], v[196:199]
    s_add_u32 m0, s64, 0x8000
    v_mfma_f32_16x16x32_bf16 v[200:203], a[72:75], a[116:119], v[200:203]
    ds_read_b128 a[60:63], v6 offset:7168
    v_mfma_f32_16x16x32_bf16 v[204:207], a[76:79], a[116:119], v[204:207]
    buffer_load_dwordx4 v3, s[48:51], s60 offen sc1 lds
    v_mfma_f32_16x16x32_bf16 v[208:211], a[80:83], a[116:119], v[208:211]
    ds_read_b64_tr_b16 a[28:29], v15 offset:2048
    v_mfma_f32_16x16x32_bf16 v[212:215], a[84:87], a[116:119], v[212:215]
    v_mfma_f32_16x16x32_bf16 v[216:219], a[88:91], a[116:119], v[216:219]
    ds_read_b64_tr_b16 a[30:31], v15 offset:10240
    v_mfma_f32_16x16x32_bf16 v[220:223], a[92:95], a[116:119], v[220:223]
    buffer_load_dwordx4 v3, s[48:51], s60 offen offset:1024 sc1 lds
    v_mfma_f32_16x16x32_bf16 v[224:227], a[64:67], a[120:123], v[224:227]
    buffer_load_dwordx4 v3, s[48:51], s60 offen offset:2048 sc1 lds
    v_mfma_f32_16x16x32_bf16 v[228:231], a[68:71], a[120:123], v[228:231]
    v_mfma_f32_16x16x32_bf16 v[232:235], a[72:75], a[120:123], v[232:235]
    buffer_load_dwordx4 v3, s[48:51], s60 offen offset:3072 sc1 lds
    v_mfma_f32_16x16x32_bf16 v[236:239], a[76:79], a[120:123], v[236:239]
    s_add_u32 s60, s60, 0x4000
    v_mfma_f32_16x16x32_bf16 v[240:243], a[80:83], a[120:123], v[240:243]
    v_mfma_f32_16x16x32_bf16 v[244:247], a[84:87], a[120:123], v[244:247]
    s_add_u32 m0, s65, 0x8000
    v_mfma_f32_16x16x32_bf16 v[248:251], a[88:91], a[120:123], v[248:251]
    buffer_load_dwordx4 v4, s[52:55], s61 offen lds
    v_mfma_f32_16x16x32_bf16 v[252:255], a[92:95], a[120:123], v[252:255]
    v_mfma_f32_16x16x32_bf16 a[128:131], a[64:67], a[124:127], a[128:131]
    buffer_load_dwordx4 v4, s[52:55], s62 offen offset:1024 lds
    v_mfma_f32_16x16x32_bf16 a[132:135], a[68:71], a[124:127], a[132:135]
    buffer_load_dwordx4 v4, s[56:59], s61 offen offset:2048 lds
    v_mfma_f32_16x16x32_bf16 a[136:139], a[72:75], a[124:127], a[136:139]
    v_mfma_f32_16x16x32_bf16 a[140:143], a[76:79], a[124:127], a[140:143]
    s_add_u32 s61, s61, 229376
    v_mfma_f32_16x16x32_bf16 a[144:147], a[80:83], a[124:127], a[144:147]
    buffer_load_dwordx4 v4, s[56:59], s62 offen offset:3072 lds
    v_mfma_f32_16x16x32_bf16 a[148:151], a[84:87], a[124:127], a[148:151]
    v_mfma_f32_16x16x32_bf16 a[152:155], a[88:91], a[124:127], a[152:155]
    s_add_u32 s62, s62, 229376
    v_mfma_f32_16x16x32_bf16 a[156:159], a[92:95], a[124:127], a[156:159]
    s_waitcnt vmcnt(16) lgkmcnt(0)
    s_barrier
    s_cmp_lg_u32 s3, 0
    s_cbranch_scc1 sf_f2y
    v_mov_b32 v30, s70
    s_mov_b64 exec, 1
    buffer_store_dword v30, v29, s[24:27], s63 offen sc1
    s_mov_b64 exec, -1
sf_f2y:
    v_mfma_f32_16x16x32_bf16 v[32:35], a[0:3], a[32:35], v[32:35]
    ds_read_b128 a[96:99], v6 offset:32768
    v_mfma_f32_16x16x32_bf16 v[36:39], a[4:7], a[32:35], v[36:39]
    s_add_u32 m0, s64, 0x10000
    v_mfma_f32_16x16x32_bf16 v[40:43], a[8:11], a[32:35], v[40:43]
    ds_read_b64_tr_b16 a[64:65], v12 offset:32768
    v_mfma_f32_16x16x32_bf16 v[44:47], a[12:15], a[32:35], v[44:47]
    buffer_load_dwordx4 v3, s[48:51], s60 offen sc1 lds
    v_mfma_f32_16x16x32_bf16 v[48:51], a[16:19], a[32:35], v[48:51]
    ds_read_b64_tr_b16 a[66:67], v12 offset:40960
    v_mfma_f32_16x16x32_bf16 v[52:55], a[20:23], a[32:35], v[52:55]
    v_mfma_f32_16x16x32_bf16 v[56:59], a[24:27], a[32:35], v[56:59]
    ds_read_b128 a[100:103], v6 offset:33792
    v_mfma_f32_16x16x32_bf16 v[60:63], a[28:31], a[32:35], v[60:63]
    v_mfma_f32_16x16x32_bf16 v[64:67], a[0:3], a[36:39], v[64:67]
    ds_read_b64_tr_b16 a[68:69], v13 offset:32768
    v_mfma_f32_16x16x32_bf16 v[68:71], a[4:7], a[36:39], v[68:71]
    v_mfma_f32_16x16x32_bf16 v[72:75], a[8:11], a[36:39], v[72:75]
    ds_read_b64_tr_b16 a[70:71], v13 offset:40960
    v_mfma_f32_16x16x32_bf16 v[76:79], a[12:15], a[36:39], v[76:79]
    buffer_load_dwordx4 v3, s[48:51], s60 offen offset:1024 sc1 lds
    v_mfma_f32_16x16x32_bf16 v[80:83], a[16:19], a[36:39], v[80:83]
    ds_read_b128 a[104:107], v6 offset:34816
    v_mfma_f32_16x16x32_bf16 v[84:87], a[20:23], a[36:39], v[84:87]
    v_mfma_f32_16x16x32_bf16 v[88:91], a[24:27], a[36:39], v[88:91]
    ds_read_b64_tr_b16 a[72:73], v14 offset:32768
    v_mfma_f32_16x16x32_bf16 v[92:95], a[28:31], a[36:39], v[92:95]
    v_mfma_f32_16x16x32_bf16 v[96:99], a[0:3], a[40:43], v[96:99]
    ds_read_b64_tr_b16 a[74:75], v14 offset:40960
    v_mfma_f32_16x16x32_bf16 v[100:103], a[4:7], a[40:43], v[100:103]
    v_mfma_f32_16x16x32_bf16 v[104:107], a[8:11], a[40:43], v[104:107]
    ds_read_b128 a[108:111], v6 offset:35840
    v_mfma_f32_16x16x32_bf16 v[108:111], a[12:15], a[40:43], v[108:111]
    buffer_load_dwordx4 v3, s[48:51], s60 offen offset:2048 sc1 lds
    v_mfma_f32_16x16x32_bf16 v[112:115], a[16:19], a[40:43], v[112:115]
    ds_read_b64_tr_b16 a[76:77], v15 offset:32768
    v_mfma_f32_16x16x32_bf16 v[116:119], a[20:23], a[40:43], v[116:119]
    v_mfma_f32_16x16x32_bf16 v[120:123], a[24:27], a[40:43], v[120:123]
    ds_read_b64_tr_b16 a[78:79], v15 offset:40960
    v_mfma_f32_16x16x32_bf16 v[124:127], a[28:31], a[40:43], v[124:127]
    v_mfma_f32_16x16x32_bf16 v[128:131], a[0:3], a[44:47], v[128:131]
    ds_read_b128 a[112:115], v6 offset:36864
    v_mfma_f32_16x16x32_bf16 v[132:135], a[4:7], a[44:47], v[132:135]
    buffer_load_dwordx4 v3, s[48:51], s60 offen offset:3072 sc1 lds
    v_mfma_f32_16x16x32_bf16 v[136:139], a[8:11], a[44:47], v[136:139]
    ds_read_b64_tr_b16 a[80:81], v12 offset:34816
    v_mfma_f32_16x16x32_bf16 v[140:143], a[12:15], a[44:47], v[140:143]
    s_add_u32 s60, s60, 0x4000
    v_mfma_f32_16x16x32_bf16 v[144:147], a[16:19], a[44:47], v[144:147]
    ds_read_b64_tr_b16 a[82:83], v12 offset:43008
    v_mfma_f32_16x16x32_bf16 v[148:151], a[20:23], a[44:47], v[148:151]
    v_mfma_f32_16x16x32_bf16 v[152:155], a[24:27], a[44:47], v[152:155]
    ds_read_b128 a[116:119], v6 offset:37888
    v_mfma_f32_16x16x32_bf16 v[156:159], a[28:31], a[44:47], v[156:159]
    s_add_u32 m0, s65, 0x10000
    v_mfma_f32_16x16x32_bf16 v[160:163], a[0:3], a[48:51], v[160:163]
    ds_read_b64_tr_b16 a[84:85], v13 offset:34816
    v_mfma_f32_16x16x32_bf16 v[164:167], a[4:7], a[48:51], v[164:167]
    buffer_load_dwordx4 v4, s[52:55], s61 offen lds
    v_mfma_f32_16x16x32_bf16 v[168:171], a[8:11], a[48:51], v[168:171]
    ds_read_b64_tr_b16 a[86:87], v13 offset:43008
    v_mfma_f32_16x16x32_bf16 v[172:175], a[12:15], a[48:51], v[172:175]
    v_mfma_f32_16x16x32_bf16 v[176:179], a[16:19], a[48:51], v[176:179]
    ds_read_b128 a[120:123], v6 offset:38912
    v_mfma_f32_16x16x32_bf16 v[180:183], a[20:23], a[48:51], v[180:183]
    v_mfma_f32_16x16x32_bf16 v[184:187], a[24:27], a[48:51], v[184:187]
    ds_read_b64_tr_b16 a[88:89], v14 offset:34816
    v_mfma_f32_16x16x32_bf16 v[188:191], a[28:31], a[48:51], v[188:191]
    v_mfma_f32_16x16x32_bf16 v[192:195], a[0:3], a[52:55], v[192:195]
    ds_read_b64_tr_b16 a[90:91], v14 offset:43008
    v_mfma_f32_16x16x32_bf16 v[196:199], a[4:7], a[52:55], v[196:199]
    buffer_load_dwordx4 v4, s[52:55], s62 offen offset:1024 lds
    v_mfma_f32_16x16x32_bf16 v[200:203], a[8:11], a[52:55], v[200:203]
    ds_read_b128 a[124:127], v6 offset:39936
    v_mfma_f32_16x16x32_bf16 v[204:207], a[12:15], a[52:55], v[204:207]
    v_mfma_f32_16x16x32_bf16 v[208:211], a[16:19], a[52:55], v[208:211]
    ds_read_b64_tr_b16 a[92:93], v15 offset:34816
    v_mfma_f32_16x16x32_bf16 v[212:215], a[20:23], a[52:55], v[212:215]
    v_mfma_f32_16x16x32_bf16 v[216:219], a[24:27], a[52:55], v[216:219]
    ds_read_b64_tr_b16 a[94:95], v15 offset:43008
    v_mfma_f32_16x16x32_bf16 v[220:223], a[28:31], a[52:55], v[220:223]
    v_mfma_f32_16x16x32_bf16 v[224:227], a[0:3], a[56:59], v[224:227]
    buffer_load_dwordx4 v4, s[56:59], s61 offen offset:2048 lds
    v_mfma_f32_16x16x32_bf16 v[228:231], a[4:7], a[56:59], v[228:231]
    s_add_u32 s61, s61, 229376
    v_mfma_f32_16x16x32_bf16 v[232:235], a[8:11], a[56:59], v[232:235]
    v_mfma_f32_16x16x32_bf16 v[236:239], a[12:15], a[56:59], v[236:239]
    v_mfma_f32_16x16x32_bf16 v[240:243], a[16:19], a[56:59], v[240:243]
    v_mfma_f32_16x16x32_bf16 v[244:247], a[20:23], a[56:59], v[244:247]
    v_mfma_f32_16x16x32_bf16 v[248:251], a[24:27], a[56:59], v[248:251]
    v_mfma_f32_16x16x32_bf16 v[252:255], a[28:31], a[56:59], v[252:255]
    buffer_load_dwordx4 v4, s[56:59], s62 offen offset:3072 lds
    v_mfma_f32_16x16x32_bf16 a[128:131], a[0:3], a[60:63], a[128:131]
    s_add_u32 s62, s62, 229376
    v_mfma_f32_16x16x32_bf16 a[132:135], a[4:7], a[60:63], a[132:135]
    v_mfma_f32_16x16x32_bf16 a[136:139], a[8:11], a[60:63], a[136:139]
    v_mfma_f32_16x16x32_bf16 a[140:143], a[12:15], a[60:63], a[140:143]
    v_mfma_f32_16x16x32_bf16 a[144:147], a[16:19], a[60:63], a[144:147]
    v_mfma_f32_16x16x32_bf16 a[148:151], a[20:23], a[60:63], a[148:151]
    v_mfma_f32_16x16x32_bf16 a[152:155], a[24:27], a[60:63], a[152:155]
    v_mfma_f32_16x16x32_bf16 a[156:159], a[28:31], a[60:63], a[156:159]
    s_waitcnt vmcnt(16) lgkmcnt(0)
    s_barrier
    s_add_u32 s32, s16, 0x0
    s_addc_u32 s33, s17, 0
    s_and_b32 s33, s33, 0xffff
    s_mov_b32 s34, 0x700000
    s_mov_b32 s35, 0x20000
    s_sub_u32 s10, s2, 32
    s_lshl_b32 s10, s10, 15
    v_mul_u32_u24 v20, 1280, v2
    v_lshl_add_u32 v20, v1, 7, v20
    v_cmp_lt_u32 vcc, 9, v1
    s_nop 1
    v_cndmask_b32 v20, v20, 2.0, vcc
    v_lshrrev_b32 v21, 2, v1
    v_lshlrev_b32 v21, 18, v21
    v_lshl_add_u32 v21, v2, 13, v21
    v_and_b32 v22, 3, v1
    v_lshl_add_u32 v21, v22, 4, v21
    s_and_b32 s8, s2, 1
    s_lshl_b32 s8, s8, 17
    s_bfe_u32 s9, s2, 0x20003
    s_lshl_b32 s9, s9, 15
    s_add_u32 s8, s8, s9
    s_lshr_b32 s9, s2, 5
    s_lshl_b32 s9, s9, 8
    s_add_u32 s8, s8, s9
    s_bfe_u32 s9, s2, 0x20001
    s_lshl_b32 s9, s9, 6
    s_add_u32 s8, s8, s9
    s_add_u32 s9, s8, 0x1000
    s_add_u32 s12, s4, 0x0
    s_addc_u32 s13, s5, 0
    s_and_b32 s13, s13, 0xffff
    s_mov_b32 s14, 0x400000
    s_mov_b32 s15, 0x20000
    s_lshl_b32 s11, s3, 12
    s_add_u32 s11, s11, 0x20000
    s_mov_b32 s63, s8
    s_add_u32 s44, s8, 0x2000
    s_getpc_b64 s[4:5]
cs_g1_npf:
    s_add_u32 s4, s4, g1_npf-cs_g1_npf
    s_addc_u32 s5, s5, 0
    s_and_b32 s5, s5, 0xffff
    s_mov_b32 s6, k_done-g1_npf
    s_mov_b32 s7, 0x20000
    s_bfe_u32 s71, s2, 0x20003
    s_lshl_b32 s71, s71, 13
    v_lshlrev_b32 v23, 7, v1
    v_lshl_add_u32 v23, v2, 11, v23
    v_lshrrev_b32 v22, 4, v1
    v_lshl_add_u32 v23, v22, 24, v23
    v_mfma_f32_16x16x32_bf16 v[32:35], a[64:67], a[96:99], v[32:35]
    ds_read_b128 a[32:35], v5 offset:0
    v_mfma_f32_16x16x32_bf16 v[36:39], a[68:71], a[96:99], v[36:39]
    s_add_u32 m0, s64, 0x18000
    v_mfma_f32_16x16x32_bf16 v[40:43], a[72:75], a[96:99], v[40:43]
    ds_read_b64_tr_b16 a[0:1], v8 offset:0
    v_mfma_f32_16x16x32_bf16 v[44:47], a[76:79], a[96:99], v[44:47]
    buffer_load_dwordx4 v3, s[48:51], s60 offen sc1 lds
    v_mfma_f32_16x16x32_bf16 v[48:51], a[80:83], a[96:99], v[48:51]
    ds_read_b64_tr_b16 a[2:3], v8 offset:8192
    v_mfma_f32_16x16x32_bf16 v[52:55], a[84:87], a[96:99], v[52:55]
    v_mfma_f32_16x16x32_bf16 v[56:59], a[88:91], a[96:99], v[56:59]
    ds_read_b128 a[36:39], v5 offset:1024
    v_mfma_f32_16x16x32_bf16 v[60:63], a[92:95], a[96:99], v[60:63]
    v_mfma_f32_16x16x32_bf16 v[64:67], a[64:67], a[100:103], v[64:67]
    ds_read_b64_tr_b16 a[4:5], v9 offset:0
    v_mfma_f32_16x16x32_bf16 v[68:71], a[68:71], a[100:103], v[68:71]
    buffer_load_dwordx4 v3, s[48:51], s60 offen offset:1024 sc1 lds
    v_mfma_f32_16x16x32_bf16 v[72:75], a[72:75], a[100:103], v[72:75]
    ds_read_b64_tr_b16 a[6:7], v9 offset:8192
    v_mfma_f32_16x16x32_bf16 v[76:79], a[76:79], a[100:103], v[76:79]
    v_mfma_f32_16x16x32_bf16 v[80:83], a[80:83], a[100:103], v[80:83]
    ds_read_b128 a[40:43], v5 offset:2048
    v_mfma_f32_16x16x32_bf16 v[84:87], a[84:87], a[100:103], v[84:87]
    buffer_load_dwordx4 v3, s[48:51], s60 offen offset:2048 sc1 lds
    v_mfma_f32_16x16x32_bf16 v[88:91], a[88:91], a[100:103], v[88:91]
    ds_read_b64_tr_b16 a[8:9], v10 offset:0
    v_mfma_f32_16x16x32_bf16 v[92:95], a[92:95], a[100:103], v[92:95]
    v_mfma_f32_16x16x32_bf16 v[96:99], a[64:67], a[104:107], v[96:99]
    ds_read_b64_tr_b16 a[10:11], v10 offset:8192
    v_mfma_f32_16x16x32_bf16 v[100:103], a[68:71], a[104:107], v[100:103]
    v_mfma_f32_16x16x32_bf16 v[104:107], a[72:75], a[104:107], v[104:107]
    ds_read_b128 a[44:47], v5 offset:3072
    v_mfma_f32_16x16x32_bf16 v[108:111], a[76:79], a[104:107], v[108:111]
    buffer_load_dwordx4 v3, s[48:51], s60 offen offset:3072 sc1 lds
    v_mfma_f32_16x16x32_bf16 v[112:115], a[80:83], a[104:107], v[112:115]
    ds_read_b64_tr_b16 a[12:13], v11 offset:0
    v_mfma_f32_16x16x32_bf16 v[116:119], a[84:87], a[104:107], v[116:119]
    s_add_u32 s60, s60, 0x4000
    v_mfma_f32_16x16x32_bf16 v[120:123], a[88:91], a[104:107], v[120:123]
    ds_read_b64_tr_b16 a[14:15], v11 offset:8192
    v_mfma_f32_16x16x32_bf16 v[124:127], a[92:95], a[104:107], v[124:127]
    s_add_u32 m0, s65, 0x18000
    v_mfma_f32_16x16x32_bf16 v[128:131], a[64:67], a[108:111], v[128:131]
    ds_read_b128 a[48:51], v5 offset:4096
    v_mfma_f32_16x16x32_bf16 v[132:135], a[68:71], a[108:111], v[132:135]
    buffer_load_dwordx4 v4, s[52:55], s61 offen lds
    v_mfma_f32_16x16x32_bf16 v[136:139], a[72:75], a[108:111], v[136:139]
    ds_read_b64_tr_b16 a[16:17], v8 offset:2048
    v_mfma_f32_16x16x32_bf16 v[140:143], a[76:79], a[108:111], v[140:143]
    v_mfma_f32_16x16x32_bf16 v[144:147], a[80:83], a[108:111], v[144:147]
    ds_read_b64_tr_b16 a[18:19], v8 offset:10240
    v_mfma_f32_16x16x32_bf16 v[148:151], a[84:87], a[108:111], v[148:151]
    buffer_load_dwordx4 v4, s[52:55], s62 offen offset:1024 lds
    v_mfma_f32_16x16x32_bf16 v[152:155], a[88:91], a[108:111], v[152:155]
    ds_read_b128 a[52:55], v5 offset:5120
    v_mfma_f32_16x16x32_bf16 v[156:159], a[92:95], a[108:111], v[156:159]
    v_mfma_f32_16x16x32_bf16 v[160:163], a[64:67], a[112:115], v[160:163]
    ds_read_b64_tr_b16 a[20:21], v9 offset:2048
    v_mfma_f32_16x16x32_bf16 v[164:167], a[68:71], a[112:115], v[164:167]
    buffer_load_dwordx4 v4, s[56:59], s61 offen offset:2048 lds
    v_mfma_f32_16x16x32_bf16 v[168:171], a[72:75], a[112:115], v[168:171]
    ds_read_b64_tr_b16 a[22:23], v9 offset:10240
    v_mfma_f32_16x16x32_bf16 v[172:175], a[76:79], a[112:115], v[172:175]
    s_add_u32 s61, s61, 229376
    v_mfma_f32_16x16x32_bf16 v[176:179], a[80:83], a[112:115], v[176:179]
    ds_read_b128 a[56:59], v5 offset:6144
    v_mfma_f32_16x16x32_bf16 v[180:183], a[84:87], a[112:115], v[180:183]
    v_mfma_f32_16x16x32_bf16 v[184:187], a[88:91], a[112:115], v[184:187]
    ds_read_b64_tr_b16 a[24:25], v10 offset:2048
    v_mfma_f32_16x16x32_bf16 v[188:191], a[92:95], a[112:115], v[188:191]
    buffer_load_dwordx4 v4, s[56:59], s62 offen offset:3072 lds
    v_mfma_f32_16x16x32_bf16 v[192:195], a[64:67], a[116:119], v[192:195]
    ds_read_b64_tr_b16 a[26:27], v10 offset:10240
    v_mfma_f32_16x16x32_bf16 v[196:199], a[68:71], a[116:119], v[196:199]
    s_add_u32 s62, s62, 229376
    v_mfma_f32_16x16x32_bf16 v[200:203], a[72:75], a[116:119], v[200:203]
    ds_read_b128 a[60:63], v5 offset:7168
    v_mfma_f32_16x16x32_bf16 v[204:207], a[76:79], a[116:119], v[204:207]
    buffer_load_dword v16, v17, s[36:39], s69 offen
    v_mfma_f32_16x16x32_bf16 v[208:211], a[80:83], a[116:119], v[208:211]
    ds_read_b64_tr_b16 a[28:29], v11 offset:2048
    v_mfma_f32_16x16x32_bf16 v[212:215], a[84:87], a[116:119], v[212:215]
    s_add_u32 s69, s69, 917504
    v_mfma_f32_16x16x32_bf16 v[216:219], a[88:91], a[116:119], v[216:219]
    ds_read_b64_tr_b16 a[30:31], v11 offset:10240
    v_mfma_f32_16x16x32_bf16 v[220:223], a[92:95], a[116:119], v[220:223]
    v_mfma_f32_16x16x32_bf16 v[224:227], a[64:67], a[120:123], v[224:227]
    buffer_load_dword v18, v20, s[32:35], s10 offen
    v_mfma_f32_16x16x32_bf16 v[228:231], a[68:71], a[120:123], v[228:231]
    s_add_u32 s10, s10, 5120
    v_mfma_f32_16x16x32_bf16 v[232:235], a[72:75], a[120:123], v[232:235]
    s_cmp_ge_u32 s63, s44
    v_mfma_f32_16x16x32_bf16 v[236:239], a[76:79], a[120:123], v[236:239]
    s_cselect_b32 s14, 0, s14
    v_mfma_f32_16x16x32_bf16 v[240:243], a[80:83], a[120:123], v[240:243]
    s_cselect_b32 s11, 0x24400, s11
    v_mfma_f32_16x16x32_bf16 v[244:247], a[84:87], a[120:123], v[244:247]
    s_mov_b32 m0, s11
    v_mfma_f32_16x16x32_bf16 v[248:251], a[88:91], a[120:123], v[248:251]
    s_add_u32 s11, s11, 1024
    v_mfma_f32_16x16x32_bf16 v[252:255], a[92:95], a[120:123], v[252:255]
    buffer_load_dwordx4 v21, s[12:15], s63 offen lds
    v_mfma_f32_16x16x32_bf16 a[128:131], a[64:67], a[124:127], a[128:131]
    s_add_u32 s63, s63, 2048
    v_mfma_f32_16x16x32_bf16 a[132:135], a[68:71], a[124:127], a[132:135]
    v_mfma_f32_16x16x32_bf16 a[136:139], a[72:75], a[124:127], a[136:139]
    buffer_load_dword v19, v23, s[4:7], s71 offen
    v_mfma_f32_16x16x32_bf16 a[140:143], a[76:79], a[124:127], a[140:143]
    v_mfma_f32_16x16x32_bf16 a[144:147], a[80:83], a[124:127], a[144:147]
    v_mfma_f32_16x16x32_bf16 a[148:151], a[84:87], a[124:127], a[148:151]
    v_mfma_f32_16x16x32_bf16 a[152:155], a[88:91], a[124:127], a[152:155]
    v_mfma_f32_16x16x32_bf16 a[156:159], a[92:95], a[124:127], a[156:159]
    s_waitcnt vmcnt(20) lgkmcnt(0)
    s_barrier
    s_mov_b32 s45, 6
.p2align 6
g1_loop:
    v_mfma_f32_16x16x32_bf16 v[32:35], a[0:3], a[32:35], v[32:35]
    ds_read_b128 a[96:99], v5 offset:32768
    v_mfma_f32_16x16x32_bf16 v[36:39], a[4:7], a[32:35], v[36:39]
    s_add_u32 m0, s64, 0x0
    v_mfma_f32_16x16x32_bf16 v[40:43], a[8:11], a[32:35], v[40:43]
    ds_read_b64_tr_b16 a[64:65], v8 offset:32768
    v_mfma_f32_16x16x32_bf16 v[44:47], a[12:15], a[32:35], v[44:47]
    buffer_load_dwordx4 v3, s[48:51], s60 offen sc1 lds
    v_mfma_f32_16x16x32_bf16 v[48:51], a[16:19], a[32:35], v[48:51]
    ds_read_b64_tr_b16 a[66:67], v8 offset:40960
    v_mfma_f32_16x16x32_bf16 v[52:55], a[20:23], a[32:35], v[52:55]
    v_mfma_f32_16x16x32_bf16 v[56:59], a[24:27], a[32:35], v[56:59]
    ds_read_b128 a[100:103], v5 offset:33792
    v_mfma_f32_16x16x32_bf16 v[60:63], a[28:31], a[32:35], v[60:63]
    v_mfma_f32_16x16x32_bf16 v[64:67], a[0:3], a[36:39], v[64:67]
    ds_read_b64_tr_b16 a[68:69], v9 offset:32768
    v_mfma_f32_16x16x32_bf16 v[68:71], a[4:7], a[36:39], v[68:71]
    v_mfma_f32_16x16x32_bf16 v[72:75], a[8:11], a[36:39], v[72:75]
    ds_read_b64_tr_b16 a[70:71], v9 offset:40960
    v_mfma_f32_16x16x32_bf16 v[76:79], a[12:15], a[36:39], v[76:79]
    buffer_load_dwordx4 v3, s[48:51], s60 offen offset:1024 sc1 lds
    v_mfma_f32_16x16x32_bf16 v[80:83], a[16:19], a[36:39], v[80:83]
    ds_read_b128 a[104:107], v5 offset:34816
    v_mfma_f32_16x16x32_bf16 v[84:87], a[20:23], a[36:39], v[84:87]
    v_mfma_f32_16x16x32_bf16 v[88:91], a[24:27], a[36:39], v[88:91]
    ds_read_b64_tr_b16 a[72:73], v10 offset:32768
    v_mfma_f32_16x16x32_bf16 v[92:95], a[28:31], a[36:39], v[92:95]
    v_mfma_f32_16x16x32_bf16 v[96:99], a[0:3], a[40:43], v[96:99]
    ds_read_b64_tr_b16 a[74:75], v10 offset:40960
    v_mfma_f32_16x16x32_bf16 v[100:103], a[4:7], a[40:43], v[100:103]
    v_mfma_f32_16x16x32_bf16 v[104:107], a[8:11], a[40:43], v[104:107]
    ds_read_b128 a[108:111], v5 offset:35840
    v_mfma_f32_16x16x32_bf16 v[108:111], a[12:15], a[40:43], v[108:111]
    buffer_load_dwordx4 v3, s[48:51], s60 offen offset:2048 sc1 lds
    v_mfma_f32_16x16x32_bf16 v[112:115], a[16:19], a[40:43], v[112:115]
    ds_read_b64_tr_b16 a[76:77], v11 offset:32768
    v_mfma_f32_16x16x32_bf16 v[116:119], a[20:23], a[40:43], v[116:119]
    v_mfma_f32_16x16x32_bf16 v[120:123], a[24:27], a[40:43], v[120:123]
    ds_read_b64_tr_b16 a[78:79], v11 offset:40960
    v_mfma_f32_16x16x32_bf16 v[124:127], a[28:31], a[40:43], v[124:127]
    v_mfma_f32_16x16x32_bf16 v[128:131], a[0:3], a[44:47], v[128:131]
    ds_read_b128 a[112:115], v5 offset:36864
    v_mfma_f32_16x16x32_bf16 v[132:135], a[4:7], a[44:47], v[132:135]
    buffer_load_dwordx4 v3, s[48:51], s60 offen offset:3072 sc1 lds
    v_mfma_f32_16x16x32_bf16 v[136:139], a[8:11], a[44:47], v[136:139]
    ds_read_b64_tr_b16 a[80:81], v8 offset:34816
    v_mfma_f32_16x16x32_bf16 v[140:143], a[12:15], a[44:47], v[140:143]
    s_add_u32 s60, s60, 0x4000
    v_mfma_f32_16x16x32_bf16 v[144:147], a[16:19], a[44:47], v[144:147]
    ds_read_b64_tr_b16 a[82:83], v8 offset:43008
    v_mfma_f32_16x16x32_bf16 v[148:151], a[20:23], a[44:47], v[148:151]
    v_mfma_f32_16x16x32_bf16 v[152:155], a[24:27], a[44:47], v[152:155]
    ds_read_b128 a[116:119], v5 offset:37888
    v_mfma_f32_16x16x32_bf16 v[156:159], a[28:31], a[44:47], v[156:159]
    s_add_u32 m0, s65, 0x0
    v_mfma_f32_16x16x32_bf16 v[160:163], a[0:3], a[48:51], v[160:163]
    ds_read_b64_tr_b16 a[84:85], v9 offset:34816
    v_mfma_f32_16x16x32_bf16 v[164:167], a[4:7], a[48:51], v[164:167]
    buffer_load_dwordx4 v4, s[52:55], s61 offen lds
    v_mfma_f32_16x16x32_bf16 v[168:171], a[8:11], a[48:51], v[168:171]
    ds_read_b64_tr_b16 a[86:87], v9 offset:43008
    v_mfma_f32_16x16x32_bf16 v[172:175], a[12:15], a[48:51], v[172:175]
    v_mfma_f32_16x16x32_bf16 v[176:179], a[16:19], a[48:51], v[176:179]
    ds_read_b128 a[120:123], v5 offset:38912
    v_mfma_f32_16x16x32_bf16 v[180:183], a[20:23], a[48:51], v[180:183]
    v_mfma_f32_16x16x32_bf16 v[184:187], a[24:27], a[48:51], v[184:187]
    ds_read_b64_tr_b16 a[88:89], v10 offset:34816
    v_mfma_f32_16x16x32_bf16 v[188:191], a[28:31], a[48:51], v[188:191]
    v_mfma_f32_16x16x32_bf16 v[192:195], a[0:3], a[52:55], v[192:195]
    ds_read_b64_tr_b16 a[90:91], v10 offset:43008
    v_mfma_f32_16x16x32_bf16 v[196:199], a[4:7], a[52:55], v[196:199]
    buffer_load_dwordx4 v4, s[52:55], s62 offen offset:1024 lds
    v_mfma_f32_16x16x32_bf16 v[200:203], a[8:11], a[52:55], v[200:203]
    ds_read_b128 a[124:127], v5 offset:39936
    v_mfma_f32_16x16x32_bf16 v[204:207], a[12:15], a[52:55], v[204:207]
    v_mfma_f32_16x16x32_bf16 v[208:211], a[16:19], a[52:55], v[208:211]
    ds_read_b64_tr_b16 a[92:93], v11 offset:34816
    v_mfma_f32_16x16x32_bf16 v[212:215], a[20:23], a[52:55], v[212:215]
    v_mfma_f32_16x16x32_bf16 v[216:219], a[24:27], a[52:55], v[216:219]
    ds_read_b64_tr_b16 a[94:95], v11 offset:43008
    v_mfma_f32_16x16x32_bf16 v[220:223], a[28:31], a[52:55], v[220:223]
    v_mfma_f32_16x16x32_bf16 v[224:227], a[0:3], a[56:59], v[224:227]
    buffer_load_dwordx4 v4, s[56:59], s61 offen offset:2048 lds
    v_mfma_f32_16x16x32_bf16 v[228:231], a[4:7], a[56:59], v[228:231]
    s_add_u32 s61, s61, 229376
    v_mfma_f32_16x16x32_bf16 v[232:235], a[8:11], a[56:59], v[232:235]
    v_mfma_f32_16x16x32_bf16 v[236:239], a[12:15], a[56:59], v[236:239]
    v_mfma_f32_16x16x32_bf16 v[240:243], a[16:19], a[56:59], v[240:243]
    v_mfma_f32_16x16x32_bf16 v[244:247], a[20:23], a[56:59], v[244:247]
    v_mfma_f32_16x16x32_bf16 v[248:251], a[24:27], a[56:59], v[248:251]
    v_mfma_f32_16x16x32_bf16 v[252:255], a[28:31], a[56:59], v[252:255]
    buffer_load_dwordx4 v4, s[56:59], s62 offen offset:3072 lds
    v_mfma_f32_16x16x32_bf16 a[128:131], a[0:3], a[60:63], a[128:131]
    s_add_u32 s62, s62, 229376
    v_mfma_f32_16x16x32_bf16 a[132:135], a[4:7], a[60:63], a[132:135]
    v_mfma_f32_16x16x32_bf16 a[136:139], a[8:11], a[60:63], a[136:139]
    v_mfma_f32_16x16x32_bf16 a[140:143], a[12:15], a[60:63], a[140:143]
    v_mfma_f32_16x16x32_bf16 a[144:147], a[16:19], a[60:63], a[144:147]
    v_mfma_f32_16x16x32_bf16 a[148:151], a[20:23], a[60:63], a[148:151]
    v_mfma_f32_16x16x32_bf16 a[152:155], a[24:27], a[60:63], a[152:155]
    v_mfma_f32_16x16x32_bf16 a[156:159], a[28:31], a[60:63], a[156:159]
    s_waitcnt vmcnt(20) lgkmcnt(0)
    s_barrier
    v_mfma_f32_16x16x32_bf16 v[32:35], a[64:67], a[96:99], v[32:35]
    ds_read_b128 a[32:35], v6 offset:0
    v_mfma_f32_16x16x32_bf16 v[36:39], a[68:71], a[96:99], v[36:39]
    s_add_u32 m0, s64, 0x8000
    v_mfma_f32_16x16x32_bf16 v[40:43], a[72:75], a[96:99], v[40:43]
    ds_read_b64_tr_b16 a[0:1], v12 offset:0
    v_mfma_f32_16x16x32_bf16 v[44:47], a[76:79], a[96:99], v[44:47]
    buffer_load_dwordx4 v3, s[48:51], s60 offen sc1 lds
    v_mfma_f32_16x16x32_bf16 v[48:51], a[80:83], a[96:99], v[48:51]
    ds_read_b64_tr_b16 a[2:3], v12 offset:8192
    v_mfma_f32_16x16x32_bf16 v[52:55], a[84:87], a[96:99], v[52:55]
    v_mfma_f32_16x16x32_bf16 v[56:59], a[88:91], a[96:99], v[56:59]
    ds_read_b128 a[36:39], v6 offset:1024
    v_mfma_f32_16x16x32_bf16 v[60:63], a[92:95], a[96:99], v[60:63]
    v_mfma_f32_16x16x32_bf16 v[64:67], a[64:67], a[100:103], v[64:67]
    ds_read_b64_tr_b16 a[4:5], v13 offset:0
    v_mfma_f32_16x16x32_bf16 v[68:71], a[68:71], a[100:103], v[68:71]
    v_mfma_f32_16x16x32_bf16 v[72:75], a[72:75], a[100:103], v[72:75]
    ds_read_b64_tr_b16 a[6:7], v13 offset:8192
    v_mfma_f32_16x16x32_bf16 v[76:79], a[76:79], a[100:103], v[76:79]
    buffer_load_dwordx4 v3, s[48:51], s60 offen offset:1024 sc1 lds
    v_mfma_f32_16x16x32_bf16 v[80:83], a[80:83], a[100:103], v[80:83]
    ds_read_b128 a[40:43], v6 offset:2048
    v_mfma_f32_16x16x32_bf16 v[84:87], a[84:87], a[100:103], v[84:87]
    v_mfma_f32_16x16x32_bf16 v[88:91], a[88:91], a[100:103], v[88:91]
    ds_read_b64_tr_b16 a[8:9], v14 offset:0
    v_mfma_f32_16x16x32_bf16 v[92:95], a[92:95], a[100:103], v[92:95]
    v_mfma_f32_16x16x32_bf16 v[96:99], a[64:67], a[104:107], v[96:99]
    ds_read_b64_tr_b16 a[10:11], v14 offset:8192
    v_mfma_f32_16x16x32_bf16 v[100:103], a[68:71], a[104:107], v[100:103]
    v_mfma_f32_16x16x32_bf16 v[104:107], a[72:75], a[104:107], v[104:107]
    ds_read_b128 a[44:47], v6 offset:3072
    v_mfma_f32_16x16x32_bf16 v[108:111], a[76:79], a[104:107], v[108:111]
    buffer_load_dwordx4 v3, s[48:51], s60 offen offset:2048 sc1 lds
    v_mfma_f32_16x16x32_bf16 v[112:115], a[80:83], a[104:107], v[112:115]
    ds_read_b64_tr_b16 a[12:13], v15 offset:0
    v_mfma_f32_16x16x32_bf16 v[116:119], a[84:87], a[104:107], v[116:119]
    v_mfma_f32_16x16x32_bf16 v[120:123], a[88:91], a[104:107], v[120:123]
    ds_read_b64_tr_b16 a[14:15], v15 offset:8192
    v_mfma_f32_16x16x32_bf16 v[124:127], a[92:95], a[104:107], v[124:127]
    v_mfma_f32_16x16x32_bf16 v[128:131], a[64:67], a[108:111], v[128:131]
    ds_read_b128 a[48:51], v6 offset:4096
    v_mfma_f32_16x16x32_bf16 v[132:135], a[68:71], a[108:111], v[132:135]
    buffer_load_dwordx4 v3, s[48:51], s60 offen offset:3072 sc1 lds
    v_mfma_f32_16x16x32_bf16 v[136:139], a[72:75], a[108:111], v[136:139]
    ds_read_b64_tr_b16 a[16:17], v12 offset:2048
    v_mfma_f32_16x16x32_bf16 v[140:143], a[76:79], a[108:111], v[140:143]
    s_add_u32 s60, s60, 0x4000
    v_mfma_f32_16x16x32_bf16 v[144:147], a[80:83], a[108:111], v[144:147]
    ds_read_b64_tr_b16 a[18:19], v12 offset:10240
    v_mfma_f32_16x16x32_bf16 v[148:151], a[84:87], a[108:111], v[148:151]
    v_mfma_f32_16x16x32_bf16 v[152:155], a[88:91], a[108:111], v[152:155]
    ds_read_b128 a[52:55], v6 offset:5120
    v_mfma_f32_16x16x32_bf16 v[156:159], a[92:95], a[108:111], v[156:159]
    s_add_u32 m0, s65, 0x8000
    v_mfma_f32_16x16x32_bf16 v[160:163], a[64:67], a[112:115], v[160:163]
    ds_read_b64_tr_b16 a[20:21], v13 offset:2048
    v_mfma_f32_16x16x32_bf16 v[164:167], a[68:71], a[112:115], v[164:167]
    buffer_load_dwordx4 v4, s[52:55], s61 offen lds
    v_mfma_f32_16x16x32_bf16 v[168:171], a[72:75], a[112:115], v[168:171]
    ds_read_b64_tr_b16 a[22:23], v13 offset:10240
    v_mfma_f32_16x16x32_bf16 v[172:175], a[76:79], a[112:115], v[172:175]
    v_mfma_f32_16x16x32_bf16 v[176:179], a[80:83], a[112:115], v[176:179]
    ds_read_b128 a[56:59], v6 offset:6144
    v_mfma_f32_16x16x32_bf16 v[180:183], a[84:87], a[112:115], v[180:183]
    v_mfma_f32_16x16x32_bf16 v[184:187], a[88:91], a[112:115], v[184:187]
    ds_read_b64_tr_b16 a[24:25], v14 offset:2048
    v_mfma_f32_16x16x32_bf16 v[188:191], a[92:95], a[112:115], v[188:191]
    v_mfma_f32_16x16x32_bf16 v[192:195], a[64:67], a[116:119], v[192:195]
    ds_read_b64_tr_b16 a[26:27], v14 offset:10240
    v_mfma_f32_16x16x32_bf16 v[196:199], a[68:71], a[116:119], v[196:199]
    buffer_load_dwordx4 v4, s[52:55], s62 offen offset:1024 lds
    v_mfma_f32_16x16x32_bf16 v[200:203], a[72:75], a[116:119], v[200:203]
    ds_read_b128 a[60:63], v6 offset:7168
    v_mfma_f32_16x16x32_bf16 v[204:207], a[76:79], a[116:119], v[204:207]
    v_mfma_f32_16x16x32_bf16 v[208:211], a[80:83], a[116:119], v[208:211]
    ds_read_b64_tr_b16 a[28:29], v15 offset:2048
    v_mfma_f32_16x16x32_bf16 v[212:215], a[84:87], a[116:119], v[212:215]
    v_mfma_f32_16x16x32_bf16 v[216:219], a[88:91], a[116:119], v[216:219]
    ds_read_b64_tr_b16 a[30:31], v15 offset:10240
    v_mfma_f32_16x16x32_bf16 v[220:223], a[92:95], a[116:119], v[220:223]
    v_mfma_f32_16x16x32_bf16 v[224:227], a[64:67], a[120:123], v[224:227]
    buffer_load_dwordx4 v4, s[56:59], s61 offen offset:2048 lds
    v_mfma_f32_16x16x32_bf16 v[228:231], a[68:71], a[120:123], v[228:231]
    s_add_u32 s61, s61, 229376
    v_mfma_f32_16x16x32_bf16 v[232:235], a[72:75], a[120:123], v[232:235]
    v_mfma_f32_16x16x32_bf16 v[236:239], a[76:79], a[120:123], v[236:239]
    v_mfma_f32_16x16x32_bf16 v[240:243], a[80:83], a[120:123], v[240:243]
    v_mfma_f32_16x16x32_bf16 v[244:247], a[84:87], a[120:123], v[244:247]
    v_mfma_f32_16x16x32_bf16 v[248:251], a[88:91], a[120:123], v[248:251]
    v_mfma_f32_16x16x32_bf16 v[252:255], a[92:95], a[120:123], v[252:255]
    buffer_load_dwordx4 v4, s[56:59], s62 offen offset:3072 lds
    v_mfma_f32_16x16x32_bf16 a[128:131], a[64:67], a[124:127], a[128:131]
    s_add_u32 s62, s62, 229376
    v_mfma_f32_16x16x32_bf16 a[132:135], a[68:71], a[124:127], a[132:135]
    v_mfma_f32_16x16x32_bf16 a[136:139], a[72:75], a[124:127], a[136:139]
    v_mfma_f32_16x16x32_bf16 a[140:143], a[76:79], a[124:127], a[140:143]
    v_mfma_f32_16x16x32_bf16 a[144:147], a[80:83], a[124:127], a[144:147]
    v_mfma_f32_16x16x32_bf16 a[148:151], a[84:87], a[124:127], a[148:151]
    v_mfma_f32_16x16x32_bf16 a[152:155], a[88:91], a[124:127], a[152:155]
    v_mfma_f32_16x16x32_bf16 a[156:159], a[92:95], a[124:127], a[156:159]
    s_waitcnt vmcnt(20) lgkmcnt(0)
    s_barrier
    v_mfma_f32_16x16x32_bf16 v[32:35], a[0:3], a[32:35], v[32:35]
    ds_read_b128 a[96:99], v6 offset:32768
    v_mfma_f32_16x16x32_bf16 v[36:39], a[4:7], a[32:35], v[36:39]
    s_add_u32 m0, s64, 0x10000
    v_mfma_f32_16x16x32_bf16 v[40:43], a[8:11], a[32:35], v[40:43]
    ds_read_b64_tr_b16 a[64:65], v12 offset:32768
    v_mfma_f32_16x16x32_bf16 v[44:47], a[12:15], a[32:35], v[44:47]
    buffer_load_dwordx4 v3, s[48:51], s60 offen sc1 lds
    v_mfma_f32_16x16x32_bf16 v[48:51], a[16:19], a[32:35], v[48:51]
    ds_read_b64_tr_b16 a[66:67], v12 offset:40960
    v_mfma_f32_16x16x32_bf16 v[52:55], a[20:23], a[32:35], v[52:55]
    v_mfma_f32_16x16x32_bf16 v[56:59], a[24:27], a[32:35], v[56:59]
    ds_read_b128 a[100:103], v6 offset:33792
    v_mfma_f32_16x16x32_bf16 v[60:63], a[28:31], a[32:35], v[60:63]
    v_mfma_f32_16x16x32_bf16 v[64:67], a[0:3], a[36:39], v[64:67]
    ds_read_b64_tr_b16 a[68:69], v13 offset:32768
    v_mfma_f32_16x16x32_bf16 v[68:71], a[4:7], a[36:39], v[68:71]
    v_mfma_f32_16x16x32_bf16 v[72:75], a[8:11], a[36:39], v[72:75]
    ds_read_b64_tr_b16 a[70:71], v13 offset:40960
    v_mfma_f32_16x16x32_bf16 v[76:79], a[12:15], a[36:39], v[76:79]
    buffer_load_dwordx4 v3, s[48:51], s60 offen offset:1024 sc1 lds
    v_mfma_f32_16x16x32_bf16 v[80:83], a[16:19], a[36:39], v[80:83]
    ds_read_b128 a[104:107], v6 offset:34816
    v_mfma_f32_16x16x32_bf16 v[84:87], a[20:23], a[36:39], v[84:87]
    v_mfma_f32_16x16x32_bf16 v[88:91], a[24:27], a[36:39], v[88:91]
    ds_read_b64_tr_b16 a[72:73], v14 offset:32768
    v_mfma_f32_16x16x32_bf16 v[92:95], a[28:31], a[36:39], v[92:95]
    v_mfma_f32_16x16x32_bf16 v[96:99], a[0:3], a[40:43], v[96:99]
    ds_read_b64_tr_b16 a[74:75], v14 offset:40960
    v_mfma_f32_16x16x32_bf16 v[100:103], a[4:7], a[40:43], v[100:103]
    v_mfma_f32_16x16x32_bf16 v[104:107], a[8:11], a[40:43], v[104:107]
    ds_read_b128 a[108:111], v6 offset:35840
    v_mfma_f32_16x16x32_bf16 v[108:111], a[12:15], a[40:43], v[108:111]
    buffer_load_dwordx4 v3, s[48:51], s60 offen offset:2048 sc1 lds
    v_mfma_f32_16x16x32_bf16 v[112:115], a[16:19], a[40:43], v[112:115]
    ds_read_b64_tr_b16 a[76:77], v15 offset:32768
    v_mfma_f32_16x16x32_bf16 v[116:119], a[20:23], a[40:43], v[116:119]
    v_mfma_f32_16x16x32_bf16 v[120:123], a[24:27], a[40:43], v[120:123]
    ds_read_b64_tr_b16 a[78:79], v15 offset:40960
    v_mfma_f32_16x16x32_bf16 v[124:127], a[28:31], a[40:43], v[124:127]
    v_mfma_f32_16x16x32_bf16 v[128:131], a[0:3], a[44:47], v[128:131]
    ds_read_b128 a[112:115], v6 offset:36864
    v_mfma_f32_16x16x32_bf16 v[132:135], a[4:7], a[44:47], v[132:135]
    buffer_load_dwordx4 v3, s[48:51], s60 offen offset:3072 sc1 lds
    v_mfma_f32_16x16x32_bf16 v[136:139], a[8:11], a[44:47], v[136:139]
    ds_read_b64_tr_b16 a[80:81], v12 offset:34816
    v_mfma_f32_16x16x32_bf16 v[140:143], a[12:15], a[44:47], v[140:143]
    s_add_u32 s60, s60, 0x4000
    v_mfma_f32_16x16x32_bf16 v[144:147], a[16:19], a[44:47], v[144:147]
    ds_read_b64_tr_b16 a[82:83], v12 offset:43008
    v_mfma_f32_16x16x32_bf16 v[148:151], a[20:23], a[44:47], v[148:151]
    v_mfma_f32_16x16x32_bf16 v[152:155], a[24:27], a[44:47], v[152:155]
    ds_read_b128 a[116:119], v6 offset:37888
    v_mfma_f32_16x16x32_bf16 v[156:159], a[28:31], a[44:47], v[156:159]
    s_add_u32 m0, s65, 0x10000
    v_mfma_f32_16x16x32_bf16 v[160:163], a[0:3], a[48:51], v[160:163]
    ds_read_b64_tr_b16 a[84:85], v13 offset:34816
    v_mfma_f32_16x16x32_bf16 v[164:167], a[4:7], a[48:51], v[164:167]
    buffer_load_dwordx4 v4, s[52:55], s61 offen lds
    v_mfma_f32_16x16x32_bf16 v[168:171], a[8:11], a[48:51], v[168:171]
    ds_read_b64_tr_b16 a[86:87], v13 offset:43008
    v_mfma_f32_16x16x32_bf16 v[172:175], a[12:15], a[48:51], v[172:175]
    v_mfma_f32_16x16x32_bf16 v[176:179], a[16:19], a[48:51], v[176:179]
    ds_read_b128 a[120:123], v6 offset:38912
    v_mfma_f32_16x16x32_bf16 v[180:183], a[20:23], a[48:51], v[180:183]
    v_mfma_f32_16x16x32_bf16 v[184:187], a[24:27], a[48:51], v[184:187]
    ds_read_b64_tr_b16 a[88:89], v14 offset:34816
    v_mfma_f32_16x16x32_bf16 v[188:191], a[28:31], a[48:51], v[188:191]
    v_mfma_f32_16x16x32_bf16 v[192:195], a[0:3], a[52:55], v[192:195]
    ds_read_b64_tr_b16 a[90:91], v14 offset:43008
    v_mfma_f32_16x16x32_bf16 v[196:199], a[4:7], a[52:55], v[196:199]
    buffer_load_dwordx4 v4, s[52:55], s62 offen offset:1024 lds
    v_mfma_f32_16x16x32_bf16 v[200:203], a[8:11], a[52:55], v[200:203]
    ds_read_b128 a[124:127], v6 offset:39936
    v_mfma_f32_16x16x32_bf16 v[204:207], a[12:15], a[52:55], v[204:207]
    v_mfma_f32_16x16x32_bf16 v[208:211], a[16:19], a[52:55], v[208:211]
    ds_read_b64_tr_b16 a[92:93], v15 offset:34816
    v_mfma_f32_16x16x32_bf16 v[212:215], a[20:23], a[52:55], v[212:215]
    v_mfma_f32_16x16x32_bf16 v[216:219], a[24:27], a[52:55], v[216:219]
    ds_read_b64_tr_b16 a[94:95], v15 offset:43008
    v_mfma_f32_16x16x32_bf16 v[220:223], a[28:31], a[52:55], v[220:223]
    v_mfma_f32_16x16x32_bf16 v[224:227], a[0:3], a[56:59], v[224:227]
    buffer_load_dwordx4 v4, s[56:59], s61 offen offset:2048 lds
    v_mfma_f32_16x16x32_bf16 v[228:231], a[4:7], a[56:59], v[228:231]
    s_add_u32 s61, s61, 229376
    v_mfma_f32_16x16x32_bf16 v[232:235], a[8:11], a[56:59], v[232:235]
    v_mfma_f32_16x16x32_bf16 v[236:239], a[12:15], a[56:59], v[236:239]
    v_mfma_f32_16x16x32_bf16 v[240:243], a[16:19], a[56:59], v[240:243]
    v_mfma_f32_16x16x32_bf16 v[244:247], a[20:23], a[56:59], v[244:247]
    v_mfma_f32_16x16x32_bf16 v[248:251], a[24:27], a[56:59], v[248:251]
    v_mfma_f32_16x16x32_bf16 v[252:255], a[28:31], a[56:59], v[252:255]
    buffer_load_dwordx4 v4, s[56:59], s62 offen offset:3072 lds
    v_mfma_f32_16x16x32_bf16 a[128:131], a[0:3], a[60:63], a[128:131]
    s_add_u32 s62, s62, 229376
    v_mfma_f32_16x16x32_bf16 a[132:135], a[4:7], a[60:63], a[132:135]
    v_mfma_f32_16x16x32_bf16 a[136:139], a[8:11], a[60:63], a[136:139]
    v_mfma_f32_16x16x32_bf16 a[140:143], a[12:15], a[60:63], a[140:143]
    v_mfma_f32_16x16x32_bf16 a[144:147], a[16:19], a[60:63], a[144:147]
    v_mfma_f32_16x16x32_bf16 a[148:151], a[20:23], a[60:63], a[148:151]
    v_mfma_f32_16x16x32_bf16 a[152:155], a[24:27], a[60:63], a[152:155]
    v_mfma_f32_16x16x32_bf16 a[156:159], a[28:31], a[60:63], a[156:159]
    s_waitcnt vmcnt(16) lgkmcnt(0)
    s_barrier
    v_mfma_f32_16x16x32_bf16 v[32:35], a[64:67], a[96:99], v[32:35]
    ds_read_b128 a[32:35], v5 offset:0
    v_mfma_f32_16x16x32_bf16 v[36:39], a[68:71], a[96:99], v[36:39]
    s_add_u32 m0, s64, 0x18000
    v_mfma_f32_16x16x32_bf16 v[40:43], a[72:75], a[96:99], v[40:43]
    ds_read_b64_tr_b16 a[0:1], v8 offset:0
    v_mfma_f32_16x16x32_bf16 v[44:47], a[76:79], a[96:99], v[44:47]
    buffer_load_dwordx4 v3, s[48:51], s60 offen sc1 lds
    v_mfma_f32_16x16x32_bf16 v[48:51], a[80:83], a[96:99], v[48:51]
    ds_read_b64_tr_b16 a[2:3], v8 offset:8192
    v_mfma_f32_16x16x32_bf16 v[52:55], a[84:87], a[96:99], v[52:55]
    v_mfma_f32_16x16x32_bf16 v[56:59], a[88:91], a[96:99], v[56:59]
    ds_read_b128 a[36:39], v5 offset:1024
    v_mfma_f32_16x16x32_bf16 v[60:63], a[92:95], a[96:99], v[60:63]
    v_mfma_f32_16x16x32_bf16 v[64:67], a[64:67], a[100:103], v[64:67]
    ds_read_b64_tr_b16 a[4:5], v9 offset:0
    v_mfma_f32_16x16x32_bf16 v[68:71], a[68:71], a[100:103], v[68:71]
    buffer_load_dwordx4 v3, s[48:51], s60 offen offset:1024 sc1 lds
    v_mfma_f32_16x16x32_bf16 v[72:75], a[72:75], a[100:103], v[72:75]
    ds_read_b64_tr_b16 a[6:7], v9 offset:8192
    v_mfma_f32_16x16x32_bf16 v[76:79], a[76:79], a[100:103], v[76:79]
    v_mfma_f32_16x16x32_bf16 v[80:83], a[80:83], a[100:103], v[80:83]
    ds_read_b128 a[40:43], v5 offset:2048
    v_mfma_f32_16x16x32_bf16 v[84:87], a[84:87], a[100:103], v[84:87]
    buffer_load_dwordx4 v3, s[48:51], s60 offen offset:2048 sc1 lds
    v_mfma_f32_16x16x32_bf16 v[88:91], a[88:91], a[100:103], v[88:91]
    ds_read_b64_tr_b16 a[8:9], v10 offset:0
    v_mfma_f32_16x16x32_bf16 v[92:95], a[92:95], a[100:103], v[92:95]
    v_mfma_f32_16x16x32_bf16 v[96:99], a[64:67], a[104:107], v[96:99]
    ds_read_b64_tr_b16 a[10:11], v10 offset:8192
    v_mfma_f32_16x16x32_bf16 v[100:103], a[68:71], a[104:107], v[100:103]
    v_mfma_f32_16x16x32_bf16 v[104:107], a[72:75], a[104:107], v[104:107]
    ds_read_b128 a[44:47], v5 offset:3072
    v_mfma_f32_16x16x32_bf16 v[108:111], a[76:79], a[104:107], v[108:111]
    buffer_load_dwordx4 v3, s[48:51], s60 offen offset:3072 sc1 lds
    v_mfma_f32_16x16x32_bf16 v[112:115], a[80:83], a[104:107], v[112:115]
    ds_read_b64_tr_b16 a[12:13], v11 offset:0
    v_mfma_f32_16x16x32_bf16 v[116:119], a[84:87], a[104:107], v[116:119]
    s_add_u32 s60, s60, 0x4000
    v_mfma_f32_16x16x32_bf16 v[120:123], a[88:91], a[104:107], v[120:123]
    ds_read_b64_tr_b16 a[14:15], v11 offset:8192
    v_mfma_f32_16x16x32_bf16 v[124:127], a[92:95], a[104:107], v[124:127]
    s_add_u32 m0, s65, 0x18000
    v_mfma_f32_16x16x32_bf16 v[128:131], a[64:67], a[108:111], v[128:131]
    ds_read_b128 a[48:51], v5 offset:4096
    v_mfma_f32_16x16x32_bf16 v[132:135], a[68:71], a[108:111], v[132:135]
    buffer_load_dwordx4 v4, s[52:55], s61 offen lds
    v_mfma_f32_16x16x32_bf16 v[136:139], a[72:75], a[108:111], v[136:139]
    ds_read_b64_tr_b16 a[16:17], v8 offset:2048
    v_mfma_f32_16x16x32_bf16 v[140:143], a[76:79], a[108:111], v[140:143]
    v_mfma_f32_16x16x32_bf16 v[144:147], a[80:83], a[108:111], v[144:147]
    ds_read_b64_tr_b16 a[18:19], v8 offset:10240
    v_mfma_f32_16x16x32_bf16 v[148:151], a[84:87], a[108:111], v[148:151]
    buffer_load_dwordx4 v4, s[52:55], s62 offen offset:1024 lds
    v_mfma_f32_16x16x32_bf16 v[152:155], a[88:91], a[108:111], v[152:155]
    ds_read_b128 a[52:55], v5 offset:5120
    v_mfma_f32_16x16x32_bf16 v[156:159], a[92:95], a[108:111], v[156:159]
    v_mfma_f32_16x16x32_bf16 v[160:163], a[64:67], a[112:115], v[160:163]
    ds_read_b64_tr_b16 a[20:21], v9 offset:2048
    v_mfma_f32_16x16x32_bf16 v[164:167], a[68:71], a[112:115], v[164:167]
    buffer_load_dwordx4 v4, s[56:59], s61 offen offset:2048 lds
    v_mfma_f32_16x16x32_bf16 v[168:171], a[72:75], a[112:115], v[168:171]
    ds_read_b64_tr_b16 a[22:23], v9 offset:10240
    v_mfma_f32_16x16x32_bf16 v[172:175], a[76:79], a[112:115], v[172:175]
    s_add_u32 s61, s61, 229376
    v_mfma_f32_16x16x32_bf16 v[176:179], a[80:83], a[112:115], v[176:179]
    ds_read_b128 a[56:59], v5 offset:6144
    v_mfma_f32_16x16x32_bf16 v[180:183], a[84:87], a[112:115], v[180:183]
    v_mfma_f32_16x16x32_bf16 v[184:187], a[88:91], a[112:115], v[184:187]
    ds_read_b64_tr_b16 a[24:25], v10 offset:2048
    v_mfma_f32_16x16x32_bf16 v[188:191], a[92:95], a[112:115], v[188:191]
    buffer_load_dwordx4 v4, s[56:59], s62 offen offset:3072 lds
    v_mfma_f32_16x16x32_bf16 v[192:195], a[64:67], a[116:119], v[192:195]
    ds_read_b64_tr_b16 a[26:27], v10 offset:10240
    v_mfma_f32_16x16x32_bf16 v[196:199], a[68:71], a[116:119], v[196:199]
    s_add_u32 s62, s62, 229376
    v_mfma_f32_16x16x32_bf16 v[200:203], a[72:75], a[116:119], v[200:203]
    ds_read_b128 a[60:63], v5 offset:7168
    v_mfma_f32_16x16x32_bf16 v[204:207], a[76:79], a[116:119], v[204:207]
    buffer_load_dword v16, v17, s[36:39], s69 offen
    v_mfma_f32_16x16x32_bf16 v[208:211], a[80:83], a[116:119], v[208:211]
    ds_read_b64_tr_b16 a[28:29], v11 offset:2048
    v_mfma_f32_16x16x32_bf16 v[212:215], a[84:87], a[116:119], v[212:215]
    s_add_u32 s69, s69, 917504
    v_mfma_f32_16x16x32_bf16 v[216:219], a[88:91], a[116:119], v[216:219]
    ds_read_b64_tr_b16 a[30:31], v11 offset:10240
    v_mfma_f32_16x16x32_bf16 v[220:223], a[92:95], a[116:119], v[220:223]
    v_mfma_f32_16x16x32_bf16 v[224:227], a[64:67], a[120:123], v[224:227]
    buffer_load_dword v18, v20, s[32:35], s10 offen
    v_mfma_f32_16x16x32_bf16 v[228:231], a[68:71], a[120:123], v[228:231]
    s_add_u32 s10, s10, 5120
    v_mfma_f32_16x16x32_bf16 v[232:235], a[72:75], a[120:123], v[232:235]
    s_cmp_ge_u32 s63, s44
    v_mfma_f32_16x16x32_bf16 v[236:239], a[76:79], a[120:123], v[236:239]
    s_cselect_b32 s14, 0, s14
    v_mfma_f32_16x16x32_bf16 v[240:243], a[80:83], a[120:123], v[240:243]
    s_cselect_b32 s11, 0x24400, s11
    v_mfma_f32_16x16x32_bf16 v[244:247], a[84:87], a[120:123], v[244:247]
    s_mov_b32 m0, s11
    v_mfma_f32_16x16x32_bf16 v[248:251], a[88:91], a[120:123], v[248:251]
    s_add_u32 s11, s11, 1024
    v_mfma_f32_16x16x32_bf16 v[252:255], a[92:95], a[120:123], v[252:255]
    buffer_load_dwordx4 v21, s[12:15], s63 offen lds
    v_mfma_f32_16x16x32_bf16 a[128:131], a[64:67], a[124:127], a[128:131]
    s_add_u32 s63, s63, 2048
    v_mfma_f32_16x16x32_bf16 a[132:135], a[68:71], a[124:127], a[132:135]
    v_mfma_f32_16x16x32_bf16 a[136:139], a[72:75], a[124:127], a[136:139]
    buffer_load_dword v19, v23, s[4:7], s71 offen
    v_mfma_f32_16x16x32_bf16 a[140:143], a[76:79], a[124:127], a[140:143]
    s_sub_u32 s45, s45, 1
    v_mfma_f32_16x16x32_bf16 a[144:147], a[80:83], a[124:127], a[144:147]
    s_cmp_lg_u32 s45, 0
    v_mfma_f32_16x16x32_bf16 a[148:151], a[84:87], a[124:127], a[148:151]
    v_mfma_f32_16x16x32_bf16 a[152:155], a[88:91], a[124:127], a[152:155]
    v_mfma_f32_16x16x32_bf16 a[156:159], a[92:95], a[124:127], a[156:159]
    s_waitcnt vmcnt(20) lgkmcnt(0)
    s_barrier
    s_cbranch_scc1 g1_loop
g1_npf:
    v_mfma_f32_16x16x32_bf16 v[32:35], a[0:3], a[32:35], v[32:35]
    ds_read_b128 a[96:99], v5 offset:32768
    v_mfma_f32_16x16x32_bf16 v[36:39], a[4:7], a[32:35], v[36:39]
    s_add_u32 s36, s22, 0x1500000
    s_addc_u32 s37, s23, 0
    v_mfma_f32_16x16x32_bf16 v[40:43], a[8:11], a[32:35], v[40:43]
    ds_read_b64_tr_b16 a[64:65], v8 offset:32768
    v_mfma_f32_16x16x32_bf16 v[44:47], a[12:15], a[32:35], v[44:47]
    s_and_b32 s37, s37, 0xffff
    s_mov_b32 s38, 0xe00000
    v_mfma_f32_16x16x32_bf16 v[48:51], a[16:19], a[32:35], v[48:51]
    ds_read_b64_tr_b16 a[66:67], v8 offset:40960
    v_mfma_f32_16x16x32_bf16 v[52:55], a[20:23], a[32:35], v[52:55]
    s_mov_b32 s39, 0x20000
    s_bfe_u32 s40, s2, 0x20001
    v_mfma_f32_16x16x32_bf16 v[56:59], a[24:27], a[32:35], v[56:59]
    ds_read_b128 a[100:103], v5 offset:33792
    v_mfma_f32_16x16x32_bf16 v[60:63], a[28:31], a[32:35], v[60:63]
    s_lshl_b32 s41, s42, 2
    s_add_u32 s41, s41, s40
    v_mfma_f32_16x16x32_bf16 v[64:67], a[0:3], a[36:39], v[64:67]
    ds_read_b64_tr_b16 a[68:69], v9 offset:32768
    v_mfma_f32_16x16x32_bf16 v[68:71], a[4:7], a[36:39], v[68:71]
    s_mul_i32 s40, s40, 7
    v_mfma_f32_16x16x32_bf16 v[72:75], a[8:11], a[36:39], v[72:75]
    ds_read_b64_tr_b16 a[70:71], v9 offset:40960
    v_mfma_f32_16x16x32_bf16 v[76:79], a[12:15], a[36:39], v[76:79]
    s_sub_u32 s40, s43, s40
    s_lshl_b32 s55, s41, 3
    v_mfma_f32_16x16x32_bf16 v[80:83], a[16:19], a[36:39], v[80:83]
    ds_read_b128 a[104:107], v5 offset:34816
    v_mfma_f32_16x16x32_bf16 v[84:87], a[20:23], a[36:39], v[84:87]
    s_add_u32 s55, s55, s40
    s_lshl_b32 s55, s55, 7
    v_mfma_f32_16x16x32_bf16 v[88:91], a[24:27], a[36:39], v[88:91]
    ds_read_b64_tr_b16 a[72:73], v10 offset:32768
    v_mfma_f32_16x16x32_bf16 v[92:95], a[28:31], a[36:39], v[92:95]
    s_add_u32 s55, s55, 98304
    s_lshl_b32 s40, s40, 1
    v_mfma_f32_16x16x32_bf16 v[96:99], a[0:3], a[40:43], v[96:99]
    ds_read_b64_tr_b16 a[74:75], v10 offset:40960
    v_mfma_f32_16x16x32_bf16 v[100:103], a[4:7], a[40:43], v[100:103]
    s_add_u32 s40, s40, s46
    s_mul_i32 s52, s41, 28
    v_mfma_f32_16x16x32_bf16 v[104:107], a[8:11], a[40:43], v[104:107]
    ds_read_b128 a[108:111], v5 offset:35840
    v_mfma_f32_16x16x32_bf16 v[108:111], a[12:15], a[40:43], v[108:111]
    s_add_u32 s52, s52, s40
    v_mfma_f32_16x16x32_bf16 v[112:115], a[16:19], a[40:43], v[112:115]
    ds_read_b64_tr_b16 a[76:77], v11 offset:32768
    v_mfma_f32_16x16x32_bf16 v[116:119], a[20:23], a[40:43], v[116:119]
    s_lshl_b32 s52, s52, 14
    s_lshl_b32 s53, s47, 13
    v_mfma_f32_16x16x32_bf16 v[120:123], a[24:27], a[40:43], v[120:123]
    ds_read_b64_tr_b16 a[78:79], v11 offset:40960
    v_mfma_f32_16x16x32_bf16 v[124:127], a[28:31], a[40:43], v[124:127]
    s_add_u32 s52, s52, s53
    s_lshl_b32 s54, s41, 1
    v_mfma_f32_16x16x32_bf16 v[128:131], a[0:3], a[44:47], v[128:131]
    ds_read_b128 a[112:115], v5 offset:36864
    v_mfma_f32_16x16x32_bf16 v[132:135], a[4:7], a[44:47], v[132:135]
    s_add_u32 s54, s54, s47
    s_lshl_b32 s54, s54, 4
    v_mfma_f32_16x16x32_bf16 v[136:139], a[8:11], a[44:47], v[136:139]
    ds_read_b64_tr_b16 a[80:81], v8 offset:34816
    v_mfma_f32_16x16x32_bf16 v[140:143], a[12:15], a[44:47], v[140:143]
    s_add_u32 s54, s54, s40
    s_lshl_b32 s54, s54, 7
    v_mfma_f32_16x16x32_bf16 v[144:147], a[16:19], a[44:47], v[144:147]
    ds_read_b64_tr_b16 a[82:83], v8 offset:43008
    v_mfma_f32_16x16x32_bf16 v[148:151], a[20:23], a[44:47], v[148:151]
    s_add_u32 s54, s54, 262144
    v_mfma_f32_16x16x32_bf16 v[152:155], a[24:27], a[44:47], v[152:155]
    ds_read_b128 a[116:119], v5 offset:37888
    v_mfma_f32_16x16x32_bf16 v[156:159], a[28:31], a[44:47], v[156:159]
    s_mov_b32 s46, 65536
    s_bfe_u32 s44, s2, 0x20001
    v_mfma_f32_16x16x32_bf16 v[160:163], a[0:3], a[48:51], v[160:163]
    ds_read_b64_tr_b16 a[84:85], v9 offset:34816
    v_mfma_f32_16x16x32_bf16 v[164:167], a[4:7], a[48:51], v[164:167]
    s_and_b32 s42, s2, 1
    s_lshl_b32 s42, s42, 2
    v_mfma_f32_16x16x32_bf16 v[168:171], a[8:11], a[48:51], v[168:171]
    ds_read_b64_tr_b16 a[86:87], v9 offset:43008
    v_mfma_f32_16x16x32_bf16 v[172:175], a[12:15], a[48:51], v[172:175]
    s_bfe_u32 s43, s2, 0x20003
    s_add_u32 s42, s42, s43
    v_mfma_f32_16x16x32_bf16 v[176:179], a[16:19], a[48:51], v[176:179]
    ds_read_b128 a[120:123], v5 offset:38912
    v_mfma_f32_16x16x32_bf16 v[180:183], a[20:23], a[48:51], v[180:183]
    s_lshr_b32 s43, s2, 5
    v_lshrrev_b32 v22, 4, v1
    v_mfma_f32_16x16x32_bf16 v[184:187], a[24:27], a[48:51], v[184:187]
    ds_read_b64_tr_b16 a[88:89], v10 offset:34816
    v_mfma_f32_16x16x32_bf16 v[188:191], a[28:31], a[48:51], v[188:191]
    v_lshlrev_b32 v31, 11, v22
    v_mfma_f32_16x16x32_bf16 v[192:195], a[0:3], a[52:55], v[192:195]
    ds_read_b64_tr_b16 a[90:91], v10 offset:43008
    v_mfma_f32_16x16x32_bf16 v[196:199], a[4:7], a[52:55], v[196:199]
    v_lshlrev_b32 v22, 1, v22
    v_and_b32 v24, 15, v1
    v_mfma_f32_16x16x32_bf16 v[200:203], a[8:11], a[52:55], v[200:203]
    ds_read_b128 a[124:127], v5 offset:39936
    v_mfma_f32_16x16x32_bf16 v[204:207], a[12:15], a[52:55], v[204:207]
    v_xor_b32 v22, v22, v24
    v_lshl_add_u32 v24, v22, 4, v31
    v_mfma_f32_16x16x32_bf16 v[208:211], a[16:19], a[52:55], v[208:211]
    ds_read_b64_tr_b16 a[92:93], v11 offset:34816
    v_mfma_f32_16x16x32_bf16 v[212:215], a[20:23], a[52:55], v[212:215]
    v_xor_b32 v25, 0x80, v24
    v_add_u32 v26, 0x3800, v24
    v_mfma_f32_16x16x32_bf16 v[216:219], a[24:27], a[52:55], v[216:219]
    ds_read_b64_tr_b16 a[94:95], v11 offset:43008
    v_mfma_f32_16x16x32_bf16 v[220:223], a[28:31], a[52:55], v[220:223]
    v_add_u32 v27, 0x5400, v25
    v_add_u32 v25, 0x1c00, v25
    v_mfma_f32_16x16x32_bf16 v[224:227], a[0:3], a[56:59], v[224:227]
    s_add_u32 s48, s16, 0x0
    v_mfma_f32_16x16x32_bf16 v[228:231], a[4:7], a[56:59], v[228:231]
    s_addc_u32 s49, s17, 0
    s_and_b32 s49, s49, 0xffff
    v_mfma_f32_16x16x32_bf16 v[232:235], a[8:11], a[56:59], v[232:235]
    s_mov_b32 s50, 0x700000
    s_mov_b32 s51, 0x20000
    v_mfma_f32_16x16x32_bf16 v[236:239], a[12:15], a[56:59], v[236:239]
    s_mul_i32 s45, s44, 1835008
    s_lshl_b32 s61, s43, 8
    v_mfma_f32_16x16x32_bf16 v[240:243], a[16:19], a[56:59], v[240:243]
    s_add_u32 s61, s61, s45
    s_add_u32 s62, s61, 1835008
    v_mfma_f32_16x16x32_bf16 v[244:247], a[20:23], a[56:59], v[244:247]
    s_lshl_b32 s45, s3, 17
    v_mfma_f32_16x16x32_bf16 v[248:251], a[24:27], a[56:59], v[248:251]
    s_add_u32 s61, s61, s45
    s_lshl_b32 s64, s3, 13
    v_mfma_f32_16x16x32_bf16 v[252:255], a[28:31], a[56:59], v[252:255]
    s_add_u32 m0, s64, 0x0
    s_nop 0
    buffer_load_dwordx4 v24, s[48:51], s61 offen lds
    v_mfma_f32_16x16x32_bf16 a[128:131], a[0:3], a[60:63], a[128:131]
    buffer_load_dwordx4 v25, s[48:51], s61 offen offset:1024 lds
    buffer_load_dwordx4 v26, s[48:51], s61 offen offset:2048 lds
    v_mfma_f32_16x16x32_bf16 a[132:135], a[4:7], a[60:63], a[132:135]
    buffer_load_dwordx4 v27, s[48:51], s61 offen offset:3072 lds
    s_add_u32 s61, s61, 0x8000
    v_mfma_f32_16x16x32_bf16 a[136:139], a[8:11], a[60:63], a[136:139]
    s_add_u32 m0, s64, 0x1000
    v_mfma_f32_16x16x32_bf16 a[140:143], a[12:15], a[60:63], a[140:143]
    buffer_load_dwordx4 v24, s[48:51], s61 offen lds
    buffer_load_dwordx4 v25, s[48:51], s61 offen offset:1024 lds
    v_mfma_f32_16x16x32_bf16 a[144:147], a[16:19], a[60:63], a[144:147]
    buffer_load_dwordx4 v26, s[48:51], s61 offen offset:2048 lds
    buffer_load_dwordx4 v27, s[48:51], s61 offen offset:3072 lds
    v_mfma_f32_16x16x32_bf16 a[148:151], a[20:23], a[60:63], a[148:151]
    s_add_u32 s61, s61, 0x78000
    s_cmp_ge_u32 s61, s62
    v_mfma_f32_16x16x32_bf16 a[152:155], a[24:27], a[60:63], a[152:155]
    s_cselect_b32 s65, 1769472, 0
    s_cselect_b32 s62, -1, s62
    v_mfma_f32_16x16x32_bf16 a[156:159], a[28:31], a[60:63], a[156:159]
    s_sub_u32 s61, s61, s65
    s_waitcnt vmcnt(16) lgkmcnt(0)
    s_barrier
    v_mfma_f32_16x16x32_bf16 v[32:35], a[64:67], a[96:99], v[32:35]
    ds_read_b128 a[32:35], v6 offset:0
    v_mfma_f32_16x16x32_bf16 v[36:39], a[68:71], a[96:99], v[36:39]
    v_lshl_add_u32 v21, v2, 12, v3
    v_mfma_f32_16x16x32_bf16 v[40:43], a[72:75], a[96:99], v[40:43]
    ds_read_b64_tr_b16 a[0:1], v12 offset:0
    v_mfma_f32_16x16x32_bf16 v[44:47], a[76:79], a[96:99], v[44:47]
    v_add_u32 v21, 0x20000, v21
    v_mfma_f32_16x16x32_bf16 v[48:51], a[80:83], a[96:99], v[48:51]
    ds_read_b64_tr_b16 a[2:3], v12 offset:8192
    v_mfma_f32_16x16x32_bf16 v[52:55], a[84:87], a[96:99], v[52:55]
    ds_read_b128 a[240:243], v21 offset:0
    v_mfma_f32_16x16x32_bf16 v[56:59], a[88:91], a[96:99], v[56:59]
    ds_read_b128 a[36:39], v6 offset:1024
    v_mfma_f32_16x16x32_bf16 v[60:63], a[92:95], a[96:99], v[60:63]
    ds_read_b128 a[244:247], v21 offset:1024
    v_mfma_f32_16x16x32_bf16 v[64:67], a[64:67], a[100:103], v[64:67]
    ds_read_b64_tr_b16 a[4:5], v13 offset:0
    v_mfma_f32_16x16x32_bf16 v[68:71], a[68:71], a[100:103], v[68:71]
    ds_read_b128 a[248:251], v21 offset:2048
    v_mfma_f32_16x16x32_bf16 v[72:75], a[72:75], a[100:103], v[72:75]
    ds_read_b64_tr_b16 a[6:7], v13 offset:8192
    v_mfma_f32_16x16x32_bf16 v[76:79], a[76:79], a[100:103], v[76:79]
    ds_read_b128 a[252:255], v21 offset:3072
    v_mfma_f32_16x16x32_bf16 v[80:83], a[80:83], a[100:103], v[80:83]
    ds_read_b128 a[40:43], v6 offset:2048
    v_mfma_f32_16x16x32_bf16 v[84:87], a[84:87], a[100:103], v[84:87]
    s_add_u32 m0, s64, 0x8000
    v_mfma_f32_16x16x32_bf16 v[88:91], a[88:91], a[100:103], v[88:91]
    ds_read_b64_tr_b16 a[8:9], v14 offset:0
    v_mfma_f32_16x16x32_bf16 v[92:95], a[92:95], a[100:103], v[92:95]
    buffer_load_dwordx4 v24, s[48:51], s61 offen lds
    v_mfma_f32_16x16x32_bf16 v[96:99], a[64:67], a[104:107], v[96:99]
    ds_read_b64_tr_b16 a[10:11], v14 offset:8192
    v_mfma_f32_16x16x32_bf16 v[100:103], a[68:71], a[104:107], v[100:103]
    buffer_load_dwordx4 v25, s[48:51], s61 offen offset:1024 lds
    v_mfma_f32_16x16x32_bf16 v[104:107], a[72:75], a[104:107], v[104:107]
    ds_read_b128 a[44:47], v6 offset:3072
    v_mfma_f32_16x16x32_bf16 v[108:111], a[76:79], a[104:107], v[108:111]
    buffer_load_dwordx4 v26, s[48:51], s61 offen offset:2048 lds
    v_mfma_f32_16x16x32_bf16 v[112:115], a[80:83], a[104:107], v[112:115]
    ds_read_b64_tr_b16 a[12:13], v15 offset:0
    v_mfma_f32_16x16x32_bf16 v[116:119], a[84:87], a[104:107], v[116:119]
    v_mfma_f32_16x16x32_bf16 v[120:123], a[88:91], a[104:107], v[120:123]
    ds_read_b64_tr_b16 a[14:15], v15 offset:8192
    v_mfma_f32_16x16x32_bf16 v[124:127], a[92:95], a[104:107], v[124:127]
    v_mfma_f32_16x16x32_bf16 v[128:131], a[64:67], a[108:111], v[128:131]
    ds_read_b128 a[48:51], v6 offset:4096
    v_mfma_f32_16x16x32_bf16 v[132:135], a[68:71], a[108:111], v[132:135]
    buffer_load_dwordx4 v27, s[48:51], s61 offen offset:3072 lds
    v_mfma_f32_16x16x32_bf16 v[136:139], a[72:75], a[108:111], v[136:139]
    ds_read_b64_tr_b16 a[16:17], v12 offset:2048
    v_mfma_f32_16x16x32_bf16 v[140:143], a[76:79], a[108:111], v[140:143]
    s_add_u32 s61, s61, 0x8000
    v_mfma_f32_16x16x32_bf16 v[144:147], a[80:83], a[108:111], v[144:147]
    ds_read_b64_tr_b16 a[18:19], v12 offset:10240
    v_mfma_f32_16x16x32_bf16 v[148:151], a[84:87], a[108:111], v[148:151]
    v_mfma_f32_16x16x32_bf16 v[152:155], a[88:91], a[108:111], v[152:155]
    ds_read_b128 a[52:55], v6 offset:5120
    v_mfma_f32_16x16x32_bf16 v[156:159], a[92:95], a[108:111], v[156:159]
    s_add_u32 m0, s64, 0x9000
    v_mfma_f32_16x16x32_bf16 v[160:163], a[64:67], a[112:115], v[160:163]
    ds_read_b64_tr_b16 a[20:21], v13 offset:2048
    v_mfma_f32_16x16x32_bf16 v[164:167], a[68:71], a[112:115], v[164:167]
    buffer_load_dwordx4 v24, s[48:51], s61 offen lds
    v_mfma_f32_16x16x32_bf16 v[168:171], a[72:75], a[112:115], v[168:171]
    ds_read_b64_tr_b16 a[22:23], v13 offset:10240
    v_mfma_f32_16x16x32_bf16 v[172:175], a[76:79], a[112:115], v[172:175]
    v_mfma_f32_16x16x32_bf16 v[176:179], a[80:83], a[112:115], v[176:179]
    ds_read_b128 a[56:59], v6 offset:6144
    v_mfma_f32_16x16x32_bf16 v[180:183], a[84:87], a[112:115], v[180:183]
    v_mfma_f32_16x16x32_bf16 v[184:187], a[88:91], a[112:115], v[184:187]
    ds_read_b64_tr_b16 a[24:25], v14 offset:2048
    v_mfma_f32_16x16x32_bf16 v[188:191], a[92:95], a[112:115], v[188:191]
    v_mfma_f32_16x16x32_bf16 v[192:195], a[64:67], a[116:119], v[192:195]
    ds_read_b64_tr_b16 a[26:27], v14 offset:10240
    v_mfma_f32_16x16x32_bf16 v[196:199], a[68:71], a[116:119], v[196:199]
    buffer_load_dwordx4 v25, s[48:51], s61 offen offset:1024 lds
    v_mfma_f32_16x16x32_bf16 v[200:203], a[72:75], a[116:119], v[200:203]
    ds_read_b128 a[60:63], v6 offset:7168
    v_mfma_f32_16x16x32_bf16 v[204:207], a[76:79], a[116:119], v[204:207]
    v_mfma_f32_16x16x32_bf16 v[208:211], a[80:83], a[116:119], v[208:211]
    ds_read_b64_tr_b16 a[28:29], v15 offset:2048
    v_mfma_f32_16x16x32_bf16 v[212:215], a[84:87], a[116:119], v[212:215]
    v_mfma_f32_16x16x32_bf16 v[216:219], a[88:91], a[116:119], v[216:219]
    ds_read_b64_tr_b16 a[30:31], v15 offset:10240
    v_mfma_f32_16x16x32_bf16 v[220:223], a[92:95], a[116:119], v[220:223]
    v_mfma_f32_16x16x32_bf16 v[224:227], a[64:67], a[120:123], v[224:227]
    buffer_load_dwordx4 v26, s[48:51], s61 offen offset:2048 lds
    v_mfma_f32_16x16x32_bf16 v[228:231], a[68:71], a[120:123], v[228:231]
    v_mfma_f32_16x16x32_bf16 v[232:235], a[72:75], a[120:123], v[232:235]
    v_mfma_f32_16x16x32_bf16 v[236:239], a[76:79], a[120:123], v[236:239]
    v_mfma_f32_16x16x32_bf16 v[240:243], a[80:83], a[120:123], v[240:243]
    v_mfma_f32_16x16x32_bf16 v[244:247], a[84:87], a[120:123], v[244:247]
    v_mfma_f32_16x16x32_bf16 v[248:251], a[88:91], a[120:123], v[248:251]
    v_mfma_f32_16x16x32_bf16 v[252:255], a[92:95], a[120:123], v[252:255]
    buffer_load_dwordx4 v27, s[48:51], s61 offen offset:3072 lds
    v_mfma_f32_16x16x32_bf16 a[128:131], a[64:67], a[124:127], a[128:131]
    s_add_u32 s61, s61, 0x78000
    v_mfma_f32_16x16x32_bf16 a[132:135], a[68:71], a[124:127], a[132:135]
    s_cmp_ge_u32 s61, s62
    v_mfma_f32_16x16x32_bf16 a[136:139], a[72:75], a[124:127], a[136:139]
    s_cselect_b32 s65, 1769472, 0
    v_mfma_f32_16x16x32_bf16 a[140:143], a[76:79], a[124:127], a[140:143]
    s_cselect_b32 s62, -1, s62
    v_mfma_f32_16x16x32_bf16 a[144:147], a[80:83], a[124:127], a[144:147]
    s_sub_u32 s61, s61, s65
    v_mfma_f32_16x16x32_bf16 a[148:151], a[84:87], a[124:127], a[148:151]
    s_xor_b32 s64, s64, 0x10000
    v_mfma_f32_16x16x32_bf16 a[152:155], a[88:91], a[124:127], a[152:155]
    v_mfma_f32_16x16x32_bf16 a[156:159], a[92:95], a[124:127], a[156:159]
    s_waitcnt vmcnt(16) lgkmcnt(0)
    s_barrier
    v_mfma_f32_16x16x32_bf16 v[32:35], a[0:3], a[32:35], v[32:35]
    ds_read_b128 a[96:99], v6 offset:32768
    v_mfma_f32_16x16x32_bf16 v[36:39], a[4:7], a[32:35], v[36:39]
    s_add_u32 m0, s64, 0x0
    v_mfma_f32_16x16x32_bf16 v[40:43], a[8:11], a[32:35], v[40:43]
    ds_read_b64_tr_b16 a[64:65], v12 offset:32768
    v_mfma_f32_16x16x32_bf16 v[44:47], a[12:15], a[32:35], v[44:47]
    buffer_load_dwordx4 v24, s[48:51], s61 offen lds
    v_mfma_f32_16x16x32_bf16 v[48:51], a[16:19], a[32:35], v[48:51]
    ds_read_b64_tr_b16 a[66:67], v12 offset:40960
    v_mfma_f32_16x16x32_bf16 v[52:55], a[20:23], a[32:35], v[52:55]
    v_mfma_f32_16x16x32_bf16 v[56:59], a[24:27], a[32:35], v[56:59]
    ds_read_b128 a[100:103], v6 offset:33792
    v_mfma_f32_16x16x32_bf16 v[60:63], a[28:31], a[32:35], v[60:63]
    v_mfma_f32_16x16x32_bf16 v[64:67], a[0:3], a[36:39], v[64:67]
    ds_read_b64_tr_b16 a[68:69], v13 offset:32768
    v_mfma_f32_16x16x32_bf16 v[68:71], a[4:7], a[36:39], v[68:71]
    v_mfma_f32_16x16x32_bf16 v[72:75], a[8:11], a[36:39], v[72:75]
    ds_read_b64_tr_b16 a[70:71], v13 offset:40960
    v_mfma_f32_16x16x32_bf16 v[76:79], a[12:15], a[36:39], v[76:79]
    v_mfma_f32_16x16x32_bf16 v[80:83], a[16:19], a[36:39], v[80:83]
    ds_read_b128 a[104:107], v6 offset:34816
    v_mfma_f32_16x16x32_bf16 v[84:87], a[20:23], a[36:39], v[84:87]
    v_mfma_f32_16x16x32_bf16 v[88:91], a[24:27], a[36:39], v[88:91]
    ds_read_b64_tr_b16 a[72:73], v14 offset:32768
    v_mfma_f32_16x16x32_bf16 v[92:95], a[28:31], a[36:39], v[92:95]
    v_mfma_f32_16x16x32_bf16 v[96:99], a[0:3], a[40:43], v[96:99]
    ds_read_b64_tr_b16 a[74:75], v14 offset:40960
    v_mfma_f32_16x16x32_bf16 v[100:103], a[4:7], a[40:43], v[100:103]
    v_mfma_f32_16x16x32_bf16 v[104:107], a[8:11], a[40:43], v[104:107]
    ds_read_b128 a[108:111], v6 offset:35840
    v_mfma_f32_16x16x32_bf16 v[108:111], a[12:15], a[40:43], v[108:111]
    buffer_load_dwordx4 v25, s[48:51], s61 offen offset:1024 lds
    v_mfma_f32_16x16x32_bf16 v[112:115], a[16:19], a[40:43], v[112:115]
    ds_read_b64_tr_b16 a[76:77], v15 offset:32768
    v_mfma_f32_16x16x32_bf16 v[116:119], a[20:23], a[40:43], v[116:119]
    v_mfma_f32_16x16x32_bf16 v[120:123], a[24:27], a[40:43], v[120:123]
    ds_read_b64_tr_b16 a[78:79], v15 offset:40960
    v_mfma_f32_16x16x32_bf16 v[124:127], a[28:31], a[40:43], v[124:127]
    v_mfma_f32_16x16x32_bf16 v[128:131], a[0:3], a[44:47], v[128:131]
    ds_read_b128 a[112:115], v6 offset:36864
    v_mfma_f32_16x16x32_bf16 v[132:135], a[4:7], a[44:47], v[132:135]
    v_mfma_f32_16x16x32_bf16 v[136:139], a[8:11], a[44:47], v[136:139]
    ds_read_b64_tr_b16 a[80:81], v12 offset:34816
    v_mfma_f32_16x16x32_bf16 v[140:143], a[12:15], a[44:47], v[140:143]
    v_mfma_f32_16x16x32_bf16 v[144:147], a[16:19], a[44:47], v[144:147]
    ds_read_b64_tr_b16 a[82:83], v12 offset:43008
    v_mfma_f32_16x16x32_bf16 v[148:151], a[20:23], a[44:47], v[148:151]
    v_mfma_f32_16x16x32_bf16 v[152:155], a[24:27], a[44:47], v[152:155]
    ds_read_b128 a[116:119], v6 offset:37888
    v_mfma_f32_16x16x32_bf16 v[156:159], a[28:31], a[44:47], v[156:159]
    v_mfma_f32_16x16x32_bf16 v[160:163], a[0:3], a[48:51], v[160:163]
    ds_read_b64_tr_b16 a[84:85], v13 offset:34816
    v_mfma_f32_16x16x32_bf16 v[164:167], a[4:7], a[48:51], v[164:167]
    buffer_load_dwordx4 v26, s[48:51], s61 offen offset:2048 lds
    v_mfma_f32_16x16x32_bf16 v[168:171], a[8:11], a[48:51], v[168:171]
    ds_read_b64_tr_b16 a[86:87], v13 offset:43008
    v_mfma_f32_16x16x32_bf16 v[172:175], a[12:15], a[48:51], v[172:175]
    v_mfma_f32_16x16x32_bf16 v[176:179], a[16:19], a[48:51], v[176:179]
    ds_read_b128 a[120:123], v6 offset:38912
    v_mfma_f32_16x16x32_bf16 v[180:183], a[20:23], a[48:51], v[180:183]
    v_mfma_f32_16x16x32_bf16 v[184:187], a[24:27], a[48:51], v[184:187]
    ds_read_b64_tr_b16 a[88:89], v14 offset:34816
    v_mfma_f32_16x16x32_bf16 v[188:191], a[28:31], a[48:51], v[188:191]
    v_mfma_f32_16x16x32_bf16 v[192:195], a[0:3], a[52:55], v[192:195]
    ds_read_b64_tr_b16 a[90:91], v14 offset:43008
    v_mfma_f32_16x16x32_bf16 v[196:199], a[4:7], a[52:55], v[196:199]
    v_mfma_f32_16x16x32_bf16 v[200:203], a[8:11], a[52:55], v[200:203]
    ds_read_b128 a[124:127], v6 offset:39936
    v_mfma_f32_16x16x32_bf16 v[204:207], a[12:15], a[52:55], v[204:207]
    v_mfma_f32_16x16x32_bf16 v[208:211], a[16:19], a[52:55], v[208:211]
    ds_read_b64_tr_b16 a[92:93], v15 offset:34816
    v_mfma_f32_16x16x32_bf16 v[212:215], a[20:23], a[52:55], v[212:215]
    v_mfma_f32_16x16x32_bf16 v[216:219], a[24:27], a[52:55], v[216:219]
    ds_read_b64_tr_b16 a[94:95], v15 offset:43008
    v_mfma_f32_16x16x32_bf16 v[220:223], a[28:31], a[52:55], v[220:223]
    v_mfma_f32_16x16x32_bf16 v[224:227], a[0:3], a[56:59], v[224:227]
    buffer_load_dwordx4 v27, s[48:51], s61 offen offset:3072 lds
    v_mfma_f32_16x16x32_bf16 v[228:231], a[4:7], a[56:59], v[228:231]
    s_add_u32 s61, s61, 0x8000
    v_mfma_f32_16x16x32_bf16 v[232:235], a[8:11], a[56:59], v[232:235]
    v_mfma_f32_16x16x32_bf16 v[236:239], a[12:15], a[56:59], v[236:239]
    v_mfma_f32_16x16x32_bf16 v[240:243], a[16:19], a[56:59], v[240:243]
    v_mfma_f32_16x16x32_bf16 v[244:247], a[20:23], a[56:59], v[244:247]
    v_mfma_f32_16x16x32_bf16 v[248:251], a[24:27], a[56:59], v[248:251]
    v_mfma_f32_16x16x32_bf16 v[252:255], a[28:31], a[56:59], v[252:255]
    v_mfma_f32_16x16x32_bf16 a[128:131], a[0:3], a[60:63], a[128:131]
    v_mfma_f32_16x16x32_bf16 a[132:135], a[4:7], a[60:63], a[132:135]
    v_mfma_f32_16x16x32_bf16 a[136:139], a[8:11], a[60:63], a[136:139]
    v_mfma_f32_16x16x32_bf16 a[140:143], a[12:15], a[60:63], a[140:143]
    v_mfma_f32_16x16x32_bf16 a[144:147], a[16:19], a[60:63], a[144:147]
    v_mfma_f32_16x16x32_bf16 a[148:151], a[20:23], a[60:63], a[148:151]
    v_mfma_f32_16x16x32_bf16 a[152:155], a[24:27], a[60:63], a[152:155]
    v_mfma_f32_16x16x32_bf16 a[156:159], a[28:31], a[60:63], a[156:159]
    s_waitcnt vmcnt(63) lgkmcnt(0)
    s_barrier
    v_mfma_f32_16x16x32_bf16 v[32:35], a[64:67], a[96:99], v[32:35]
    v_mov_b32 v5, v24
    v_mfma_f32_16x16x32_bf16 v[36:39], a[68:71], a[96:99], v[36:39]
    v_mov_b32 v6, v25
    v_mfma_f32_16x16x32_bf16 v[40:43], a[72:75], a[96:99], v[40:43]
    v_mov_b32 v14, v26
    v_mfma_f32_16x16x32_bf16 v[44:47], a[76:79], a[96:99], v[44:47]
    v_mov_b32 v15, v27
    v_mfma_f32_16x16x32_bf16 v[48:51], a[80:83], a[96:99], v[48:51]
    s_lshl_b32 s71, s3, 12
    v_mfma_f32_16x16x32_bf16 v[52:55], a[84:87], a[96:99], v[52:55]
    s_add_u32 m0, s71, 0x18000
    v_mfma_f32_16x16x32_bf16 v[56:59], a[88:91], a[96:99], v[56:59]
    s_add_u32 s71, s71, 0x6000
    v_mfma_f32_16x16x32_bf16 v[60:63], a[92:95], a[96:99], v[60:63]
    buffer_load_dwordx4 v3, s[28:31], s71 offen lds
    v_mfma_f32_16x16x32_bf16 v[64:67], a[64:67], a[100:103], v[64:67]
    v_mfma_f32_16x16x32_bf16 v[68:71], a[68:71], a[100:103], v[68:71]
    v_mfma_f32_16x16x32_bf16 v[72:75], a[72:75], a[100:103], v[72:75]
    v_mfma_f32_16x16x32_bf16 v[76:79], a[76:79], a[100:103], v[76:79]
    v_mfma_f32_16x16x32_bf16 v[80:83], a[80:83], a[100:103], v[80:83]
    v_mfma_f32_16x16x32_bf16 v[84:87], a[84:87], a[100:103], v[84:87]
    v_mfma_f32_16x16x32_bf16 v[88:91], a[88:91], a[100:103], v[88:91]
    v_mfma_f32_16x16x32_bf16 v[92:95], a[92:95], a[100:103], v[92:95]
    buffer_load_dwordx4 v3, s[28:31], s71 offen offset:1024 lds
    v_mfma_f32_16x16x32_bf16 v[96:99], a[64:67], a[104:107], v[96:99]
    v_mfma_f32_16x16x32_bf16 v[100:103], a[68:71], a[104:107], v[100:103]
    v_mfma_f32_16x16x32_bf16 v[104:107], a[72:75], a[104:107], v[104:107]
    v_mfma_f32_16x16x32_bf16 v[108:111], a[76:79], a[104:107], v[108:111]
    v_mfma_f32_16x16x32_bf16 v[112:115], a[80:83], a[104:107], v[112:115]
    v_mfma_f32_16x16x32_bf16 v[116:119], a[84:87], a[104:107], v[116:119]
    v_mfma_f32_16x16x32_bf16 v[120:123], a[88:91], a[104:107], v[120:123]
    v_mfma_f32_16x16x32_bf16 v[124:127], a[92:95], a[104:107], v[124:127]
    v_mfma_f32_16x16x32_bf16 v[128:131], a[64:67], a[108:111], v[128:131]
    v_mfma_f32_16x16x32_bf16 v[132:135], a[68:71], a[108:111], v[132:135]
    v_mfma_f32_16x16x32_bf16 v[136:139], a[72:75], a[108:111], v[136:139]
    v_mfma_f32_16x16x32_bf16 v[140:143], a[76:79], a[108:111], v[140:143]
    buffer_load_dwordx4 v3, s[28:31], s71 offen offset:2048 lds
    v_mfma_f32_16x16x32_bf16 v[144:147], a[80:83], a[108:111], v[144:147]
    v_mfma_f32_16x16x32_bf16 v[148:151], a[84:87], a[108:111], v[148:151]
    v_mfma_f32_16x16x32_bf16 v[152:155], a[88:91], a[108:111], v[152:155]
    v_mfma_f32_16x16x32_bf16 v[156:159], a[92:95], a[108:111], v[156:159]
    v_mfma_f32_16x16x32_bf16 v[160:163], a[64:67], a[112:115], v[160:163]
    v_mfma_f32_16x16x32_bf16 v[164:167], a[68:71], a[112:115], v[164:167]
    v_mfma_f32_16x16x32_bf16 v[168:171], a[72:75], a[112:115], v[168:171]
    v_mfma_f32_16x16x32_bf16 v[172:175], a[76:79], a[112:115], v[172:175]
    v_mfma_f32_16x16x32_bf16 v[176:179], a[80:83], a[112:115], v[176:179]
    v_mfma_f32_16x16x32_bf16 v[180:183], a[84:87], a[112:115], v[180:183]
    v_mfma_f32_16x16x32_bf16 v[184:187], a[88:91], a[112:115], v[184:187]
    v_mfma_f32_16x16x32_bf16 v[188:191], a[92:95], a[112:115], v[188:191]
    buffer_load_dwordx4 v3, s[28:31], s71 offen offset:3072 lds
    v_mfma_f32_16x16x32_bf16 v[192:195], a[64:67], a[116:119], v[192:195]
    s_lshl_b32 s71, s3, 10
    v_mfma_f32_16x16x32_bf16 v[196:199], a[68:71], a[116:119], v[196:199]
    v_mfma_f32_16x16x32_bf16 v[200:203], a[72:75], a[116:119], v[200:203]
    v_mfma_f32_16x16x32_bf16 v[204:207], a[76:79], a[116:119], v[204:207]
    v_mfma_f32_16x16x32_bf16 v[208:211], a[80:83], a[116:119], v[208:211]
    v_mfma_f32_16x16x32_bf16 v[212:215], a[84:87], a[116:119], v[212:215]
    v_mfma_f32_16x16x32_bf16 v[216:219], a[88:91], a[116:119], v[216:219]
    v_mfma_f32_16x16x32_bf16 v[220:223], a[92:95], a[116:119], v[220:223]
    v_mfma_f32_16x16x32_bf16 v[224:227], a[64:67], a[120:123], v[224:227]
    v_mfma_f32_16x16x32_bf16 v[228:231], a[68:71], a[120:123], v[228:231]
    s_add_u32 m0, s71, 0x1c000
    v_mfma_f32_16x16x32_bf16 v[232:235], a[72:75], a[120:123], v[232:235]
    s_add_u32 s71, s71, 0xa000
    v_mfma_f32_16x16x32_bf16 v[236:239], a[76:79], a[120:123], v[236:239]
    buffer_load_dwordx4 v3, s[28:31], s71 offen lds
    v_mfma_f32_16x16x32_bf16 v[240:243], a[80:83], a[120:123], v[240:243]
    v_mov_b32 v7, v28
    v_mfma_f32_16x16x32_bf16 v[244:247], a[84:87], a[120:123], v[244:247]
    v_mfma_f32_16x16x32_bf16 v[248:251], a[88:91], a[120:123], v[248:251]
    v_mfma_f32_16x16x32_bf16 v[252:255], a[92:95], a[120:123], v[252:255]
    v_mfma_f32_16x16x32_bf16 a[128:131], a[64:67], a[124:127], a[128:131]
    v_mfma_f32_16x16x32_bf16 a[132:135], a[68:71], a[124:127], a[132:135]
    v_mfma_f32_16x16x32_bf16 a[136:139], a[72:75], a[124:127], a[136:139]
    v_mfma_f32_16x16x32_bf16 a[140:143], a[76:79], a[124:127], a[140:143]
    v_mfma_f32_16x16x32_bf16 a[144:147], a[80:83], a[124:127], a[144:147]
    v_mfma_f32_16x16x32_bf16 a[148:151], a[84:87], a[124:127], a[148:151]
    v_mfma_f32_16x16x32_bf16 a[152:155], a[88:91], a[124:127], a[152:155]
    v_mfma_f32_16x16x32_bf16 a[156:159], a[92:95], a[124:127], a[156:159]
    s_mov_b32 s56, 0xbdd2d3e8
    s_mov_b32 s57, s56
    v_mov_b32 v8, 0xc0135761
    v_mov_b32 v9, v8
    v_mov_b32 v10, 1.0
    v_mov_b32 v11, 1.0
    v_mov_b32 v12, 0
    v_pk_mul_f32 v[16:17], v[32:33], v[32:33]
    v_pk_mul_f32 v[18:19], v[34:35], v[34:35]
    v_pk_mul_f32 v[20:21], v[36:37], v[36:37]
    v_pk_mul_f32 v[22:23], v[38:39], v[38:39]
    v_pk_fma_f32 v[16:17], v[16:17], s[56:57], v[8:9]
    v_pk_fma_f32 v[18:19], v[18:19], s[56:57], v[8:9]
    v_pk_fma_f32 v[20:21], v[20:21], s[56:57], v[8:9]
    v_pk_fma_f32 v[22:23], v[22:23], s[56:57], v[8:9]
    v_pk_mul_f32 v[16:17], v[16:17], v[32:33]
    v_pk_mul_f32 v[18:19], v[18:19], v[34:35]
    v_pk_mul_f32 v[20:21], v[20:21], v[36:37]
    v_pk_mul_f32 v[22:23], v[22:23], v[38:39]
    v_exp_f32 v16, v16
    v_exp_f32 v17, v17
    v_exp_f32 v18, v18
    v_exp_f32 v19, v19
    v_exp_f32 v20, v20
    v_exp_f32 v21, v21
    v_exp_f32 v22, v22
    v_exp_f32 v23, v23
    v_pk_mul_f32 v[48:49], v[48:49], v[32:33]
    v_pk_mul_f32 v[50:51], v[50:51], v[34:35]
    v_pk_mul_f32 v[52:53], v[52:53], v[36:37]
    v_pk_mul_f32 v[54:55], v[54:55], v[38:39]
    v_pk_add_f32 v[16:17], v[16:17], v[10:11]
    v_pk_add_f32 v[18:19], v[18:19], v[10:11]
    v_pk_add_f32 v[20:21], v[20:21], v[10:11]
    v_pk_add_f32 v[22:23], v[22:23], v[10:11]
    v_rcp_f32 v16, v16
    v_rcp_f32 v17, v17
    v_rcp_f32 v18, v18
    v_rcp_f32 v19, v19
    v_rcp_f32 v20, v20
    v_rcp_f32 v21, v21
    v_rcp_f32 v22, v22
    v_rcp_f32 v23, v23
    s_add_u32 s53, s52, 0x0
    v_pk_mul_f32 v[48:49], v[48:49], v[16:17]
    v_pk_mul_f32 v[50:51], v[50:51], v[18:19]
    v_pk_mul_f32 v[52:53], v[52:53], v[20:21]
    v_pk_mul_f32 v[54:55], v[54:55], v[22:23]
    v_cvt_pk_bf16_f32 v32, v48, v49
    v_cvt_pk_bf16_f32 v33, v50, v51
    v_cvt_pk_bf16_f32 v34, v52, v53
    v_cvt_pk_bf16_f32 v35, v54, v55
    buffer_store_dwordx4 v[32:35], v3, s[36:39], s53 offen offset:0 sc1
    v_pk_mul_f32 v[24:25], v[64:65], v[64:65]
    v_pk_mul_f32 v[26:27], v[66:67], v[66:67]
    v_pk_mul_f32 v[28:29], v[68:69], v[68:69]
    v_pk_mul_f32 v[30:31], v[70:71], v[70:71]
    v_pk_fma_f32 v[24:25], v[24:25], s[56:57], v[8:9]
    v_pk_fma_f32 v[26:27], v[26:27], s[56:57], v[8:9]
    v_pk_fma_f32 v[28:29], v[28:29], s[56:57], v[8:9]
    v_pk_fma_f32 v[30:31], v[30:31], s[56:57], v[8:9]
    v_pk_mul_f32 v[24:25], v[24:25], v[64:65]
    v_pk_mul_f32 v[26:27], v[26:27], v[66:67]
    v_pk_mul_f32 v[28:29], v[28:29], v[68:69]
    v_pk_mul_f32 v[30:31], v[30:31], v[70:71]
    v_exp_f32 v24, v24
    v_exp_f32 v25, v25
    v_exp_f32 v26, v26
    v_exp_f32 v27, v27
    v_exp_f32 v28, v28
    v_exp_f32 v29, v29
    v_exp_f32 v30, v30
    v_exp_f32 v31, v31
    v_pk_mul_f32 v[80:81], v[80:81], v[64:65]
    v_pk_mul_f32 v[82:83], v[82:83], v[66:67]
    v_pk_mul_f32 v[84:85], v[84:85], v[68:69]
    v_pk_mul_f32 v[86:87], v[86:87], v[70:71]
    v_pk_add_f32 v[24:25], v[24:25], v[10:11]
    v_pk_add_f32 v[26:27], v[26:27], v[10:11]
    v_pk_add_f32 v[28:29], v[28:29], v[10:11]
    v_pk_add_f32 v[30:31], v[30:31], v[10:11]
    v_rcp_f32 v24, v24
    v_rcp_f32 v25, v25
    v_rcp_f32 v26, v26
    v_rcp_f32 v27, v27
    v_rcp_f32 v28, v28
    v_rcp_f32 v29, v29
    v_rcp_f32 v30, v30
    v_rcp_f32 v31, v31
    s_add_u32 s53, s52, 0x0
    v_pk_mul_f32 v[80:81], v[80:81], v[24:25]
    v_pk_mul_f32 v[82:83], v[82:83], v[26:27]
    v_pk_mul_f32 v[84:85], v[84:85], v[28:29]
    v_pk_mul_f32 v[86:87], v[86:87], v[30:31]
    v_cvt_pk_bf16_f32 v64, v80, v81
    v_cvt_pk_bf16_f32 v65, v82, v83
    v_cvt_pk_bf16_f32 v66, v84, v85
    v_cvt_pk_bf16_f32 v67, v86, v87
    buffer_store_dwordx4 v[64:67], v3, s[36:39], s53 offen offset:1024 sc1
    v_pk_mul_f32 v[16:17], v[96:97], v[96:97]
    v_pk_mul_f32 v[18:19], v[98:99], v[98:99]
    v_pk_mul_f32 v[20:21], v[100:101], v[100:101]
    v_pk_mul_f32 v[22:23], v[102:103], v[102:103]
    v_pk_fma_f32 v[16:17], v[16:17], s[56:57], v[8:9]
    v_pk_fma_f32 v[18:19], v[18:19], s[56:57], v[8:9]
    v_pk_fma_f32 v[20:21], v[20:21], s[56:57], v[8:9]
    v_pk_fma_f32 v[22:23], v[22:23], s[56:57], v[8:9]
    v_pk_mul_f32 v[16:17], v[16:17], v[96:97]
    v_pk_mul_f32 v[18:19], v[18:19], v[98:99]
    v_pk_mul_f32 v[20:21], v[20:21], v[100:101]
    v_pk_mul_f32 v[22:23], v[22:23], v[102:103]
    v_exp_f32 v16, v16
    v_exp_f32 v17, v17
    v_exp_f32 v18, v18
    v_exp_f32 v19, v19
    v_exp_f32 v20, v20
    v_exp_f32 v21, v21
    v_exp_f32 v22, v22
    v_exp_f32 v23, v23
    v_pk_mul_f32 v[112:113], v[112:113], v[96:97]
    v_pk_mul_f32 v[114:115], v[114:115], v[98:99]
    v_pk_mul_f32 v[116:117], v[116:117], v[100:101]
    v_pk_mul_f32 v[118:119], v[118:119], v[102:103]
    v_pk_add_f32 v[16:17], v[16:17], v[10:11]
    v_pk_add_f32 v[18:19], v[18:19], v[10:11]
    v_pk_add_f32 v[20:21], v[20:21], v[10:11]
    v_pk_add_f32 v[22:23], v[22:23], v[10:11]
    v_rcp_f32 v16, v16
    v_rcp_f32 v17, v17
    v_rcp_f32 v18, v18
    v_rcp_f32 v19, v19
    v_rcp_f32 v20, v20
    v_rcp_f32 v21, v21
    v_rcp_f32 v22, v22
    v_rcp_f32 v23, v23
    s_add_u32 s53, s52, 0x0
    v_pk_mul_f32 v[112:113], v[112:113], v[16:17]
    v_pk_mul_f32 v[114:115], v[114:115], v[18:19]
    v_pk_mul_f32 v[116:117], v[116:117], v[20:21]
    v_pk_mul_f32 v[118:119], v[118:119], v[22:23]
    v_cvt_pk_bf16_f32 v96, v112, v113
    v_cvt_pk_bf16_f32 v97, v114, v115
    v_cvt_pk_bf16_f32 v98, v116, v117
    v_cvt_pk_bf16_f32 v99, v118, v119
    buffer_store_dwordx4 v[96:99], v3, s[36:39], s53 offen offset:2048 sc1
    v_pk_mul_f32 v[24:25], v[128:129], v[128:129]
    v_pk_mul_f32 v[26:27], v[130:131], v[130:131]
    v_pk_mul_f32 v[28:29], v[132:133], v[132:133]
    v_pk_mul_f32 v[30:31], v[134:135], v[134:135]
    v_pk_fma_f32 v[24:25], v[24:25], s[56:57], v[8:9]
    v_pk_fma_f32 v[26:27], v[26:27], s[56:57], v[8:9]
    v_pk_fma_f32 v[28:29], v[28:29], s[56:57], v[8:9]
    v_pk_fma_f32 v[30:31], v[30:31], s[56:57], v[8:9]
    v_pk_mul_f32 v[24:25], v[24:25], v[128:129]
    v_pk_mul_f32 v[26:27], v[26:27], v[130:131]
    v_pk_mul_f32 v[28:29], v[28:29], v[132:133]
    v_pk_mul_f32 v[30:31], v[30:31], v[134:135]
    v_exp_f32 v24, v24
    v_exp_f32 v25, v25
    v_exp_f32 v26, v26
    v_exp_f32 v27, v27
    v_exp_f32 v28, v28
    v_exp_f32 v29, v29
    v_exp_f32 v30, v30
    v_exp_f32 v31, v31
    v_pk_mul_f32 v[144:145], v[144:145], v[128:129]
    v_pk_mul_f32 v[146:147], v[146:147], v[130:131]
    v_pk_mul_f32 v[148:149], v[148:149], v[132:133]
    v_pk_mul_f32 v[150:151], v[150:151], v[134:135]
    v_pk_add_f32 v[24:25], v[24:25], v[10:11]
    v_pk_add_f32 v[26:27], v[26:27], v[10:11]
    v_pk_add_f32 v[28:29], v[28:29], v[10:11]
    v_pk_add_f32 v[30:31], v[30:31], v[10:11]
    v_rcp_f32 v24, v24
    v_rcp_f32 v25, v25
    v_rcp_f32 v26, v26
    v_rcp_f32 v27, v27
    v_rcp_f32 v28, v28
    v_rcp_f32 v29, v29
    v_rcp_f32 v30, v30
    v_rcp_f32 v31, v31
    s_add_u32 s53, s52, 0x0
    v_pk_mul_f32 v[144:145], v[144:145], v[24:25]
    v_pk_mul_f32 v[146:147], v[146:147], v[26:27]
    v_pk_mul_f32 v[148:149], v[148:149], v[28:29]
    v_pk_mul_f32 v[150:151], v[150:151], v[30:31]
    v_cvt_pk_bf16_f32 v128, v144, v145
    v_cvt_pk_bf16_f32 v129, v146, v147
    v_cvt_pk_bf16_f32 v130, v148, v149
    v_cvt_pk_bf16_f32 v131, v150, v151
    buffer_store_dwordx4 v[128:131], v3, s[36:39], s53 offen offset:3072 sc1
    v_pk_mul_f32 v[16:17], v[160:161], v[160:161]
    v_pk_mul_f32 v[18:19], v[162:163], v[162:163]
    v_pk_mul_f32 v[20:21], v[164:165], v[164:165]
    v_pk_mul_f32 v[22:23], v[166:167], v[166:167]
    v_pk_fma_f32 v[16:17], v[16:17], s[56:57], v[8:9]
    v_pk_fma_f32 v[18:19], v[18:19], s[56:57], v[8:9]
    v_pk_fma_f32 v[20:21], v[20:21], s[56:57], v[8:9]
    v_pk_fma_f32 v[22:23], v[22:23], s[56:57], v[8:9]
    v_pk_mul_f32 v[16:17], v[16:17], v[160:161]
    v_pk_mul_f32 v[18:19], v[18:19], v[162:163]
    v_pk_mul_f32 v[20:21], v[20:21], v[164:165]
    v_pk_mul_f32 v[22:23], v[22:23], v[166:167]
    v_exp_f32 v16, v16
    v_exp_f32 v17, v17
    v_exp_f32 v18, v18
    v_exp_f32 v19, v19
    v_exp_f32 v20, v20
    v_exp_f32 v21, v21
    v_exp_f32 v22, v22
    v_exp_f32 v23, v23
    v_pk_mul_f32 v[176:177], v[176:177], v[160:161]
    v_pk_mul_f32 v[178:179], v[178:179], v[162:163]
    v_pk_mul_f32 v[180:181], v[180:181], v[164:165]
    v_pk_mul_f32 v[182:183], v[182:183], v[166:167]
    v_pk_add_f32 v[16:17], v[16:17], v[10:11]
    v_pk_add_f32 v[18:19], v[18:19], v[10:11]
    v_pk_add_f32 v[20:21], v[20:21], v[10:11]
    v_pk_add_f32 v[22:23], v[22:23], v[10:11]
    v_rcp_f32 v16, v16
    v_rcp_f32 v17, v17
    v_rcp_f32 v18, v18
    v_rcp_f32 v19, v19
    v_rcp_f32 v20, v20
    v_rcp_f32 v21, v21
    v_rcp_f32 v22, v22
    v_rcp_f32 v23, v23
    s_add_u32 s53, s52, 0x1000
    v_pk_mul_f32 v[176:177], v[176:177], v[16:17]
    v_pk_mul_f32 v[178:179], v[178:179], v[18:19]
    v_pk_mul_f32 v[180:181], v[180:181], v[20:21]
    v_pk_mul_f32 v[182:183], v[182:183], v[22:23]
    v_cvt_pk_bf16_f32 v160, v176, v177
    v_cvt_pk_bf16_f32 v161, v178, v179
    v_cvt_pk_bf16_f32 v162, v180, v181
    v_cvt_pk_bf16_f32 v163, v182, v183
    buffer_store_dwordx4 v[160:163], v3, s[36:39], s53 offen offset:0 sc1
    v_pk_mul_f32 v[24:25], v[192:193], v[192:193]
    v_pk_mul_f32 v[26:27], v[194:195], v[194:195]
    v_pk_mul_f32 v[28:29], v[196:197], v[196:197]
    v_pk_mul_f32 v[30:31], v[198:199], v[198:199]
    v_pk_fma_f32 v[24:25], v[24:25], s[56:57], v[8:9]
    v_pk_fma_f32 v[26:27], v[26:27], s[56:57], v[8:9]
    v_pk_fma_f32 v[28:29], v[28:29], s[56:57], v[8:9]
    v_pk_fma_f32 v[30:31], v[30:31], s[56:57], v[8:9]
    v_pk_mul_f32 v[24:25], v[24:25], v[192:193]
    v_pk_mul_f32 v[26:27], v[26:27], v[194:195]
    v_pk_mul_f32 v[28:29], v[28:29], v[196:197]
    v_pk_mul_f32 v[30:31], v[30:31], v[198:199]
    v_exp_f32 v24, v24
    v_exp_f32 v25, v25
    v_exp_f32 v26, v26
    v_exp_f32 v27, v27
    v_exp_f32 v28, v28
    v_exp_f32 v29, v29
    v_exp_f32 v30, v30
    v_exp_f32 v31, v31
    v_pk_mul_f32 v[208:209], v[208:209], v[192:193]
    v_pk_mul_f32 v[210:211], v[210:211], v[194:195]
    v_pk_mul_f32 v[212:213], v[212:213], v[196:197]
    v_pk_mul_f32 v[214:215], v[214:215], v[198:199]
    v_pk_add_f32 v[24:25], v[24:25], v[10:11]
    v_pk_add_f32 v[26:27], v[26:27], v[10:11]
    v_pk_add_f32 v[28:29], v[28:29], v[10:11]
    v_pk_add_f32 v[30:31], v[30:31], v[10:11]
    v_rcp_f32 v24, v24
    v_rcp_f32 v25, v25
    v_rcp_f32 v26, v26
    v_rcp_f32 v27, v27
    v_rcp_f32 v28, v28
    v_rcp_f32 v29, v29
    v_rcp_f32 v30, v30
    v_rcp_f32 v31, v31
    s_add_u32 s53, s52, 0x1000
    v_pk_mul_f32 v[208:209], v[208:209], v[24:25]
    v_pk_mul_f32 v[210:211], v[210:211], v[26:27]
    v_pk_mul_f32 v[212:213], v[212:213], v[28:29]
    v_pk_mul_f32 v[214:215], v[214:215], v[30:31]
    v_cvt_pk_bf16_f32 v192, v208, v209
    v_cvt_pk_bf16_f32 v193, v210, v211
    v_cvt_pk_bf16_f32 v194, v212, v213
    v_cvt_pk_bf16_f32 v195, v214, v215
    buffer_store_dwordx4 v[192:195], v3, s[36:39], s53 offen offset:1024 sc1
    s_bfm_b64 exec, 32, 0
    buffer_load_dword v4, v7, s[24:27], s46 offen sc1
    s_mov_b64 exec, -1
    v_pk_mul_f32 v[16:17], v[224:225], v[224:225]
    v_pk_mul_f32 v[18:19], v[226:227], v[226:227]
    v_pk_mul_f32 v[20:21], v[228:229], v[228:229]
    v_pk_mul_f32 v[22:23], v[230:231], v[230:231]
    v_pk_fma_f32 v[16:17], v[16:17], s[56:57], v[8:9]
    v_pk_fma_f32 v[18:19], v[18:19], s[56:57], v[8:9]
    v_pk_fma_f32 v[20:21], v[20:21], s[56:57], v[8:9]
    v_pk_fma_f32 v[22:23], v[22:23], s[56:57], v[8:9]
    v_pk_mul_f32 v[16:17], v[16:17], v[224:225]
    v_pk_mul_f32 v[18:19], v[18:19], v[226:227]
    v_pk_mul_f32 v[20:21], v[20:21], v[228:229]
    v_pk_mul_f32 v[22:23], v[22:23], v[230:231]
    v_exp_f32 v16, v16
    v_exp_f32 v17, v17
    v_exp_f32 v18, v18
    v_exp_f32 v19, v19
    v_exp_f32 v20, v20
    v_exp_f32 v21, v21
    v_exp_f32 v22, v22
    v_exp_f32 v23, v23
    v_pk_mul_f32 v[240:241], v[240:241], v[224:225]
    v_pk_mul_f32 v[242:243], v[242:243], v[226:227]
    v_pk_mul_f32 v[244:245], v[244:245], v[228:229]
    v_pk_mul_f32 v[246:247], v[246:247], v[230:231]
    v_pk_add_f32 v[16:17], v[16:17], v[10:11]
    v_pk_add_f32 v[18:19], v[18:19], v[10:11]
    v_pk_add_f32 v[20:21], v[20:21], v[10:11]
    v_pk_add_f32 v[22:23], v[22:23], v[10:11]
    v_rcp_f32 v16, v16
    v_rcp_f32 v17, v17
    v_rcp_f32 v18, v18
    v_rcp_f32 v19, v19
    v_rcp_f32 v20, v20
    v_rcp_f32 v21, v21
    v_rcp_f32 v22, v22
    v_rcp_f32 v23, v23
    s_add_u32 s53, s52, 0x1000
    v_pk_mul_f32 v[240:241], v[240:241], v[16:17]
    v_pk_mul_f32 v[242:243], v[242:243], v[18:19]
    v_pk_mul_f32 v[244:245], v[244:245], v[20:21]
    v_pk_mul_f32 v[246:247], v[246:247], v[22:23]
    v_cvt_pk_bf16_f32 v224, v240, v241
    v_cvt_pk_bf16_f32 v225, v242, v243
    v_cvt_pk_bf16_f32 v226, v244, v245
    v_cvt_pk_bf16_f32 v227, v246, v247
    buffer_store_dwordx4 v[224:227], v3, s[36:39], s53 offen offset:2048 sc1
    v_accvgpr_read_b32 v32, a128
    v_accvgpr_read_b32 v48, a144
    v_accvgpr_read_b32 v33, a129
    v_accvgpr_read_b32 v49, a145
    v_accvgpr_read_b32 v34, a130
    v_accvgpr_read_b32 v50, a146
    v_accvgpr_read_b32 v35, a131
    v_accvgpr_read_b32 v51, a147
    v_accvgpr_read_b32 v36, a132
    v_accvgpr_read_b32 v52, a148
    v_accvgpr_read_b32 v37, a133
    v_accvgpr_read_b32 v53, a149
    v_accvgpr_read_b32 v38, a134
    v_accvgpr_read_b32 v54, a150
    v_accvgpr_read_b32 v39, a135
    v_accvgpr_read_b32 v55, a151
    v_pk_mul_f32 v[24:25], v[32:33], v[32:33]
    v_pk_mul_f32 v[26:27], v[34:35], v[34:35]
    v_pk_mul_f32 v[28:29], v[36:37], v[36:37]
    v_pk_mul_f32 v[30:31], v[38:39], v[38:39]
    v_pk_fma_f32 v[24:25], v[24:25], s[56:57], v[8:9]
    v_pk_fma_f32 v[26:27], v[26:27], s[56:57], v[8:9]
    v_pk_fma_f32 v[28:29], v[28:29], s[56:57], v[8:9]
    v_pk_fma_f32 v[30:31], v[30:31], s[56:57], v[8:9]
    v_pk_mul_f32 v[24:25], v[24:25], v[32:33]
    v_pk_mul_f32 v[26:27], v[26:27], v[34:35]
    v_pk_mul_f32 v[28:29], v[28:29], v[36:37]
    v_pk_mul_f32 v[30:31], v[30:31], v[38:39]
    v_exp_f32 v24, v24
    v_exp_f32 v25, v25
    v_exp_f32 v26, v26
    v_exp_f32 v27, v27
    v_exp_f32 v28, v28
    v_exp_f32 v29, v29
    v_exp_f32 v30, v30
    v_exp_f32 v31, v31
    v_pk_mul_f32 v[48:49], v[48:49], v[32:33]
    v_pk_mul_f32 v[50:51], v[50:51], v[34:35]
    v_pk_mul_f32 v[52:53], v[52:53], v[36:37]
    v_pk_mul_f32 v[54:55], v[54:55], v[38:39]
    v_pk_add_f32 v[24:25], v[24:25], v[10:11]
    v_pk_add_f32 v[26:27], v[26:27], v[10:11]
    v_pk_add_f32 v[28:29], v[28:29], v[10:11]
    v_pk_add_f32 v[30:31], v[30:31], v[10:11]
    v_rcp_f32 v24, v24
    v_rcp_f32 v25, v25
    v_rcp_f32 v26, v26
    v_rcp_f32 v27, v27
    v_rcp_f32 v28, v28
    v_rcp_f32 v29, v29
    v_rcp_f32 v30, v30
    v_rcp_f32 v31, v31
    s_add_u32 s53, s52, 0x1000
    v_pk_mul_f32 v[48:49], v[48:49], v[24:25]
    v_pk_mul_f32 v[50:51], v[50:51], v[26:27]
    v_pk_mul_f32 v[52:53], v[52:53], v[28:29]
    v_pk_mul_f32 v[54:55], v[54:55], v[30:31]
    v_cvt_pk_bf16_f32 v32, v48, v49
    v_cvt_pk_bf16_f32 v33, v50, v51
    v_cvt_pk_bf16_f32 v34, v52, v53
    v_cvt_pk_bf16_f32 v35, v54, v55
    buffer_store_dwordx4 v[32:35], v3, s[36:39], s53 offen offset:3072 sc1
    v_pk_mul_f32 v[16:17], v[40:41], v[40:41]
    v_pk_mul_f32 v[18:19], v[42:43], v[42:43]
    v_pk_mul_f32 v[20:21], v[44:45], v[44:45]
    v_pk_mul_f32 v[22:23], v[46:47], v[46:47]
    v_pk_fma_f32 v[16:17], v[16:17], s[56:57], v[8:9]
    v_pk_fma_f32 v[18:19], v[18:19], s[56:57], v[8:9]
    v_pk_fma_f32 v[20:21], v[20:21], s[56:57], v[8:9]
    v_pk_fma_f32 v[22:23], v[22:23], s[56:57], v[8:9]
    v_pk_mul_f32 v[16:17], v[16:17], v[40:41]
    v_pk_mul_f32 v[18:19], v[18:19], v[42:43]
    v_pk_mul_f32 v[20:21], v[20:21], v[44:45]
    v_pk_mul_f32 v[22:23], v[22:23], v[46:47]
    v_exp_f32 v16, v16
    v_exp_f32 v17, v17
    v_exp_f32 v18, v18
    v_exp_f32 v19, v19
    v_exp_f32 v20, v20
    v_exp_f32 v21, v21
    v_exp_f32 v22, v22
    v_exp_f32 v23, v23
    v_pk_mul_f32 v[56:57], v[56:57], v[40:41]
    v_pk_mul_f32 v[58:59], v[58:59], v[42:43]
    v_pk_mul_f32 v[60:61], v[60:61], v[44:45]
    v_pk_mul_f32 v[62:63], v[62:63], v[46:47]
    v_pk_add_f32 v[16:17], v[16:17], v[10:11]
    v_pk_add_f32 v[18:19], v[18:19], v[10:11]
    v_pk_add_f32 v[20:21], v[20:21], v[10:11]
    v_pk_add_f32 v[22:23], v[22:23], v[10:11]
    v_rcp_f32 v16, v16
    v_rcp_f32 v17, v17
    v_rcp_f32 v18, v18
    v_rcp_f32 v19, v19
    v_rcp_f32 v20, v20
    v_rcp_f32 v21, v21
    v_rcp_f32 v22, v22
    v_rcp_f32 v23, v23
    s_add_u32 s53, s52, 0x38000
    v_pk_mul_f32 v[56:57], v[56:57], v[16:17]
    v_pk_mul_f32 v[58:59], v[58:59], v[18:19]
    v_pk_mul_f32 v[60:61], v[60:61], v[20:21]
    v_pk_mul_f32 v[62:63], v[62:63], v[22:23]
    v_cvt_pk_bf16_f32 v40, v56, v57
    v_cvt_pk_bf16_f32 v41, v58, v59
    v_cvt_pk_bf16_f32 v42, v60, v61
    v_cvt_pk_bf16_f32 v43, v62, v63
    buffer_store_dwordx4 v[40:43], v3, s[36:39], s53 offen offset:0 sc1
    v_pk_mul_f32 v[24:25], v[72:73], v[72:73]
    v_pk_mul_f32 v[26:27], v[74:75], v[74:75]
    v_pk_mul_f32 v[28:29], v[76:77], v[76:77]
    v_pk_mul_f32 v[30:31], v[78:79], v[78:79]
    v_pk_fma_f32 v[24:25], v[24:25], s[56:57], v[8:9]
    v_pk_fma_f32 v[26:27], v[26:27], s[56:57], v[8:9]
    v_pk_fma_f32 v[28:29], v[28:29], s[56:57], v[8:9]
    v_pk_fma_f32 v[30:31], v[30:31], s[56:57], v[8:9]
    v_pk_mul_f32 v[24:25], v[24:25], v[72:73]
    v_pk_mul_f32 v[26:27], v[26:27], v[74:75]
    v_pk_mul_f32 v[28:29], v[28:29], v[76:77]
    v_pk_mul_f32 v[30:31], v[30:31], v[78:79]
    v_exp_f32 v24, v24
    v_exp_f32 v25, v25
    v_exp_f32 v26, v26
    v_exp_f32 v27, v27
    v_exp_f32 v28, v28
    v_exp_f32 v29, v29
    v_exp_f32 v30, v30
    v_exp_f32 v31, v31
    v_pk_mul_f32 v[88:89], v[88:89], v[72:73]
    v_pk_mul_f32 v[90:91], v[90:91], v[74:75]
    v_pk_mul_f32 v[92:93], v[92:93], v[76:77]
    v_pk_mul_f32 v[94:95], v[94:95], v[78:79]
    v_pk_add_f32 v[24:25], v[24:25], v[10:11]
    v_pk_add_f32 v[26:27], v[26:27], v[10:11]
    v_pk_add_f32 v[28:29], v[28:29], v[10:11]
    v_pk_add_f32 v[30:31], v[30:31], v[10:11]
    v_rcp_f32 v24, v24
    v_rcp_f32 v25, v25
    v_rcp_f32 v26, v26
    v_rcp_f32 v27, v27
    v_rcp_f32 v28, v28
    v_rcp_f32 v29, v29
    v_rcp_f32 v30, v30
    v_rcp_f32 v31, v31
    s_add_u32 s53, s52, 0x38000
    v_pk_mul_f32 v[88:89], v[88:89], v[24:25]
    v_pk_mul_f32 v[90:91], v[90:91], v[26:27]
    v_pk_mul_f32 v[92:93], v[92:93], v[28:29]
    v_pk_mul_f32 v[94:95], v[94:95], v[30:31]
    v_cvt_pk_bf16_f32 v72, v88, v89
    v_cvt_pk_bf16_f32 v73, v90, v91
    v_cvt_pk_bf16_f32 v74, v92, v93
    v_cvt_pk_bf16_f32 v75, v94, v95
    buffer_store_dwordx4 v[72:75], v3, s[36:39], s53 offen offset:1024 sc1
    s_waitcnt vmcnt(4)
    v_cmp_ne_u32 vcc, s70, v4
    s_nop 1
    s_mov_b32 vcc_hi, 0
    s_nop 3
    s_cbranch_vccz pd_f3g
    s_mov_b32 s68, 0x20000
pl_f3g:
    s_bfm_b64 exec, 32, 0
    buffer_load_dword v4, v7, s[24:27], s46 offen sc1
    s_mov_b64 exec, -1
    s_waitcnt vmcnt(0)
    v_cmp_ne_u32 vcc, s70, v4
    s_nop 1
    s_bfm_b64 s[66:67], 32, 0
    s_and_b64 vcc, vcc, s[66:67]
    s_nop 3
    s_cbranch_vccz pd_f3g
    s_sleep 4
    s_sub_u32 s68, s68, 1
    s_cmp_lg_u32 s68, 0
    s_cbranch_scc1 pl_f3g
pd_f3g:
    s_add_u32 s32, s22, 0xd00000
    s_addc_u32 s33, s23, 0
    s_and_b32 s33, s33, 0xffff
    s_mov_b32 s34, 0x400000
    s_mov_b32 s35, 0x20000
    v_lshrrev_b32 v7, 4, v1
    v_and_b32 v13, 7, v1
    v_xor_b32 v7, v7, v13
    v_lshlrev_b32 v7, 4, v7
    v_lshrrev_b32 v13, 3, v1
    v_lshl_add_u32 v7, v13, 8, v7
    v_xor_b32 v13, 64, v7
    s_lshr_b32 s40, s2, 1
    s_lshl_b32 s40, s40, 15
    s_and_b32 s41, s2, 1
    s_lshl_b32 s41, s41, 7
    s_add_u32 s40, s40, s41
    s_lshl_b32 s41, s3, 13
    s_add_u32 s40, s40, s41
    s_lshl_b32 s41, s3, 12
    s_add_u32 m0, s41, 0x20000
    s_nop 0
    buffer_load_dwordx4 v7, s[32:35], s40 offen sc1 lds
    s_add_u32 s40, s40, 1024
    buffer_load_dwordx4 v13, s[32:35], s40 offen offset:1024 sc1 lds
    s_add_u32 s40, s40, 1024
    buffer_load_dwordx4 v7, s[32:35], s40 offen offset:2048 sc1 lds
    s_add_u32 s40, s40, 1024
    buffer_load_dwordx4 v13, s[32:35], s40 offen offset:3072 sc1 lds
    s_add_u32 s40, s40, 1024
    v_pk_mul_f32 v[16:17], v[104:105], v[104:105]
    v_pk_mul_f32 v[18:19], v[106:107], v[106:107]
    v_pk_mul_f32 v[20:21], v[108:109], v[108:109]
    v_pk_mul_f32 v[22:23], v[110:111], v[110:111]
    v_pk_fma_f32 v[16:17], v[16:17], s[56:57], v[8:9]
    v_pk_fma_f32 v[18:19], v[18:19], s[56:57], v[8:9]
    v_pk_fma_f32 v[20:21], v[20:21], s[56:57], v[8:9]
    v_pk_fma_f32 v[22:23], v[22:23], s[56:57], v[8:9]
    v_pk_mul_f32 v[16:17], v[16:17], v[104:105]
    v_pk_mul_f32 v[18:19], v[18:19], v[106:107]
    v_pk_mul_f32 v[20:21], v[20:21], v[108:109]
    v_pk_mul_f32 v[22:23], v[22:23], v[110:111]
    v_exp_f32 v16, v16
    v_exp_f32 v17, v17
    v_exp_f32 v18, v18
    v_exp_f32 v19, v19
    v_exp_f32 v20, v20
    v_exp_f32 v21, v21
    v_exp_f32 v22, v22
    v_exp_f32 v23, v23
    v_pk_mul_f32 v[120:121], v[120:121], v[104:105]
    v_pk_mul_f32 v[122:123], v[122:123], v[106:107]
    v_pk_mul_f32 v[124:125], v[124:125], v[108:109]
    v_pk_mul_f32 v[126:127], v[126:127], v[110:111]
    v_pk_add_f32 v[16:17], v[16:17], v[10:11]
    v_pk_add_f32 v[18:19], v[18:19], v[10:11]
    v_pk_add_f32 v[20:21], v[20:21], v[10:11]
    v_pk_add_f32 v[22:23], v[22:23], v[10:11]
    v_rcp_f32 v16, v16
    v_rcp_f32 v17, v17
    v_rcp_f32 v18, v18
    v_rcp_f32 v19, v19
    v_rcp_f32 v20, v20
    v_rcp_f32 v21, v21
    v_rcp_f32 v22, v22
    v_rcp_f32 v23, v23
    s_add_u32 s53, s52, 0x38000
    v_pk_mul_f32 v[120:121], v[120:121], v[16:17]
    v_pk_mul_f32 v[122:123], v[122:123], v[18:19]
    v_pk_mul_f32 v[124:125], v[124:125], v[20:21]
    v_pk_mul_f32 v[126:127], v[126:127], v[22:23]
    v_cvt_pk_bf16_f32 v104, v120, v121
    v_cvt_pk_bf16_f32 v105, v122, v123
    v_cvt_pk_bf16_f32 v106, v124, v125
    v_cvt_pk_bf16_f32 v107, v126, v127
    buffer_store_dwordx4 v[104:107], v3, s[36:39], s53 offen offset:2048 sc1
    v_pk_mul_f32 v[24:25], v[136:137], v[136:137]
    v_pk_mul_f32 v[26:27], v[138:139], v[138:139]
    v_pk_mul_f32 v[28:29], v[140:141], v[140:141]
    v_pk_mul_f32 v[30:31], v[142:143], v[142:143]
    v_pk_fma_f32 v[24:25], v[24:25], s[56:57], v[8:9]
    v_pk_fma_f32 v[26:27], v[26:27], s[56:57], v[8:9]
    v_pk_fma_f32 v[28:29], v[28:29], s[56:57], v[8:9]
    v_pk_fma_f32 v[30:31], v[30:31], s[56:57], v[8:9]
    v_pk_mul_f32 v[24:25], v[24:25], v[136:137]
    v_pk_mul_f32 v[26:27], v[26:27], v[138:139]
    v_pk_mul_f32 v[28:29], v[28:29], v[140:141]
    v_pk_mul_f32 v[30:31], v[30:31], v[142:143]
    v_exp_f32 v24, v24
    v_exp_f32 v25, v25
    v_exp_f32 v26, v26
    v_exp_f32 v27, v27
    v_exp_f32 v28, v28
    v_exp_f32 v29, v29
    v_exp_f32 v30, v30
    v_exp_f32 v31, v31
    v_pk_mul_f32 v[152:153], v[152:153], v[136:137]
    v_pk_mul_f32 v[154:155], v[154:155], v[138:139]
    v_pk_mul_f32 v[156:157], v[156:157], v[140:141]
    v_pk_mul_f32 v[158:159], v[158:159], v[142:143]
    v_pk_add_f32 v[24:25], v[24:25], v[10:11]
    v_pk_add_f32 v[26:27], v[26:27], v[10:11]
    v_pk_add_f32 v[28:29], v[28:29], v[10:11]
    v_pk_add_f32 v[30:31], v[30:31], v[10:11]
    v_rcp_f32 v24, v24
    v_rcp_f32 v25, v25
    v_rcp_f32 v26, v26
    v_rcp_f32 v27, v27
    v_rcp_f32 v28, v28
    v_rcp_f32 v29, v29
    v_rcp_f32 v30, v30
    v_rcp_f32 v31, v31
    s_add_u32 s53, s52, 0x38000
    v_pk_mul_f32 v[152:153], v[152:153], v[24:25]
    v_pk_mul_f32 v[154:155], v[154:155], v[26:27]
    v_pk_mul_f32 v[156:157], v[156:157], v[28:29]
    v_pk_mul_f32 v[158:159], v[158:159], v[30:31]
    v_cvt_pk_bf16_f32 v136, v152, v153
    v_cvt_pk_bf16_f32 v137, v154, v155
    v_cvt_pk_bf16_f32 v138, v156, v157
    v_cvt_pk_bf16_f32 v139, v158, v159
    buffer_store_dwordx4 v[136:139], v3, s[36:39], s53 offen offset:3072 sc1
    s_waitcnt vmcnt(8)
    v_mov_b32 v4, s70
    s_mov_b64 exec, 1
    buffer_store_dword v4, v12, s[24:27], s54 offen sc1
    s_mov_b64 exec, -1
    v_pk_mul_f32 v[16:17], v[168:169], v[168:169]
    v_pk_mul_f32 v[18:19], v[170:171], v[170:171]
    v_pk_mul_f32 v[20:21], v[172:173], v[172:173]
    v_pk_mul_f32 v[22:23], v[174:175], v[174:175]
    v_pk_fma_f32 v[16:17], v[16:17], s[56:57], v[8:9]
    v_pk_fma_f32 v[18:19], v[18:19], s[56:57], v[8:9]
    v_pk_fma_f32 v[20:21], v[20:21], s[56:57], v[8:9]
    v_pk_fma_f32 v[22:23], v[22:23], s[56:57], v[8:9]
    v_pk_mul_f32 v[16:17], v[16:17], v[168:169]
    v_pk_mul_f32 v[18:19], v[18:19], v[170:171]
    v_pk_mul_f32 v[20:21], v[20:21], v[172:173]
    v_pk_mul_f32 v[22:23], v[22:23], v[174:175]
    v_exp_f32 v16, v16
    v_exp_f32 v17, v17
    v_exp_f32 v18, v18
    v_exp_f32 v19, v19
    v_exp_f32 v20, v20
    v_exp_f32 v21, v21
    v_exp_f32 v22, v22
    v_exp_f32 v23, v23
    v_pk_mul_f32 v[184:185], v[184:185], v[168:169]
    v_pk_mul_f32 v[186:187], v[186:187], v[170:171]
    v_pk_mul_f32 v[188:189], v[188:189], v[172:173]
    v_pk_mul_f32 v[190:191], v[190:191], v[174:175]
    v_pk_add_f32 v[16:17], v[16:17], v[10:11]
    v_pk_add_f32 v[18:19], v[18:19], v[10:11]
    v_pk_add_f32 v[20:21], v[20:21], v[10:11]
    v_pk_add_f32 v[22:23], v[22:23], v[10:11]
    v_rcp_f32 v16, v16
    v_rcp_f32 v17, v17
    v_rcp_f32 v18, v18
    v_rcp_f32 v19, v19
    v_rcp_f32 v20, v20
    v_rcp_f32 v21, v21
    v_rcp_f32 v22, v22
    v_rcp_f32 v23, v23
    s_add_u32 s53, s52, 0x39000
    v_pk_mul_f32 v[184:185], v[184:185], v[16:17]
    v_pk_mul_f32 v[186:187], v[186:187], v[18:19]
    v_pk_mul_f32 v[188:189], v[188:189], v[20:21]
    v_pk_mul_f32 v[190:191], v[190:191], v[22:23]
    v_cvt_pk_bf16_f32 v168, v184, v185
    v_cvt_pk_bf16_f32 v169, v186, v187
    v_cvt_pk_bf16_f32 v170, v188, v189
    v_cvt_pk_bf16_f32 v171, v190, v191
    buffer_store_dwordx4 v[168:171], v3, s[36:39], s53 offen offset:0 sc1
    v_pk_mul_f32 v[24:25], v[200:201], v[200:201]
    v_pk_mul_f32 v[26:27], v[202:203], v[202:203]
    v_pk_mul_f32 v[28:29], v[204:205], v[204:205]
    v_pk_mul_f32 v[30:31], v[206:207], v[206:207]
    v_pk_fma_f32 v[24:25], v[24:25], s[56:57], v[8:9]
    v_pk_fma_f32 v[26:27], v[26:27], s[56:57], v[8:9]
    v_pk_fma_f32 v[28:29], v[28:29], s[56:57], v[8:9]
    v_pk_fma_f32 v[30:31], v[30:31], s[56:57], v[8:9]
    v_pk_mul_f32 v[24:25], v[24:25], v[200:201]
    v_pk_mul_f32 v[26:27], v[26:27], v[202:203]
    v_pk_mul_f32 v[28:29], v[28:29], v[204:205]
    v_pk_mul_f32 v[30:31], v[30:31], v[206:207]
    v_exp_f32 v24, v24
    v_exp_f32 v25, v25
    v_exp_f32 v26, v26
    v_exp_f32 v27, v27
    v_exp_f32 v28, v28
    v_exp_f32 v29, v29
    v_exp_f32 v30, v30
    v_exp_f32 v31, v31
    v_pk_mul_f32 v[216:217], v[216:217], v[200:201]
    v_pk_mul_f32 v[218:219], v[218:219], v[202:203]
    v_pk_mul_f32 v[220:221], v[220:221], v[204:205]
    v_pk_mul_f32 v[222:223], v[222:223], v[206:207]
    v_pk_add_f32 v[24:25], v[24:25], v[10:11]
    v_pk_add_f32 v[26:27], v[26:27], v[10:11]
    v_pk_add_f32 v[28:29], v[28:29], v[10:11]
    v_pk_add_f32 v[30:31], v[30:31], v[10:11]
    v_rcp_f32 v24, v24
    v_rcp_f32 v25, v25
    v_rcp_f32 v26, v26
    v_rcp_f32 v27, v27
    v_rcp_f32 v28, v28
    v_rcp_f32 v29, v29
    v_rcp_f32 v30, v30
    v_rcp_f32 v31, v31
    s_add_u32 s53, s52, 0x39000
    v_pk_mul_f32 v[216:217], v[216:217], v[24:25]
    v_pk_mul_f32 v[218:219], v[218:219], v[26:27]
    v_pk_mul_f32 v[220:221], v[220:221], v[28:29]
    v_pk_mul_f32 v[222:223], v[222:223], v[30:31]
    v_cvt_pk_bf16_f32 v200, v216, v217
    v_cvt_pk_bf16_f32 v201, v218, v219
    v_cvt_pk_bf16_f32 v202, v220, v221
    v_cvt_pk_bf16_f32 v203, v222, v223
    buffer_store_dwordx4 v[200:203], v3, s[36:39], s53 offen offset:1024 sc1
    v_pk_mul_f32 v[16:17], v[232:233], v[232:233]
    v_pk_mul_f32 v[18:19], v[234:235], v[234:235]
    v_pk_mul_f32 v[20:21], v[236:237], v[236:237]
    v_pk_mul_f32 v[22:23], v[238:239], v[238:239]
    v_pk_fma_f32 v[16:17], v[16:17], s[56:57], v[8:9]
    v_pk_fma_f32 v[18:19], v[18:19], s[56:57], v[8:9]
    v_pk_fma_f32 v[20:21], v[20:21], s[56:57], v[8:9]
    v_pk_fma_f32 v[22:23], v[22:23], s[56:57], v[8:9]
    v_pk_mul_f32 v[16:17], v[16:17], v[232:233]
    v_pk_mul_f32 v[18:19], v[18:19], v[234:235]
    v_pk_mul_f32 v[20:21], v[20:21], v[236:237]
    v_pk_mul_f32 v[22:23], v[22:23], v[238:239]
    v_exp_f32 v16, v16
    v_exp_f32 v17, v17
    v_exp_f32 v18, v18
    v_exp_f32 v19, v19
    v_exp_f32 v20, v20
    v_exp_f32 v21, v21
    v_exp_f32 v22, v22
    v_exp_f32 v23, v23
    v_pk_mul_f32 v[248:249], v[248:249], v[232:233]
    v_pk_mul_f32 v[250:251], v[250:251], v[234:235]
    v_pk_mul_f32 v[252:253], v[252:253], v[236:237]
    v_pk_mul_f32 v[254:255], v[254:255], v[238:239]
    v_pk_add_f32 v[16:17], v[16:17], v[10:11]
    v_pk_add_f32 v[18:19], v[18:19], v[10:11]
    v_pk_add_f32 v[20:21], v[20:21], v[10:11]
    v_pk_add_f32 v[22:23], v[22:23], v[10:11]
    v_rcp_f32 v16, v16
    v_rcp_f32 v17, v17
    v_rcp_f32 v18, v18
    v_rcp_f32 v19, v19
    v_rcp_f32 v20, v20
    v_rcp_f32 v21, v21
    v_rcp_f32 v22, v22
    v_rcp_f32 v23, v23
    s_add_u32 s53, s52, 0x39000
    v_pk_mul_f32 v[248:249], v[248:249], v[16:17]
    v_pk_mul_f32 v[250:251], v[250:251], v[18:19]
    v_pk_mul_f32 v[252:253], v[252:253], v[20:21]
    v_pk_mul_f32 v[254:255], v[254:255], v[22:23]
    v_cvt_pk_bf16_f32 v232, v248, v249
    v_cvt_pk_bf16_f32 v233, v250, v251
    v_cvt_pk_bf16_f32 v234, v252, v253
    v_cvt_pk_bf16_f32 v235, v254, v255
    buffer_store_dwordx4 v[232:235], v3, s[36:39], s53 offen offset:2048 sc1
    v_accvgpr_read_b32 v40, a136
    v_accvgpr_read_b32 v56, a152
    v_accvgpr_read_b32 v41, a137
    v_accvgpr_read_b32 v57, a153
    v_accvgpr_read_b32 v42, a138
    v_accvgpr_read_b32 v58, a154
    v_accvgpr_read_b32 v43, a139
    v_accvgpr_read_b32 v59, a155
    v_accvgpr_read_b32 v44, a140
    v_accvgpr_read_b32 v60, a156
    v_accvgpr_read_b32 v45, a141
    v_accvgpr_read_b32 v61, a157
    v_accvgpr_read_b32 v46, a142
    v_accvgpr_read_b32 v62, a158
    v_accvgpr_read_b32 v47, a143
    v_accvgpr_read_b32 v63, a159
    v_pk_mul_f32 v[24:25], v[40:41], v[40:41]
    v_pk_mul_f32 v[26:27], v[42:43], v[42:43]
    v_pk_mul_f32 v[28:29], v[44:45], v[44:45]
    v_pk_mul_f32 v[30:31], v[46:47], v[46:47]
    v_pk_fma_f32 v[24:25], v[24:25], s[56:57], v[8:9]
    v_pk_fma_f32 v[26:27], v[26:27], s[56:57], v[8:9]
    v_pk_fma_f32 v[28:29], v[28:29], s[56:57], v[8:9]
    v_pk_fma_f32 v[30:31], v[30:31], s[56:57], v[8:9]
    v_pk_mul_f32 v[24:25], v[24:25], v[40:41]
    v_pk_mul_f32 v[26:27], v[26:27], v[42:43]
    v_pk_mul_f32 v[28:29], v[28:29], v[44:45]
    v_pk_mul_f32 v[30:31], v[30:31], v[46:47]
    v_exp_f32 v24, v24
    v_exp_f32 v25, v25
    v_exp_f32 v26, v26
    v_exp_f32 v27, v27
    v_exp_f32 v28, v28
    v_exp_f32 v29, v29
    v_exp_f32 v30, v30
    v_exp_f32 v31, v31
    v_pk_mul_f32 v[56:57], v[56:57], v[40:41]
    v_pk_mul_f32 v[58:59], v[58:59], v[42:43]
    v_pk_mul_f32 v[60:61], v[60:61], v[44:45]
    v_pk_mul_f32 v[62:63], v[62:63], v[46:47]
    v_pk_add_f32 v[24:25], v[24:25], v[10:11]
    v_pk_add_f32 v[26:27], v[26:27], v[10:11]
    v_pk_add_f32 v[28:29], v[28:29], v[10:11]
    v_pk_add_f32 v[30:31], v[30:31], v[10:11]
    v_rcp_f32 v24, v24
    v_rcp_f32 v25, v25
    v_rcp_f32 v26, v26
    v_rcp_f32 v27, v27
    v_rcp_f32 v28, v28
    v_rcp_f32 v29, v29
    v_rcp_f32 v30, v30
    v_rcp_f32 v31, v31
    s_add_u32 s53, s52, 0x39000
    v_pk_mul_f32 v[56:57], v[56:57], v[24:25]
    v_pk_mul_f32 v[58:59], v[58:59], v[26:27]
    v_pk_mul_f32 v[60:61], v[60:61], v[28:29]
    v_pk_mul_f32 v[62:63], v[62:63], v[30:31]
    v_cvt_pk_bf16_f32 v40, v56, v57
    v_cvt_pk_bf16_f32 v41, v58, v59
    v_cvt_pk_bf16_f32 v42, v60, v61
    v_cvt_pk_bf16_f32 v43, v62, v63
    buffer_store_dwordx4 v[40:43], v3, s[36:39], s53 offen offset:3072 sc1
    s_waitcnt vmcnt(7)
    s_mov_b32 s58, 1
k_g2:
    v_lshrrev_b32 v28, 2, v1
    v_lshlrev_b32 v28, 18, v28
    v_lshl_add_u32 v28, v2, 13, v28
    v_and_b32 v29, 3, v1
    v_lshl_add_u32 v28, v29, 4, v28
    s_and_b32 s8, s2, 1
    s_lshl_b32 s8, s8, 17
    s_bfe_u32 s9, s2, 0x20003
    s_lshl_b32 s9, s9, 15
    s_add_u32 s8, s8, s9
    s_lshr_b32 s9, s2, 5
    s_lshl_b32 s9, s9, 8
    s_add_u32 s8, s8, s9
    s_bfe_u32 s9, s2, 0x20001
    s_lshl_b32 s9, s9, 6
    s_add_u32 s8, s8, s9
    s_add_u32 s9, s8, 0x1000
    v_accvgpr_read_b32 v176, a240
    v_accvgpr_read_b32 v177, a241
    v_accvgpr_read_b32 v178, a242
    v_accvgpr_read_b32 v179, a243
    v_accvgpr_read_b32 v180, a244
    v_accvgpr_read_b32 v181, a245
    v_accvgpr_read_b32 v182, a246
    v_accvgpr_read_b32 v183, a247
    v_accvgpr_read_b32 v184, a248
    v_accvgpr_read_b32 v185, a249
    v_accvgpr_read_b32 v186, a250
    v_accvgpr_read_b32 v187, a251
    v_accvgpr_read_b32 v188, a252
    v_accvgpr_read_b32 v189, a253
    v_accvgpr_read_b32 v190, a254
    v_accvgpr_read_b32 v191, a255
    s_barrier
    v_lshrrev_b32 v20, 1, v1
    v_and_b32 v20, 7, v20
    v_lshlrev_b32 v21, 1, v2
    v_xor_b32 v20, v20, v21
    v_lshlrev_b32 v20, 4, v20
    v_lshl_add_u32 v20, v1, 7, v20
    v_add_u32 v20, 0x20000, v20
    v_xor_b32 v21, 16, v20
    ds_read_b128 v[32:35], v20 offset:0
    ds_read_b128 v[36:39], v20 offset:8192
    ds_read_b128 v[40:43], v21 offset:0
    ds_read_b128 v[44:47], v21 offset:8192
    v_add_u32 v23, 0x18000, v3
    ds_read_b128 a[160:163], v23 offset:0
    ds_read_b128 a[168:171], v23 offset:2048
    ds_read_b128 a[176:179], v23 offset:4096
    ds_read_b128 a[184:187], v23 offset:6144
    ds_read_b128 a[164:167], v23 offset:1024
    ds_read_b128 a[172:175], v23 offset:3072
    ds_read_b128 a[180:183], v23 offset:5120
    ds_read_b128 a[188:191], v23 offset:7168
    ds_read_b128 a[192:195], v23 offset:8192
    ds_read_b128 a[196:199], v23 offset:9216
    ds_read_b128 a[200:203], v23 offset:10240
    ds_read_b128 a[204:207], v23 offset:11264
    ds_read_b128 v[128:131], v23 offset:14336
    ds_read_b128 v[132:135], v23 offset:15360
    ds_read_b128 v[136:139], v23 offset:16384
    ds_read_b128 v[140:143], v23 offset:17408
    ds_read_b128 a[208:211], v23 offset:12288
    ds_read_b128 a[212:215], v23 offset:13312
    v_and_b32 v22, 15, v1
    v_lshlrev_b32 v22, 10, v22
    v_lshrrev_b32 v23, 4, v1
    v_lshl_add_u32 v22, v23, 4, v22
    s_and_b32 s40, s2, 1
    s_lshl_b32 s40, s40, 9
    s_lshl_b32 s41, s3, 7
    s_add_u32 s40, s40, s41
    s_lshr_b32 s41, s2, 1
    s_lshl_b32 s41, s41, 15
    s_add_u32 s40, s40, s41
    s_add_u32 s41, s40, 0x4000
    s_mov_b32 s69, s58
    s_add_u32 s56, s22, 0x1100000
    s_addc_u32 s57, s23, 0
    s_and_b32 s57, s57, 0xffff
    s_mov_b32 s58, 0x400000
    s_mov_b32 s59, 0x20000
    s_mov_b64 s[46:47], 0xffff
    s_waitcnt lgkmcnt(6)
    v_mfma_f32_16x16x32_bf16 v[48:51], v[32:35], a[160:163], 0
    v_mfma_f32_16x16x32_bf16 v[52:55], v[32:35], a[168:171], 0
    v_mfma_f32_16x16x32_bf16 v[56:59], v[32:35], a[176:179], 0
    v_mfma_f32_16x16x32_bf16 v[60:63], v[32:35], a[184:187], 0
    v_mfma_f32_16x16x32_bf16 v[48:51], v[36:39], a[164:167], v[48:51]
    v_mfma_f32_16x16x32_bf16 v[52:55], v[36:39], a[172:175], v[52:55]
    v_mfma_f32_16x16x32_bf16 v[56:59], v[36:39], a[180:183], v[56:59]
    v_mfma_f32_16x16x32_bf16 v[60:63], v[36:39], a[188:191], v[60:63]
    v_mfma_f32_16x16x32_bf16 v[80:83], v[32:35], a[192:195], 0
    v_mfma_f32_16x16x32_bf16 v[84:87], v[36:39], a[196:199], 0
    v_mfma_f32_16x16x32_bf16 v[88:91], v[32:35], a[200:203], 0
    v_mfma_f32_16x16x32_bf16 v[92:95], v[36:39], a[204:207], 0
    v_mfma_f32_16x16x32_bf16 v[64:67], v[40:43], a[160:163], 0
    v_mfma_f32_16x16x32_bf16 v[68:71], v[40:43], a[168:171], 0
    v_mfma_f32_16x16x32_bf16 v[72:75], v[40:43], a[176:179], 0
    v_mfma_f32_16x16x32_bf16 v[76:79], v[40:43], a[184:187], 0
    v_mfma_f32_16x16x32_bf16 v[64:67], v[44:47], a[164:167], v[64:67]
    v_mfma_f32_16x16x32_bf16 v[68:71], v[44:47], a[172:175], v[68:71]
    v_mfma_f32_16x16x32_bf16 v[72:75], v[44:47], a[180:183], v[72:75]
    v_mfma_f32_16x16x32_bf16 v[76:79], v[44:47], a[188:191], v[76:79]
    v_mfma_f32_16x16x32_bf16 v[96:99], v[40:43], a[192:195], 0
    v_mfma_f32_16x16x32_bf16 v[100:103], v[44:47], a[196:199], 0
    v_mfma_f32_16x16x32_bf16 v[104:107], v[40:43], a[200:203], 0
    v_mfma_f32_16x16x32_bf16 v[108:111], v[44:47], a[204:207], 0
    s_waitcnt lgkmcnt(0)
    v_cndmask_b32 v48, v48, v80, s[46:47]
    v_cndmask_b32 v52, v52, v84, s[46:47]
    v_cndmask_b32 v56, v56, v88, s[46:47]
    v_cndmask_b32 v60, v60, v92, s[46:47]
    v_pk_mul_f32 v[144:145], v[48:49], v[128:129]
    v_pk_mul_f32 v[146:147], v[50:51], v[130:131]
    v_pk_mul_f32 v[148:149], v[52:53], v[128:129]
    v_pk_mul_f32 v[150:151], v[54:55], v[130:131]
    v_pk_fma_f32 v[144:145], v[52:53], v[132:133], v[144:145] neg_lo:[1,0,0] neg_hi:[1,0,0]
    v_pk_fma_f32 v[146:147], v[54:55], v[134:135], v[146:147] neg_lo:[1,0,0] neg_hi:[1,0,0]
    v_pk_fma_f32 v[148:149], v[48:49], v[132:133], v[148:149]
    v_pk_fma_f32 v[150:151], v[50:51], v[134:135], v[150:151]
    v_cvt_pk_bf16_f32 v112, v144, v148
    v_cvt_pk_bf16_f32 v113, v145, v149
    v_cvt_pk_bf16_f32 v114, v146, v150
    v_cvt_pk_bf16_f32 v115, v147, v151
    v_pk_mul_f32 v[152:153], v[56:57], v[136:137]
    v_pk_mul_f32 v[154:155], v[58:59], v[138:139]
    v_pk_mul_f32 v[156:157], v[60:61], v[136:137]
    v_pk_mul_f32 v[158:159], v[62:63], v[138:139]
    v_pk_fma_f32 v[152:153], v[60:61], v[140:141], v[152:153] neg_lo:[1,0,0] neg_hi:[1,0,0]
    v_pk_fma_f32 v[154:155], v[62:63], v[142:143], v[154:155] neg_lo:[1,0,0] neg_hi:[1,0,0]
    v_pk_fma_f32 v[156:157], v[56:57], v[140:141], v[156:157]
    v_pk_fma_f32 v[158:159], v[58:59], v[142:143], v[158:159]
    v_cvt_pk_bf16_f32 v116, v152, v156
    v_cvt_pk_bf16_f32 v117, v153, v157
    v_cvt_pk_bf16_f32 v118, v154, v158
    v_cvt_pk_bf16_f32 v119, v155, v159
    v_cndmask_b32 v64, v64, v96, s[46:47]
    v_cndmask_b32 v68, v68, v100, s[46:47]
    v_cndmask_b32 v72, v72, v104, s[46:47]
    v_cndmask_b32 v76, v76, v108, s[46:47]
    v_pk_mul_f32 v[144:145], v[64:65], v[128:129]
    v_pk_mul_f32 v[146:147], v[66:67], v[130:131]
    v_pk_mul_f32 v[148:149], v[68:69], v[128:129]
    v_pk_mul_f32 v[150:151], v[70:71], v[130:131]
    v_pk_fma_f32 v[144:145], v[68:69], v[132:133], v[144:145] neg_lo:[1,0,0] neg_hi:[1,0,0]
    v_pk_fma_f32 v[146:147], v[70:71], v[134:135], v[146:147] neg_lo:[1,0,0] neg_hi:[1,0,0]
    v_pk_fma_f32 v[148:149], v[64:65], v[132:133], v[148:149]
    v_pk_fma_f32 v[150:151], v[66:67], v[134:135], v[150:151]
    v_cvt_pk_bf16_f32 v120, v144, v148
    v_cvt_pk_bf16_f32 v121, v145, v149
    v_cvt_pk_bf16_f32 v122, v146, v150
    v_cvt_pk_bf16_f32 v123, v147, v151
    v_pk_mul_f32 v[152:153], v[72:73], v[136:137]
    v_pk_mul_f32 v[154:155], v[74:75], v[138:139]
    v_pk_mul_f32 v[156:157], v[76:77], v[136:137]
    v_pk_mul_f32 v[158:159], v[78:79], v[138:139]
    v_pk_fma_f32 v[152:153], v[76:77], v[140:141], v[152:153] neg_lo:[1,0,0] neg_hi:[1,0,0]
    v_pk_fma_f32 v[154:155], v[78:79], v[142:143], v[154:155] neg_lo:[1,0,0] neg_hi:[1,0,0]
    v_pk_fma_f32 v[156:157], v[72:73], v[140:141], v[156:157]
    v_pk_fma_f32 v[158:159], v[74:75], v[142:143], v[158:159]
    v_cvt_pk_bf16_f32 v124, v152, v156
    v_cvt_pk_bf16_f32 v125, v153, v157
    v_cvt_pk_bf16_f32 v126, v154, v158
    v_cvt_pk_bf16_f32 v127, v155, v159
    v_mfma_f32_16x16x32_bf16 v[48:51], v[112:115], a[208:211], 0
    v_mfma_f32_16x16x32_bf16 v[52:55], v[116:119], a[208:211], 0
    v_mfma_f32_16x16x32_bf16 v[56:59], v[112:115], a[212:215], 0
    v_mfma_f32_16x16x32_bf16 v[60:63], v[116:119], a[212:215], 0
    v_mfma_f32_16x16x32_bf16 v[64:67], v[120:123], a[208:211], 0
    v_mfma_f32_16x16x32_bf16 v[68:71], v[124:127], a[208:211], 0
    v_mfma_f32_16x16x32_bf16 v[72:75], v[120:123], a[212:215], 0
    v_mfma_f32_16x16x32_bf16 v[76:79], v[124:127], a[212:215], 0
    v_lshl_add_u32 v4, v2, 12, v3
    v_lshrrev_b32 v24, 2, v1
    v_lshlrev_b32 v25, 8, v24
    v_and_b32 v26, 3, v1
    v_lshl_add_u32 v25, v26, 3, v25
    v_and_b32 v24, 7, v24
    s_lshl_b32 s45, s44, 1
    v_xor_b32 v24, s45, v24
    v_xor_b32 v26, 0, v24
    v_lshl_add_u32 v232, v26, 5, v25
    v_add_u32 v240, 0x10000, v232
    v_xor_b32 v26, 1, v24
    v_lshl_add_u32 v233, v26, 5, v25
    v_add_u32 v241, 0x10000, v233
    v_xor_b32 v26, 2, v24
    v_lshl_add_u32 v234, v26, 5, v25
    v_add_u32 v242, 0x10000, v234
    v_xor_b32 v26, 3, v24
    v_lshl_add_u32 v235, v26, 5, v25
    v_add_u32 v243, 0x10000, v235
    v_xor_b32 v26, 4, v24
    v_lshl_add_u32 v236, v26, 5, v25
    v_add_u32 v244, 0x10000, v236
    v_xor_b32 v26, 5, v24
    v_lshl_add_u32 v237, v26, 5, v25
    v_add_u32 v245, 0x10000, v237
    v_xor_b32 v26, 6, v24
    v_lshl_add_u32 v238, v26, 5, v25
    v_add_u32 v246, 0x10000, v238
    v_xor_b32 v26, 7, v24
    v_lshl_add_u32 v239, v26, 5, v25
    v_add_u32 v247, 0x10000, v239
    v_mov_b32 v12, 0
    v_lshlrev_b32 v13, 7, v1
    v_cvt_pk_bf16_f32 v160, v48, v49
    v_cvt_pk_bf16_f32 v161, v50, v51
    v_cvt_pk_bf16_f32 v162, v52, v53
    v_cvt_pk_bf16_f32 v163, v54, v55
    v_cvt_pk_bf16_f32 v164, v56, v57
    v_cvt_pk_bf16_f32 v165, v58, v59
    v_cvt_pk_bf16_f32 v166, v60, v61
    v_cvt_pk_bf16_f32 v167, v62, v63
    v_cvt_pk_bf16_f32 v168, v64, v65
    v_cvt_pk_bf16_f32 v169, v66, v67
    v_cvt_pk_bf16_f32 v170, v68, v69
    v_cvt_pk_bf16_f32 v171, v70, v71
    v_cvt_pk_bf16_f32 v172, v72, v73
    v_cvt_pk_bf16_f32 v173, v74, v75
    v_cvt_pk_bf16_f32 v174, v76, v77
    v_cvt_pk_bf16_f32 v175, v78, v79
    s_lshl_b32 s60, s42, 2
    s_add_u32 s60, s60, s44
    s_lshl_b32 s47, s60, 10
    s_add_u32 s47, s47, 98304
    s_lshl_b32 s46, s60, 1
    s_lshr_b32 s45, s3, 1
    s_add_u32 s46, s46, s45
    s_lshl_b32 s46, s46, 11
    s_add_u32 s46, s46, 262144
    s_mul_i32 s60, s60, 458752
    s_mov_b32 s68, 0x20000
pl_fa:
    s_bfm_b64 exec, 14, 0
    buffer_load_dword v31, v13, s[24:27], s46 offen sc1
    s_mov_b64 exec, -1
    s_waitcnt vmcnt(0)
    v_cmp_ne_u32 vcc, s70, v31
    s_nop 1
    s_bfm_b64 s[66:67], 14, 0
    s_and_b64 vcc, vcc, s[66:67]
    s_nop 3
    s_cbranch_vccz pd_fa
    s_sleep 4
    s_sub_u32 s68, s68, 1
    s_cmp_lg_u32 s68, 0
    s_cbranch_scc1 pl_fa
pd_fa:
    s_add_u32 s32, s22, 0x1500000
    s_addc_u32 s33, s23, 0
    s_and_b32 s33, s33, 0xffff
    s_mov_b32 s34, 0xe00000
    s_mov_b32 s35, 0x20000
    buffer_load_dwordx4 a[128:131], v4, s[32:35], s60 offen offset:0 sc1
    buffer_load_dwordx4 a[132:135], v4, s[32:35], s60 offen offset:1024 sc1
    buffer_load_dwordx4 a[136:139], v4, s[32:35], s60 offen offset:2048 sc1
    buffer_load_dwordx4 a[140:143], v4, s[32:35], s60 offen offset:3072 sc1
    s_add_u32 s60, s60, 0x4000
    buffer_load_dwordx4 a[144:147], v4, s[32:35], s60 offen offset:0 sc1
    buffer_load_dwordx4 a[148:151], v4, s[32:35], s60 offen offset:1024 sc1
    buffer_load_dwordx4 a[152:155], v4, s[32:35], s60 offen offset:2048 sc1
    buffer_load_dwordx4 a[156:159], v4, s[32:35], s60 offen offset:3072 sc1
    s_add_u32 s60, s60, 0x4000
    buffer_load_dwordx4 a[160:163], v4, s[32:35], s60 offen offset:0 sc1
    buffer_load_dwordx4 a[164:167], v4, s[32:35], s60 offen offset:1024 sc1
    buffer_load_dwordx4 a[168:171], v4, s[32:35], s60 offen offset:2048 sc1
    buffer_load_dwordx4 a[172:175], v4, s[32:35], s60 offen offset:3072 sc1
    s_add_u32 s60, s60, 0x4000
    ds_read_b64_tr_b16 a[0:1], v232 offset:0
    ds_read_b64_tr_b16 a[2:3], v232 offset:4096
    ds_read_b64_tr_b16 a[4:5], v233 offset:0
    ds_read_b64_tr_b16 a[6:7], v233 offset:4096
    ds_read_b64_tr_b16 a[8:9], v234 offset:0
    ds_read_b64_tr_b16 a[10:11], v234 offset:4096
    ds_read_b64_tr_b16 a[12:13], v235 offset:0
    ds_read_b64_tr_b16 a[14:15], v235 offset:4096
    ds_read_b64_tr_b16 a[16:17], v236 offset:0
    ds_read_b64_tr_b16 a[18:19], v236 offset:4096
    ds_read_b64_tr_b16 a[20:21], v237 offset:0
    ds_read_b64_tr_b16 a[22:23], v237 offset:4096
    ds_read_b64_tr_b16 a[24:25], v238 offset:0
    ds_read_b64_tr_b16 a[26:27], v238 offset:4096
    ds_read_b64_tr_b16 a[28:29], v239 offset:0
    ds_read_b64_tr_b16 a[30:31], v239 offset:4096
    ds_read_b64_tr_b16 a[32:33], v232 offset:8192
    ds_read_b64_tr_b16 a[34:35], v232 offset:12288
    ds_read_b64_tr_b16 a[36:37], v233 offset:8192
    ds_read_b64_tr_b16 a[38:39], v233 offset:12288
    ds_read_b64_tr_b16 a[40:41], v234 offset:8192
    ds_read_b64_tr_b16 a[42:43], v234 offset:12288
    ds_read_b64_tr_b16 a[44:45], v235 offset:8192
    ds_read_b64_tr_b16 a[46:47], v235 offset:12288
    ds_read_b64_tr_b16 a[48:49], v236 offset:8192
    ds_read_b64_tr_b16 a[50:51], v236 offset:12288
    ds_read_b64_tr_b16 a[52:53], v237 offset:8192
    ds_read_b64_tr_b16 a[54:55], v237 offset:12288
    ds_read_b64_tr_b16 a[56:57], v238 offset:8192
    ds_read_b64_tr_b16 a[58:59], v238 offset:12288
    ds_read_b64_tr_b16 a[60:61], v239 offset:8192
    ds_read_b64_tr_b16 a[62:63], v239 offset:12288
    s_lshl_b32 s53, s2, 2
    s_add_u32 s53, s53, s3
    s_mul_i32 s52, s53, 12288
    s_lshl_b32 s53, s53, 9
    s_add_u32 s53, s53, 393216
    s_lshl_b32 s54, s2, 7
    s_add_u32 s54, s54, 131072
    s_lshl_b32 s46, s42, 12
    s_lshl_b32 s45, s3, 10
    s_add_u32 s46, s46, s45
    s_add_u32 s46, s46, 131072
    s_add_u32 s36, s22, 0x2400000
    s_addc_u32 s37, s23, 0
    s_and_b32 s37, s37, 0xffff
    s_mov_b32 s38, 0xc00000
    s_mov_b32 s39, 0x20000
    v_and_b32 v21, 15, v1
    v_mul_u32_u24 v16, 80, v21
    v_lshrrev_b32 v21, 4, v1
    v_lshl_add_u32 v16, v21, 3, v16
    v_lshl_add_u32 v16, v2, 13, v16
    v_lshrrev_b32 v21, 2, v1
    v_mul_u32_u24 v17, 80, v21
    v_and_b32 v21, 3, v1
    v_lshl_add_u32 v17, v21, 4, v17
    v_lshl_add_u32 v17, v2, 13, v17
    s_waitcnt vmcnt(8) lgkmcnt(15)
    v_mfma_f32_16x16x32_bf16 v[32:35], a[0:3], a[128:131], 0
    ds_read_b64_tr_b16 a[64:65], v232 offset:16384
    v_mfma_f32_16x16x32_bf16 v[48:51], a[4:7], a[128:131], 0
    v_mfma_f32_16x16x32_bf16 v[64:67], a[8:11], a[128:131], 0
    ds_read_b64_tr_b16 a[66:67], v232 offset:20480
    v_mfma_f32_16x16x32_bf16 v[80:83], a[12:15], a[128:131], 0
    buffer_load_dwordx4 a[176:179], v4, s[32:35], s60 offen offset:0 sc1
    v_mfma_f32_16x16x32_bf16 v[96:99], a[16:19], a[128:131], 0
    ds_read_b64_tr_b16 a[68:69], v233 offset:16384
    v_mfma_f32_16x16x32_bf16 v[112:115], a[20:23], a[128:131], 0
    s_add_u32 m0, s64, 0x1000
    v_mfma_f32_16x16x32_bf16 v[128:131], a[24:27], a[128:131], 0
    ds_read_b64_tr_b16 a[70:71], v233 offset:20480
    v_mfma_f32_16x16x32_bf16 v[144:147], a[28:31], a[128:131], 0
    buffer_load_dwordx4 v5, s[48:51], s61 offen lds
    v_mfma_f32_16x16x32_bf16 v[36:39], a[0:3], a[132:135], 0
    ds_read_b64_tr_b16 a[72:73], v234 offset:16384
    v_mfma_f32_16x16x32_bf16 v[52:55], a[4:7], a[132:135], 0
    buffer_load_dwordx4 a[180:183], v4, s[32:35], s60 offen offset:1024 sc1
    v_mfma_f32_16x16x32_bf16 v[68:71], a[8:11], a[132:135], 0
    ds_read_b64_tr_b16 a[74:75], v234 offset:20480
    v_mfma_f32_16x16x32_bf16 v[84:87], a[12:15], a[132:135], 0
    buffer_load_dwordx4 a[184:187], v4, s[32:35], s60 offen offset:2048 sc1
    v_mfma_f32_16x16x32_bf16 v[100:103], a[16:19], a[132:135], 0
    ds_read_b64_tr_b16 a[76:77], v235 offset:16384
    v_mfma_f32_16x16x32_bf16 v[116:119], a[20:23], a[132:135], 0
    v_mfma_f32_16x16x32_bf16 v[132:135], a[24:27], a[132:135], 0
    ds_read_b64_tr_b16 a[78:79], v235 offset:20480
    v_mfma_f32_16x16x32_bf16 v[148:151], a[28:31], a[132:135], 0
    buffer_load_dwordx4 a[188:191], v4, s[32:35], s60 offen offset:3072 sc1
    v_mfma_f32_16x16x32_bf16 v[40:43], a[0:3], a[136:139], 0
    ds_read_b64_tr_b16 a[80:81], v236 offset:16384
    v_mfma_f32_16x16x32_bf16 v[56:59], a[4:7], a[136:139], 0
    s_add_u32 s60, s60, 0x4000
    v_mfma_f32_16x16x32_bf16 v[72:75], a[8:11], a[136:139], 0
    ds_read_b64_tr_b16 a[82:83], v236 offset:20480
    v_mfma_f32_16x16x32_bf16 v[88:91], a[12:15], a[136:139], 0
    buffer_load_dwordx4 a[192:195], v4, s[32:35], s60 offen offset:0 sc1
    v_mfma_f32_16x16x32_bf16 v[104:107], a[16:19], a[136:139], 0
    ds_read_b64_tr_b16 a[84:85], v237 offset:16384
    v_mfma_f32_16x16x32_bf16 v[120:123], a[20:23], a[136:139], 0
    buffer_load_dwordx4 v6, s[48:51], s61 offen offset:1024 lds
    v_mfma_f32_16x16x32_bf16 v[136:139], a[24:27], a[136:139], 0
    ds_read_b64_tr_b16 a[86:87], v237 offset:20480
    v_mfma_f32_16x16x32_bf16 v[152:155], a[28:31], a[136:139], 0
    buffer_load_dwordx4 a[196:199], v4, s[32:35], s60 offen offset:1024 sc1
    v_mfma_f32_16x16x32_bf16 v[44:47], a[0:3], a[140:143], 0
    ds_read_b64_tr_b16 a[88:89], v238 offset:16384
    v_mfma_f32_16x16x32_bf16 v[60:63], a[4:7], a[140:143], 0
    v_mfma_f32_16x16x32_bf16 v[76:79], a[8:11], a[140:143], 0
    ds_read_b64_tr_b16 a[90:91], v238 offset:20480
    v_mfma_f32_16x16x32_bf16 v[92:95], a[12:15], a[140:143], 0
    buffer_load_dwordx4 a[200:203], v4, s[32:35], s60 offen offset:2048 sc1
    v_mfma_f32_16x16x32_bf16 v[108:111], a[16:19], a[140:143], 0
    ds_read_b64_tr_b16 a[92:93], v239 offset:16384
    v_mfma_f32_16x16x32_bf16 v[124:127], a[20:23], a[140:143], 0
    v_mfma_f32_16x16x32_bf16 v[140:143], a[24:27], a[140:143], 0
    ds_read_b64_tr_b16 a[94:95], v239 offset:20480
    v_mfma_f32_16x16x32_bf16 v[156:159], a[28:31], a[140:143], 0
    buffer_load_dwordx4 a[204:207], v4, s[32:35], s60 offen offset:3072 sc1
    s_add_u32 s60, s60, 0x4000
    s_waitcnt vmcnt(14) lgkmcnt(15)
    v_mfma_f32_16x16x32_bf16 v[32:35], a[32:35], a[144:147], v[32:35]
    ds_read_b64_tr_b16 a[96:97], v232 offset:24576
    v_mfma_f32_16x16x32_bf16 v[48:51], a[36:39], a[144:147], v[48:51]
    v_mfma_f32_16x16x32_bf16 v[64:67], a[40:43], a[144:147], v[64:67]
    ds_read_b64_tr_b16 a[98:99], v232 offset:28672
    v_mfma_f32_16x16x32_bf16 v[80:83], a[44:47], a[144:147], v[80:83]
    buffer_load_dwordx4 a[208:211], v4, s[32:35], s60 offen offset:0 sc1
    v_mfma_f32_16x16x32_bf16 v[96:99], a[48:51], a[144:147], v[96:99]
    ds_read_b64_tr_b16 a[100:101], v233 offset:24576
    v_mfma_f32_16x16x32_bf16 v[112:115], a[52:55], a[144:147], v[112:115]
    buffer_load_dwordx4 v14, s[48:51], s61 offen offset:2048 lds
    v_mfma_f32_16x16x32_bf16 v[128:131], a[56:59], a[144:147], v[128:131]
    ds_read_b64_tr_b16 a[102:103], v233 offset:28672
    v_mfma_f32_16x16x32_bf16 v[144:147], a[60:63], a[144:147], v[144:147]
    buffer_load_dwordx4 a[212:215], v4, s[32:35], s60 offen offset:1024 sc1
    v_mfma_f32_16x16x32_bf16 v[36:39], a[32:35], a[148:151], v[36:39]
    ds_read_b64_tr_b16 a[104:105], v234 offset:24576
    v_mfma_f32_16x16x32_bf16 v[52:55], a[36:39], a[148:151], v[52:55]
    v_mfma_f32_16x16x32_bf16 v[68:71], a[40:43], a[148:151], v[68:71]
    ds_read_b64_tr_b16 a[106:107], v234 offset:28672
    v_mfma_f32_16x16x32_bf16 v[84:87], a[44:47], a[148:151], v[84:87]
    buffer_load_dwordx4 a[216:219], v4, s[32:35], s60 offen offset:2048 sc1
    v_mfma_f32_16x16x32_bf16 v[100:103], a[48:51], a[148:151], v[100:103]
    ds_read_b64_tr_b16 a[108:109], v235 offset:24576
    v_mfma_f32_16x16x32_bf16 v[116:119], a[52:55], a[148:151], v[116:119]
    v_mfma_f32_16x16x32_bf16 v[132:135], a[56:59], a[148:151], v[132:135]
    ds_read_b64_tr_b16 a[110:111], v235 offset:28672
    v_mfma_f32_16x16x32_bf16 v[148:151], a[60:63], a[148:151], v[148:151]
    buffer_load_dwordx4 a[220:223], v4, s[32:35], s60 offen offset:3072 sc1
    v_mfma_f32_16x16x32_bf16 v[40:43], a[32:35], a[152:155], v[40:43]
    ds_read_b64_tr_b16 a[112:113], v236 offset:24576
    v_mfma_f32_16x16x32_bf16 v[56:59], a[36:39], a[152:155], v[56:59]
    s_add_u32 s60, s60, 0x4000
    v_mfma_f32_16x16x32_bf16 v[72:75], a[40:43], a[152:155], v[72:75]
    ds_read_b64_tr_b16 a[114:115], v236 offset:28672
    v_mfma_f32_16x16x32_bf16 v[88:91], a[44:47], a[152:155], v[88:91]
    buffer_load_dwordx4 a[224:227], v4, s[32:35], s60 offen offset:0 sc1
    v_mfma_f32_16x16x32_bf16 v[104:107], a[48:51], a[152:155], v[104:107]
    ds_read_b64_tr_b16 a[116:117], v237 offset:24576
    v_mfma_f32_16x16x32_bf16 v[120:123], a[52:55], a[152:155], v[120:123]
    buffer_load_dwordx4 v15, s[48:51], s61 offen offset:3072 lds
    v_mfma_f32_16x16x32_bf16 v[136:139], a[56:59], a[152:155], v[136:139]
    ds_read_b64_tr_b16 a[118:119], v237 offset:28672
    v_mfma_f32_16x16x32_bf16 v[152:155], a[60:63], a[152:155], v[152:155]
    s_add_u32 s61, s61, 0x78000
    v_mfma_f32_16x16x32_bf16 v[44:47], a[32:35], a[156:159], v[44:47]
    ds_read_b64_tr_b16 a[120:121], v238 offset:24576
    v_mfma_f32_16x16x32_bf16 v[60:63], a[36:39], a[156:159], v[60:63]
    s_cmp_ge_u32 s61, s62
    v_mfma_f32_16x16x32_bf16 v[76:79], a[40:43], a[156:159], v[76:79]
    ds_read_b64_tr_b16 a[122:123], v238 offset:28672
    v_mfma_f32_16x16x32_bf16 v[92:95], a[44:47], a[156:159], v[92:95]
    s_cselect_b32 s65, 1769472, 0
    v_mfma_f32_16x16x32_bf16 v[108:111], a[48:51], a[156:159], v[108:111]
    ds_read_b64_tr_b16 a[124:125], v239 offset:24576
    v_mfma_f32_16x16x32_bf16 v[124:127], a[52:55], a[156:159], v[124:127]
    s_cselect_b32 s62, -1, s62
    v_mfma_f32_16x16x32_bf16 v[140:143], a[56:59], a[156:159], v[140:143]
    ds_read_b64_tr_b16 a[126:127], v239 offset:28672
    v_mfma_f32_16x16x32_bf16 v[156:159], a[60:63], a[156:159], v[156:159]
    s_sub_u32 s61, s61, s65
    buffer_load_dwordx4 a[228:231], v4, s[32:35], s60 offen offset:1024 sc1
    buffer_load_dwordx4 a[232:235], v4, s[32:35], s60 offen offset:2048 sc1
    buffer_load_dwordx4 a[236:239], v4, s[32:35], s60 offen offset:3072 sc1
    s_add_u32 s60, s60, 0x4000
    s_waitcnt vmcnt(20) lgkmcnt(15)
    s_barrier
    s_cmp_lg_u32 s3, 0
    s_cbranch_scc1 g2_np
    s_cmp_eq_u32 s69, 0
    s_cbranch_scc1 g2_np
    v_mov_b32 v25, s70
    s_mov_b64 exec, 1
    buffer_store_dword v25, v12, s[24:27], s55 offen sc1
    s_mov_b64 exec, -1
g2_np:
    v_mfma_f32_16x16x32_bf16 v[32:35], a[64:67], a[160:163], v[32:35]
    ds_read_b64_tr_b16 a[0:1], v232 offset:32768
    v_mfma_f32_16x16x32_bf16 v[48:51], a[68:71], a[160:163], v[48:51]
    v_mfma_f32_16x16x32_bf16 v[64:67], a[72:75], a[160:163], v[64:67]
    ds_read_b64_tr_b16 a[2:3], v232 offset:36864
    v_mfma_f32_16x16x32_bf16 v[80:83], a[76:79], a[160:163], v[80:83]
    buffer_load_dwordx4 a[240:243], v4, s[32:35], s60 offen offset:0 sc1
    v_mfma_f32_16x16x32_bf16 v[96:99], a[80:83], a[160:163], v[96:99]
    ds_read_b64_tr_b16 a[4:5], v233 offset:32768
    v_mfma_f32_16x16x32_bf16 v[112:115], a[84:87], a[160:163], v[112:115]
    s_add_u32 m0, s64, 0x8000
    v_mfma_f32_16x16x32_bf16 v[128:131], a[88:91], a[160:163], v[128:131]
    ds_read_b64_tr_b16 a[6:7], v233 offset:36864
    v_mfma_f32_16x16x32_bf16 v[144:147], a[92:95], a[160:163], v[144:147]
    buffer_load_dwordx4 v5, s[48:51], s61 offen lds
    v_mfma_f32_16x16x32_bf16 v[36:39], a[64:67], a[164:167], v[36:39]
    ds_read_b64_tr_b16 a[8:9], v234 offset:32768
    v_mfma_f32_16x16x32_bf16 v[52:55], a[68:71], a[164:167], v[52:55]
    buffer_load_dwordx4 a[244:247], v4, s[32:35], s60 offen offset:1024 sc1
    v_mfma_f32_16x16x32_bf16 v[68:71], a[72:75], a[164:167], v[68:71]
    ds_read_b64_tr_b16 a[10:11], v234 offset:36864
    v_mfma_f32_16x16x32_bf16 v[84:87], a[76:79], a[164:167], v[84:87]
    buffer_load_dwordx4 a[248:251], v4, s[32:35], s60 offen offset:2048 sc1
    v_mfma_f32_16x16x32_bf16 v[100:103], a[80:83], a[164:167], v[100:103]
    ds_read_b64_tr_b16 a[12:13], v235 offset:32768
    v_mfma_f32_16x16x32_bf16 v[116:119], a[84:87], a[164:167], v[116:119]
    v_mfma_f32_16x16x32_bf16 v[132:135], a[88:91], a[164:167], v[132:135]
    ds_read_b64_tr_b16 a[14:15], v235 offset:36864
    v_mfma_f32_16x16x32_bf16 v[148:151], a[92:95], a[164:167], v[148:151]
    buffer_load_dwordx4 a[252:255], v4, s[32:35], s60 offen offset:3072 sc1
    v_mfma_f32_16x16x32_bf16 v[40:43], a[64:67], a[168:171], v[40:43]
    ds_read_b64_tr_b16 a[16:17], v236 offset:32768
    v_mfma_f32_16x16x32_bf16 v[56:59], a[68:71], a[168:171], v[56:59]
    s_add_u32 s60, s60, 0x4000
    v_mfma_f32_16x16x32_bf16 v[72:75], a[72:75], a[168:171], v[72:75]
    ds_read_b64_tr_b16 a[18:19], v236 offset:36864
    v_mfma_f32_16x16x32_bf16 v[88:91], a[76:79], a[168:171], v[88:91]
    buffer_load_dwordx4 a[128:131], v4, s[32:35], s60 offen offset:0 sc1
    v_mfma_f32_16x16x32_bf16 v[104:107], a[80:83], a[168:171], v[104:107]
    ds_read_b64_tr_b16 a[20:21], v237 offset:32768
    v_mfma_f32_16x16x32_bf16 v[120:123], a[84:87], a[168:171], v[120:123]
    buffer_load_dwordx4 v6, s[48:51], s61 offen offset:1024 lds
    v_mfma_f32_16x16x32_bf16 v[136:139], a[88:91], a[168:171], v[136:139]
    ds_read_b64_tr_b16 a[22:23], v237 offset:36864
    v_mfma_f32_16x16x32_bf16 v[152:155], a[92:95], a[168:171], v[152:155]
    buffer_load_dwordx4 a[132:135], v4, s[32:35], s60 offen offset:1024 sc1
    v_mfma_f32_16x16x32_bf16 v[44:47], a[64:67], a[172:175], v[44:47]
    ds_read_b64_tr_b16 a[24:25], v238 offset:32768
    v_mfma_f32_16x16x32_bf16 v[60:63], a[68:71], a[172:175], v[60:63]
    v_mfma_f32_16x16x32_bf16 v[76:79], a[72:75], a[172:175], v[76:79]
    ds_read_b64_tr_b16 a[26:27], v238 offset:36864
    v_mfma_f32_16x16x32_bf16 v[92:95], a[76:79], a[172:175], v[92:95]
    buffer_load_dwordx4 a[136:139], v4, s[32:35], s60 offen offset:2048 sc1
    v_mfma_f32_16x16x32_bf16 v[108:111], a[80:83], a[172:175], v[108:111]
    ds_read_b64_tr_b16 a[28:29], v239 offset:32768
    v_mfma_f32_16x16x32_bf16 v[124:127], a[84:87], a[172:175], v[124:127]
    v_mfma_f32_16x16x32_bf16 v[140:143], a[88:91], a[172:175], v[140:143]
    ds_read_b64_tr_b16 a[30:31], v239 offset:36864
    v_mfma_f32_16x16x32_bf16 v[156:159], a[92:95], a[172:175], v[156:159]
    buffer_load_dwordx4 a[140:143], v4, s[32:35], s60 offen offset:3072 sc1
    s_add_u32 s60, s60, 0x4000
    s_waitcnt vmcnt(25) lgkmcnt(15)
    v_mfma_f32_16x16x32_bf16 v[32:35], a[96:99], a[176:179], v[32:35]
    ds_read_b64_tr_b16 a[32:33], v232 offset:40960
    v_mfma_f32_16x16x32_bf16 v[48:51], a[100:103], a[176:179], v[48:51]
    v_mfma_f32_16x16x32_bf16 v[64:67], a[104:107], a[176:179], v[64:67]
    ds_read_b64_tr_b16 a[34:35], v232 offset:45056
    v_mfma_f32_16x16x32_bf16 v[80:83], a[108:111], a[176:179], v[80:83]
    buffer_load_dwordx4 a[144:147], v4, s[32:35], s60 offen offset:0 sc1
    v_mfma_f32_16x16x32_bf16 v[96:99], a[112:115], a[176:179], v[96:99]
    ds_read_b64_tr_b16 a[36:37], v233 offset:40960
    v_mfma_f32_16x16x32_bf16 v[112:115], a[116:119], a[176:179], v[112:115]
    buffer_load_dwordx4 v14, s[48:51], s61 offen offset:2048 lds
    v_mfma_f32_16x16x32_bf16 v[128:131], a[120:123], a[176:179], v[128:131]
    ds_read_b64_tr_b16 a[38:39], v233 offset:45056
    v_mfma_f32_16x16x32_bf16 v[144:147], a[124:127], a[176:179], v[144:147]
    v_mfma_f32_16x16x32_bf16 v[36:39], a[96:99], a[180:183], v[36:39]
    ds_read_b64_tr_b16 a[40:41], v234 offset:40960
    v_mfma_f32_16x16x32_bf16 v[52:55], a[100:103], a[180:183], v[52:55]
    v_mfma_f32_16x16x32_bf16 v[68:71], a[104:107], a[180:183], v[68:71]
    ds_read_b64_tr_b16 a[42:43], v234 offset:45056
    v_mfma_f32_16x16x32_bf16 v[84:87], a[108:111], a[180:183], v[84:87]
    buffer_load_dwordx4 a[148:151], v4, s[32:35], s60 offen offset:1024 sc1
    v_mfma_f32_16x16x32_bf16 v[100:103], a[112:115], a[180:183], v[100:103]
    ds_read_b64_tr_b16 a[44:45], v235 offset:40960
    v_mfma_f32_16x16x32_bf16 v[116:119], a[116:119], a[180:183], v[116:119]
    v_mfma_f32_16x16x32_bf16 v[132:135], a[120:123], a[180:183], v[132:135]
    ds_read_b64_tr_b16 a[46:47], v235 offset:45056
    v_mfma_f32_16x16x32_bf16 v[148:151], a[124:127], a[180:183], v[148:151]
    v_mfma_f32_16x16x32_bf16 v[40:43], a[96:99], a[184:187], v[40:43]
    ds_read_b64_tr_b16 a[48:49], v236 offset:40960
    v_mfma_f32_16x16x32_bf16 v[56:59], a[100:103], a[184:187], v[56:59]
    v_mfma_f32_16x16x32_bf16 v[72:75], a[104:107], a[184:187], v[72:75]
    ds_read_b64_tr_b16 a[50:51], v236 offset:45056
    v_mfma_f32_16x16x32_bf16 v[88:91], a[108:111], a[184:187], v[88:91]
    buffer_load_dwordx4 a[152:155], v4, s[32:35], s60 offen offset:2048 sc1
    v_mfma_f32_16x16x32_bf16 v[104:107], a[112:115], a[184:187], v[104:107]
    ds_read_b64_tr_b16 a[52:53], v237 offset:40960
    v_mfma_f32_16x16x32_bf16 v[120:123], a[116:119], a[184:187], v[120:123]
    buffer_load_dwordx4 v15, s[48:51], s61 offen offset:3072 lds
    v_mfma_f32_16x16x32_bf16 v[136:139], a[120:123], a[184:187], v[136:139]
    ds_read_b64_tr_b16 a[54:55], v237 offset:45056
    v_mfma_f32_16x16x32_bf16 v[152:155], a[124:127], a[184:187], v[152:155]
    s_add_u32 s61, s61, 0x8000
    v_mfma_f32_16x16x32_bf16 v[44:47], a[96:99], a[188:191], v[44:47]
    ds_read_b64_tr_b16 a[56:57], v238 offset:40960
    v_mfma_f32_16x16x32_bf16 v[60:63], a[100:103], a[188:191], v[60:63]
    v_mfma_f32_16x16x32_bf16 v[76:79], a[104:107], a[188:191], v[76:79]
    ds_read_b64_tr_b16 a[58:59], v238 offset:45056
    v_mfma_f32_16x16x32_bf16 v[92:95], a[108:111], a[188:191], v[92:95]
    buffer_load_dwordx4 a[156:159], v4, s[32:35], s60 offen offset:3072 sc1
    v_mfma_f32_16x16x32_bf16 v[108:111], a[112:115], a[188:191], v[108:111]
    ds_read_b64_tr_b16 a[60:61], v239 offset:40960
    v_mfma_f32_16x16x32_bf16 v[124:127], a[116:119], a[188:191], v[124:127]
    s_add_u32 s60, s60, 0x4000
    v_mfma_f32_16x16x32_bf16 v[140:143], a[120:123], a[188:191], v[140:143]
    ds_read_b64_tr_b16 a[62:63], v239 offset:45056
    v_mfma_f32_16x16x32_bf16 v[156:159], a[124:127], a[188:191], v[156:159]
    s_waitcnt vmcnt(26) lgkmcnt(15)
    v_mfma_f32_16x16x32_bf16 v[32:35], a[0:3], a[192:195], v[32:35]
    ds_read_b64_tr_b16 a[64:65], v232 offset:49152
    v_mfma_f32_16x16x32_bf16 v[48:51], a[4:7], a[192:195], v[48:51]
    v_mfma_f32_16x16x32_bf16 v[64:67], a[8:11], a[192:195], v[64:67]
    ds_read_b64_tr_b16 a[66:67], v232 offset:53248
    v_mfma_f32_16x16x32_bf16 v[80:83], a[12:15], a[192:195], v[80:83]
    buffer_load_dwordx4 a[160:163], v4, s[32:35], s60 offen offset:0 sc1
    v_mfma_f32_16x16x32_bf16 v[96:99], a[16:19], a[192:195], v[96:99]
    ds_read_b64_tr_b16 a[68:69], v233 offset:49152
    v_mfma_f32_16x16x32_bf16 v[112:115], a[20:23], a[192:195], v[112:115]
    s_add_u32 m0, s64, 0x9000
    v_mfma_f32_16x16x32_bf16 v[128:131], a[24:27], a[192:195], v[128:131]
    ds_read_b64_tr_b16 a[70:71], v233 offset:53248
    v_mfma_f32_16x16x32_bf16 v[144:147], a[28:31], a[192:195], v[144:147]
    buffer_load_dwordx4 v5, s[48:51], s61 offen lds
    v_mfma_f32_16x16x32_bf16 v[36:39], a[0:3], a[196:199], v[36:39]
    ds_read_b64_tr_b16 a[72:73], v234 offset:49152
    v_mfma_f32_16x16x32_bf16 v[52:55], a[4:7], a[196:199], v[52:55]
    v_mfma_f32_16x16x32_bf16 v[68:71], a[8:11], a[196:199], v[68:71]
    ds_read_b64_tr_b16 a[74:75], v234 offset:53248
    v_mfma_f32_16x16x32_bf16 v[84:87], a[12:15], a[196:199], v[84:87]
    buffer_load_dwordx4 a[164:167], v4, s[32:35], s60 offen offset:1024 sc1
    v_mfma_f32_16x16x32_bf16 v[100:103], a[16:19], a[196:199], v[100:103]
    ds_read_b64_tr_b16 a[76:77], v235 offset:49152
    v_mfma_f32_16x16x32_bf16 v[116:119], a[20:23], a[196:199], v[116:119]
    v_mfma_f32_16x16x32_bf16 v[132:135], a[24:27], a[196:199], v[132:135]
    ds_read_b64_tr_b16 a[78:79], v235 offset:53248
    v_mfma_f32_16x16x32_bf16 v[148:151], a[28:31], a[196:199], v[148:151]
    v_mfma_f32_16x16x32_bf16 v[40:43], a[0:3], a[200:203], v[40:43]
    ds_read_b64_tr_b16 a[80:81], v236 offset:49152
    v_mfma_f32_16x16x32_bf16 v[56:59], a[4:7], a[200:203], v[56:59]
    v_mfma_f32_16x16x32_bf16 v[72:75], a[8:11], a[200:203], v[72:75]
    ds_read_b64_tr_b16 a[82:83], v236 offset:53248
    v_mfma_f32_16x16x32_bf16 v[88:91], a[12:15], a[200:203], v[88:91]
    buffer_load_dwordx4 a[168:171], v4, s[32:35], s60 offen offset:2048 sc1
    v_mfma_f32_16x16x32_bf16 v[104:107], a[16:19], a[200:203], v[104:107]
    ds_read_b64_tr_b16 a[84:85], v237 offset:49152
    v_mfma_f32_16x16x32_bf16 v[120:123], a[20:23], a[200:203], v[120:123]
    buffer_load_dwordx4 v6, s[48:51], s61 offen offset:1024 lds
    v_mfma_f32_16x16x32_bf16 v[136:139], a[24:27], a[200:203], v[136:139]
    ds_read_b64_tr_b16 a[86:87], v237 offset:53248
    v_mfma_f32_16x16x32_bf16 v[152:155], a[28:31], a[200:203], v[152:155]
    v_mfma_f32_16x16x32_bf16 v[44:47], a[0:3], a[204:207], v[44:47]
    ds_read_b64_tr_b16 a[88:89], v238 offset:49152
    v_mfma_f32_16x16x32_bf16 v[60:63], a[4:7], a[204:207], v[60:63]
    v_mfma_f32_16x16x32_bf16 v[76:79], a[8:11], a[204:207], v[76:79]
    ds_read_b64_tr_b16 a[90:91], v238 offset:53248
    v_mfma_f32_16x16x32_bf16 v[92:95], a[12:15], a[204:207], v[92:95]
    buffer_load_dwordx4 a[172:175], v4, s[32:35], s60 offen offset:3072 sc1
    v_mfma_f32_16x16x32_bf16 v[108:111], a[16:19], a[204:207], v[108:111]
    ds_read_b64_tr_b16 a[92:93], v239 offset:49152
    v_mfma_f32_16x16x32_bf16 v[124:127], a[20:23], a[204:207], v[124:127]
    s_add_u32 s60, s60, 0x4000
    v_mfma_f32_16x16x32_bf16 v[140:143], a[24:27], a[204:207], v[140:143]
    ds_read_b64_tr_b16 a[94:95], v239 offset:53248
    v_mfma_f32_16x16x32_bf16 v[156:159], a[28:31], a[204:207], v[156:159]
    s_waitcnt vmcnt(27) lgkmcnt(15)
    v_mfma_f32_16x16x32_bf16 v[32:35], a[32:35], a[208:211], v[32:35]
    ds_read_b64_tr_b16 a[96:97], v232 offset:57344
    v_mfma_f32_16x16x32_bf16 v[48:51], a[36:39], a[208:211], v[48:51]
    v_mfma_f32_16x16x32_bf16 v[64:67], a[40:43], a[208:211], v[64:67]
    ds_read_b64_tr_b16 a[98:99], v232 offset:61440
    v_mfma_f32_16x16x32_bf16 v[80:83], a[44:47], a[208:211], v[80:83]
    buffer_load_dwordx4 a[176:179], v4, s[32:35], s60 offen offset:0 sc1
    v_mfma_f32_16x16x32_bf16 v[96:99], a[48:51], a[208:211], v[96:99]
    ds_read_b64_tr_b16 a[100:101], v233 offset:57344
    v_mfma_f32_16x16x32_bf16 v[112:115], a[52:55], a[208:211], v[112:115]
    buffer_load_dwordx4 v14, s[48:51], s61 offen offset:2048 lds
    v_mfma_f32_16x16x32_bf16 v[128:131], a[56:59], a[208:211], v[128:131]
    ds_read_b64_tr_b16 a[102:103], v233 offset:61440
    v_mfma_f32_16x16x32_bf16 v[144:147], a[60:63], a[208:211], v[144:147]
    v_mfma_f32_16x16x32_bf16 v[36:39], a[32:35], a[212:215], v[36:39]
    ds_read_b64_tr_b16 a[104:105], v234 offset:57344
    v_mfma_f32_16x16x32_bf16 v[52:55], a[36:39], a[212:215], v[52:55]
    v_mfma_f32_16x16x32_bf16 v[68:71], a[40:43], a[212:215], v[68:71]
    ds_read_b64_tr_b16 a[106:107], v234 offset:61440
    v_mfma_f32_16x16x32_bf16 v[84:87], a[44:47], a[212:215], v[84:87]
    buffer_load_dwordx4 a[180:183], v4, s[32:35], s60 offen offset:1024 sc1
    v_mfma_f32_16x16x32_bf16 v[100:103], a[48:51], a[212:215], v[100:103]
    ds_read_b64_tr_b16 a[108:109], v235 offset:57344
    v_mfma_f32_16x16x32_bf16 v[116:119], a[52:55], a[212:215], v[116:119]
    v_mfma_f32_16x16x32_bf16 v[132:135], a[56:59], a[212:215], v[132:135]
    ds_read_b64_tr_b16 a[110:111], v235 offset:61440
    v_mfma_f32_16x16x32_bf16 v[148:151], a[60:63], a[212:215], v[148:151]
    v_mfma_f32_16x16x32_bf16 v[40:43], a[32:35], a[216:219], v[40:43]
    ds_read_b64_tr_b16 a[112:113], v236 offset:57344
    v_mfma_f32_16x16x32_bf16 v[56:59], a[36:39], a[216:219], v[56:59]
    v_mfma_f32_16x16x32_bf16 v[72:75], a[40:43], a[216:219], v[72:75]
    ds_read_b64_tr_b16 a[114:115], v236 offset:61440
    v_mfma_f32_16x16x32_bf16 v[88:91], a[44:47], a[216:219], v[88:91]
    buffer_load_dwordx4 a[184:187], v4, s[32:35], s60 offen offset:2048 sc1
    v_mfma_f32_16x16x32_bf16 v[104:107], a[48:51], a[216:219], v[104:107]
    ds_read_b64_tr_b16 a[116:117], v237 offset:57344
    v_mfma_f32_16x16x32_bf16 v[120:123], a[52:55], a[216:219], v[120:123]
    buffer_load_dwordx4 v15, s[48:51], s61 offen offset:3072 lds
    v_mfma_f32_16x16x32_bf16 v[136:139], a[56:59], a[216:219], v[136:139]
    ds_read_b64_tr_b16 a[118:119], v237 offset:61440
    v_mfma_f32_16x16x32_bf16 v[152:155], a[60:63], a[216:219], v[152:155]
    s_add_u32 s61, s61, 0x78000
    v_mfma_f32_16x16x32_bf16 v[44:47], a[32:35], a[220:223], v[44:47]
    ds_read_b64_tr_b16 a[120:121], v238 offset:57344
    v_mfma_f32_16x16x32_bf16 v[60:63], a[36:39], a[220:223], v[60:63]
    s_cmp_ge_u32 s61, s62
    v_mfma_f32_16x16x32_bf16 v[76:79], a[40:43], a[220:223], v[76:79]
    ds_read_b64_tr_b16 a[122:123], v238 offset:61440
    v_mfma_f32_16x16x32_bf16 v[92:95], a[44:47], a[220:223], v[92:95]
    s_cselect_b32 s65, 1769472, 0
    v_mfma_f32_16x16x32_bf16 v[108:111], a[48:51], a[220:223], v[108:111]
    ds_read_b64_tr_b16 a[124:125], v239 offset:57344
    v_mfma_f32_16x16x32_bf16 v[124:127], a[52:55], a[220:223], v[124:127]
    s_cselect_b32 s62, -1, s62
    v_mfma_f32_16x16x32_bf16 v[140:143], a[56:59], a[220:223], v[140:143]
    ds_read_b64_tr_b16 a[126:127], v239 offset:61440
    v_mfma_f32_16x16x32_bf16 v[156:159], a[60:63], a[220:223], v[156:159]
    s_sub_u32 s61, s61, s65
    s_xor_b32 s64, s64, 0x10000
    buffer_load_dwordx4 a[188:191], v4, s[32:35], s60 offen offset:3072 sc1
    s_add_u32 s60, s60, 0x4000
    s_bfm_b64 exec, 7, 0
    buffer_load_dword v18, v13, s[24:27], s47 offen sc1
    s_mov_b64 exec, -1
    s_waitcnt vmcnt(29) lgkmcnt(15)
    s_barrier
    v_mfma_f32_16x16x32_bf16 v[32:35], a[64:67], a[224:227], v[32:35]
    ds_read_b64_tr_b16 a[0:1], v240 offset:0
    v_mfma_f32_16x16x32_bf16 v[48:51], a[68:71], a[224:227], v[48:51]
    v_mfma_f32_16x16x32_bf16 v[64:67], a[72:75], a[224:227], v[64:67]
    ds_read_b64_tr_b16 a[2:3], v240 offset:4096
    v_mfma_f32_16x16x32_bf16 v[80:83], a[76:79], a[224:227], v[80:83]
    buffer_load_dwordx4 a[192:195], v4, s[32:35], s60 offen offset:0 sc1
    v_mfma_f32_16x16x32_bf16 v[96:99], a[80:83], a[224:227], v[96:99]
    ds_read_b64_tr_b16 a[4:5], v241 offset:0
    v_mfma_f32_16x16x32_bf16 v[112:115], a[84:87], a[224:227], v[112:115]
    s_add_u32 m0, s64, 0x0
    v_mfma_f32_16x16x32_bf16 v[128:131], a[88:91], a[224:227], v[128:131]
    ds_read_b64_tr_b16 a[6:7], v241 offset:4096
    v_mfma_f32_16x16x32_bf16 v[144:147], a[92:95], a[224:227], v[144:147]
    buffer_load_dwordx4 v5, s[48:51], s61 offen lds
    v_mfma_f32_16x16x32_bf16 v[36:39], a[64:67], a[228:231], v[36:39]
    ds_read_b64_tr_b16 a[8:9], v242 offset:0
    v_mfma_f32_16x16x32_bf16 v[52:55], a[68:71], a[228:231], v[52:55]
    v_mfma_f32_16x16x32_bf16 v[68:71], a[72:75], a[228:231], v[68:71]
    ds_read_b64_tr_b16 a[10:11], v242 offset:4096
    v_mfma_f32_16x16x32_bf16 v[84:87], a[76:79], a[228:231], v[84:87]
    buffer_load_dwordx4 a[196:199], v4, s[32:35], s60 offen offset:1024 sc1
    v_mfma_f32_16x16x32_bf16 v[100:103], a[80:83], a[228:231], v[100:103]
    ds_read_b64_tr_b16 a[12:13], v243 offset:0
    v_mfma_f32_16x16x32_bf16 v[116:119], a[84:87], a[228:231], v[116:119]
    v_mfma_f32_16x16x32_bf16 v[132:135], a[88:91], a[228:231], v[132:135]
    ds_read_b64_tr_b16 a[14:15], v243 offset:4096
    v_mfma_f32_16x16x32_bf16 v[148:151], a[92:95], a[228:231], v[148:151]
    v_mfma_f32_16x16x32_bf16 v[40:43], a[64:67], a[232:235], v[40:43]
    ds_read_b64_tr_b16 a[16:17], v244 offset:0
    v_mfma_f32_16x16x32_bf16 v[56:59], a[68:71], a[232:235], v[56:59]
    v_mfma_f32_16x16x32_bf16 v[72:75], a[72:75], a[232:235], v[72:75]
    ds_read_b64_tr_b16 a[18:19], v244 offset:4096
    v_mfma_f32_16x16x32_bf16 v[88:91], a[76:79], a[232:235], v[88:91]
    buffer_load_dwordx4 a[200:203], v4, s[32:35], s60 offen offset:2048 sc1
    v_mfma_f32_16x16x32_bf16 v[104:107], a[80:83], a[232:235], v[104:107]
    ds_read_b64_tr_b16 a[20:21], v245 offset:0
    v_mfma_f32_16x16x32_bf16 v[120:123], a[84:87], a[232:235], v[120:123]
    buffer_load_dwordx4 v6, s[48:51], s61 offen offset:1024 lds
    v_mfma_f32_16x16x32_bf16 v[136:139], a[88:91], a[232:235], v[136:139]
    ds_read_b64_tr_b16 a[22:23], v245 offset:4096
    v_mfma_f32_16x16x32_bf16 v[152:155], a[92:95], a[232:235], v[152:155]
    v_mfma_f32_16x16x32_bf16 v[44:47], a[64:67], a[236:239], v[44:47]
    ds_read_b64_tr_b16 a[24:25], v246 offset:0
    v_mfma_f32_16x16x32_bf16 v[60:63], a[68:71], a[236:239], v[60:63]
    v_mfma_f32_16x16x32_bf16 v[76:79], a[72:75], a[236:239], v[76:79]
    ds_read_b64_tr_b16 a[26:27], v246 offset:4096
    v_mfma_f32_16x16x32_bf16 v[92:95], a[76:79], a[236:239], v[92:95]
    buffer_load_dwordx4 a[204:207], v4, s[32:35], s60 offen offset:3072 sc1
    v_mfma_f32_16x16x32_bf16 v[108:111], a[80:83], a[236:239], v[108:111]
    ds_read_b64_tr_b16 a[28:29], v247 offset:0
    v_mfma_f32_16x16x32_bf16 v[124:127], a[84:87], a[236:239], v[124:127]
    s_add_u32 s60, s60, 0x4000
    v_mfma_f32_16x16x32_bf16 v[140:143], a[88:91], a[236:239], v[140:143]
    ds_read_b64_tr_b16 a[30:31], v247 offset:4096
    v_mfma_f32_16x16x32_bf16 v[156:159], a[92:95], a[236:239], v[156:159]
    s_waitcnt vmcnt(30) lgkmcnt(15)
    v_mfma_f32_16x16x32_bf16 v[32:35], a[96:99], a[240:243], v[32:35]
    ds_read_b64_tr_b16 a[32:33], v240 offset:8192
    v_mfma_f32_16x16x32_bf16 v[48:51], a[100:103], a[240:243], v[48:51]
    v_mfma_f32_16x16x32_bf16 v[64:67], a[104:107], a[240:243], v[64:67]
    ds_read_b64_tr_b16 a[34:35], v240 offset:12288
    v_mfma_f32_16x16x32_bf16 v[80:83], a[108:111], a[240:243], v[80:83]
    buffer_load_dwordx4 a[208:211], v4, s[32:35], s60 offen offset:0 sc1
    v_mfma_f32_16x16x32_bf16 v[96:99], a[112:115], a[240:243], v[96:99]
    ds_read_b64_tr_b16 a[36:37], v241 offset:8192
    v_mfma_f32_16x16x32_bf16 v[112:115], a[116:119], a[240:243], v[112:115]
    buffer_load_dwordx4 v14, s[48:51], s61 offen offset:2048 lds
    v_mfma_f32_16x16x32_bf16 v[128:131], a[120:123], a[240:243], v[128:131]
    ds_read_b64_tr_b16 a[38:39], v241 offset:12288
    v_mfma_f32_16x16x32_bf16 v[144:147], a[124:127], a[240:243], v[144:147]
    v_mfma_f32_16x16x32_bf16 v[36:39], a[96:99], a[244:247], v[36:39]
    ds_read_b64_tr_b16 a[40:41], v242 offset:8192
    v_mfma_f32_16x16x32_bf16 v[52:55], a[100:103], a[244:247], v[52:55]
    v_mfma_f32_16x16x32_bf16 v[68:71], a[104:107], a[244:247], v[68:71]
    ds_read_b64_tr_b16 a[42:43], v242 offset:12288
    v_mfma_f32_16x16x32_bf16 v[84:87], a[108:111], a[244:247], v[84:87]
    buffer_load_dwordx4 a[212:215], v4, s[32:35], s60 offen offset:1024 sc1
    v_mfma_f32_16x16x32_bf16 v[100:103], a[112:115], a[244:247], v[100:103]
    ds_read_b64_tr_b16 a[44:45], v243 offset:8192
    v_mfma_f32_16x16x32_bf16 v[116:119], a[116:119], a[244:247], v[116:119]
    v_mfma_f32_16x16x32_bf16 v[132:135], a[120:123], a[244:247], v[132:135]
    ds_read_b64_tr_b16 a[46:47], v243 offset:12288
    v_mfma_f32_16x16x32_bf16 v[148:151], a[124:127], a[244:247], v[148:151]
    v_mfma_f32_16x16x32_bf16 v[40:43], a[96:99], a[248:251], v[40:43]
    ds_read_b64_tr_b16 a[48:49], v244 offset:8192
    v_mfma_f32_16x16x32_bf16 v[56:59], a[100:103], a[248:251], v[56:59]
    v_mfma_f32_16x16x32_bf16 v[72:75], a[104:107], a[248:251], v[72:75]
    ds_read_b64_tr_b16 a[50:51], v244 offset:12288
    v_mfma_f32_16x16x32_bf16 v[88:91], a[108:111], a[248:251], v[88:91]
    buffer_load_dwordx4 a[216:219], v4, s[32:35], s60 offen offset:2048 sc1
    v_mfma_f32_16x16x32_bf16 v[104:107], a[112:115], a[248:251], v[104:107]
    ds_read_b64_tr_b16 a[52:53], v245 offset:8192
    v_mfma_f32_16x16x32_bf16 v[120:123], a[116:119], a[248:251], v[120:123]
    buffer_load_dwordx4 v15, s[48:51], s61 offen offset:3072 lds
    v_mfma_f32_16x16x32_bf16 v[136:139], a[120:123], a[248:251], v[136:139]
    ds_read_b64_tr_b16 a[54:55], v245 offset:12288
    v_mfma_f32_16x16x32_bf16 v[152:155], a[124:127], a[248:251], v[152:155]
    s_add_u32 s61, s61, 0x8000
    v_mfma_f32_16x16x32_bf16 v[44:47], a[96:99], a[252:255], v[44:47]
    ds_read_b64_tr_b16 a[56:57], v246 offset:8192
    v_mfma_f32_16x16x32_bf16 v[60:63], a[100:103], a[252:255], v[60:63]
    v_mfma_f32_16x16x32_bf16 v[76:79], a[104:107], a[252:255], v[76:79]
    ds_read_b64_tr_b16 a[58:59], v246 offset:12288
    v_mfma_f32_16x16x32_bf16 v[92:95], a[108:111], a[252:255], v[92:95]
    buffer_load_dwordx4 a[220:223], v4, s[32:35], s60 offen offset:3072 sc1
    v_mfma_f32_16x16x32_bf16 v[108:111], a[112:115], a[252:255], v[108:111]
    ds_read_b64_tr_b16 a[60:61], v247 offset:8192
    v_mfma_f32_16x16x32_bf16 v[124:127], a[116:119], a[252:255], v[124:127]
    s_add_u32 s60, s60, 0x4000
    v_mfma_f32_16x16x32_bf16 v[140:143], a[120:123], a[252:255], v[140:143]
    ds_read_b64_tr_b16 a[62:63], v247 offset:12288
    v_mfma_f32_16x16x32_bf16 v[156:159], a[124:127], a[252:255], v[156:159]
    s_waitcnt vmcnt(12) lgkmcnt(15)
    v_cmp_ne_u32 vcc, s70, v18
    s_nop 1
    s_bfm_b64 s[66:67], 7, 0
    s_and_b64 vcc, vcc, s[66:67]
    s_nop 3
    s_cbranch_vccz pd_fb
    s_mov_b32 s68, 0x20000
pl_fb:
    s_bfm_b64 exec, 7, 0
    buffer_load_dword v18, v13, s[24:27], s47 offen sc1
    s_mov_b64 exec, -1
    s_waitcnt vmcnt(0)
    v_cmp_ne_u32 vcc, s70, v18
    s_nop 1
    s_bfm_b64 s[66:67], 7, 0
    s_and_b64 vcc, vcc, s[66:67]
    s_nop 3
    s_cbranch_vccz pd_fb
    s_sleep 2
    s_sub_u32 s68, s68, 1
    s_cmp_lg_u32 s68, 0
    s_cbranch_scc1 pl_fb
pd_fb:
    v_mfma_f32_16x16x32_bf16 v[32:35], a[0:3], a[128:131], v[32:35]
    ds_read_b64_tr_b16 a[64:65], v240 offset:16384
    v_mfma_f32_16x16x32_bf16 v[48:51], a[4:7], a[128:131], v[48:51]
    v_mfma_f32_16x16x32_bf16 v[64:67], a[8:11], a[128:131], v[64:67]
    ds_read_b64_tr_b16 a[66:67], v240 offset:20480
    v_mfma_f32_16x16x32_bf16 v[80:83], a[12:15], a[128:131], v[80:83]
    buffer_load_dwordx4 a[224:227], v4, s[32:35], s60 offen offset:0 sc1
    v_mfma_f32_16x16x32_bf16 v[96:99], a[16:19], a[128:131], v[96:99]
    ds_read_b64_tr_b16 a[68:69], v241 offset:16384
    v_mfma_f32_16x16x32_bf16 v[112:115], a[20:23], a[128:131], v[112:115]
    s_add_u32 m0, s64, 0x1000
    v_mfma_f32_16x16x32_bf16 v[128:131], a[24:27], a[128:131], v[128:131]
    ds_read_b64_tr_b16 a[70:71], v241 offset:20480
    v_mfma_f32_16x16x32_bf16 v[144:147], a[28:31], a[128:131], v[144:147]
    buffer_load_dwordx4 v5, s[48:51], s61 offen lds
    v_mfma_f32_16x16x32_bf16 v[36:39], a[0:3], a[132:135], v[36:39]
    ds_read_b64_tr_b16 a[72:73], v242 offset:16384
    v_mfma_f32_16x16x32_bf16 v[52:55], a[4:7], a[132:135], v[52:55]
    v_mfma_f32_16x16x32_bf16 v[68:71], a[8:11], a[132:135], v[68:71]
    ds_read_b64_tr_b16 a[74:75], v242 offset:20480
    v_mfma_f32_16x16x32_bf16 v[84:87], a[12:15], a[132:135], v[84:87]
    buffer_load_dwordx4 a[228:231], v4, s[32:35], s60 offen offset:1024 sc1
    v_mfma_f32_16x16x32_bf16 v[100:103], a[16:19], a[132:135], v[100:103]
    ds_read_b64_tr_b16 a[76:77], v243 offset:16384
    v_mfma_f32_16x16x32_bf16 v[116:119], a[20:23], a[132:135], v[116:119]
    v_mfma_f32_16x16x32_bf16 v[132:135], a[24:27], a[132:135], v[132:135]
    ds_read_b64_tr_b16 a[78:79], v243 offset:20480
    v_mfma_f32_16x16x32_bf16 v[148:151], a[28:31], a[132:135], v[148:151]
    buffer_store_dwordx4 v[160:163], v22, s[56:59], s40 offen offset:0 sc1
    v_mfma_f32_16x16x32_bf16 v[40:43], a[0:3], a[136:139], v[40:43]
    ds_read_b64_tr_b16 a[80:81], v244 offset:16384
    v_mfma_f32_16x16x32_bf16 v[56:59], a[4:7], a[136:139], v[56:59]
    v_mfma_f32_16x16x32_bf16 v[72:75], a[8:11], a[136:139], v[72:75]
    ds_read_b64_tr_b16 a[82:83], v244 offset:20480
    v_mfma_f32_16x16x32_bf16 v[88:91], a[12:15], a[136:139], v[88:91]
    buffer_load_dwordx4 a[232:235], v4, s[32:35], s60 offen offset:2048 sc1
    v_mfma_f32_16x16x32_bf16 v[104:107], a[16:19], a[136:139], v[104:107]
    ds_read_b64_tr_b16 a[84:85], v245 offset:16384
    v_mfma_f32_16x16x32_bf16 v[120:123], a[20:23], a[136:139], v[120:123]
    buffer_load_dwordx4 v6, s[48:51], s61 offen offset:1024 lds
    v_mfma_f32_16x16x32_bf16 v[136:139], a[24:27], a[136:139], v[136:139]
    ds_read_b64_tr_b16 a[86:87], v245 offset:20480
    v_mfma_f32_16x16x32_bf16 v[152:155], a[28:31], a[136:139], v[152:155]
    v_mfma_f32_16x16x32_bf16 v[44:47], a[0:3], a[140:143], v[44:47]
    ds_read_b64_tr_b16 a[88:89], v246 offset:16384
    v_mfma_f32_16x16x32_bf16 v[60:63], a[4:7], a[140:143], v[60:63]
    v_mfma_f32_16x16x32_bf16 v[76:79], a[8:11], a[140:143], v[76:79]
    ds_read_b64_tr_b16 a[90:91], v246 offset:20480
    v_mfma_f32_16x16x32_bf16 v[92:95], a[12:15], a[140:143], v[92:95]
    buffer_load_dwordx4 a[236:239], v4, s[32:35], s60 offen offset:3072 sc1
    v_mfma_f32_16x16x32_bf16 v[108:111], a[16:19], a[140:143], v[108:111]
    ds_read_b64_tr_b16 a[92:93], v247 offset:16384
    v_mfma_f32_16x16x32_bf16 v[124:127], a[20:23], a[140:143], v[124:127]
    s_add_u32 s60, s60, 0x4000
    v_mfma_f32_16x16x32_bf16 v[140:143], a[24:27], a[140:143], v[140:143]
    ds_read_b64_tr_b16 a[94:95], v247 offset:20480
    v_mfma_f32_16x16x32_bf16 v[156:159], a[28:31], a[140:143], v[156:159]
    buffer_store_dwordx4 v[164:167], v22, s[56:59], s41 offen offset:0 sc1
    s_waitcnt vmcnt(33) lgkmcnt(15)
    v_mfma_f32_16x16x32_bf16 v[32:35], a[32:35], a[144:147], v[32:35]
    ds_read_b64_tr_b16 a[96:97], v240 offset:24576
    v_mfma_f32_16x16x32_bf16 v[48:51], a[36:39], a[144:147], v[48:51]
    v_mfma_f32_16x16x32_bf16 v[64:67], a[40:43], a[144:147], v[64:67]
    ds_read_b64_tr_b16 a[98:99], v240 offset:28672
    v_mfma_f32_16x16x32_bf16 v[80:83], a[44:47], a[144:147], v[80:83]
    buffer_load_dwordx4 a[240:243], v4, s[32:35], s60 offen offset:0 sc1
    v_mfma_f32_16x16x32_bf16 v[96:99], a[48:51], a[144:147], v[96:99]
    ds_read_b64_tr_b16 a[100:101], v241 offset:24576
    v_mfma_f32_16x16x32_bf16 v[112:115], a[52:55], a[144:147], v[112:115]
    buffer_load_dwordx4 v14, s[48:51], s61 offen offset:2048 lds
    v_mfma_f32_16x16x32_bf16 v[128:131], a[56:59], a[144:147], v[128:131]
    ds_read_b64_tr_b16 a[102:103], v241 offset:28672
    v_mfma_f32_16x16x32_bf16 v[144:147], a[60:63], a[144:147], v[144:147]
    v_mfma_f32_16x16x32_bf16 v[36:39], a[32:35], a[148:151], v[36:39]
    ds_read_b64_tr_b16 a[104:105], v242 offset:24576
    v_mfma_f32_16x16x32_bf16 v[52:55], a[36:39], a[148:151], v[52:55]
    v_mfma_f32_16x16x32_bf16 v[68:71], a[40:43], a[148:151], v[68:71]
    ds_read_b64_tr_b16 a[106:107], v242 offset:28672
    v_mfma_f32_16x16x32_bf16 v[84:87], a[44:47], a[148:151], v[84:87]
    buffer_load_dwordx4 a[244:247], v4, s[32:35], s60 offen offset:1024 sc1
    v_mfma_f32_16x16x32_bf16 v[100:103], a[48:51], a[148:151], v[100:103]
    ds_read_b64_tr_b16 a[108:109], v243 offset:24576
    v_mfma_f32_16x16x32_bf16 v[116:119], a[52:55], a[148:151], v[116:119]
    v_mfma_f32_16x16x32_bf16 v[132:135], a[56:59], a[148:151], v[132:135]
    ds_read_b64_tr_b16 a[110:111], v243 offset:28672
    v_mfma_f32_16x16x32_bf16 v[148:151], a[60:63], a[148:151], v[148:151]
    buffer_store_dwordx4 v[168:171], v22, s[56:59], s40 offen offset:64 sc1
    v_mfma_f32_16x16x32_bf16 v[40:43], a[32:35], a[152:155], v[40:43]
    ds_read_b64_tr_b16 a[112:113], v244 offset:24576
    v_mfma_f32_16x16x32_bf16 v[56:59], a[36:39], a[152:155], v[56:59]
    v_mfma_f32_16x16x32_bf16 v[72:75], a[40:43], a[152:155], v[72:75]
    ds_read_b64_tr_b16 a[114:115], v244 offset:28672
    v_mfma_f32_16x16x32_bf16 v[88:91], a[44:47], a[152:155], v[88:91]
    buffer_load_dwordx4 a[248:251], v4, s[32:35], s60 offen offset:2048 sc1
    v_mfma_f32_16x16x32_bf16 v[104:107], a[48:51], a[152:155], v[104:107]
    ds_read_b64_tr_b16 a[116:117], v245 offset:24576
    v_mfma_f32_16x16x32_bf16 v[120:123], a[52:55], a[152:155], v[120:123]
    buffer_load_dwordx4 v15, s[48:51], s61 offen offset:3072 lds
    v_mfma_f32_16x16x32_bf16 v[136:139], a[56:59], a[152:155], v[136:139]
    ds_read_b64_tr_b16 a[118:119], v245 offset:28672
    v_mfma_f32_16x16x32_bf16 v[152:155], a[60:63], a[152:155], v[152:155]
    s_add_u32 s61, s61, 0x78000
    v_mfma_f32_16x16x32_bf16 v[44:47], a[32:35], a[156:159], v[44:47]
    ds_read_b64_tr_b16 a[120:121], v246 offset:24576
    v_mfma_f32_16x16x32_bf16 v[60:63], a[36:39], a[156:159], v[60:63]
    s_cmp_ge_u32 s61, s62
    v_mfma_f32_16x16x32_bf16 v[76:79], a[40:43], a[156:159], v[76:79]
    ds_read_b64_tr_b16 a[122:123], v246 offset:28672
    v_mfma_f32_16x16x32_bf16 v[92:95], a[44:47], a[156:159], v[92:95]
    s_cselect_b32 s65, 1769472, 0
    v_mfma_f32_16x16x32_bf16 v[108:111], a[48:51], a[156:159], v[108:111]
    ds_read_b64_tr_b16 a[124:125], v247 offset:24576
    v_mfma_f32_16x16x32_bf16 v[124:127], a[52:55], a[156:159], v[124:127]
    s_cselect_b32 s62, -1, s62
    v_mfma_f32_16x16x32_bf16 v[140:143], a[56:59], a[156:159], v[140:143]
    ds_read_b64_tr_b16 a[126:127], v247 offset:28672
    v_mfma_f32_16x16x32_bf16 v[156:159], a[60:63], a[156:159], v[156:159]
    s_sub_u32 s61, s61, s65
    buffer_load_dwordx4 a[252:255], v4, s[32:35], s60 offen offset:3072 sc1
    s_add_u32 s60, s60, 0x4000
    buffer_store_dwordx4 v[172:175], v22, s[56:59], s41 offen offset:64 sc1
    s_waitcnt vmcnt(30) lgkmcnt(15)
    s_barrier
    v_mfma_f32_16x16x32_bf16 v[32:35], a[64:67], a[160:163], v[32:35]
    ds_read_b64_tr_b16 a[0:1], v240 offset:32768
    v_mfma_f32_16x16x32_bf16 v[48:51], a[68:71], a[160:163], v[48:51]
    v_mfma_f32_16x16x32_bf16 v[64:67], a[72:75], a[160:163], v[64:67]
    ds_read_b64_tr_b16 a[2:3], v240 offset:36864
    v_mfma_f32_16x16x32_bf16 v[80:83], a[76:79], a[160:163], v[80:83]
    buffer_load_dwordx4 a[128:131], v4, s[32:35], s60 offen offset:0 sc1
    v_mfma_f32_16x16x32_bf16 v[96:99], a[80:83], a[160:163], v[96:99]
    ds_read_b64_tr_b16 a[4:5], v241 offset:32768
    v_mfma_f32_16x16x32_bf16 v[112:115], a[84:87], a[160:163], v[112:115]
    s_add_u32 m0, s64, 0x8000
    v_mfma_f32_16x16x32_bf16 v[128:131], a[88:91], a[160:163], v[128:131]
    ds_read_b64_tr_b16 a[6:7], v241 offset:36864
    v_mfma_f32_16x16x32_bf16 v[144:147], a[92:95], a[160:163], v[144:147]
    buffer_load_dwordx4 v5, s[48:51], s61 offen lds
    v_mfma_f32_16x16x32_bf16 v[36:39], a[64:67], a[164:167], v[36:39]
    ds_read_b64_tr_b16 a[8:9], v242 offset:32768
    v_mfma_f32_16x16x32_bf16 v[52:55], a[68:71], a[164:167], v[52:55]
    v_mfma_f32_16x16x32_bf16 v[68:71], a[72:75], a[164:167], v[68:71]
    ds_read_b64_tr_b16 a[10:11], v242 offset:36864
    v_mfma_f32_16x16x32_bf16 v[84:87], a[76:79], a[164:167], v[84:87]
    buffer_load_dwordx4 a[132:135], v4, s[32:35], s60 offen offset:1024 sc1
    v_mfma_f32_16x16x32_bf16 v[100:103], a[80:83], a[164:167], v[100:103]
    ds_read_b64_tr_b16 a[12:13], v243 offset:32768
    v_mfma_f32_16x16x32_bf16 v[116:119], a[84:87], a[164:167], v[116:119]
    v_mfma_f32_16x16x32_bf16 v[132:135], a[88:91], a[164:167], v[132:135]
    ds_read_b64_tr_b16 a[14:15], v243 offset:36864
    v_mfma_f32_16x16x32_bf16 v[148:151], a[92:95], a[164:167], v[148:151]
    v_mfma_f32_16x16x32_bf16 v[40:43], a[64:67], a[168:171], v[40:43]
    ds_read_b64_tr_b16 a[16:17], v244 offset:32768
    v_mfma_f32_16x16x32_bf16 v[56:59], a[68:71], a[168:171], v[56:59]
    v_mfma_f32_16x16x32_bf16 v[72:75], a[72:75], a[168:171], v[72:75]
    ds_read_b64_tr_b16 a[18:19], v244 offset:36864
    v_mfma_f32_16x16x32_bf16 v[88:91], a[76:79], a[168:171], v[88:91]
    buffer_load_dwordx4 a[136:139], v4, s[32:35], s60 offen offset:2048 sc1
    v_mfma_f32_16x16x32_bf16 v[104:107], a[80:83], a[168:171], v[104:107]
    ds_read_b64_tr_b16 a[20:21], v245 offset:32768
    v_mfma_f32_16x16x32_bf16 v[120:123], a[84:87], a[168:171], v[120:123]
    buffer_load_dwordx4 v6, s[48:51], s61 offen offset:1024 lds
    v_mfma_f32_16x16x32_bf16 v[136:139], a[88:91], a[168:171], v[136:139]
    ds_read_b64_tr_b16 a[22:23], v245 offset:36864
    v_mfma_f32_16x16x32_bf16 v[152:155], a[92:95], a[168:171], v[152:155]
    v_mfma_f32_16x16x32_bf16 v[44:47], a[64:67], a[172:175], v[44:47]
    ds_read_b64_tr_b16 a[24:25], v246 offset:32768
    v_mfma_f32_16x16x32_bf16 v[60:63], a[68:71], a[172:175], v[60:63]
    v_mfma_f32_16x16x32_bf16 v[76:79], a[72:75], a[172:175], v[76:79]
    ds_read_b64_tr_b16 a[26:27], v246 offset:36864
    v_mfma_f32_16x16x32_bf16 v[92:95], a[76:79], a[172:175], v[92:95]
    buffer_load_dwordx4 a[140:143], v4, s[32:35], s60 offen offset:3072 sc1
    v_mfma_f32_16x16x32_bf16 v[108:111], a[80:83], a[172:175], v[108:111]
    ds_read_b64_tr_b16 a[28:29], v247 offset:32768
    v_mfma_f32_16x16x32_bf16 v[124:127], a[84:87], a[172:175], v[124:127]
    s_add_u32 s60, s60, 0x4000
    v_mfma_f32_16x16x32_bf16 v[140:143], a[88:91], a[172:175], v[140:143]
    ds_read_b64_tr_b16 a[30:31], v247 offset:36864
    v_mfma_f32_16x16x32_bf16 v[156:159], a[92:95], a[172:175], v[156:159]
    s_waitcnt vmcnt(35) lgkmcnt(15)
    v_mfma_f32_16x16x32_bf16 v[32:35], a[96:99], a[176:179], v[32:35]
    ds_read_b64_tr_b16 a[32:33], v240 offset:40960
    v_mfma_f32_16x16x32_bf16 v[48:51], a[100:103], a[176:179], v[48:51]
    v_mfma_f32_16x16x32_bf16 v[64:67], a[104:107], a[176:179], v[64:67]
    ds_read_b64_tr_b16 a[34:35], v240 offset:45056
    v_mfma_f32_16x16x32_bf16 v[80:83], a[108:111], a[176:179], v[80:83]
    buffer_load_dwordx4 a[144:147], v4, s[32:35], s60 offen offset:0 sc1
    v_mfma_f32_16x16x32_bf16 v[96:99], a[112:115], a[176:179], v[96:99]
    ds_read_b64_tr_b16 a[36:37], v241 offset:40960
    v_mfma_f32_16x16x32_bf16 v[112:115], a[116:119], a[176:179], v[112:115]
    buffer_load_dwordx4 v14, s[48:51], s61 offen offset:2048 lds
    v_mfma_f32_16x16x32_bf16 v[128:131], a[120:123], a[176:179], v[128:131]
    ds_read_b64_tr_b16 a[38:39], v241 offset:45056
    v_mfma_f32_16x16x32_bf16 v[144:147], a[124:127], a[176:179], v[144:147]
    v_mfma_f32_16x16x32_bf16 v[36:39], a[96:99], a[180:183], v[36:39]
    ds_read_b64_tr_b16 a[40:41], v242 offset:40960
    v_mfma_f32_16x16x32_bf16 v[52:55], a[100:103], a[180:183], v[52:55]
    v_mfma_f32_16x16x32_bf16 v[68:71], a[104:107], a[180:183], v[68:71]
    ds_read_b64_tr_b16 a[42:43], v242 offset:45056
    v_mfma_f32_16x16x32_bf16 v[84:87], a[108:111], a[180:183], v[84:87]
    buffer_load_dwordx4 a[148:151], v4, s[32:35], s60 offen offset:1024 sc1
    v_mfma_f32_16x16x32_bf16 v[100:103], a[112:115], a[180:183], v[100:103]
    ds_read_b64_tr_b16 a[44:45], v243 offset:40960
    v_mfma_f32_16x16x32_bf16 v[116:119], a[116:119], a[180:183], v[116:119]
    v_mfma_f32_16x16x32_bf16 v[132:135], a[120:123], a[180:183], v[132:135]
    ds_read_b64_tr_b16 a[46:47], v243 offset:45056
    v_mfma_f32_16x16x32_bf16 v[148:151], a[124:127], a[180:183], v[148:151]
    v_mfma_f32_16x16x32_bf16 v[40:43], a[96:99], a[184:187], v[40:43]
    ds_read_b64_tr_b16 a[48:49], v244 offset:40960
    v_mfma_f32_16x16x32_bf16 v[56:59], a[100:103], a[184:187], v[56:59]
    v_mfma_f32_16x16x32_bf16 v[72:75], a[104:107], a[184:187], v[72:75]
    ds_read_b64_tr_b16 a[50:51], v244 offset:45056
    v_mfma_f32_16x16x32_bf16 v[88:91], a[108:111], a[184:187], v[88:91]
    buffer_load_dwordx4 a[152:155], v4, s[32:35], s60 offen offset:2048 sc1
    v_mfma_f32_16x16x32_bf16 v[104:107], a[112:115], a[184:187], v[104:107]
    ds_read_b64_tr_b16 a[52:53], v245 offset:40960
    v_mfma_f32_16x16x32_bf16 v[120:123], a[116:119], a[184:187], v[120:123]
    buffer_load_dwordx4 v15, s[48:51], s61 offen offset:3072 lds
    v_mfma_f32_16x16x32_bf16 v[136:139], a[120:123], a[184:187], v[136:139]
    ds_read_b64_tr_b16 a[54:55], v245 offset:45056
    v_mfma_f32_16x16x32_bf16 v[152:155], a[124:127], a[184:187], v[152:155]
    s_add_u32 s61, s61, 0x8000
    v_mfma_f32_16x16x32_bf16 v[44:47], a[96:99], a[188:191], v[44:47]
    ds_read_b64_tr_b16 a[56:57], v246 offset:40960
    v_mfma_f32_16x16x32_bf16 v[60:63], a[100:103], a[188:191], v[60:63]
    v_mfma_f32_16x16x32_bf16 v[76:79], a[104:107], a[188:191], v[76:79]
    ds_read_b64_tr_b16 a[58:59], v246 offset:45056
    v_mfma_f32_16x16x32_bf16 v[92:95], a[108:111], a[188:191], v[92:95]
    buffer_load_dwordx4 a[156:159], v4, s[32:35], s60 offen offset:3072 sc1
    v_mfma_f32_16x16x32_bf16 v[108:111], a[112:115], a[188:191], v[108:111]
    ds_read_b64_tr_b16 a[60:61], v247 offset:40960
    v_mfma_f32_16x16x32_bf16 v[124:127], a[116:119], a[188:191], v[124:127]
    s_add_u32 s60, s60, 0x4000
    v_mfma_f32_16x16x32_bf16 v[140:143], a[120:123], a[188:191], v[140:143]
    ds_read_b64_tr_b16 a[62:63], v247 offset:45056
    v_mfma_f32_16x16x32_bf16 v[156:159], a[124:127], a[188:191], v[156:159]
    s_waitcnt vmcnt(34) lgkmcnt(15)
    v_mfma_f32_16x16x32_bf16 v[32:35], a[0:3], a[192:195], v[32:35]
    ds_read_b64_tr_b16 a[64:65], v240 offset:49152
    v_mfma_f32_16x16x32_bf16 v[48:51], a[4:7], a[192:195], v[48:51]
    v_mfma_f32_16x16x32_bf16 v[64:67], a[8:11], a[192:195], v[64:67]
    ds_read_b64_tr_b16 a[66:67], v240 offset:53248
    v_mfma_f32_16x16x32_bf16 v[80:83], a[12:15], a[192:195], v[80:83]
    buffer_load_dwordx4 a[160:163], v4, s[32:35], s60 offen offset:0 sc1
    v_mfma_f32_16x16x32_bf16 v[96:99], a[16:19], a[192:195], v[96:99]
    ds_read_b64_tr_b16 a[68:69], v241 offset:49152
    v_mfma_f32_16x16x32_bf16 v[112:115], a[20:23], a[192:195], v[112:115]
    s_add_u32 m0, s64, 0x9000
    v_mfma_f32_16x16x32_bf16 v[128:131], a[24:27], a[192:195], v[128:131]
    ds_read_b64_tr_b16 a[70:71], v241 offset:53248
    v_mfma_f32_16x16x32_bf16 v[144:147], a[28:31], a[192:195], v[144:147]
    buffer_load_dwordx4 v5, s[48:51], s61 offen lds
    v_mfma_f32_16x16x32_bf16 v[36:39], a[0:3], a[196:199], v[36:39]
    ds_read_b64_tr_b16 a[72:73], v242 offset:49152
    v_mfma_f32_16x16x32_bf16 v[52:55], a[4:7], a[196:199], v[52:55]
    v_mfma_f32_16x16x32_bf16 v[68:71], a[8:11], a[196:199], v[68:71]
    ds_read_b64_tr_b16 a[74:75], v242 offset:53248
    v_mfma_f32_16x16x32_bf16 v[84:87], a[12:15], a[196:199], v[84:87]
    buffer_load_dwordx4 a[164:167], v4, s[32:35], s60 offen offset:1024 sc1
    v_mfma_f32_16x16x32_bf16 v[100:103], a[16:19], a[196:199], v[100:103]
    ds_read_b64_tr_b16 a[76:77], v243 offset:49152
    v_mfma_f32_16x16x32_bf16 v[116:119], a[20:23], a[196:199], v[116:119]
    v_mfma_f32_16x16x32_bf16 v[132:135], a[24:27], a[196:199], v[132:135]
    ds_read_b64_tr_b16 a[78:79], v243 offset:53248
    v_mfma_f32_16x16x32_bf16 v[148:151], a[28:31], a[196:199], v[148:151]
    v_mfma_f32_16x16x32_bf16 v[40:43], a[0:3], a[200:203], v[40:43]
    ds_read_b64_tr_b16 a[80:81], v244 offset:49152
    v_mfma_f32_16x16x32_bf16 v[56:59], a[4:7], a[200:203], v[56:59]
    v_mfma_f32_16x16x32_bf16 v[72:75], a[8:11], a[200:203], v[72:75]
    ds_read_b64_tr_b16 a[82:83], v244 offset:53248
    v_mfma_f32_16x16x32_bf16 v[88:91], a[12:15], a[200:203], v[88:91]
    buffer_load_dwordx4 a[168:171], v4, s[32:35], s60 offen offset:2048 sc1
    v_mfma_f32_16x16x32_bf16 v[104:107], a[16:19], a[200:203], v[104:107]
    ds_read_b64_tr_b16 a[84:85], v245 offset:49152
    v_mfma_f32_16x16x32_bf16 v[120:123], a[20:23], a[200:203], v[120:123]
    buffer_load_dwordx4 v6, s[48:51], s61 offen offset:1024 lds
    v_mfma_f32_16x16x32_bf16 v[136:139], a[24:27], a[200:203], v[136:139]
    ds_read_b64_tr_b16 a[86:87], v245 offset:53248
    v_mfma_f32_16x16x32_bf16 v[152:155], a[28:31], a[200:203], v[152:155]
    v_mfma_f32_16x16x32_bf16 v[44:47], a[0:3], a[204:207], v[44:47]
    ds_read_b64_tr_b16 a[88:89], v246 offset:49152
    v_mfma_f32_16x16x32_bf16 v[60:63], a[4:7], a[204:207], v[60:63]
    v_mfma_f32_16x16x32_bf16 v[76:79], a[8:11], a[204:207], v[76:79]
    ds_read_b64_tr_b16 a[90:91], v246 offset:53248
    v_mfma_f32_16x16x32_bf16 v[92:95], a[12:15], a[204:207], v[92:95]
    buffer_load_dwordx4 a[172:175], v4, s[32:35], s60 offen offset:3072 sc1
    v_mfma_f32_16x16x32_bf16 v[108:111], a[16:19], a[204:207], v[108:111]
    ds_read_b64_tr_b16 a[92:93], v247 offset:49152
    v_mfma_f32_16x16x32_bf16 v[124:127], a[20:23], a[204:207], v[124:127]
    s_add_u32 s60, s60, 0x4000
    v_mfma_f32_16x16x32_bf16 v[140:143], a[24:27], a[204:207], v[140:143]
    ds_read_b64_tr_b16 a[94:95], v247 offset:53248
    v_mfma_f32_16x16x32_bf16 v[156:159], a[28:31], a[204:207], v[156:159]
    s_waitcnt vmcnt(34) lgkmcnt(15)
    v_mfma_f32_16x16x32_bf16 v[32:35], a[32:35], a[208:211], v[32:35]
    ds_read_b64_tr_b16 a[96:97], v240 offset:57344
    v_mfma_f32_16x16x32_bf16 v[48:51], a[36:39], a[208:211], v[48:51]
    v_mfma_f32_16x16x32_bf16 v[64:67], a[40:43], a[208:211], v[64:67]
    ds_read_b64_tr_b16 a[98:99], v240 offset:61440
    v_mfma_f32_16x16x32_bf16 v[80:83], a[44:47], a[208:211], v[80:83]
    buffer_load_dwordx4 a[176:179], v4, s[32:35], s60 offen offset:0 sc1
    v_mfma_f32_16x16x32_bf16 v[96:99], a[48:51], a[208:211], v[96:99]
    ds_read_b64_tr_b16 a[100:101], v241 offset:57344
    v_mfma_f32_16x16x32_bf16 v[112:115], a[52:55], a[208:211], v[112:115]
    buffer_load_dwordx4 v14, s[48:51], s61 offen offset:2048 lds
    v_mfma_f32_16x16x32_bf16 v[128:131], a[56:59], a[208:211], v[128:131]
    ds_read_b64_tr_b16 a[102:103], v241 offset:61440
    v_mfma_f32_16x16x32_bf16 v[144:147], a[60:63], a[208:211], v[144:147]
    v_mfma_f32_16x16x32_bf16 v[36:39], a[32:35], a[212:215], v[36:39]
    ds_read_b64_tr_b16 a[104:105], v242 offset:57344
    v_mfma_f32_16x16x32_bf16 v[52:55], a[36:39], a[212:215], v[52:55]
    v_mfma_f32_16x16x32_bf16 v[68:71], a[40:43], a[212:215], v[68:71]
    ds_read_b64_tr_b16 a[106:107], v242 offset:61440
    v_mfma_f32_16x16x32_bf16 v[84:87], a[44:47], a[212:215], v[84:87]
    buffer_load_dwordx4 a[180:183], v4, s[32:35], s60 offen offset:1024 sc1
    v_mfma_f32_16x16x32_bf16 v[100:103], a[48:51], a[212:215], v[100:103]
    ds_read_b64_tr_b16 a[108:109], v243 offset:57344
    v_mfma_f32_16x16x32_bf16 v[116:119], a[52:55], a[212:215], v[116:119]
    v_mfma_f32_16x16x32_bf16 v[132:135], a[56:59], a[212:215], v[132:135]
    ds_read_b64_tr_b16 a[110:111], v243 offset:61440
    v_mfma_f32_16x16x32_bf16 v[148:151], a[60:63], a[212:215], v[148:151]
    v_mfma_f32_16x16x32_bf16 v[40:43], a[32:35], a[216:219], v[40:43]
    ds_read_b64_tr_b16 a[112:113], v244 offset:57344
    v_mfma_f32_16x16x32_bf16 v[56:59], a[36:39], a[216:219], v[56:59]
    v_mfma_f32_16x16x32_bf16 v[72:75], a[40:43], a[216:219], v[72:75]
    ds_read_b64_tr_b16 a[114:115], v244 offset:61440
    v_mfma_f32_16x16x32_bf16 v[88:91], a[44:47], a[216:219], v[88:91]
    buffer_load_dwordx4 a[184:187], v4, s[32:35], s60 offen offset:2048 sc1
    v_mfma_f32_16x16x32_bf16 v[104:107], a[48:51], a[216:219], v[104:107]
    ds_read_b64_tr_b16 a[116:117], v245 offset:57344
    v_mfma_f32_16x16x32_bf16 v[120:123], a[52:55], a[216:219], v[120:123]
    buffer_load_dwordx4 v15, s[48:51], s61 offen offset:3072 lds
    v_mfma_f32_16x16x32_bf16 v[136:139], a[56:59], a[216:219], v[136:139]
    ds_read_b64_tr_b16 a[118:119], v245 offset:61440
    v_mfma_f32_16x16x32_bf16 v[152:155], a[60:63], a[216:219], v[152:155]
    s_add_u32 s61, s61, 0x78000
    v_mfma_f32_16x16x32_bf16 v[44:47], a[32:35], a[220:223], v[44:47]
    ds_read_b64_tr_b16 a[120:121], v246 offset:57344
    v_mfma_f32_16x16x32_bf16 v[60:63], a[36:39], a[220:223], v[60:63]
    s_cmp_ge_u32 s61, s62
    v_mfma_f32_16x16x32_bf16 v[76:79], a[40:43], a[220:223], v[76:79]
    ds_read_b64_tr_b16 a[122:123], v246 offset:61440
    v_mfma_f32_16x16x32_bf16 v[92:95], a[44:47], a[220:223], v[92:95]
    s_cselect_b32 s65, 1769472, 0
    v_mfma_f32_16x16x32_bf16 v[108:111], a[48:51], a[220:223], v[108:111]
    ds_read_b64_tr_b16 a[124:125], v247 offset:57344
    v_mfma_f32_16x16x32_bf16 v[124:127], a[52:55], a[220:223], v[124:127]
    s_cselect_b32 s62, -1, s62
    v_mfma_f32_16x16x32_bf16 v[140:143], a[56:59], a[220:223], v[140:143]
    ds_read_b64_tr_b16 a[126:127], v247 offset:61440
    v_mfma_f32_16x16x32_bf16 v[156:159], a[60:63], a[220:223], v[156:159]
    s_sub_u32 s61, s61, s65
    s_xor_b32 s64, s64, 0x10000
    buffer_load_dwordx4 a[188:191], v4, s[32:35], s60 offen offset:3072 sc1
    s_add_u32 s60, s60, 0x4000
    s_waitcnt vmcnt(24) lgkmcnt(15)
    s_barrier
    s_cmp_lg_u32 s3, 0
    s_cbranch_scc1 sf_fs
    v_mov_b32 v25, s70
    s_mov_b64 exec, 1
    buffer_store_dword v25, v12, s[24:27], s54 offen sc1
    s_mov_b64 exec, -1
sf_fs:
    v_mfma_f32_16x16x32_bf16 v[32:35], a[64:67], a[224:227], v[32:35]
    ds_read_b64_tr_b16 a[0:1], v232 offset:0
    v_mfma_f32_16x16x32_bf16 v[48:51], a[68:71], a[224:227], v[48:51]
    v_mfma_f32_16x16x32_bf16 v[64:67], a[72:75], a[224:227], v[64:67]
    ds_read_b64_tr_b16 a[2:3], v232 offset:4096
    v_mfma_f32_16x16x32_bf16 v[80:83], a[76:79], a[224:227], v[80:83]
    buffer_load_dwordx4 a[192:195], v4, s[32:35], s60 offen offset:0 sc1
    v_mfma_f32_16x16x32_bf16 v[96:99], a[80:83], a[224:227], v[96:99]
    ds_read_b64_tr_b16 a[4:5], v233 offset:0
    v_mfma_f32_16x16x32_bf16 v[112:115], a[84:87], a[224:227], v[112:115]
    s_add_u32 m0, s64, 0x0
    v_mfma_f32_16x16x32_bf16 v[128:131], a[88:91], a[224:227], v[128:131]
    ds_read_b64_tr_b16 a[6:7], v233 offset:4096
    v_mfma_f32_16x16x32_bf16 v[144:147], a[92:95], a[224:227], v[144:147]
    buffer_load_dwordx4 v5, s[48:51], s61 offen lds
    v_mfma_f32_16x16x32_bf16 v[36:39], a[64:67], a[228:231], v[36:39]
    ds_read_b64_tr_b16 a[8:9], v234 offset:0
    v_mfma_f32_16x16x32_bf16 v[52:55], a[68:71], a[228:231], v[52:55]
    buffer_load_dwordx4 v6, s[48:51], s61 offen offset:1024 lds
    v_mfma_f32_16x16x32_bf16 v[68:71], a[72:75], a[228:231], v[68:71]
    ds_read_b64_tr_b16 a[10:11], v234 offset:4096
    v_mfma_f32_16x16x32_bf16 v[84:87], a[76:79], a[228:231], v[84:87]
    buffer_load_dwordx4 a[196:199], v4, s[32:35], s60 offen offset:1024 sc1
    v_mfma_f32_16x16x32_bf16 v[100:103], a[80:83], a[228:231], v[100:103]
    ds_read_b64_tr_b16 a[12:13], v235 offset:0
    v_mfma_f32_16x16x32_bf16 v[116:119], a[84:87], a[228:231], v[116:119]
    v_mfma_f32_16x16x32_bf16 v[132:135], a[88:91], a[228:231], v[132:135]
    ds_read_b64_tr_b16 a[14:15], v235 offset:4096
    v_mfma_f32_16x16x32_bf16 v[148:151], a[92:95], a[228:231], v[148:151]
    v_mfma_f32_16x16x32_bf16 v[40:43], a[64:67], a[232:235], v[40:43]
    ds_read_b64_tr_b16 a[16:17], v236 offset:0
    v_mfma_f32_16x16x32_bf16 v[56:59], a[68:71], a[232:235], v[56:59]
    v_mfma_f32_16x16x32_bf16 v[72:75], a[72:75], a[232:235], v[72:75]
    ds_read_b64_tr_b16 a[18:19], v236 offset:4096
    v_mfma_f32_16x16x32_bf16 v[88:91], a[76:79], a[232:235], v[88:91]
    buffer_load_dwordx4 a[200:203], v4, s[32:35], s60 offen offset:2048 sc1
    v_mfma_f32_16x16x32_bf16 v[104:107], a[80:83], a[232:235], v[104:107]
    ds_read_b64_tr_b16 a[20:21], v237 offset:0
    v_mfma_f32_16x16x32_bf16 v[120:123], a[84:87], a[232:235], v[120:123]
    buffer_load_dwordx4 v14, s[48:51], s61 offen offset:2048 lds
    v_mfma_f32_16x16x32_bf16 v[136:139], a[88:91], a[232:235], v[136:139]
    ds_read_b64_tr_b16 a[22:23], v237 offset:4096
    v_mfma_f32_16x16x32_bf16 v[152:155], a[92:95], a[232:235], v[152:155]
    v_mfma_f32_16x16x32_bf16 v[44:47], a[64:67], a[236:239], v[44:47]
    ds_read_b64_tr_b16 a[24:25], v238 offset:0
    v_mfma_f32_16x16x32_bf16 v[60:63], a[68:71], a[236:239], v[60:63]
    buffer_load_dwordx4 v15, s[48:51], s61 offen offset:3072 lds
    v_mfma_f32_16x16x32_bf16 v[76:79], a[72:75], a[236:239], v[76:79]
    ds_read_b64_tr_b16 a[26:27], v238 offset:4096
    v_mfma_f32_16x16x32_bf16 v[92:95], a[76:79], a[236:239], v[92:95]
    s_add_u32 s61, s61, 0x8000
    v_mfma_f32_16x16x32_bf16 v[108:111], a[80:83], a[236:239], v[108:111]
    ds_read_b64_tr_b16 a[28:29], v239 offset:0
    v_mfma_f32_16x16x32_bf16 v[124:127], a[84:87], a[236:239], v[124:127]
    buffer_load_dwordx4 a[204:207], v4, s[32:35], s60 offen offset:3072 sc1
    v_mfma_f32_16x16x32_bf16 v[140:143], a[88:91], a[236:239], v[140:143]
    ds_read_b64_tr_b16 a[30:31], v239 offset:4096
    v_mfma_f32_16x16x32_bf16 v[156:159], a[92:95], a[236:239], v[156:159]
    s_add_u32 s60, s60, 0x4000
    s_waitcnt vmcnt(33) lgkmcnt(15)
    v_mfma_f32_16x16x32_bf16 v[32:35], a[96:99], a[240:243], v[32:35]
    ds_read_b64_tr_b16 a[32:33], v232 offset:8192
    v_mfma_f32_16x16x32_bf16 v[48:51], a[100:103], a[240:243], v[48:51]
    v_mfma_f32_16x16x32_bf16 v[64:67], a[104:107], a[240:243], v[64:67]
    ds_read_b64_tr_b16 a[34:35], v232 offset:12288
    v_mfma_f32_16x16x32_bf16 v[80:83], a[108:111], a[240:243], v[80:83]
    buffer_load_dwordx4 a[208:211], v4, s[32:35], s60 offen offset:0 sc1
    v_mfma_f32_16x16x32_bf16 v[96:99], a[112:115], a[240:243], v[96:99]
    ds_read_b64_tr_b16 a[36:37], v233 offset:8192
    v_mfma_f32_16x16x32_bf16 v[112:115], a[116:119], a[240:243], v[112:115]
    s_add_u32 m0, s64, 0x1000
    v_mfma_f32_16x16x32_bf16 v[128:131], a[120:123], a[240:243], v[128:131]
    ds_read_b64_tr_b16 a[38:39], v233 offset:12288
    v_mfma_f32_16x16x32_bf16 v[144:147], a[124:127], a[240:243], v[144:147]
    buffer_load_dwordx4 v5, s[48:51], s61 offen lds
    v_mfma_f32_16x16x32_bf16 v[36:39], a[96:99], a[244:247], v[36:39]
    ds_read_b64_tr_b16 a[40:41], v234 offset:8192
    v_mfma_f32_16x16x32_bf16 v[52:55], a[100:103], a[244:247], v[52:55]
    buffer_load_dwordx4 v6, s[48:51], s61 offen offset:1024 lds
    v_mfma_f32_16x16x32_bf16 v[68:71], a[104:107], a[244:247], v[68:71]
    ds_read_b64_tr_b16 a[42:43], v234 offset:12288
    v_mfma_f32_16x16x32_bf16 v[84:87], a[108:111], a[244:247], v[84:87]
    buffer_load_dwordx4 a[212:215], v4, s[32:35], s60 offen offset:1024 sc1
    v_mfma_f32_16x16x32_bf16 v[100:103], a[112:115], a[244:247], v[100:103]
    ds_read_b64_tr_b16 a[44:45], v235 offset:8192
    v_mfma_f32_16x16x32_bf16 v[116:119], a[116:119], a[244:247], v[116:119]
    v_mfma_f32_16x16x32_bf16 v[132:135], a[120:123], a[244:247], v[132:135]
    ds_read_b64_tr_b16 a[46:47], v235 offset:12288
    v_mfma_f32_16x16x32_bf16 v[148:151], a[124:127], a[244:247], v[148:151]
    v_mfma_f32_16x16x32_bf16 v[40:43], a[96:99], a[248:251], v[40:43]
    ds_read_b64_tr_b16 a[48:49], v236 offset:8192
    v_mfma_f32_16x16x32_bf16 v[56:59], a[100:103], a[248:251], v[56:59]
    v_mfma_f32_16x16x32_bf16 v[72:75], a[104:107], a[248:251], v[72:75]
    ds_read_b64_tr_b16 a[50:51], v236 offset:12288
    v_mfma_f32_16x16x32_bf16 v[88:91], a[108:111], a[248:251], v[88:91]
    buffer_load_dwordx4 a[216:219], v4, s[32:35], s60 offen offset:2048 sc1
    v_mfma_f32_16x16x32_bf16 v[104:107], a[112:115], a[248:251], v[104:107]
    ds_read_b64_tr_b16 a[52:53], v237 offset:8192
    v_mfma_f32_16x16x32_bf16 v[120:123], a[116:119], a[248:251], v[120:123]
    buffer_load_dwordx4 v14, s[48:51], s61 offen offset:2048 lds
    v_mfma_f32_16x16x32_bf16 v[136:139], a[120:123], a[248:251], v[136:139]
    ds_read_b64_tr_b16 a[54:55], v237 offset:12288
    v_mfma_f32_16x16x32_bf16 v[152:155], a[124:127], a[248:251], v[152:155]
    v_mfma_f32_16x16x32_bf16 v[44:47], a[96:99], a[252:255], v[44:47]
    ds_read_b64_tr_b16 a[56:57], v238 offset:8192
    v_mfma_f32_16x16x32_bf16 v[60:63], a[100:103], a[252:255], v[60:63]
    buffer_load_dwordx4 v15, s[48:51], s61 offen offset:3072 lds
    v_mfma_f32_16x16x32_bf16 v[76:79], a[104:107], a[252:255], v[76:79]
    ds_read_b64_tr_b16 a[58:59], v238 offset:12288
    v_mfma_f32_16x16x32_bf16 v[92:95], a[108:111], a[252:255], v[92:95]
    s_add_u32 s61, s61, 0x78000
    v_mfma_f32_16x16x32_bf16 v[108:111], a[112:115], a[252:255], v[108:111]
    ds_read_b64_tr_b16 a[60:61], v239 offset:8192
    v_mfma_f32_16x16x32_bf16 v[124:127], a[116:119], a[252:255], v[124:127]
    s_cmp_ge_u32 s61, s62
    v_mfma_f32_16x16x32_bf16 v[140:143], a[120:123], a[252:255], v[140:143]
    ds_read_b64_tr_b16 a[62:63], v239 offset:12288
    v_mfma_f32_16x16x32_bf16 v[156:159], a[124:127], a[252:255], v[156:159]
    s_cselect_b32 s65, 1769472, 0
    s_cselect_b32 s62, -1, s62
    s_sub_u32 s61, s61, s65
    buffer_load_dwordx4 a[220:223], v4, s[32:35], s60 offen offset:3072 sc1
    s_add_u32 s60, s60, 0x4000
    s_waitcnt vmcnt(34) lgkmcnt(15)
    v_mfma_f32_16x16x32_bf16 v[32:35], a[0:3], a[128:131], v[32:35]
    ds_read_b64_tr_b16 a[64:65], v232 offset:16384
    v_mfma_f32_16x16x32_bf16 v[48:51], a[4:7], a[128:131], v[48:51]
    v_mfma_f32_16x16x32_bf16 v[64:67], a[8:11], a[128:131], v[64:67]
    ds_read_b64_tr_b16 a[66:67], v232 offset:20480
    v_mfma_f32_16x16x32_bf16 v[80:83], a[12:15], a[128:131], v[80:83]
    buffer_load_dwordx4 a[224:227], v4, s[32:35], s60 offen offset:0 sc1
    v_mfma_f32_16x16x32_bf16 v[96:99], a[16:19], a[128:131], v[96:99]
    ds_read_b64_tr_b16 a[68:69], v233 offset:16384
    v_mfma_f32_16x16x32_bf16 v[112:115], a[20:23], a[128:131], v[112:115]
    v_mfma_f32_16x16x32_bf16 v[128:131], a[24:27], a[128:131], v[128:131]
    ds_read_b64_tr_b16 a[70:71], v233 offset:20480
    v_mfma_f32_16x16x32_bf16 v[144:147], a[28:31], a[128:131], v[144:147]
    v_mfma_f32_16x16x32_bf16 v[36:39], a[0:3], a[132:135], v[36:39]
    ds_read_b64_tr_b16 a[72:73], v234 offset:16384
    v_mfma_f32_16x16x32_bf16 v[52:55], a[4:7], a[132:135], v[52:55]
    v_mfma_f32_16x16x32_bf16 v[68:71], a[8:11], a[132:135], v[68:71]
    ds_read_b64_tr_b16 a[74:75], v234 offset:20480
    v_mfma_f32_16x16x32_bf16 v[84:87], a[12:15], a[132:135], v[84:87]
    buffer_load_dwordx4 a[228:231], v4, s[32:35], s60 offen offset:1024 sc1
    v_mfma_f32_16x16x32_bf16 v[100:103], a[16:19], a[132:135], v[100:103]
    ds_read_b64_tr_b16 a[76:77], v235 offset:16384
    v_mfma_f32_16x16x32_bf16 v[116:119], a[20:23], a[132:135], v[116:119]
    v_mfma_f32_16x16x32_bf16 v[132:135], a[24:27], a[132:135], v[132:135]
    ds_read_b64_tr_b16 a[78:79], v235 offset:20480
    v_mfma_f32_16x16x32_bf16 v[148:151], a[28:31], a[132:135], v[148:151]
    v_mfma_f32_16x16x32_bf16 v[40:43], a[0:3], a[136:139], v[40:43]
    ds_read_b64_tr_b16 a[80:81], v236 offset:16384
    v_mfma_f32_16x16x32_bf16 v[56:59], a[4:7], a[136:139], v[56:59]
    v_mfma_f32_16x16x32_bf16 v[72:75], a[8:11], a[136:139], v[72:75]
    ds_read_b64_tr_b16 a[82:83], v236 offset:20480
    v_mfma_f32_16x16x32_bf16 v[88:91], a[12:15], a[136:139], v[88:91]
    buffer_load_dwordx4 a[232:235], v4, s[32:35], s60 offen offset:2048 sc1
    v_mfma_f32_16x16x32_bf16 v[104:107], a[16:19], a[136:139], v[104:107]
    ds_read_b64_tr_b16 a[84:85], v237 offset:16384
    v_mfma_f32_16x16x32_bf16 v[120:123], a[20:23], a[136:139], v[120:123]
    v_mfma_f32_16x16x32_bf16 v[136:139], a[24:27], a[136:139], v[136:139]
    ds_read_b64_tr_b16 a[86:87], v237 offset:20480
    v_mfma_f32_16x16x32_bf16 v[152:155], a[28:31], a[136:139], v[152:155]
    v_mfma_f32_16x16x32_bf16 v[44:47], a[0:3], a[140:143], v[44:47]
    ds_read_b64_tr_b16 a[88:89], v238 offset:16384
    v_mfma_f32_16x16x32_bf16 v[60:63], a[4:7], a[140:143], v[60:63]
    v_mfma_f32_16x16x32_bf16 v[76:79], a[8:11], a[140:143], v[76:79]
    ds_read_b64_tr_b16 a[90:91], v238 offset:20480
    v_mfma_f32_16x16x32_bf16 v[92:95], a[12:15], a[140:143], v[92:95]
    buffer_load_dwordx4 a[236:239], v4, s[32:35], s60 offen offset:3072 sc1
    v_mfma_f32_16x16x32_bf16 v[108:111], a[16:19], a[140:143], v[108:111]
    ds_read_b64_tr_b16 a[92:93], v239 offset:16384
    v_mfma_f32_16x16x32_bf16 v[124:127], a[20:23], a[140:143], v[124:127]
    s_add_u32 s60, s60, 0x4000
    v_mfma_f32_16x16x32_bf16 v[140:143], a[24:27], a[140:143], v[140:143]
    ds_read_b64_tr_b16 a[94:95], v239 offset:20480
    v_mfma_f32_16x16x32_bf16 v[156:159], a[28:31], a[140:143], v[156:159]
    s_waitcnt vmcnt(32) lgkmcnt(15)
    v_mfma_f32_16x16x32_bf16 v[32:35], a[32:35], a[144:147], v[32:35]
    ds_read_b64_tr_b16 a[96:97], v232 offset:24576
    v_mfma_f32_16x16x32_bf16 v[48:51], a[36:39], a[144:147], v[48:51]
    v_mfma_f32_16x16x32_bf16 v[64:67], a[40:43], a[144:147], v[64:67]
    ds_read_b64_tr_b16 a[98:99], v232 offset:28672
    v_mfma_f32_16x16x32_bf16 v[80:83], a[44:47], a[144:147], v[80:83]
    buffer_load_dwordx4 a[240:243], v4, s[32:35], s60 offen offset:0 sc1
    v_mfma_f32_16x16x32_bf16 v[96:99], a[48:51], a[144:147], v[96:99]
    ds_read_b64_tr_b16 a[100:101], v233 offset:24576
    v_mfma_f32_16x16x32_bf16 v[112:115], a[52:55], a[144:147], v[112:115]
    v_mfma_f32_16x16x32_bf16 v[128:131], a[56:59], a[144:147], v[128:131]
    ds_read_b64_tr_b16 a[102:103], v233 offset:28672
    v_mfma_f32_16x16x32_bf16 v[144:147], a[60:63], a[144:147], v[144:147]
    buffer_load_dwordx4 a[244:247], v4, s[32:35], s60 offen offset:1024 sc1
    v_mfma_f32_16x16x32_bf16 v[36:39], a[32:35], a[148:151], v[36:39]
    ds_read_b64_tr_b16 a[104:105], v234 offset:24576
    v_mfma_f32_16x16x32_bf16 v[52:55], a[36:39], a[148:151], v[52:55]
    v_mfma_f32_16x16x32_bf16 v[68:71], a[40:43], a[148:151], v[68:71]
    ds_read_b64_tr_b16 a[106:107], v234 offset:28672
    v_mfma_f32_16x16x32_bf16 v[84:87], a[44:47], a[148:151], v[84:87]
    buffer_load_dwordx4 a[248:251], v4, s[32:35], s60 offen offset:2048 sc1
    v_mfma_f32_16x16x32_bf16 v[100:103], a[48:51], a[148:151], v[100:103]
    ds_read_b64_tr_b16 a[108:109], v235 offset:24576
    v_mfma_f32_16x16x32_bf16 v[116:119], a[52:55], a[148:151], v[116:119]
    v_mfma_f32_16x16x32_bf16 v[132:135], a[56:59], a[148:151], v[132:135]
    ds_read_b64_tr_b16 a[110:111], v235 offset:28672
    v_mfma_f32_16x16x32_bf16 v[148:151], a[60:63], a[148:151], v[148:151]
    buffer_load_dwordx4 a[252:255], v4, s[32:35], s60 offen offset:3072 sc1
    v_mfma_f32_16x16x32_bf16 v[40:43], a[32:35], a[152:155], v[40:43]
    ds_read_b64_tr_b16 a[112:113], v236 offset:24576
    v_mfma_f32_16x16x32_bf16 v[56:59], a[36:39], a[152:155], v[56:59]
    s_add_u32 s60, s60, 0x4000
    v_mfma_f32_16x16x32_bf16 v[72:75], a[40:43], a[152:155], v[72:75]
    ds_read_b64_tr_b16 a[114:115], v236 offset:28672
    v_mfma_f32_16x16x32_bf16 v[88:91], a[44:47], a[152:155], v[88:91]
    buffer_load_dwordx4 a[128:131], v4, s[32:35], s60 offen offset:0 sc1
    v_mfma_f32_16x16x32_bf16 v[104:107], a[48:51], a[152:155], v[104:107]
    ds_read_b64_tr_b16 a[116:117], v237 offset:24576
    v_mfma_f32_16x16x32_bf16 v[120:123], a[52:55], a[152:155], v[120:123]
    v_mfma_f32_16x16x32_bf16 v[136:139], a[56:59], a[152:155], v[136:139]
    ds_read_b64_tr_b16 a[118:119], v237 offset:28672
    v_mfma_f32_16x16x32_bf16 v[152:155], a[60:63], a[152:155], v[152:155]
    buffer_load_dwordx4 a[132:135], v4, s[32:35], s60 offen offset:1024 sc1
    v_mfma_f32_16x16x32_bf16 v[44:47], a[32:35], a[156:159], v[44:47]
    ds_read_b64_tr_b16 a[120:121], v238 offset:24576
    v_mfma_f32_16x16x32_bf16 v[60:63], a[36:39], a[156:159], v[60:63]
    v_mfma_f32_16x16x32_bf16 v[76:79], a[40:43], a[156:159], v[76:79]
    ds_read_b64_tr_b16 a[122:123], v238 offset:28672
    v_mfma_f32_16x16x32_bf16 v[92:95], a[44:47], a[156:159], v[92:95]
    buffer_load_dwordx4 a[136:139], v4, s[32:35], s60 offen offset:2048 sc1
    v_mfma_f32_16x16x32_bf16 v[108:111], a[48:51], a[156:159], v[108:111]
    ds_read_b64_tr_b16 a[124:125], v239 offset:24576
    v_mfma_f32_16x16x32_bf16 v[124:127], a[52:55], a[156:159], v[124:127]
    v_mfma_f32_16x16x32_bf16 v[140:143], a[56:59], a[156:159], v[140:143]
    ds_read_b64_tr_b16 a[126:127], v239 offset:28672
    v_mfma_f32_16x16x32_bf16 v[156:159], a[60:63], a[156:159], v[156:159]
    buffer_load_dwordx4 a[140:143], v4, s[32:35], s60 offen offset:3072 sc1
    s_add_u32 s60, s60, 0x4000
    s_waitcnt vmcnt(29) lgkmcnt(15)
    s_barrier
    v_mfma_f32_16x16x32_bf16 v[32:35], a[64:67], a[160:163], v[32:35]
    ds_read_b64_tr_b16 a[0:1], v238 offset:32768
    v_mfma_f32_16x16x32_bf16 v[48:51], a[68:71], a[160:163], v[48:51]
    v_mfma_f32_16x16x32_bf16 v[64:67], a[72:75], a[160:163], v[64:67]
    ds_read_b64_tr_b16 a[2:3], v238 offset:36864
    v_mfma_f32_16x16x32_bf16 v[80:83], a[76:79], a[160:163], v[80:83]
    buffer_load_dwordx4 a[144:147], v4, s[32:35], s60 offen offset:0 sc1
    v_mfma_f32_16x16x32_bf16 v[96:99], a[80:83], a[160:163], v[96:99]
    ds_read_b64_tr_b16 a[4:5], v239 offset:32768
    v_mfma_f32_16x16x32_bf16 v[112:115], a[84:87], a[160:163], v[112:115]
    v_mfma_f32_16x16x32_bf16 v[128:131], a[88:91], a[160:163], v[128:131]
    ds_read_b64_tr_b16 a[6:7], v239 offset:36864
    v_mfma_f32_16x16x32_bf16 v[144:147], a[92:95], a[160:163], v[144:147]
    v_mfma_f32_16x16x32_bf16 v[36:39], a[64:67], a[164:167], v[36:39]
    ds_read_b64_tr_b16 a[8:9], v238 offset:40960
    v_mfma_f32_16x16x32_bf16 v[52:55], a[68:71], a[164:167], v[52:55]
    v_mfma_f32_16x16x32_bf16 v[68:71], a[72:75], a[164:167], v[68:71]
    ds_read_b64_tr_b16 a[10:11], v238 offset:45056
    v_mfma_f32_16x16x32_bf16 v[84:87], a[76:79], a[164:167], v[84:87]
    buffer_load_dwordx4 a[148:151], v4, s[32:35], s60 offen offset:1024 sc1
    v_mfma_f32_16x16x32_bf16 v[100:103], a[80:83], a[164:167], v[100:103]
    ds_read_b64_tr_b16 a[12:13], v239 offset:40960
    v_mfma_f32_16x16x32_bf16 v[116:119], a[84:87], a[164:167], v[116:119]
    v_mfma_f32_16x16x32_bf16 v[132:135], a[88:91], a[164:167], v[132:135]
    ds_read_b64_tr_b16 a[14:15], v239 offset:45056
    v_mfma_f32_16x16x32_bf16 v[148:151], a[92:95], a[164:167], v[148:151]
    v_mfma_f32_16x16x32_bf16 v[40:43], a[64:67], a[168:171], v[40:43]
    ds_read_b64_tr_b16 a[16:17], v238 offset:49152
    v_mfma_f32_16x16x32_bf16 v[56:59], a[68:71], a[168:171], v[56:59]
    v_mfma_f32_16x16x32_bf16 v[72:75], a[72:75], a[168:171], v[72:75]
    ds_read_b64_tr_b16 a[18:19], v238 offset:53248
    v_mfma_f32_16x16x32_bf16 v[88:91], a[76:79], a[168:171], v[88:91]
    buffer_load_dwordx4 a[152:155], v4, s[32:35], s60 offen offset:2048 sc1
    v_mfma_f32_16x16x32_bf16 v[104:107], a[80:83], a[168:171], v[104:107]
    ds_read_b64_tr_b16 a[20:21], v239 offset:49152
    v_mfma_f32_16x16x32_bf16 v[120:123], a[84:87], a[168:171], v[120:123]
    v_mfma_f32_16x16x32_bf16 v[136:139], a[88:91], a[168:171], v[136:139]
    ds_read_b64_tr_b16 a[22:23], v239 offset:53248
    v_mfma_f32_16x16x32_bf16 v[152:155], a[92:95], a[168:171], v[152:155]
    v_mfma_f32_16x16x32_bf16 v[44:47], a[64:67], a[172:175], v[44:47]
    ds_read_b64_tr_b16 a[24:25], v238 offset:57344
    v_mfma_f32_16x16x32_bf16 v[60:63], a[68:71], a[172:175], v[60:63]
    v_mfma_f32_16x16x32_bf16 v[76:79], a[72:75], a[172:175], v[76:79]
    ds_read_b64_tr_b16 a[26:27], v238 offset:61440
    v_mfma_f32_16x16x32_bf16 v[92:95], a[76:79], a[172:175], v[92:95]
    buffer_load_dwordx4 a[156:159], v4, s[32:35], s60 offen offset:3072 sc1
    v_mfma_f32_16x16x32_bf16 v[108:111], a[80:83], a[172:175], v[108:111]
    ds_read_b64_tr_b16 a[28:29], v239 offset:57344
    v_mfma_f32_16x16x32_bf16 v[124:127], a[84:87], a[172:175], v[124:127]
    s_add_u32 s60, s60, 0x4000
    v_mfma_f32_16x16x32_bf16 v[140:143], a[88:91], a[172:175], v[140:143]
    ds_read_b64_tr_b16 a[30:31], v239 offset:61440
    v_mfma_f32_16x16x32_bf16 v[156:159], a[92:95], a[172:175], v[156:159]
    s_bfm_b64 exec, 8, 0
    buffer_load_dword v19, v13, s[24:27], s46 offen sc1
    s_mov_b64 exec, -1
    s_waitcnt vmcnt(18) lgkmcnt(15)
    s_barrier
    v_mfma_f32_16x16x32_bf16 v[32:35], a[96:99], a[176:179], v[32:35]
    ds_read_b64_tr_b16 a[32:33], v246 offset:0
    v_mfma_f32_16x16x32_bf16 v[48:51], a[100:103], a[176:179], v[48:51]
    buffer_load_dwordx4 a[160:163], v4, s[32:35], s60 offen offset:0 sc1
    v_mfma_f32_16x16x32_bf16 v[64:67], a[104:107], a[176:179], v[64:67]
    ds_read_b64_tr_b16 a[34:35], v246 offset:4096
    v_mfma_f32_16x16x32_bf16 v[80:83], a[108:111], a[176:179], v[80:83]
    buffer_load_dwordx4 a[164:167], v4, s[32:35], s60 offen offset:1024 sc1
    v_mfma_f32_16x16x32_bf16 v[96:99], a[112:115], a[176:179], v[96:99]
    ds_read_b64_tr_b16 a[36:37], v247 offset:0
    v_mfma_f32_16x16x32_bf16 v[112:115], a[116:119], a[176:179], v[112:115]
    buffer_load_dwordx4 a[168:171], v4, s[32:35], s60 offen offset:2048 sc1
    v_mfma_f32_16x16x32_bf16 v[128:131], a[120:123], a[176:179], v[128:131]
    ds_read_b64_tr_b16 a[38:39], v247 offset:4096
    v_mfma_f32_16x16x32_bf16 v[144:147], a[124:127], a[176:179], v[144:147]
    buffer_load_dwordx4 a[172:175], v4, s[32:35], s60 offen offset:3072 sc1
    v_mfma_f32_16x16x32_bf16 v[36:39], a[96:99], a[180:183], v[36:39]
    ds_read_b64_tr_b16 a[40:41], v246 offset:8192
    v_mfma_f32_16x16x32_bf16 v[52:55], a[100:103], a[180:183], v[52:55]
    s_add_u32 s60, s60, 0x4000
    v_mfma_f32_16x16x32_bf16 v[68:71], a[104:107], a[180:183], v[68:71]
    ds_read_b64_tr_b16 a[42:43], v246 offset:12288
    v_mfma_f32_16x16x32_bf16 v[84:87], a[108:111], a[180:183], v[84:87]
    buffer_load_dwordx4 a[176:179], v4, s[32:35], s60 offen offset:0 sc1
    v_mfma_f32_16x16x32_bf16 v[100:103], a[112:115], a[180:183], v[100:103]
    ds_read_b64_tr_b16 a[44:45], v247 offset:8192
    v_mfma_f32_16x16x32_bf16 v[116:119], a[116:119], a[180:183], v[116:119]
    v_mfma_f32_16x16x32_bf16 v[132:135], a[120:123], a[180:183], v[132:135]
    ds_read_b64_tr_b16 a[46:47], v247 offset:12288
    v_mfma_f32_16x16x32_bf16 v[148:151], a[124:127], a[180:183], v[148:151]
    buffer_load_dwordx4 a[180:183], v4, s[32:35], s60 offen offset:1024 sc1
    v_mfma_f32_16x16x32_bf16 v[40:43], a[96:99], a[184:187], v[40:43]
    ds_read_b64_tr_b16 a[48:49], v246 offset:16384
    v_mfma_f32_16x16x32_bf16 v[56:59], a[100:103], a[184:187], v[56:59]
    v_mfma_f32_16x16x32_bf16 v[72:75], a[104:107], a[184:187], v[72:75]
    ds_read_b64_tr_b16 a[50:51], v246 offset:20480
    v_mfma_f32_16x16x32_bf16 v[88:91], a[108:111], a[184:187], v[88:91]
    v_mfma_f32_16x16x32_bf16 v[104:107], a[112:115], a[184:187], v[104:107]
    ds_read_b64_tr_b16 a[52:53], v247 offset:16384
    v_mfma_f32_16x16x32_bf16 v[120:123], a[116:119], a[184:187], v[120:123]
    v_mfma_f32_16x16x32_bf16 v[136:139], a[120:123], a[184:187], v[136:139]
    ds_read_b64_tr_b16 a[54:55], v247 offset:20480
    v_mfma_f32_16x16x32_bf16 v[152:155], a[124:127], a[184:187], v[152:155]
    buffer_load_dwordx4 a[184:187], v4, s[32:35], s60 offen offset:2048 sc1
    v_mfma_f32_16x16x32_bf16 v[44:47], a[96:99], a[188:191], v[44:47]
    ds_read_b64_tr_b16 a[56:57], v246 offset:24576
    v_mfma_f32_16x16x32_bf16 v[60:63], a[100:103], a[188:191], v[60:63]
    v_mfma_f32_16x16x32_bf16 v[76:79], a[104:107], a[188:191], v[76:79]
    ds_read_b64_tr_b16 a[58:59], v246 offset:28672
    v_mfma_f32_16x16x32_bf16 v[92:95], a[108:111], a[188:191], v[92:95]
    v_mfma_f32_16x16x32_bf16 v[108:111], a[112:115], a[188:191], v[108:111]
    ds_read_b64_tr_b16 a[60:61], v247 offset:24576
    v_mfma_f32_16x16x32_bf16 v[124:127], a[116:119], a[188:191], v[124:127]
    v_mfma_f32_16x16x32_bf16 v[140:143], a[120:123], a[188:191], v[140:143]
    ds_read_b64_tr_b16 a[62:63], v247 offset:28672
    v_mfma_f32_16x16x32_bf16 v[156:159], a[124:127], a[188:191], v[156:159]
    buffer_load_dwordx4 a[188:191], v4, s[32:35], s60 offen offset:3072 sc1
    s_add_u32 s60, s60, 0x4000
    s_waitcnt vmcnt(17) lgkmcnt(15)
    v_mfma_f32_16x16x32_bf16 v[128:131], a[0:3], a[192:195], v[128:131]
    ds_read_b64_tr_b16 a[64:65], v236 offset:32768
    v_mfma_f32_16x16x32_bf16 v[132:135], a[0:3], a[196:199], v[132:135]
    v_mfma_f32_16x16x32_bf16 v[136:139], a[0:3], a[200:203], v[136:139]
    ds_read_b64_tr_b16 a[66:67], v236 offset:36864
    v_mfma_f32_16x16x32_bf16 v[140:143], a[0:3], a[204:207], v[140:143]
    v_mfma_f32_16x16x32_bf16 v[144:147], a[4:7], a[192:195], v[144:147]
    ds_read_b64_tr_b16 a[68:69], v237 offset:32768
    v_mfma_f32_16x16x32_bf16 v[148:151], a[4:7], a[196:199], v[148:151]
    v_mfma_f32_16x16x32_bf16 v[152:155], a[4:7], a[200:203], v[152:155]
    ds_read_b64_tr_b16 a[70:71], v237 offset:36864
    v_mfma_f32_16x16x32_bf16 v[156:159], a[4:7], a[204:207], v[156:159]
    v_mfma_f32_16x16x32_bf16 v[128:131], a[8:11], a[208:211], v[128:131]
    ds_read_b64_tr_b16 a[72:73], v236 offset:40960
    v_mfma_f32_16x16x32_bf16 v[132:135], a[8:11], a[212:215], v[132:135]
    v_mfma_f32_16x16x32_bf16 v[136:139], a[8:11], a[216:219], v[136:139]
    ds_read_b64_tr_b16 a[74:75], v236 offset:45056
    v_mfma_f32_16x16x32_bf16 v[140:143], a[8:11], a[220:223], v[140:143]
    v_mfma_f32_16x16x32_bf16 v[144:147], a[12:15], a[208:211], v[144:147]
    ds_read_b64_tr_b16 a[76:77], v237 offset:40960
    v_mfma_f32_16x16x32_bf16 v[148:151], a[12:15], a[212:215], v[148:151]
    v_mfma_f32_16x16x32_bf16 v[152:155], a[12:15], a[216:219], v[152:155]
    ds_read_b64_tr_b16 a[78:79], v237 offset:45056
    v_mfma_f32_16x16x32_bf16 v[156:159], a[12:15], a[220:223], v[156:159]
    v_mfma_f32_16x16x32_bf16 v[128:131], a[16:19], a[224:227], v[128:131]
    ds_read_b64_tr_b16 a[80:81], v236 offset:49152
    v_mfma_f32_16x16x32_bf16 v[132:135], a[16:19], a[228:231], v[132:135]
    v_mfma_f32_16x16x32_bf16 v[136:139], a[16:19], a[232:235], v[136:139]
    ds_read_b64_tr_b16 a[82:83], v236 offset:53248
    v_mfma_f32_16x16x32_bf16 v[140:143], a[16:19], a[236:239], v[140:143]
    v_mfma_f32_16x16x32_bf16 v[144:147], a[20:23], a[224:227], v[144:147]
    ds_read_b64_tr_b16 a[84:85], v237 offset:49152
    v_mfma_f32_16x16x32_bf16 v[148:151], a[20:23], a[228:231], v[148:151]
    v_mfma_f32_16x16x32_bf16 v[152:155], a[20:23], a[232:235], v[152:155]
    ds_read_b64_tr_b16 a[86:87], v237 offset:53248
    v_mfma_f32_16x16x32_bf16 v[156:159], a[20:23], a[236:239], v[156:159]
    v_mfma_f32_16x16x32_bf16 v[128:131], a[24:27], a[240:243], v[128:131]
    ds_read_b64_tr_b16 a[88:89], v236 offset:57344
    v_mfma_f32_16x16x32_bf16 v[132:135], a[24:27], a[244:247], v[132:135]
    v_mfma_f32_16x16x32_bf16 v[136:139], a[24:27], a[248:251], v[136:139]
    ds_read_b64_tr_b16 a[90:91], v236 offset:61440
    v_mfma_f32_16x16x32_bf16 v[140:143], a[24:27], a[252:255], v[140:143]
    v_mfma_f32_16x16x32_bf16 v[144:147], a[28:31], a[240:243], v[144:147]
    ds_read_b64_tr_b16 a[92:93], v237 offset:57344
    v_mfma_f32_16x16x32_bf16 v[148:151], a[28:31], a[244:247], v[148:151]
    v_mfma_f32_16x16x32_bf16 v[152:155], a[28:31], a[248:251], v[152:155]
    ds_read_b64_tr_b16 a[94:95], v237 offset:61440
    v_mfma_f32_16x16x32_bf16 v[156:159], a[28:31], a[252:255], v[156:159]
    s_waitcnt vmcnt(0) lgkmcnt(15)
    v_cmp_ne_u32 vcc, s70, v19
    s_nop 1
    s_bfm_b64 s[66:67], 8, 0
    s_and_b64 vcc, vcc, s[66:67]
    s_nop 3
    s_cbranch_vccz pd_fs
    s_mov_b32 s68, 0x20000
pl_fs:
    s_bfm_b64 exec, 8, 0
    buffer_load_dword v19, v13, s[24:27], s46 offen sc1
    s_mov_b64 exec, -1
    s_waitcnt vmcnt(0)
    v_cmp_ne_u32 vcc, s70, v19
    s_nop 1
    s_bfm_b64 s[66:67], 8, 0
    s_and_b64 vcc, vcc, s[66:67]
    s_nop 3
    s_cbranch_vccz pd_fs
    s_sleep 2
    s_sub_u32 s68, s68, 1
    s_cmp_lg_u32 s68, 0
    s_cbranch_scc1 pl_fs
pd_fs:
    v_mfma_f32_16x16x32_bf16 v[128:131], a[32:35], a[128:131], v[128:131]
    ds_read_b64_tr_b16 a[96:97], v244 offset:0
    v_mfma_f32_16x16x32_bf16 v[132:135], a[32:35], a[132:135], v[132:135]
    s_lshl_b32 s6, s42, 19
    v_mfma_f32_16x16x32_bf16 v[136:139], a[32:35], a[136:139], v[136:139]
    ds_read_b64_tr_b16 a[98:99], v244 offset:4096
    v_mfma_f32_16x16x32_bf16 v[140:143], a[32:35], a[140:143], v[140:143]
    s_lshl_b32 s7, s3, 17
    v_mfma_f32_16x16x32_bf16 v[144:147], a[36:39], a[128:131], v[144:147]
    ds_read_b64_tr_b16 a[100:101], v245 offset:0
    v_mfma_f32_16x16x32_bf16 v[148:151], a[36:39], a[132:135], v[148:151]
    s_add_u32 s6, s6, s7
    v_mfma_f32_16x16x32_bf16 v[152:155], a[36:39], a[136:139], v[152:155]
    ds_read_b64_tr_b16 a[102:103], v245 offset:4096
    v_mfma_f32_16x16x32_bf16 v[156:159], a[36:39], a[140:143], v[156:159]
    s_lshl_b32 s7, s43, 12
    v_mfma_f32_16x16x32_bf16 v[128:131], a[40:43], a[144:147], v[128:131]
    ds_read_b64_tr_b16 a[104:105], v244 offset:8192
    v_mfma_f32_16x16x32_bf16 v[132:135], a[40:43], a[148:151], v[132:135]
    s_add_u32 s6, s6, s7
    v_mfma_f32_16x16x32_bf16 v[136:139], a[40:43], a[152:155], v[136:139]
    ds_read_b64_tr_b16 a[106:107], v244 offset:12288
    v_mfma_f32_16x16x32_bf16 v[140:143], a[40:43], a[156:159], v[140:143]
    s_lshl_b32 s7, s44, 10
    v_mfma_f32_16x16x32_bf16 v[144:147], a[44:47], a[144:147], v[144:147]
    ds_read_b64_tr_b16 a[108:109], v245 offset:8192
    v_mfma_f32_16x16x32_bf16 v[148:151], a[44:47], a[148:151], v[148:151]
    s_add_u32 s6, s6, s7
    v_mfma_f32_16x16x32_bf16 v[152:155], a[44:47], a[152:155], v[152:155]
    ds_read_b64_tr_b16 a[110:111], v245 offset:12288
    v_mfma_f32_16x16x32_bf16 v[156:159], a[44:47], a[156:159], v[156:159]
    buffer_load_dwordx4 v[192:195], v3, s[56:59], s6 offen sc1
    v_mfma_f32_16x16x32_bf16 v[128:131], a[48:51], a[160:163], v[128:131]
    ds_read_b64_tr_b16 a[112:113], v244 offset:16384
    v_mfma_f32_16x16x32_bf16 v[132:135], a[48:51], a[164:167], v[132:135]
    s_add_u32 s6, s6, 0x8000
    v_mfma_f32_16x16x32_bf16 v[136:139], a[48:51], a[168:171], v[136:139]
    ds_read_b64_tr_b16 a[114:115], v244 offset:20480
    v_mfma_f32_16x16x32_bf16 v[140:143], a[48:51], a[172:175], v[140:143]
    buffer_load_dwordx4 v[196:199], v3, s[56:59], s6 offen sc1
    v_mfma_f32_16x16x32_bf16 v[144:147], a[52:55], a[160:163], v[144:147]
    ds_read_b64_tr_b16 a[116:117], v245 offset:16384
    v_mfma_f32_16x16x32_bf16 v[148:151], a[52:55], a[164:167], v[148:151]
    s_add_u32 s6, s6, 0x8000
    v_mfma_f32_16x16x32_bf16 v[152:155], a[52:55], a[168:171], v[152:155]
    ds_read_b64_tr_b16 a[118:119], v245 offset:20480
    v_mfma_f32_16x16x32_bf16 v[156:159], a[52:55], a[172:175], v[156:159]
    buffer_load_dwordx4 v[200:203], v3, s[56:59], s6 offen sc1
    v_mfma_f32_16x16x32_bf16 v[128:131], a[56:59], a[176:179], v[128:131]
    ds_read_b64_tr_b16 a[120:121], v244 offset:24576
    v_mfma_f32_16x16x32_bf16 v[132:135], a[56:59], a[180:183], v[132:135]
    s_add_u32 s6, s6, 0x8000
    v_mfma_f32_16x16x32_bf16 v[136:139], a[56:59], a[184:187], v[136:139]
    ds_read_b64_tr_b16 a[122:123], v244 offset:28672
    v_mfma_f32_16x16x32_bf16 v[140:143], a[56:59], a[188:191], v[140:143]
    buffer_load_dwordx4 v[204:207], v3, s[56:59], s6 offen sc1
    v_mfma_f32_16x16x32_bf16 v[144:147], a[60:63], a[176:179], v[144:147]
    ds_read_b64_tr_b16 a[124:125], v245 offset:24576
    v_mfma_f32_16x16x32_bf16 v[148:151], a[60:63], a[180:183], v[148:151]
    s_add_u32 s6, s6, 0x8000
    v_mfma_f32_16x16x32_bf16 v[152:155], a[60:63], a[184:187], v[152:155]
    ds_read_b64_tr_b16 a[126:127], v245 offset:28672
    v_mfma_f32_16x16x32_bf16 v[156:159], a[60:63], a[188:191], v[156:159]
    s_waitcnt vmcnt(21) lgkmcnt(15)
    v_mfma_f32_16x16x32_bf16 v[96:99], a[64:67], a[192:195], v[96:99]
    ds_read_b64_tr_b16 a[0:1], v234 offset:32768
    s_xor_b32 s45, s2, 6
    s_lshl_b32 s45, s45, 2
    s_add_u32 s45, s45, s3
    s_mul_i32 s45, s45, 12288
    s_add_u32 s45, s45, 8192
    v_mfma_f32_16x16x32_bf16 v[100:103], a[64:67], a[196:199], v[100:103]
    v_mfma_f32_16x16x32_bf16 v[104:107], a[64:67], a[200:203], v[104:107]
    ds_read_b64_tr_b16 a[2:3], v234 offset:36864
    v_mfma_f32_16x16x32_bf16 v[108:111], a[64:67], a[204:207], v[108:111]
    v_mfma_f32_16x16x32_bf16 v[112:115], a[68:71], a[192:195], v[112:115]
    ds_read_b64_tr_b16 a[4:5], v235 offset:32768
    v_cvt_pk_bf16_f32 v128, v128, v129
    v_mfma_f32_16x16x32_bf16 v[116:119], a[68:71], a[196:199], v[116:119]
    v_cvt_pk_bf16_f32 v129, v130, v131
    v_mfma_f32_16x16x32_bf16 v[120:123], a[68:71], a[200:203], v[120:123]
    ds_read_b64_tr_b16 a[6:7], v235 offset:36864
    v_cvt_pk_bf16_f32 v130, v132, v133
    v_mfma_f32_16x16x32_bf16 v[124:127], a[68:71], a[204:207], v[124:127]
    v_cvt_pk_bf16_f32 v131, v134, v135
    v_mfma_f32_16x16x32_bf16 v[96:99], a[72:75], a[208:211], v[96:99]
    ds_read_b64_tr_b16 a[8:9], v234 offset:40960
    buffer_store_dwordx4 v[128:131], v3, s[36:39], s45 offen offset:0 sc1
    v_cvt_pk_bf16_f32 v136, v136, v137
    v_mfma_f32_16x16x32_bf16 v[100:103], a[72:75], a[212:215], v[100:103]
    v_cvt_pk_bf16_f32 v137, v138, v139
    v_mfma_f32_16x16x32_bf16 v[104:107], a[72:75], a[216:219], v[104:107]
    ds_read_b64_tr_b16 a[10:11], v234 offset:45056
    v_cvt_pk_bf16_f32 v138, v140, v141
    v_mfma_f32_16x16x32_bf16 v[108:111], a[72:75], a[220:223], v[108:111]
    v_cvt_pk_bf16_f32 v139, v142, v143
    v_mfma_f32_16x16x32_bf16 v[112:115], a[76:79], a[208:211], v[112:115]
    ds_read_b64_tr_b16 a[12:13], v235 offset:40960
    buffer_store_dwordx4 v[136:139], v3, s[36:39], s45 offen offset:1024 sc1
    v_cvt_pk_bf16_f32 v144, v144, v145
    v_mfma_f32_16x16x32_bf16 v[116:119], a[76:79], a[212:215], v[116:119]
    v_cvt_pk_bf16_f32 v145, v146, v147
    v_mfma_f32_16x16x32_bf16 v[120:123], a[76:79], a[216:219], v[120:123]
    ds_read_b64_tr_b16 a[14:15], v235 offset:45056
    v_cvt_pk_bf16_f32 v146, v148, v149
    v_mfma_f32_16x16x32_bf16 v[124:127], a[76:79], a[220:223], v[124:127]
    v_cvt_pk_bf16_f32 v147, v150, v151
    v_mfma_f32_16x16x32_bf16 v[96:99], a[80:83], a[224:227], v[96:99]
    ds_read_b64_tr_b16 a[16:17], v234 offset:49152
    buffer_store_dwordx4 v[144:147], v3, s[36:39], s45 offen offset:2048 sc1
    v_cvt_pk_bf16_f32 v152, v152, v153
    v_mfma_f32_16x16x32_bf16 v[100:103], a[80:83], a[228:231], v[100:103]
    v_cvt_pk_bf16_f32 v153, v154, v155
    v_mfma_f32_16x16x32_bf16 v[104:107], a[80:83], a[232:235], v[104:107]
    ds_read_b64_tr_b16 a[18:19], v234 offset:53248
    v_cvt_pk_bf16_f32 v154, v156, v157
    v_mfma_f32_16x16x32_bf16 v[108:111], a[80:83], a[236:239], v[108:111]
    v_cvt_pk_bf16_f32 v155, v158, v159
    v_mfma_f32_16x16x32_bf16 v[112:115], a[84:87], a[224:227], v[112:115]
    ds_read_b64_tr_b16 a[20:21], v235 offset:49152
    buffer_store_dwordx4 v[152:155], v3, s[36:39], s45 offen offset:3072 sc1
    v_mfma_f32_16x16x32_bf16 v[116:119], a[84:87], a[228:231], v[116:119]
    v_mfma_f32_16x16x32_bf16 v[120:123], a[84:87], a[232:235], v[120:123]
    ds_read_b64_tr_b16 a[22:23], v235 offset:53248
    v_mfma_f32_16x16x32_bf16 v[124:127], a[84:87], a[236:239], v[124:127]
    v_mfma_f32_16x16x32_bf16 v[96:99], a[88:91], a[240:243], v[96:99]
    ds_read_b64_tr_b16 a[24:25], v234 offset:57344
    v_mfma_f32_16x16x32_bf16 v[100:103], a[88:91], a[244:247], v[100:103]
    v_mfma_f32_16x16x32_bf16 v[104:107], a[88:91], a[248:251], v[104:107]
    ds_read_b64_tr_b16 a[26:27], v234 offset:61440
    v_mfma_f32_16x16x32_bf16 v[108:111], a[88:91], a[252:255], v[108:111]
    v_mfma_f32_16x16x32_bf16 v[112:115], a[92:95], a[240:243], v[112:115]
    ds_read_b64_tr_b16 a[28:29], v235 offset:57344
    v_mfma_f32_16x16x32_bf16 v[116:119], a[92:95], a[244:247], v[116:119]
    v_mfma_f32_16x16x32_bf16 v[120:123], a[92:95], a[248:251], v[120:123]
    ds_read_b64_tr_b16 a[30:31], v235 offset:61440
    v_mfma_f32_16x16x32_bf16 v[124:127], a[92:95], a[252:255], v[124:127]
    s_waitcnt vmcnt(8) lgkmcnt(15)
    v_mfma_f32_16x16x32_bf16 v[96:99], a[96:99], a[128:131], v[96:99]
    ds_read_b64_tr_b16 a[32:33], v242 offset:0
    v_mfma_f32_16x16x32_bf16 v[100:103], a[96:99], a[132:135], v[100:103]
    v_mfma_f32_16x16x32_bf16 v[104:107], a[96:99], a[136:139], v[104:107]
    ds_read_b64_tr_b16 a[34:35], v242 offset:4096
    v_mfma_f32_16x16x32_bf16 v[108:111], a[96:99], a[140:143], v[108:111]
    v_mfma_f32_16x16x32_bf16 v[112:115], a[100:103], a[128:131], v[112:115]
    ds_read_b64_tr_b16 a[36:37], v243 offset:0
    v_mfma_f32_16x16x32_bf16 v[116:119], a[100:103], a[132:135], v[116:119]
    v_mfma_f32_16x16x32_bf16 v[120:123], a[100:103], a[136:139], v[120:123]
    ds_read_b64_tr_b16 a[38:39], v243 offset:4096
    v_mfma_f32_16x16x32_bf16 v[124:127], a[100:103], a[140:143], v[124:127]
    v_mfma_f32_16x16x32_bf16 v[96:99], a[104:107], a[144:147], v[96:99]
    ds_read_b64_tr_b16 a[40:41], v242 offset:8192
    v_mfma_f32_16x16x32_bf16 v[100:103], a[104:107], a[148:151], v[100:103]
    v_mfma_f32_16x16x32_bf16 v[104:107], a[104:107], a[152:155], v[104:107]
    ds_read_b64_tr_b16 a[42:43], v242 offset:12288
    v_mfma_f32_16x16x32_bf16 v[108:111], a[104:107], a[156:159], v[108:111]
    v_mfma_f32_16x16x32_bf16 v[112:115], a[108:111], a[144:147], v[112:115]
    ds_read_b64_tr_b16 a[44:45], v243 offset:8192
    v_mfma_f32_16x16x32_bf16 v[116:119], a[108:111], a[148:151], v[116:119]
    v_mfma_f32_16x16x32_bf16 v[120:123], a[108:111], a[152:155], v[120:123]
    ds_read_b64_tr_b16 a[46:47], v243 offset:12288
    v_mfma_f32_16x16x32_bf16 v[124:127], a[108:111], a[156:159], v[124:127]
    v_mfma_f32_16x16x32_bf16 v[96:99], a[112:115], a[160:163], v[96:99]
    ds_read_b64_tr_b16 a[48:49], v242 offset:16384
    v_mfma_f32_16x16x32_bf16 v[100:103], a[112:115], a[164:167], v[100:103]
    v_mfma_f32_16x16x32_bf16 v[104:107], a[112:115], a[168:171], v[104:107]
    ds_read_b64_tr_b16 a[50:51], v242 offset:20480
    v_mfma_f32_16x16x32_bf16 v[108:111], a[112:115], a[172:175], v[108:111]
    v_mfma_f32_16x16x32_bf16 v[112:115], a[116:119], a[160:163], v[112:115]
    ds_read_b64_tr_b16 a[52:53], v243 offset:16384
    v_mfma_f32_16x16x32_bf16 v[116:119], a[116:119], a[164:167], v[116:119]
    v_mfma_f32_16x16x32_bf16 v[120:123], a[116:119], a[168:171], v[120:123]
    ds_read_b64_tr_b16 a[54:55], v243 offset:20480
    v_mfma_f32_16x16x32_bf16 v[124:127], a[116:119], a[172:175], v[124:127]
    v_mfma_f32_16x16x32_bf16 v[96:99], a[120:123], a[176:179], v[96:99]
    ds_read_b64_tr_b16 a[56:57], v242 offset:24576
    v_mfma_f32_16x16x32_bf16 v[100:103], a[120:123], a[180:183], v[100:103]
    v_mfma_f32_16x16x32_bf16 v[104:107], a[120:123], a[184:187], v[104:107]
    ds_read_b64_tr_b16 a[58:59], v242 offset:28672
    v_mfma_f32_16x16x32_bf16 v[108:111], a[120:123], a[188:191], v[108:111]
    v_mfma_f32_16x16x32_bf16 v[112:115], a[124:127], a[176:179], v[112:115]
    ds_read_b64_tr_b16 a[60:61], v243 offset:24576
    v_mfma_f32_16x16x32_bf16 v[116:119], a[124:127], a[180:183], v[116:119]
    v_mfma_f32_16x16x32_bf16 v[120:123], a[124:127], a[184:187], v[120:123]
    ds_read_b64_tr_b16 a[62:63], v243 offset:28672
    v_mfma_f32_16x16x32_bf16 v[124:127], a[124:127], a[188:191], v[124:127]
    s_waitcnt vmcnt(25) lgkmcnt(15)
    v_mfma_f32_16x16x32_bf16 v[64:67], a[0:3], a[192:195], v[64:67]
    ds_read_b64_tr_b16 a[64:65], v232 offset:32768
    s_xor_b32 s45, s2, 4
    s_lshl_b32 s45, s45, 2
    s_add_u32 s45, s45, s3
    s_mul_i32 s45, s45, 12288
    s_add_u32 s45, s45, 4096
    v_mfma_f32_16x16x32_bf16 v[68:71], a[0:3], a[196:199], v[68:71]
    v_mfma_f32_16x16x32_bf16 v[72:75], a[0:3], a[200:203], v[72:75]
    ds_read_b64_tr_b16 a[66:67], v232 offset:36864
    v_mfma_f32_16x16x32_bf16 v[76:79], a[0:3], a[204:207], v[76:79]
    v_mfma_f32_16x16x32_bf16 v[80:83], a[4:7], a[192:195], v[80:83]
    ds_read_b64_tr_b16 a[68:69], v233 offset:32768
    v_cvt_pk_bf16_f32 v96, v96, v97
    v_mfma_f32_16x16x32_bf16 v[84:87], a[4:7], a[196:199], v[84:87]
    v_cvt_pk_bf16_f32 v97, v98, v99
    v_mfma_f32_16x16x32_bf16 v[88:91], a[4:7], a[200:203], v[88:91]
    ds_read_b64_tr_b16 a[70:71], v233 offset:36864
    v_cvt_pk_bf16_f32 v98, v100, v101
    v_mfma_f32_16x16x32_bf16 v[92:95], a[4:7], a[204:207], v[92:95]
    v_cvt_pk_bf16_f32 v99, v102, v103
    v_mfma_f32_16x16x32_bf16 v[64:67], a[8:11], a[208:211], v[64:67]
    ds_read_b64_tr_b16 a[72:73], v232 offset:40960
    buffer_store_dwordx4 v[96:99], v3, s[36:39], s45 offen offset:0 sc1
    v_cvt_pk_bf16_f32 v104, v104, v105
    v_mfma_f32_16x16x32_bf16 v[68:71], a[8:11], a[212:215], v[68:71]
    v_cvt_pk_bf16_f32 v105, v106, v107
    v_mfma_f32_16x16x32_bf16 v[72:75], a[8:11], a[216:219], v[72:75]
    ds_read_b64_tr_b16 a[74:75], v232 offset:45056
    v_cvt_pk_bf16_f32 v106, v108, v109
    v_mfma_f32_16x16x32_bf16 v[76:79], a[8:11], a[220:223], v[76:79]
    v_cvt_pk_bf16_f32 v107, v110, v111
    v_mfma_f32_16x16x32_bf16 v[80:83], a[12:15], a[208:211], v[80:83]
    ds_read_b64_tr_b16 a[76:77], v233 offset:40960
    buffer_store_dwordx4 v[104:107], v3, s[36:39], s45 offen offset:1024 sc1
    v_cvt_pk_bf16_f32 v112, v112, v113
    v_mfma_f32_16x16x32_bf16 v[84:87], a[12:15], a[212:215], v[84:87]
    v_cvt_pk_bf16_f32 v113, v114, v115
    v_mfma_f32_16x16x32_bf16 v[88:91], a[12:15], a[216:219], v[88:91]
    ds_read_b64_tr_b16 a[78:79], v233 offset:45056
    v_cvt_pk_bf16_f32 v114, v116, v117
    v_mfma_f32_16x16x32_bf16 v[92:95], a[12:15], a[220:223], v[92:95]
    v_cvt_pk_bf16_f32 v115, v118, v119
    v_mfma_f32_16x16x32_bf16 v[64:67], a[16:19], a[224:227], v[64:67]
    ds_read_b64_tr_b16 a[80:81], v232 offset:49152
    buffer_store_dwordx4 v[112:115], v3, s[36:39], s45 offen offset:2048 sc1
    v_cvt_pk_bf16_f32 v120, v120, v121
    v_mfma_f32_16x16x32_bf16 v[68:71], a[16:19], a[228:231], v[68:71]
    v_cvt_pk_bf16_f32 v121, v122, v123
    v_mfma_f32_16x16x32_bf16 v[72:75], a[16:19], a[232:235], v[72:75]
    ds_read_b64_tr_b16 a[82:83], v232 offset:53248
    v_cvt_pk_bf16_f32 v122, v124, v125
    v_mfma_f32_16x16x32_bf16 v[76:79], a[16:19], a[236:239], v[76:79]
    v_cvt_pk_bf16_f32 v123, v126, v127
    v_mfma_f32_16x16x32_bf16 v[80:83], a[20:23], a[224:227], v[80:83]
    ds_read_b64_tr_b16 a[84:85], v233 offset:49152
    buffer_store_dwordx4 v[120:123], v3, s[36:39], s45 offen offset:3072 sc1
    v_mfma_f32_16x16x32_bf16 v[84:87], a[20:23], a[228:231], v[84:87]
    v_mfma_f32_16x16x32_bf16 v[88:91], a[20:23], a[232:235], v[88:91]
    ds_read_b64_tr_b16 a[86:87], v233 offset:53248
    v_mfma_f32_16x16x32_bf16 v[92:95], a[20:23], a[236:239], v[92:95]
    v_mfma_f32_16x16x32_bf16 v[64:67], a[24:27], a[240:243], v[64:67]
    ds_read_b64_tr_b16 a[88:89], v232 offset:57344
    v_mfma_f32_16x16x32_bf16 v[68:71], a[24:27], a[244:247], v[68:71]
    v_mfma_f32_16x16x32_bf16 v[72:75], a[24:27], a[248:251], v[72:75]
    ds_read_b64_tr_b16 a[90:91], v232 offset:61440
    v_mfma_f32_16x16x32_bf16 v[76:79], a[24:27], a[252:255], v[76:79]
    v_mfma_f32_16x16x32_bf16 v[80:83], a[28:31], a[240:243], v[80:83]
    ds_read_b64_tr_b16 a[92:93], v233 offset:57344
    v_mfma_f32_16x16x32_bf16 v[84:87], a[28:31], a[244:247], v[84:87]
    v_mfma_f32_16x16x32_bf16 v[88:91], a[28:31], a[248:251], v[88:91]
    ds_read_b64_tr_b16 a[94:95], v233 offset:61440
    v_mfma_f32_16x16x32_bf16 v[92:95], a[28:31], a[252:255], v[92:95]
    s_waitcnt vmcnt(4) lgkmcnt(15)
    v_mfma_f32_16x16x32_bf16 v[64:67], a[32:35], a[128:131], v[64:67]
    ds_read_b64_tr_b16 a[96:97], v240 offset:0
    v_mfma_f32_16x16x32_bf16 v[68:71], a[32:35], a[132:135], v[68:71]
    s_xor_b32 s45, s53, 0x3000
    v_mov_b32 v25, s70
    s_mov_b64 exec, 1
    buffer_store_dword v25, v12, s[24:27], s45 offen offset:256 sc1
    s_mov_b64 exec, -1
    v_mfma_f32_16x16x32_bf16 v[72:75], a[32:35], a[136:139], v[72:75]
    ds_read_b64_tr_b16 a[98:99], v240 offset:4096
    v_mfma_f32_16x16x32_bf16 v[76:79], a[32:35], a[140:143], v[76:79]
    v_mfma_f32_16x16x32_bf16 v[80:83], a[36:39], a[128:131], v[80:83]
    ds_read_b64_tr_b16 a[100:101], v241 offset:0
    v_mfma_f32_16x16x32_bf16 v[84:87], a[36:39], a[132:135], v[84:87]
    v_mfma_f32_16x16x32_bf16 v[88:91], a[36:39], a[136:139], v[88:91]
    ds_read_b64_tr_b16 a[102:103], v241 offset:4096
    v_mfma_f32_16x16x32_bf16 v[92:95], a[36:39], a[140:143], v[92:95]
    v_mfma_f32_16x16x32_bf16 v[64:67], a[40:43], a[144:147], v[64:67]
    ds_read_b64_tr_b16 a[104:105], v240 offset:8192
    v_mfma_f32_16x16x32_bf16 v[68:71], a[40:43], a[148:151], v[68:71]
    v_mfma_f32_16x16x32_bf16 v[72:75], a[40:43], a[152:155], v[72:75]
    ds_read_b64_tr_b16 a[106:107], v240 offset:12288
    v_mfma_f32_16x16x32_bf16 v[76:79], a[40:43], a[156:159], v[76:79]
    v_mfma_f32_16x16x32_bf16 v[80:83], a[44:47], a[144:147], v[80:83]
    ds_read_b64_tr_b16 a[108:109], v241 offset:8192
    v_mfma_f32_16x16x32_bf16 v[84:87], a[44:47], a[148:151], v[84:87]
    v_mfma_f32_16x16x32_bf16 v[88:91], a[44:47], a[152:155], v[88:91]
    ds_read_b64_tr_b16 a[110:111], v241 offset:12288
    v_mfma_f32_16x16x32_bf16 v[92:95], a[44:47], a[156:159], v[92:95]
    v_mfma_f32_16x16x32_bf16 v[64:67], a[48:51], a[160:163], v[64:67]
    ds_read_b64_tr_b16 a[112:113], v240 offset:16384
    v_mfma_f32_16x16x32_bf16 v[68:71], a[48:51], a[164:167], v[68:71]
    v_mfma_f32_16x16x32_bf16 v[72:75], a[48:51], a[168:171], v[72:75]
    ds_read_b64_tr_b16 a[114:115], v240 offset:20480
    v_mfma_f32_16x16x32_bf16 v[76:79], a[48:51], a[172:175], v[76:79]
    v_mfma_f32_16x16x32_bf16 v[80:83], a[52:55], a[160:163], v[80:83]
    ds_read_b64_tr_b16 a[116:117], v241 offset:16384
    v_mfma_f32_16x16x32_bf16 v[84:87], a[52:55], a[164:167], v[84:87]
    v_mfma_f32_16x16x32_bf16 v[88:91], a[52:55], a[168:171], v[88:91]
    ds_read_b64_tr_b16 a[118:119], v241 offset:20480
    v_mfma_f32_16x16x32_bf16 v[92:95], a[52:55], a[172:175], v[92:95]
    v_mfma_f32_16x16x32_bf16 v[64:67], a[56:59], a[176:179], v[64:67]
    ds_read_b64_tr_b16 a[120:121], v240 offset:24576
    v_mfma_f32_16x16x32_bf16 v[68:71], a[56:59], a[180:183], v[68:71]
    v_mfma_f32_16x16x32_bf16 v[72:75], a[56:59], a[184:187], v[72:75]
    ds_read_b64_tr_b16 a[122:123], v240 offset:28672
    v_mfma_f32_16x16x32_bf16 v[76:79], a[56:59], a[188:191], v[76:79]
    v_mfma_f32_16x16x32_bf16 v[80:83], a[60:63], a[176:179], v[80:83]
    ds_read_b64_tr_b16 a[124:125], v241 offset:24576
    v_mfma_f32_16x16x32_bf16 v[84:87], a[60:63], a[180:183], v[84:87]
    v_mfma_f32_16x16x32_bf16 v[88:91], a[60:63], a[184:187], v[88:91]
    ds_read_b64_tr_b16 a[126:127], v241 offset:28672
    v_mfma_f32_16x16x32_bf16 v[92:95], a[60:63], a[188:191], v[92:95]
    s_waitcnt vmcnt(30) lgkmcnt(15)
    v_mfma_f32_16x16x32_bf16 v[32:35], a[64:67], a[192:195], v[32:35]
    s_xor_b32 s45, s2, 2
    s_lshl_b32 s45, s45, 2
    s_add_u32 s45, s45, s3
    s_mul_i32 s45, s45, 12288
    s_add_u32 s45, s45, 0
    v_mfma_f32_16x16x32_bf16 v[36:39], a[64:67], a[196:199], v[36:39]
    s_bfm_b64 exec, 3, 0
    buffer_load_dword v23, v13, s[24:27], s53 offen sc1
    s_mov_b64 exec, -1
    v_mfma_f32_16x16x32_bf16 v[40:43], a[64:67], a[200:203], v[40:43]
    v_mfma_f32_16x16x32_bf16 v[44:47], a[64:67], a[204:207], v[44:47]
    v_mfma_f32_16x16x32_bf16 v[48:51], a[68:71], a[192:195], v[48:51]
    v_cvt_pk_bf16_f32 v64, v64, v65
    v_mfma_f32_16x16x32_bf16 v[52:55], a[68:71], a[196:199], v[52:55]
    v_cvt_pk_bf16_f32 v65, v66, v67
    v_mfma_f32_16x16x32_bf16 v[56:59], a[68:71], a[200:203], v[56:59]
    v_cvt_pk_bf16_f32 v66, v68, v69
    v_mfma_f32_16x16x32_bf16 v[60:63], a[68:71], a[204:207], v[60:63]
    v_cvt_pk_bf16_f32 v67, v70, v71
    v_mfma_f32_16x16x32_bf16 v[32:35], a[72:75], a[208:211], v[32:35]
    buffer_store_dwordx4 v[64:67], v3, s[36:39], s45 offen offset:0 sc1
    v_cvt_pk_bf16_f32 v72, v72, v73
    v_mfma_f32_16x16x32_bf16 v[36:39], a[72:75], a[212:215], v[36:39]
    v_cvt_pk_bf16_f32 v73, v74, v75
    v_mfma_f32_16x16x32_bf16 v[40:43], a[72:75], a[216:219], v[40:43]
    v_cvt_pk_bf16_f32 v74, v76, v77
    v_mfma_f32_16x16x32_bf16 v[44:47], a[72:75], a[220:223], v[44:47]
    v_cvt_pk_bf16_f32 v75, v78, v79
    v_mfma_f32_16x16x32_bf16 v[48:51], a[76:79], a[208:211], v[48:51]
    buffer_store_dwordx4 v[72:75], v3, s[36:39], s45 offen offset:1024 sc1
    v_cvt_pk_bf16_f32 v80, v80, v81
    v_mfma_f32_16x16x32_bf16 v[52:55], a[76:79], a[212:215], v[52:55]
    v_cvt_pk_bf16_f32 v81, v82, v83
    v_mfma_f32_16x16x32_bf16 v[56:59], a[76:79], a[216:219], v[56:59]
    v_cvt_pk_bf16_f32 v82, v84, v85
    v_mfma_f32_16x16x32_bf16 v[60:63], a[76:79], a[220:223], v[60:63]
    v_cvt_pk_bf16_f32 v83, v86, v87
    v_mfma_f32_16x16x32_bf16 v[32:35], a[80:83], a[224:227], v[32:35]
    buffer_store_dwordx4 v[80:83], v3, s[36:39], s45 offen offset:2048 sc1
    v_cvt_pk_bf16_f32 v88, v88, v89
    v_mfma_f32_16x16x32_bf16 v[36:39], a[80:83], a[228:231], v[36:39]
    v_cvt_pk_bf16_f32 v89, v90, v91
    v_mfma_f32_16x16x32_bf16 v[40:43], a[80:83], a[232:235], v[40:43]
    v_cvt_pk_bf16_f32 v90, v92, v93
    v_mfma_f32_16x16x32_bf16 v[44:47], a[80:83], a[236:239], v[44:47]
    v_cvt_pk_bf16_f32 v91, v94, v95
    v_mfma_f32_16x16x32_bf16 v[48:51], a[84:87], a[224:227], v[48:51]
    buffer_store_dwordx4 v[88:91], v3, s[36:39], s45 offen offset:3072 sc1
    v_mfma_f32_16x16x32_bf16 v[52:55], a[84:87], a[228:231], v[52:55]
    v_mfma_f32_16x16x32_bf16 v[56:59], a[84:87], a[232:235], v[56:59]
    v_mfma_f32_16x16x32_bf16 v[60:63], a[84:87], a[236:239], v[60:63]
    v_mfma_f32_16x16x32_bf16 v[32:35], a[88:91], a[240:243], v[32:35]
    v_mfma_f32_16x16x32_bf16 v[36:39], a[88:91], a[244:247], v[36:39]
    v_mfma_f32_16x16x32_bf16 v[40:43], a[88:91], a[248:251], v[40:43]
    v_mfma_f32_16x16x32_bf16 v[44:47], a[88:91], a[252:255], v[44:47]
    v_mfma_f32_16x16x32_bf16 v[48:51], a[92:95], a[240:243], v[48:51]
    v_mfma_f32_16x16x32_bf16 v[52:55], a[92:95], a[244:247], v[52:55]
    v_mfma_f32_16x16x32_bf16 v[56:59], a[92:95], a[248:251], v[56:59]
    v_mfma_f32_16x16x32_bf16 v[60:63], a[92:95], a[252:255], v[60:63]
    s_waitcnt vmcnt(4) lgkmcnt(0)
    v_cmp_ne_u32 s[6:7], s70, v23
    s_nop 1
    s_bitcmp1_b32 s6, 2
    s_cselect_b32 s62, 0x7fff0000, s52
    s_add_u32 s62, s62, 8192
    s_bitcmp1_b32 s6, 1
    s_cselect_b32 s61, 0x7fff0000, s52
    s_add_u32 s61, s61, 4096
    v_mfma_f32_16x16x32_bf16 v[32:35], a[96:99], a[128:131], v[32:35]
    v_mfma_f32_16x16x32_bf16 v[36:39], a[96:99], a[132:135], v[36:39]
    s_xor_b32 s45, s53, 0x2000
    v_mov_b32 v25, s70
    s_mov_b64 exec, 1
    buffer_store_dword v25, v12, s[24:27], s45 offen offset:128 sc1
    s_mov_b64 exec, -1
    v_mfma_f32_16x16x32_bf16 v[40:43], a[96:99], a[136:139], v[40:43]
    v_mfma_f32_16x16x32_bf16 v[44:47], a[96:99], a[140:143], v[44:47]
    buffer_load_dwordx4 v[160:163], v3, s[36:39], s62 offen offset:0 sc1
    v_mfma_f32_16x16x32_bf16 v[48:51], a[100:103], a[128:131], v[48:51]
    v_mfma_f32_16x16x32_bf16 v[52:55], a[100:103], a[132:135], v[52:55]
    buffer_load_dwordx4 v[164:167], v3, s[36:39], s62 offen offset:1024 sc1
    v_mfma_f32_16x16x32_bf16 v[56:59], a[100:103], a[136:139], v[56:59]
    v_mfma_f32_16x16x32_bf16 v[60:63], a[100:103], a[140:143], v[60:63]
    buffer_load_dwordx4 v[168:171], v3, s[36:39], s62 offen offset:2048 sc1
    v_mfma_f32_16x16x32_bf16 v[32:35], a[104:107], a[144:147], v[32:35]
    v_mfma_f32_16x16x32_bf16 v[36:39], a[104:107], a[148:151], v[36:39]
    buffer_load_dwordx4 v[172:175], v3, s[36:39], s62 offen offset:3072 sc1
    v_mfma_f32_16x16x32_bf16 v[40:43], a[104:107], a[152:155], v[40:43]
    v_mfma_f32_16x16x32_bf16 v[44:47], a[104:107], a[156:159], v[44:47]
    buffer_load_dwordx4 v[144:147], v3, s[36:39], s61 offen offset:0 sc1
    v_mfma_f32_16x16x32_bf16 v[48:51], a[108:111], a[144:147], v[48:51]
    v_mfma_f32_16x16x32_bf16 v[52:55], a[108:111], a[148:151], v[52:55]
    buffer_load_dwordx4 v[148:151], v3, s[36:39], s61 offen offset:1024 sc1
    v_mfma_f32_16x16x32_bf16 v[56:59], a[108:111], a[152:155], v[56:59]
    v_mfma_f32_16x16x32_bf16 v[60:63], a[108:111], a[156:159], v[60:63]
    buffer_load_dwordx4 v[152:155], v3, s[36:39], s61 offen offset:2048 sc1
    v_mfma_f32_16x16x32_bf16 v[32:35], a[112:115], a[160:163], v[32:35]
    v_mfma_f32_16x16x32_bf16 v[36:39], a[112:115], a[164:167], v[36:39]
    buffer_load_dwordx4 v[156:159], v3, s[36:39], s61 offen offset:3072 sc1
    v_mfma_f32_16x16x32_bf16 v[40:43], a[112:115], a[168:171], v[40:43]
    v_mfma_f32_16x16x32_bf16 v[44:47], a[112:115], a[172:175], v[44:47]
    v_mfma_f32_16x16x32_bf16 v[48:51], a[116:119], a[160:163], v[48:51]
    v_mfma_f32_16x16x32_bf16 v[52:55], a[116:119], a[164:167], v[52:55]
    s_bfm_b64 exec, 3, 0
    buffer_load_dword v24, v13, s[24:27], s53 offen sc1
    s_mov_b64 exec, -1
    v_mfma_f32_16x16x32_bf16 v[56:59], a[116:119], a[168:171], v[56:59]
    v_mfma_f32_16x16x32_bf16 v[60:63], a[116:119], a[172:175], v[60:63]
    v_mfma_f32_16x16x32_bf16 v[32:35], a[120:123], a[176:179], v[32:35]
    v_mfma_f32_16x16x32_bf16 v[36:39], a[120:123], a[180:183], v[36:39]
    v_mfma_f32_16x16x32_bf16 v[40:43], a[120:123], a[184:187], v[40:43]
    v_mfma_f32_16x16x32_bf16 v[44:47], a[120:123], a[188:191], v[44:47]
    v_mfma_f32_16x16x32_bf16 v[48:51], a[124:127], a[176:179], v[48:51]
    v_mfma_f32_16x16x32_bf16 v[52:55], a[124:127], a[180:183], v[52:55]
    v_mfma_f32_16x16x32_bf16 v[56:59], a[124:127], a[184:187], v[56:59]
    v_mfma_f32_16x16x32_bf16 v[60:63], a[124:127], a[188:191], v[60:63]
    s_mov_b32 s56, 0xbfb8aa3b
    s_mov_b32 s57, s56
    s_mov_b32 s59, 0xffff0000
    v_mov_b32 v26, 1.0
    v_mov_b32 v27, 1.0
    s_waitcnt vmcnt(10)
    s_xor_b32 s45, s53, 0x1000
    v_mov_b32 v25, s70
    s_mov_b64 exec, 1
    buffer_store_dword v25, v12, s[24:27], s45 offen offset:0 sc1
    s_mov_b64 exec, -1
    s_waitcnt vmcnt(1)
    v_cmp_ne_u32 s[10:11], s70, v24
    s_nop 1
    s_bitcmp1_b32 s6, 2
    s_cbranch_scc0 fx_have2
    s_bitcmp1_b32 s10, 2
    s_cbranch_scc0 pd_fx2
    s_add_u32 s45, s53, 256
    s_mov_b32 s68, 0x20000
pl_fx2:
    s_bfm_b64 exec, 1, 0
    buffer_load_dword v24, v13, s[24:27], s45 offen sc1
    s_mov_b64 exec, -1
    s_waitcnt vmcnt(0)
    v_cmp_ne_u32 vcc, s70, v24
    s_nop 1
    s_bfm_b64 s[66:67], 1, 0
    s_and_b64 vcc, vcc, s[66:67]
    s_nop 3
    s_cbranch_vccz pd_fx2
    s_sleep 1
    s_sub_u32 s68, s68, 1
    s_cmp_lg_u32 s68, 0
    s_cbranch_scc1 pl_fx2
pd_fx2:
    s_add_u32 s45, s52, 8192
    buffer_load_dwordx4 v[160:163], v3, s[36:39], s45 offen offset:0 sc1
    buffer_load_dwordx4 v[164:167], v3, s[36:39], s45 offen offset:1024 sc1
    buffer_load_dwordx4 v[168:171], v3, s[36:39], s45 offen offset:2048 sc1
    buffer_load_dwordx4 v[172:175], v3, s[36:39], s45 offen offset:3072 sc1
fx_have2:
    s_bitcmp1_b32 s6, 1
    s_cbranch_scc0 fx_have1
    s_bitcmp1_b32 s10, 1
    s_cbranch_scc0 pd_fx1
    s_add_u32 s45, s53, 128
    s_mov_b32 s68, 0x20000
pl_fx1:
    s_bfm_b64 exec, 1, 0
    buffer_load_dword v24, v13, s[24:27], s45 offen sc1
    s_mov_b64 exec, -1
    s_waitcnt vmcnt(0)
    v_cmp_ne_u32 vcc, s70, v24
    s_nop 1
    s_bfm_b64 s[66:67], 1, 0
    s_and_b64 vcc, vcc, s[66:67]
    s_nop 3
    s_cbranch_vccz pd_fx1
    s_sleep 1
    s_sub_u32 s68, s68, 1
    s_cmp_lg_u32 s68, 0
    s_cbranch_scc1 pl_fx1
pd_fx1:
    s_add_u32 s45, s52, 4096
    buffer_load_dwordx4 v[144:147], v3, s[36:39], s45 offen offset:0 sc1
    buffer_load_dwordx4 v[148:151], v3, s[36:39], s45 offen offset:1024 sc1
    buffer_load_dwordx4 v[152:155], v3, s[36:39], s45 offen offset:2048 sc1
    buffer_load_dwordx4 v[156:159], v3, s[36:39], s45 offen offset:3072 sc1
fx_have1:
    s_bitcmp1_b32 s10, 0
    s_cbranch_scc0 pd_fx0
    s_add_u32 s45, s53, 0
    s_mov_b32 s68, 0x20000
pl_fx0:
    s_bfm_b64 exec, 1, 0
    buffer_load_dword v24, v13, s[24:27], s45 offen sc1
    s_mov_b64 exec, -1
    s_waitcnt vmcnt(0)
    v_cmp_ne_u32 vcc, s70, v24
    s_nop 1
    s_bfm_b64 s[66:67], 1, 0
    s_and_b64 vcc, vcc, s[66:67]
    s_nop 3
    s_cbranch_vccz pd_fx0
    s_sleep 1
    s_sub_u32 s68, s68, 1
    s_cmp_lg_u32 s68, 0
    s_cbranch_scc1 pl_fx0
pd_fx0:
    s_add_u32 s45, s52, 0
    buffer_load_dwordx4 v[128:131], v3, s[36:39], s45 offen offset:0 sc1
    buffer_load_dwordx4 v[132:135], v3, s[36:39], s45 offen offset:1024 sc1
    buffer_load_dwordx4 v[136:139], v3, s[36:39], s45 offen offset:2048 sc1
    buffer_load_dwordx4 v[140:143], v3, s[36:39], s45 offen offset:3072 sc1
    v_lshlrev_b32 v64, 16, v176
    v_and_b32 v65, s59, v176
    v_lshlrev_b32 v96, 16, v192
    v_and_b32 v97, s59, v192
    v_lshlrev_b32 v66, 16, v177
    v_and_b32 v67, s59, v177
    v_lshlrev_b32 v98, 16, v193
    v_and_b32 v99, s59, v193
    v_lshlrev_b32 v68, 16, v178
    v_and_b32 v69, s59, v178
    v_lshlrev_b32 v100, 16, v194
    v_and_b32 v101, s59, v194
    v_lshlrev_b32 v70, 16, v179
    v_and_b32 v71, s59, v179
    v_lshlrev_b32 v102, 16, v195
    v_and_b32 v103, s59, v195
    v_lshlrev_b32 v72, 16, v180
    v_and_b32 v73, s59, v180
    v_lshlrev_b32 v104, 16, v196
    v_and_b32 v105, s59, v196
    v_lshlrev_b32 v74, 16, v181
    v_and_b32 v75, s59, v181
    v_lshlrev_b32 v106, 16, v197
    v_and_b32 v107, s59, v197
    v_lshlrev_b32 v76, 16, v182
    v_and_b32 v77, s59, v182
    v_lshlrev_b32 v108, 16, v198
    v_and_b32 v109, s59, v198
    v_lshlrev_b32 v78, 16, v183
    v_and_b32 v79, s59, v183
    v_lshlrev_b32 v110, 16, v199
    v_and_b32 v111, s59, v199
    v_lshlrev_b32 v80, 16, v184
    v_and_b32 v81, s59, v184
    v_lshlrev_b32 v112, 16, v200
    v_and_b32 v113, s59, v200
    v_lshlrev_b32 v82, 16, v185
    v_and_b32 v83, s59, v185
    v_lshlrev_b32 v114, 16, v201
    v_and_b32 v115, s59, v201
    v_lshlrev_b32 v84, 16, v186
    v_and_b32 v85, s59, v186
    v_lshlrev_b32 v116, 16, v202
    v_and_b32 v117, s59, v202
    v_lshlrev_b32 v86, 16, v187
    v_and_b32 v87, s59, v187
    v_lshlrev_b32 v118, 16, v203
    v_and_b32 v119, s59, v203
    v_lshlrev_b32 v88, 16, v188
    v_and_b32 v89, s59, v188
    v_lshlrev_b32 v120, 16, v204
    v_and_b32 v121, s59, v204
    v_lshlrev_b32 v90, 16, v189
    v_and_b32 v91, s59, v189
    v_lshlrev_b32 v122, 16, v205
    v_and_b32 v123, s59, v205
    v_lshlrev_b32 v92, 16, v190
    v_and_b32 v93, s59, v190
    v_lshlrev_b32 v124, 16, v206
    v_and_b32 v125, s59, v206
    v_lshlrev_b32 v94, 16, v191
    v_and_b32 v95, s59, v191
    v_lshlrev_b32 v126, 16, v207
    v_and_b32 v127, s59, v207
    s_barrier
    s_waitcnt vmcnt(4)
    s_add_u32 s12, s18, 0x0
    s_addc_u32 s13, s19, 0
    s_and_b32 s13, s13, 0xffff
    s_mov_b32 s14, 0x400000
    s_mov_b32 s15, 0x20000
    v_lshlrev_b32 v224, 16, v160
    v_and_b32 v225, s59, v160
    v_lshlrev_b32 v226, 16, v161
    v_and_b32 v227, s59, v161
    v_lshlrev_b32 v228, 16, v162
    v_and_b32 v229, s59, v162
    v_lshlrev_b32 v230, 16, v163
    v_and_b32 v231, s59, v163
    v_pk_add_f32 v[32:33], v[32:33], v[224:225]
    v_pk_add_f32 v[34:35], v[34:35], v[226:227]
    v_pk_add_f32 v[36:37], v[36:37], v[228:229]
    v_pk_add_f32 v[38:39], v[38:39], v[230:231]
    v_lshlrev_b32 v216, 16, v144
    v_and_b32 v217, s59, v144
    v_lshlrev_b32 v218, 16, v145
    v_and_b32 v219, s59, v145
    v_lshlrev_b32 v220, 16, v146
    v_and_b32 v221, s59, v146
    v_lshlrev_b32 v222, 16, v147
    v_and_b32 v223, s59, v147
    v_pk_add_f32 v[32:33], v[32:33], v[216:217]
    v_pk_add_f32 v[34:35], v[34:35], v[218:219]
    v_pk_add_f32 v[36:37], v[36:37], v[220:221]
    v_pk_add_f32 v[38:39], v[38:39], v[222:223]
    v_lshlrev_b32 v224, 16, v164
    v_and_b32 v225, s59, v164
    v_lshlrev_b32 v226, 16, v165
    v_and_b32 v227, s59, v165
    v_lshlrev_b32 v228, 16, v166
    v_and_b32 v229, s59, v166
    v_lshlrev_b32 v230, 16, v167
    v_and_b32 v231, s59, v167
    v_pk_add_f32 v[40:41], v[40:41], v[224:225]
    v_pk_add_f32 v[42:43], v[42:43], v[226:227]
    v_pk_add_f32 v[44:45], v[44:45], v[228:229]
    v_pk_add_f32 v[46:47], v[46:47], v[230:231]
    v_lshlrev_b32 v216, 16, v148
    v_and_b32 v217, s59, v148
    v_lshlrev_b32 v218, 16, v149
    v_and_b32 v219, s59, v149
    v_lshlrev_b32 v220, 16, v150
    v_and_b32 v221, s59, v150
    v_lshlrev_b32 v222, 16, v151
    v_and_b32 v223, s59, v151
    v_pk_add_f32 v[40:41], v[40:41], v[216:217]
    v_pk_add_f32 v[42:43], v[42:43], v[218:219]
    v_pk_add_f32 v[44:45], v[44:45], v[220:221]
    v_pk_add_f32 v[46:47], v[46:47], v[222:223]
    v_lshlrev_b32 v224, 16, v168
    v_and_b32 v225, s59, v168
    v_lshlrev_b32 v226, 16, v169
    v_and_b32 v227, s59, v169
    v_lshlrev_b32 v228, 16, v170
    v_and_b32 v229, s59, v170
    v_lshlrev_b32 v230, 16, v171
    v_and_b32 v231, s59, v171
    v_pk_add_f32 v[48:49], v[48:49], v[224:225]
    v_pk_add_f32 v[50:51], v[50:51], v[226:227]
    v_pk_add_f32 v[52:53], v[52:53], v[228:229]
    v_pk_add_f32 v[54:55], v[54:55], v[230:231]
    v_lshlrev_b32 v216, 16, v152
    v_and_b32 v217, s59, v152
    v_lshlrev_b32 v218, 16, v153
    v_and_b32 v219, s59, v153
    v_lshlrev_b32 v220, 16, v154
    v_and_b32 v221, s59, v154
    v_lshlrev_b32 v222, 16, v155
    v_and_b32 v223, s59, v155
    v_pk_add_f32 v[48:49], v[48:49], v[216:217]
    v_pk_add_f32 v[50:51], v[50:51], v[218:219]
    v_pk_add_f32 v[52:53], v[52:53], v[220:221]
    v_pk_add_f32 v[54:55], v[54:55], v[222:223]
    v_lshlrev_b32 v224, 16, v172
    v_and_b32 v225, s59, v172
    v_lshlrev_b32 v226, 16, v173
    v_and_b32 v227, s59, v173
    v_lshlrev_b32 v228, 16, v174
    v_and_b32 v229, s59, v174
    v_lshlrev_b32 v230, 16, v175
    v_and_b32 v231, s59, v175
    v_pk_add_f32 v[56:57], v[56:57], v[224:225]
    v_pk_add_f32 v[58:59], v[58:59], v[226:227]
    v_pk_add_f32 v[60:61], v[60:61], v[228:229]
    v_pk_add_f32 v[62:63], v[62:63], v[230:231]
    v_lshlrev_b32 v216, 16, v156
    v_and_b32 v217, s59, v156
    v_lshlrev_b32 v218, 16, v157
    v_and_b32 v219, s59, v157
    v_lshlrev_b32 v220, 16, v158
    v_and_b32 v221, s59, v158
    v_lshlrev_b32 v222, 16, v159
    v_and_b32 v223, s59, v159
    v_pk_add_f32 v[56:57], v[56:57], v[216:217]
    v_pk_add_f32 v[58:59], v[58:59], v[218:219]
    v_pk_add_f32 v[60:61], v[60:61], v[220:221]
    v_pk_add_f32 v[62:63], v[62:63], v[222:223]
    s_waitcnt vmcnt(3)
    v_lshlrev_b32 v208, 16, v128
    v_and_b32 v209, s59, v128
    v_lshlrev_b32 v210, 16, v129
    v_and_b32 v211, s59, v129
    v_lshlrev_b32 v212, 16, v130
    v_and_b32 v213, s59, v130
    v_lshlrev_b32 v214, 16, v131
    v_and_b32 v215, s59, v131
    v_pk_add_f32 v[32:33], v[32:33], v[208:209]
    v_pk_add_f32 v[34:35], v[34:35], v[210:211]
    v_pk_add_f32 v[36:37], v[36:37], v[212:213]
    v_pk_add_f32 v[38:39], v[38:39], v[214:215]
    v_pk_mul_f32 v[208:209], v[32:33], s[56:57]
    v_pk_mul_f32 v[210:211], v[34:35], s[56:57]
    v_pk_mul_f32 v[212:213], v[36:37], s[56:57]
    v_pk_mul_f32 v[214:215], v[38:39], s[56:57]
    v_exp_f32 v208, v208
    v_exp_f32 v209, v209
    v_exp_f32 v210, v210
    v_exp_f32 v211, v211
    v_exp_f32 v212, v212
    v_exp_f32 v213, v213
    v_exp_f32 v214, v214
    v_exp_f32 v215, v215
    s_nop 0
    v_pk_add_f32 v[208:209], v[208:209], v[26:27]
    v_pk_add_f32 v[210:211], v[210:211], v[26:27]
    v_pk_add_f32 v[212:213], v[212:213], v[26:27]
    v_pk_add_f32 v[214:215], v[214:215], v[26:27]
    v_rcp_f32 v208, v208
    v_rcp_f32 v209, v209
    v_rcp_f32 v210, v210
    v_rcp_f32 v211, v211
    v_rcp_f32 v212, v212
    v_rcp_f32 v213, v213
    v_rcp_f32 v214, v214
    v_rcp_f32 v215, v215
    s_nop 0
    v_pk_mul_f32 v[32:33], v[32:33], v[208:209]
    v_pk_mul_f32 v[34:35], v[34:35], v[210:211]
    v_pk_mul_f32 v[36:37], v[36:37], v[212:213]
    v_pk_mul_f32 v[38:39], v[38:39], v[214:215]
    v_cvt_pk_bf16_f32 v192, v32, v33
    v_cvt_pk_bf16_f32 v193, v34, v35
    v_cvt_pk_bf16_f32 v194, v36, v37
    v_cvt_pk_bf16_f32 v195, v38, v39
    ds_write_b64 v16, v[192:193] offset:0
    ds_write_b64 v16, v[194:195] offset:1280
    s_waitcnt vmcnt(2)
    v_lshlrev_b32 v216, 16, v132
    v_and_b32 v217, s59, v132
    v_lshlrev_b32 v218, 16, v133
    v_and_b32 v219, s59, v133
    v_lshlrev_b32 v220, 16, v134
    v_and_b32 v221, s59, v134
    v_lshlrev_b32 v222, 16, v135
    v_and_b32 v223, s59, v135
    v_pk_add_f32 v[40:41], v[40:41], v[216:217]
    v_pk_add_f32 v[42:43], v[42:43], v[218:219]
    v_pk_add_f32 v[44:45], v[44:45], v[220:221]
    v_pk_add_f32 v[46:47], v[46:47], v[222:223]
    v_pk_mul_f32 v[216:217], v[40:41], s[56:57]
    v_pk_mul_f32 v[218:219], v[42:43], s[56:57]
    v_pk_mul_f32 v[220:221], v[44:45], s[56:57]
    v_pk_mul_f32 v[222:223], v[46:47], s[56:57]
    v_exp_f32 v216, v216
    v_exp_f32 v217, v217
    v_exp_f32 v218, v218
    v_exp_f32 v219, v219
    v_exp_f32 v220, v220
    v_exp_f32 v221, v221
    v_exp_f32 v222, v222
    v_exp_f32 v223, v223
    s_nop 0
    v_pk_add_f32 v[216:217], v[216:217], v[26:27]
    v_pk_add_f32 v[218:219], v[218:219], v[26:27]
    v_pk_add_f32 v[220:221], v[220:221], v[26:27]
    v_pk_add_f32 v[222:223], v[222:223], v[26:27]
    v_rcp_f32 v216, v216
    v_rcp_f32 v217, v217
    v_rcp_f32 v218, v218
    v_rcp_f32 v219, v219
    v_rcp_f32 v220, v220
    v_rcp_f32 v221, v221
    v_rcp_f32 v222, v222
    v_rcp_f32 v223, v223
    s_nop 0
    v_pk_mul_f32 v[40:41], v[40:41], v[216:217]
    v_pk_mul_f32 v[42:43], v[42:43], v[218:219]
    v_pk_mul_f32 v[44:45], v[44:45], v[220:221]
    v_pk_mul_f32 v[46:47], v[46:47], v[222:223]
    v_cvt_pk_bf16_f32 v196, v40, v41
    v_cvt_pk_bf16_f32 v197, v42, v43
    v_cvt_pk_bf16_f32 v198, v44, v45
    v_cvt_pk_bf16_f32 v199, v46, v47
    ds_write_b64 v16, v[196:197] offset:2560
    ds_write_b64 v16, v[198:199] offset:3840
    s_waitcnt vmcnt(1)
    v_lshlrev_b32 v208, 16, v136
    v_and_b32 v209, s59, v136
    v_lshlrev_b32 v210, 16, v137
    v_and_b32 v211, s59, v137
    v_lshlrev_b32 v212, 16, v138
    v_and_b32 v213, s59, v138
    v_lshlrev_b32 v214, 16, v139
    v_and_b32 v215, s59, v139
    v_pk_add_f32 v[48:49], v[48:49], v[208:209]
    v_pk_add_f32 v[50:51], v[50:51], v[210:211]
    v_pk_add_f32 v[52:53], v[52:53], v[212:213]
    v_pk_add_f32 v[54:55], v[54:55], v[214:215]
    v_pk_mul_f32 v[208:209], v[48:49], s[56:57]
    v_pk_mul_f32 v[210:211], v[50:51], s[56:57]
    v_pk_mul_f32 v[212:213], v[52:53], s[56:57]
    v_pk_mul_f32 v[214:215], v[54:55], s[56:57]
    v_exp_f32 v208, v208
    v_exp_f32 v209, v209
    v_exp_f32 v210, v210
    v_exp_f32 v211, v211
    v_exp_f32 v212, v212
    v_exp_f32 v213, v213
    v_exp_f32 v214, v214
    v_exp_f32 v215, v215
    s_nop 0
    v_pk_add_f32 v[208:209], v[208:209], v[26:27]
    v_pk_add_f32 v[210:211], v[210:211], v[26:27]
    v_pk_add_f32 v[212:213], v[212:213], v[26:27]
    v_pk_add_f32 v[214:215], v[214:215], v[26:27]
    v_rcp_f32 v208, v208
    v_rcp_f32 v209, v209
    v_rcp_f32 v210, v210
    v_rcp_f32 v211, v211
    v_rcp_f32 v212, v212
    v_rcp_f32 v213, v213
    v_rcp_f32 v214, v214
    v_rcp_f32 v215, v215
    s_nop 0
    v_pk_mul_f32 v[48:49], v[48:49], v[208:209]
    v_pk_mul_f32 v[50:51], v[50:51], v[210:211]
    v_pk_mul_f32 v[52:53], v[52:53], v[212:213]
    v_pk_mul_f32 v[54:55], v[54:55], v[214:215]
    v_cvt_pk_bf16_f32 v200, v48, v49
    v_cvt_pk_bf16_f32 v201, v50, v51
    v_cvt_pk_bf16_f32 v202, v52, v53
    v_cvt_pk_bf16_f32 v203, v54, v55
    ds_write_b64 v16, v[200:201] offset:32
    ds_write_b64 v16, v[202:203] offset:1312
    s_waitcnt vmcnt(0)
    v_lshlrev_b32 v216, 16, v140
    v_and_b32 v217, s59, v140
    v_lshlrev_b32 v218, 16, v141
    v_and_b32 v219, s59, v141
    v_lshlrev_b32 v220, 16, v142
    v_and_b32 v221, s59, v142
    v_lshlrev_b32 v222, 16, v143
    v_and_b32 v223, s59, v143
    v_pk_add_f32 v[56:57], v[56:57], v[216:217]
    v_pk_add_f32 v[58:59], v[58:59], v[218:219]
    v_pk_add_f32 v[60:61], v[60:61], v[220:221]
    v_pk_add_f32 v[62:63], v[62:63], v[222:223]
    v_pk_mul_f32 v[216:217], v[56:57], s[56:57]
    v_pk_mul_f32 v[218:219], v[58:59], s[56:57]
    v_pk_mul_f32 v[220:221], v[60:61], s[56:57]
    v_pk_mul_f32 v[222:223], v[62:63], s[56:57]
    v_exp_f32 v216, v216
    v_exp_f32 v217, v217
    v_exp_f32 v218, v218
    v_exp_f32 v219, v219
    v_exp_f32 v220, v220
    v_exp_f32 v221, v221
    v_exp_f32 v222, v222
    v_exp_f32 v223, v223
    s_nop 0
    v_pk_add_f32 v[216:217], v[216:217], v[26:27]
    v_pk_add_f32 v[218:219], v[218:219], v[26:27]
    v_pk_add_f32 v[220:221], v[220:221], v[26:27]
    v_pk_add_f32 v[222:223], v[222:223], v[26:27]
    v_rcp_f32 v216, v216
    v_rcp_f32 v217, v217
    v_rcp_f32 v218, v218
    v_rcp_f32 v219, v219
    v_rcp_f32 v220, v220
    v_rcp_f32 v221, v221
    v_rcp_f32 v222, v222
    v_rcp_f32 v223, v223
    s_nop 0
    v_pk_mul_f32 v[56:57], v[56:57], v[216:217]
    v_pk_mul_f32 v[58:59], v[58:59], v[218:219]
    v_pk_mul_f32 v[60:61], v[60:61], v[220:221]
    v_pk_mul_f32 v[62:63], v[62:63], v[222:223]
    v_cvt_pk_bf16_f32 v204, v56, v57
    v_cvt_pk_bf16_f32 v205, v58, v59
    v_cvt_pk_bf16_f32 v206, v60, v61
    v_cvt_pk_bf16_f32 v207, v62, v63
    ds_write_b64 v16, v[204:205] offset:2592
    ds_write_b64 v16, v[206:207] offset:3872
    s_waitcnt lgkmcnt(0)
    ds_read_b128 v[32:35], v17 offset:0
    ds_read_b128 v[36:39], v17 offset:1280
    ds_read_b128 v[40:43], v17 offset:2560
    ds_read_b128 v[44:47], v17 offset:3840
    s_waitcnt lgkmcnt(3)
    v_lshlrev_b32 v208, 16, v32
    v_and_b32 v209, s59, v32
    v_lshlrev_b32 v210, 16, v33
    v_and_b32 v211, s59, v33
    v_lshlrev_b32 v212, 16, v34
    v_and_b32 v213, s59, v34
    v_lshlrev_b32 v214, 16, v35
    v_and_b32 v215, s59, v35
    v_pk_fma_f32 v[64:65], v[96:97], v[208:209], v[64:65]
    v_pk_fma_f32 v[66:67], v[98:99], v[210:211], v[66:67]
    v_pk_fma_f32 v[68:69], v[100:101], v[212:213], v[68:69]
    v_pk_fma_f32 v[70:71], v[102:103], v[214:215], v[70:71]
    v_cvt_pk_bf16_f32 v176, v64, v65
    v_cvt_pk_bf16_f32 v177, v66, v67
    v_cvt_pk_bf16_f32 v178, v68, v69
    v_cvt_pk_bf16_f32 v179, v70, v71
    buffer_store_dwordx4 v[176:179], v28, s[12:15], s8 offen offset:0
    s_waitcnt lgkmcnt(2)
    v_lshlrev_b32 v216, 16, v36
    v_and_b32 v217, s59, v36
    v_lshlrev_b32 v218, 16, v37
    v_and_b32 v219, s59, v37
    v_lshlrev_b32 v220, 16, v38
    v_and_b32 v221, s59, v38
    v_lshlrev_b32 v222, 16, v39
    v_and_b32 v223, s59, v39
    v_pk_fma_f32 v[72:73], v[104:105], v[216:217], v[72:73]
    v_pk_fma_f32 v[74:75], v[106:107], v[218:219], v[74:75]
    v_pk_fma_f32 v[76:77], v[108:109], v[220:221], v[76:77]
    v_pk_fma_f32 v[78:79], v[110:111], v[222:223], v[78:79]
    v_cvt_pk_bf16_f32 v180, v72, v73
    v_cvt_pk_bf16_f32 v181, v74, v75
    v_cvt_pk_bf16_f32 v182, v76, v77
    v_cvt_pk_bf16_f32 v183, v78, v79
    buffer_store_dwordx4 v[180:183], v28, s[12:15], s8 offen offset:2048
    s_waitcnt lgkmcnt(1)
    v_lshlrev_b32 v208, 16, v40
    v_and_b32 v209, s59, v40
    v_lshlrev_b32 v210, 16, v41
    v_and_b32 v211, s59, v41
    v_lshlrev_b32 v212, 16, v42
    v_and_b32 v213, s59, v42
    v_lshlrev_b32 v214, 16, v43
    v_and_b32 v215, s59, v43
    v_pk_fma_f32 v[80:81], v[112:113], v[208:209], v[80:81]
    v_pk_fma_f32 v[82:83], v[114:115], v[210:211], v[82:83]
    v_pk_fma_f32 v[84:85], v[116:117], v[212:213], v[84:85]
    v_pk_fma_f32 v[86:87], v[118:119], v[214:215], v[86:87]
    v_cvt_pk_bf16_f32 v184, v80, v81
    v_cvt_pk_bf16_f32 v185, v82, v83
    v_cvt_pk_bf16_f32 v186, v84, v85
    v_cvt_pk_bf16_f32 v187, v86, v87
    buffer_store_dwordx4 v[184:187], v28, s[12:15], s9 offen offset:0
    s_waitcnt lgkmcnt(0)
    v_lshlrev_b32 v216, 16, v44
    v_and_b32 v217, s59, v44
    v_lshlrev_b32 v218, 16, v45
    v_and_b32 v219, s59, v45
    v_lshlrev_b32 v220, 16, v46
    v_and_b32 v221, s59, v46
    v_lshlrev_b32 v222, 16, v47
    v_and_b32 v223, s59, v47
    v_pk_fma_f32 v[88:89], v[120:121], v[216:217], v[88:89]
    v_pk_fma_f32 v[90:91], v[122:123], v[218:219], v[90:91]
    v_pk_fma_f32 v[92:93], v[124:125], v[220:221], v[92:93]
    v_pk_fma_f32 v[94:95], v[126:127], v[222:223], v[94:95]
    v_cvt_pk_bf16_f32 v188, v88, v89
    v_cvt_pk_bf16_f32 v189, v90, v91
    v_cvt_pk_bf16_f32 v190, v92, v93
    v_cvt_pk_bf16_f32 v191, v94, v95
    buffer_store_dwordx4 v[188:191], v28, s[12:15], s9 offen offset:2048
    s_endpgm
k_fft:
    s_waitcnt lgkmcnt(0)
    buffer_store_dwordx4 a[160:163], v18, s[32:35], s10 offen sc1
    s_add_u32 s10, s10, 0x100000
    buffer_store_dwordx4 a[164:167], v18, s[32:35], s10 offen sc1
    s_add_u32 s10, s10, 0x100000
    buffer_store_dwordx4 a[168:171], v18, s[32:35], s10 offen sc1
    s_add_u32 s10, s10, 0x100000
    buffer_store_dwordx4 a[172:175], v18, s[32:35], s10 offen sc1
    s_add_u32 s10, s10, 0x100000
    s_add_u32 s36, s22, 0x800000
    s_addc_u32 s37, s23, 0
    s_and_b32 s37, s37, 0xffff
    s_mov_b32 s38, 0x404000
    s_mov_b32 s39, 0x20000
    v_mov_b32 v240, 0
    v_lshlrev_b32 v242, 7, v1
    s_barrier
    s_mul_i32 s96, s2, 65664
    s_mul_i32 s97, s3, 10240
    s_add_u32 s99, s96, s97
    s_add_u32 m0, s97, 0x17400
    s_add_u32 s98, s99, 28672
    buffer_load_dwordx4 v3, s[56:59], s98 offen lds
    buffer_load_dwordx4 v3, s[56:59], s98 offen offset:1024 lds
    buffer_load_dwordx4 v3, s[56:59], s98 offen offset:2048 lds
    buffer_load_dwordx4 v3, s[56:59], s98 offen offset:3072 lds
    s_add_u32 m0, s97, 0x18400
    s_add_u32 s98, s99, 32768
    buffer_load_dwordx4 v3, s[56:59], s98 offen lds
    buffer_load_dwordx4 v3, s[56:59], s98 offen offset:1024 lds
    buffer_load_dwordx4 v3, s[56:59], s98 offen offset:2048 lds
    buffer_load_dwordx4 v3, s[56:59], s98 offen offset:3072 lds
    s_add_u32 m0, s97, 0x19400
    s_add_u32 s98, s99, 36864
    buffer_load_dwordx4 v3, s[56:59], s98 offen lds
    buffer_load_dwordx4 v3, s[56:59], s98 offen offset:1024 lds
    s_mov_b32 m0, 0x10000
    s_add_u32 s98, s96, 0x10000
    buffer_load_dwordx4 v3, s[52:55], s98 offen lds
    s_waitcnt vmcnt(11)
    s_barrier
    s_cmp_lg_u32 s3, 0
    s_cbranch_scc1 sf_f2f
    v_mov_b32 v241, s70
    s_mov_b64 exec, 1
    buffer_store_dword v241, v240, s[24:27], s63 offen sc1
    s_mov_b64 exec, -1
sf_f2f:
    v_and_b32 v232, 7, v0
    v_lshrrev_b32 v233, 3, v0
    v_lshlrev_b32 v235, 16, v233
    v_lshl_add_u32 v235, v232, 4, v235
    v_mul_u32_u24 v236, 1026, v232
    v_and_b32 v236, -4, v236
    v_lshl_add_u32 v236, v233, 4, v236
    v_add_u32 v237, 0x10400, v236
    v_and_b32 v239, 1, v0
    v_lshlrev_b32 v239, 4, v239
    s_lshl_b32 s43, s2, 8
    s_mov_b32 s48, 0x05040100
    s_mov_b32 s49, 0x07060302
    s_lshl_b32 s41, s2, 6
    v_add_u32 v200, s41, v1
    v_sub_u32 v201, 2048, v200
    v_and_b32 v201, 0x7ff, v201
    v_mul_u32_u24 v202, 1026, v200
    v_mul_u32_u24 v201, 1026, v201
    s_mov_b32 s42, 0x4800
    buffer_load_dwordx4 a[160:163], v3, s[28:31], s42 offen
    s_mov_b32 s42, 0x4c00
    buffer_load_dwordx4 a[164:167], v3, s[28:31], s42 offen
    s_mov_b32 s42, 0x5000
    buffer_load_dwordx4 a[168:171], v3, s[28:31], s42 offen
    s_mov_b32 s42, 0x5400
    buffer_load_dwordx4 a[172:175], v3, s[28:31], s42 offen
    s_mov_b32 s42, 0x5800
    buffer_load_dwordx4 a[176:179], v3, s[28:31], s42 offen
    s_mov_b32 s42, 0x5c00
    buffer_load_dwordx4 a[180:183], v3, s[28:31], s42 offen
    v_and_b32 v8, 15, v1
    v_lshrrev_b32 v9, 4, v1
    v_lshlrev_b32 v9, 2, v9
    v_add_u32 v10, 0, v9
    v_mul_u32_u24 v11, v10, v8
    v_lshl_add_u32 v10, v10, 4, v8
    v_cvt_f32_u32 v11, v11
    v_cvt_f32_u32 v12, v10
    v_mul_f32 v11, 0x3b800000, v11
    v_cos_f32 v40, v11
    v_sin_f32 v44, v11
    v_add_u32 v10, 1, v9
    v_mul_u32_u24 v11, v10, v8
    v_lshl_add_u32 v10, v10, 4, v8
    v_cvt_f32_u32 v11, v11
    v_cvt_f32_u32 v13, v10
    v_mul_f32 v11, 0x3b800000, v11
    v_cos_f32 v41, v11
    v_sin_f32 v45, v11
    v_add_u32 v10, 2, v9
    v_mul_u32_u24 v11, v10, v8
    v_lshl_add_u32 v10, v10, 4, v8
    v_cvt_f32_u32 v11, v11
    v_cvt_f32_u32 v14, v10
    v_mul_f32 v11, 0x3b800000, v11
    v_cos_f32 v42, v11
    v_sin_f32 v46, v11
    v_add_u32 v10, 3, v9
    v_mul_u32_u24 v11, v10, v8
    v_lshl_add_u32 v10, v10, 4, v8
    v_cvt_f32_u32 v11, v11
    v_cvt_f32_u32 v15, v10
    v_mul_f32 v11, 0x3b800000, v11
    v_cos_f32 v43, v11
    v_sin_f32 v47, v11
    v_mul_f32 v16, 0x3a000000, v12
    v_mul_f32 v17, 0x3a000000, v13
    v_mul_f32 v18, 0x3a000000, v14
    v_mul_f32 v19, 0x3a000000, v15
    v_cos_f32 v48, v16
    v_sin_f32 v52, v16
    v_cos_f32 v49, v17
    v_sin_f32 v53, v17
    v_cos_f32 v50, v18
    v_sin_f32 v54, v18
    v_cos_f32 v51, v19
    v_sin_f32 v55, v19
    v_mul_f32 v16, 0x3a800000, v12
    v_mul_f32 v17, 0x3a800000, v13
    v_mul_f32 v18, 0x3a800000, v14
    v_mul_f32 v19, 0x3a800000, v15
    v_cos_f32 v56, v16
    v_sin_f32 v60, v16
    v_cos_f32 v57, v17
    v_sin_f32 v61, v17
    v_cos_f32 v58, v18
    v_sin_f32 v62, v18
    v_cos_f32 v59, v19
    v_sin_f32 v63, v19
    v_mul_f32 v16, 0x3ac00000, v12
    v_mul_f32 v17, 0x3ac00000, v13
    v_mul_f32 v18, 0x3ac00000, v14
    v_mul_f32 v19, 0x3ac00000, v15
    v_cos_f32 v64, v16
    v_sin_f32 v68, v16
    v_cos_f32 v65, v17
    v_sin_f32 v69, v17
    v_cos_f32 v66, v18
    v_sin_f32 v70, v18
    v_cos_f32 v67, v19
    v_sin_f32 v71, v19
    v_mul_f32 v16, 0x3b000000, v12
    v_mul_f32 v17, 0x3b000000, v13
    v_mul_f32 v18, 0x3b000000, v14
    v_mul_f32 v19, 0x3b000000, v15
    v_cos_f32 v72, v16
    v_sin_f32 v76, v16
    v_cos_f32 v73, v17
    v_sin_f32 v77, v17
    v_cos_f32 v74, v18
    v_sin_f32 v78, v18
    v_cos_f32 v75, v19
    v_sin_f32 v79, v19
    v_mul_f32 v16, 0x3b200000, v12
    v_mul_f32 v17, 0x3b200000, v13
    v_mul_f32 v18, 0x3b200000, v14
    v_mul_f32 v19, 0x3b200000, v15
    v_cos_f32 v80, v16
    v_sin_f32 v84, v16
    v_cos_f32 v81, v17
    v_sin_f32 v85, v17
    v_cos_f32 v82, v18
    v_sin_f32 v86, v18
    v_cos_f32 v83, v19
    v_sin_f32 v87, v19
    v_mul_f32 v16, 0x3b400000, v12
    v_mul_f32 v17, 0x3b400000, v13
    v_mul_f32 v18, 0x3b400000, v14
    v_mul_f32 v19, 0x3b400000, v15
    v_cos_f32 v88, v16
    v_sin_f32 v92, v16
    v_cos_f32 v89, v17
    v_sin_f32 v93, v17
    v_cos_f32 v90, v18
    v_sin_f32 v94, v18
    v_cos_f32 v91, v19
    v_sin_f32 v95, v19
    v_mul_f32 v16, 0x3b600000, v12
    v_mul_f32 v17, 0x3b600000, v13
    v_mul_f32 v18, 0x3b600000, v14
    v_mul_f32 v19, 0x3b600000, v15
    v_cos_f32 v96, v16
    v_sin_f32 v100, v16
    v_cos_f32 v97, v17
    v_sin_f32 v101, v17
    v_cos_f32 v98, v18
    v_sin_f32 v102, v18
    v_cos_f32 v99, v19
    v_sin_f32 v103, v19
    s_waitcnt vmcnt(6)
    s_barrier
    s_cmp_lg_u32 s3, 0
    s_cbranch_scc1 r_noabl
    buffer_load_ushort v208, v202, s[52:55], 0 offen offset:0
    buffer_load_ushort v209, v202, s[56:59], 0 offen offset:0
    buffer_load_ushort v210, v201, s[52:55], 0 offen offset:0
    buffer_load_ushort v211, v201, s[56:59], 0 offen offset:0
    buffer_load_ushort v212, v202, s[52:55], 0 offen offset:1024
    buffer_load_ushort v213, v202, s[56:59], 0 offen offset:1024
    buffer_load_ushort v214, v201, s[52:55], 0 offen offset:1024
    buffer_load_ushort v215, v201, s[56:59], 0 offen offset:1024
r_noabl:
    s_lshl_b32 s44, s3, 13
    s_add_u32 s44, s44, 32768
    ds_read_b32 v104, v236 offset:0
    ds_read_b32 v105, v236 offset:4
    ds_read_b32 v106, v236 offset:8
    ds_read_b32 v107, v236 offset:12
    ds_read_b32 v108, v236 offset:16
    ds_read_b32 v110, v237 offset:0
    ds_read_b32 v111, v237 offset:4
    ds_read_b32 v112, v237 offset:8
    ds_read_b32 v113, v237 offset:12
    ds_read_b32 v114, v237 offset:16
    ds_read_b32 v116, v236 offset:16416
    ds_read_b32 v117, v236 offset:16420
    ds_read_b32 v118, v236 offset:16424
    ds_read_b32 v119, v236 offset:16428
    ds_read_b32 v120, v236 offset:16432
    ds_read_b32 v122, v237 offset:16416
    ds_read_b32 v123, v237 offset:16420
    ds_read_b32 v124, v237 offset:16424
    ds_read_b32 v125, v237 offset:16428
    ds_read_b32 v126, v237 offset:16432
    ds_read_b32 v128, v236 offset:32832
    ds_read_b32 v129, v236 offset:32836
    ds_read_b32 v130, v236 offset:32840
    ds_read_b32 v131, v236 offset:32844
    ds_read_b32 v132, v236 offset:32848
    ds_read_b32 v134, v237 offset:32832
    ds_read_b32 v135, v237 offset:32836
    ds_read_b32 v136, v237 offset:32840
    ds_read_b32 v137, v237 offset:32844
    ds_read_b32 v138, v237 offset:32848
    ds_read_b32 v140, v236 offset:49248
    ds_read_b32 v141, v236 offset:49252
    ds_read_b32 v142, v236 offset:49256
    ds_read_b32 v143, v236 offset:49260
    ds_read_b32 v144, v236 offset:49264
    ds_read_b32 v146, v237 offset:49248
    ds_read_b32 v147, v237 offset:49252
    ds_read_b32 v148, v237 offset:49256
    ds_read_b32 v149, v237 offset:49260
    ds_read_b32 v150, v237 offset:49264
    s_waitcnt lgkmcnt(0)
    ds_read_b32 v152, v236 offset:512
    ds_read_b32 v153, v236 offset:516
    ds_read_b32 v154, v236 offset:520
    ds_read_b32 v155, v236 offset:524
    ds_read_b32 v156, v236 offset:528
    ds_read_b32 v158, v237 offset:512
    ds_read_b32 v159, v237 offset:516
    ds_read_b32 v160, v237 offset:520
    ds_read_b32 v161, v237 offset:524
    ds_read_b32 v162, v237 offset:528
    ds_read_b32 v164, v236 offset:16928
    ds_read_b32 v165, v236 offset:16932
    ds_read_b32 v166, v236 offset:16936
    ds_read_b32 v167, v236 offset:16940
    ds_read_b32 v168, v236 offset:16944
    ds_read_b32 v170, v237 offset:16928
    ds_read_b32 v171, v237 offset:16932
    ds_read_b32 v172, v237 offset:16936
    ds_read_b32 v173, v237 offset:16940
    ds_read_b32 v174, v237 offset:16944
    ds_read_b32 v176, v236 offset:33344
    ds_read_b32 v177, v236 offset:33348
    ds_read_b32 v178, v236 offset:33352
    ds_read_b32 v179, v236 offset:33356
    ds_read_b32 v180, v236 offset:33360
    ds_read_b32 v182, v237 offset:33344
    ds_read_b32 v183, v237 offset:33348
    ds_read_b32 v184, v237 offset:33352
    ds_read_b32 v185, v237 offset:33356
    ds_read_b32 v186, v237 offset:33360
    ds_read_b32 v188, v236 offset:49760
    ds_read_b32 v189, v236 offset:49764
    ds_read_b32 v190, v236 offset:49768
    ds_read_b32 v191, v236 offset:49772
    ds_read_b32 v192, v236 offset:49776
    ds_read_b32 v194, v237 offset:49760
    ds_read_b32 v195, v237 offset:49764
    ds_read_b32 v196, v237 offset:49768
    ds_read_b32 v197, v237 offset:49772
    ds_read_b32 v198, v237 offset:49776
    v_alignbit_b32 v104, v105, v104, v239
    v_alignbit_b32 v105, v106, v105, v239
    v_alignbit_b32 v106, v107, v106, v239
    v_alignbit_b32 v107, v108, v107, v239
    v_alignbit_b32 v110, v111, v110, v239
    v_alignbit_b32 v111, v112, v111, v239
    v_alignbit_b32 v112, v113, v112, v239
    v_alignbit_b32 v113, v114, v113, v239
    v_alignbit_b32 v116, v117, v116, v239
    v_alignbit_b32 v117, v118, v117, v239
    v_alignbit_b32 v118, v119, v118, v239
    v_alignbit_b32 v119, v120, v119, v239
    v_alignbit_b32 v122, v123, v122, v239
    v_alignbit_b32 v123, v124, v123, v239
    v_alignbit_b32 v124, v125, v124, v239
    v_alignbit_b32 v125, v126, v125, v239
    v_alignbit_b32 v128, v129, v128, v239
    v_alignbit_b32 v129, v130, v129, v239
    v_alignbit_b32 v130, v131, v130, v239
    v_alignbit_b32 v131, v132, v131, v239
    v_alignbit_b32 v134, v135, v134, v239
    v_alignbit_b32 v135, v136, v135, v239
    v_alignbit_b32 v136, v137, v136, v239
    v_alignbit_b32 v137, v138, v137, v239
    v_alignbit_b32 v140, v141, v140, v239
    v_alignbit_b32 v141, v142, v141, v239
    v_alignbit_b32 v142, v143, v142, v239
    v_alignbit_b32 v143, v144, v143, v239
    v_alignbit_b32 v146, v147, v146, v239
    v_alignbit_b32 v147, v148, v147, v239
    v_alignbit_b32 v148, v149, v148, v239
    v_alignbit_b32 v149, v150, v149, v239
    v_perm_b32 v8, v110, v104, s48
    v_perm_b32 v9, v122, v116, s48
    v_perm_b32 v10, v134, v128, s48
    v_perm_b32 v11, v146, v140, s48
    s_add_u32 s41, s43, 0x0
    buffer_store_dwordx4 v[8:11], v235, s[36:39], s41 offen sc1
    v_perm_b32 v12, v110, v104, s49
    v_perm_b32 v13, v122, v116, s49
    v_perm_b32 v14, v134, v128, s49
    v_perm_b32 v15, v146, v140, s49
    s_add_u32 s41, s43, 0x2000
    buffer_store_dwordx4 v[12:15], v235, s[36:39], s41 offen sc1
    v_perm_b32 v16, v111, v105, s48
    v_perm_b32 v17, v123, v117, s48
    v_perm_b32 v18, v135, v129, s48
    v_perm_b32 v19, v147, v141, s48
    s_add_u32 s41, s43, 0x4000
    buffer_store_dwordx4 v[16:19], v235, s[36:39], s41 offen sc1
    v_perm_b32 v20, v111, v105, s49
    v_perm_b32 v21, v123, v117, s49
    v_perm_b32 v22, v135, v129, s49
    v_perm_b32 v23, v147, v141, s49
    s_add_u32 s41, s43, 0x6000
    buffer_store_dwordx4 v[20:23], v235, s[36:39], s41 offen sc1
    v_perm_b32 v24, v112, v106, s48
    v_perm_b32 v25, v124, v118, s48
    v_perm_b32 v26, v136, v130, s48
    v_perm_b32 v27, v148, v142, s48
    s_add_u32 s41, s43, 0x8000
    buffer_store_dwordx4 v[24:27], v235, s[36:39], s41 offen sc1
    v_perm_b32 v28, v112, v106, s49
    v_perm_b32 v29, v124, v118, s49
    v_perm_b32 v30, v136, v130, s49
    v_perm_b32 v31, v148, v142, s49
    s_add_u32 s41, s43, 0xa000
    buffer_store_dwordx4 v[28:31], v235, s[36:39], s41 offen sc1
    v_perm_b32 v32, v113, v107, s48
    v_perm_b32 v33, v125, v119, s48
    v_perm_b32 v34, v137, v131, s48
    v_perm_b32 v35, v149, v143, s48
    s_add_u32 s41, s43, 0xc000
    buffer_store_dwordx4 v[32:35], v235, s[36:39], s41 offen sc1
    v_perm_b32 v36, v113, v107, s49
    v_perm_b32 v37, v125, v119, s49
    v_perm_b32 v38, v137, v131, s49
    v_perm_b32 v39, v149, v143, s49
    s_add_u32 s41, s43, 0xe000
    buffer_store_dwordx4 v[36:39], v235, s[36:39], s41 offen sc1
    s_waitcnt lgkmcnt(0)
    ds_read_b32 v104, v236 offset:8208
    ds_read_b32 v105, v236 offset:8212
    ds_read_b32 v106, v236 offset:8216
    ds_read_b32 v107, v236 offset:8220
    ds_read_b32 v108, v236 offset:8224
    ds_read_b32 v110, v237 offset:8208
    ds_read_b32 v111, v237 offset:8212
    ds_read_b32 v112, v237 offset:8216
    ds_read_b32 v113, v237 offset:8220
    ds_read_b32 v114, v237 offset:8224
    ds_read_b32 v116, v236 offset:24624
    ds_read_b32 v117, v236 offset:24628
    ds_read_b32 v118, v236 offset:24632
    ds_read_b32 v119, v236 offset:24636
    ds_read_b32 v120, v236 offset:24640
    ds_read_b32 v122, v237 offset:24624
    ds_read_b32 v123, v237 offset:24628
    ds_read_b32 v124, v237 offset:24632
    ds_read_b32 v125, v237 offset:24636
    ds_read_b32 v126, v237 offset:24640
    ds_read_b32 v128, v236 offset:41040
    ds_read_b32 v129, v236 offset:41044
    ds_read_b32 v130, v236 offset:41048
    ds_read_b32 v131, v236 offset:41052
    ds_read_b32 v132, v236 offset:41056
    ds_read_b32 v134, v237 offset:41040
    ds_read_b32 v135, v237 offset:41044
    ds_read_b32 v136, v237 offset:41048
    ds_read_b32 v137, v237 offset:41052
    ds_read_b32 v138, v237 offset:41056
    ds_read_b32 v140, v236 offset:57456
    ds_read_b32 v141, v236 offset:57460
    ds_read_b32 v142, v236 offset:57464
    ds_read_b32 v143, v236 offset:57468
    ds_read_b32 v144, v236 offset:57472
    ds_read_b32 v146, v237 offset:57456
    ds_read_b32 v147, v237 offset:57460
    ds_read_b32 v148, v237 offset:57464
    ds_read_b32 v149, v237 offset:57468
    ds_read_b32 v150, v237 offset:57472
    v_alignbit_b32 v152, v153, v152, v239
    v_alignbit_b32 v153, v154, v153, v239
    v_alignbit_b32 v154, v155, v154, v239
    v_alignbit_b32 v155, v156, v155, v239
    v_alignbit_b32 v158, v159, v158, v239
    v_alignbit_b32 v159, v160, v159, v239
    v_alignbit_b32 v160, v161, v160, v239
    v_alignbit_b32 v161, v162, v161, v239
    v_alignbit_b32 v164, v165, v164, v239
    v_alignbit_b32 v165, v166, v165, v239
    v_alignbit_b32 v166, v167, v166, v239
    v_alignbit_b32 v167, v168, v167, v239
    v_alignbit_b32 v170, v171, v170, v239
    v_alignbit_b32 v171, v172, v171, v239
    v_alignbit_b32 v172, v173, v172, v239
    v_alignbit_b32 v173, v174, v173, v239
    v_alignbit_b32 v176, v177, v176, v239
    v_alignbit_b32 v177, v178, v177, v239
    v_alignbit_b32 v178, v179, v178, v239
    v_alignbit_b32 v179, v180, v179, v239
    v_alignbit_b32 v182, v183, v182, v239
    v_alignbit_b32 v183, v184, v183, v239
    v_alignbit_b32 v184, v185, v184, v239
    v_alignbit_b32 v185, v186, v185, v239
    v_alignbit_b32 v188, v189, v188, v239
    v_alignbit_b32 v189, v190, v189, v239
    v_alignbit_b32 v190, v191, v190, v239
    v_alignbit_b32 v191, v192, v191, v239
    v_alignbit_b32 v194, v195, v194, v239
    v_alignbit_b32 v195, v196, v195, v239
    v_alignbit_b32 v196, v197, v196, v239
    v_alignbit_b32 v197, v198, v197, v239
    v_perm_b32 v8, v158, v152, s48
    v_perm_b32 v9, v170, v164, s48
    v_perm_b32 v10, v182, v176, s48
    v_perm_b32 v11, v194, v188, s48
    s_add_u32 s41, s43, 0x200000
    buffer_store_dwordx4 v[8:11], v235, s[36:39], s41 offen sc1
    v_perm_b32 v12, v158, v152, s49
    v_perm_b32 v13, v170, v164, s49
    v_perm_b32 v14, v182, v176, s49
    v_perm_b32 v15, v194, v188, s49
    s_add_u32 s41, s43, 0x202000
    buffer_store_dwordx4 v[12:15], v235, s[36:39], s41 offen sc1
    v_perm_b32 v16, v159, v153, s48
    v_perm_b32 v17, v171, v165, s48
    v_perm_b32 v18, v183, v177, s48
    v_perm_b32 v19, v195, v189, s48
    s_add_u32 s41, s43, 0x204000
    buffer_store_dwordx4 v[16:19], v235, s[36:39], s41 offen sc1
    v_perm_b32 v20, v159, v153, s49
    v_perm_b32 v21, v171, v165, s49
    v_perm_b32 v22, v183, v177, s49
    v_perm_b32 v23, v195, v189, s49
    s_add_u32 s41, s43, 0x206000
    buffer_store_dwordx4 v[20:23], v235, s[36:39], s41 offen sc1
    v_perm_b32 v24, v160, v154, s48
    v_perm_b32 v25, v172, v166, s48
    v_perm_b32 v26, v184, v178, s48
    v_perm_b32 v27, v196, v190, s48
    s_add_u32 s41, s43, 0x208000
    buffer_store_dwordx4 v[24:27], v235, s[36:39], s41 offen sc1
    v_perm_b32 v28, v160, v154, s49
    v_perm_b32 v29, v172, v166, s49
    v_perm_b32 v30, v184, v178, s49
    v_perm_b32 v31, v196, v190, s49
    s_add_u32 s41, s43, 0x20a000
    buffer_store_dwordx4 v[28:31], v235, s[36:39], s41 offen sc1
    v_perm_b32 v32, v161, v155, s48
    v_perm_b32 v33, v173, v167, s48
    v_perm_b32 v34, v185, v179, s48
    v_perm_b32 v35, v197, v191, s48
    s_add_u32 s41, s43, 0x20c000
    buffer_store_dwordx4 v[32:35], v235, s[36:39], s41 offen sc1
    v_perm_b32 v36, v161, v155, s49
    v_perm_b32 v37, v173, v167, s49
    v_perm_b32 v38, v185, v179, s49
    v_perm_b32 v39, v197, v191, s49
    s_add_u32 s41, s43, 0x20e000
    buffer_store_dwordx4 v[36:39], v235, s[36:39], s41 offen sc1
    s_waitcnt lgkmcnt(0)
    ds_read_b32 v152, v236 offset:8720
    ds_read_b32 v153, v236 offset:8724
    ds_read_b32 v154, v236 offset:8728
    ds_read_b32 v155, v236 offset:8732
    ds_read_b32 v156, v236 offset:8736
    ds_read_b32 v158, v237 offset:8720
    ds_read_b32 v159, v237 offset:8724
    ds_read_b32 v160, v237 offset:8728
    ds_read_b32 v161, v237 offset:8732
    ds_read_b32 v162, v237 offset:8736
    ds_read_b32 v164, v236 offset:25136
    ds_read_b32 v165, v236 offset:25140
    ds_read_b32 v166, v236 offset:25144
    ds_read_b32 v167, v236 offset:25148
    ds_read_b32 v168, v236 offset:25152
    ds_read_b32 v170, v237 offset:25136
    ds_read_b32 v171, v237 offset:25140
    ds_read_b32 v172, v237 offset:25144
    ds_read_b32 v173, v237 offset:25148
    ds_read_b32 v174, v237 offset:25152
    ds_read_b32 v176, v236 offset:41552
    ds_read_b32 v177, v236 offset:41556
    ds_read_b32 v178, v236 offset:41560
    ds_read_b32 v179, v236 offset:41564
    ds_read_b32 v180, v236 offset:41568
    ds_read_b32 v182, v237 offset:41552
    ds_read_b32 v183, v237 offset:41556
    ds_read_b32 v184, v237 offset:41560
    ds_read_b32 v185, v237 offset:41564
    ds_read_b32 v186, v237 offset:41568
    ds_read_b32 v188, v236 offset:57968
    ds_read_b32 v189, v236 offset:57972
    ds_read_b32 v190, v236 offset:57976
    ds_read_b32 v191, v236 offset:57980
    ds_read_b32 v192, v236 offset:57984
    ds_read_b32 v194, v237 offset:57968
    ds_read_b32 v195, v237 offset:57972
    ds_read_b32 v196, v237 offset:57976
    ds_read_b32 v197, v237 offset:57980
    ds_read_b32 v198, v237 offset:57984
    v_alignbit_b32 v104, v105, v104, v239
    v_alignbit_b32 v105, v106, v105, v239
    v_alignbit_b32 v106, v107, v106, v239
    v_alignbit_b32 v107, v108, v107, v239
    v_alignbit_b32 v110, v111, v110, v239
    v_alignbit_b32 v111, v112, v111, v239
    v_alignbit_b32 v112, v113, v112, v239
    v_alignbit_b32 v113, v114, v113, v239
    v_alignbit_b32 v116, v117, v116, v239
    v_alignbit_b32 v117, v118, v117, v239
    v_alignbit_b32 v118, v119, v118, v239
    v_alignbit_b32 v119, v120, v119, v239
    v_alignbit_b32 v122, v123, v122, v239
    v_alignbit_b32 v123, v124, v123, v239
    v_alignbit_b32 v124, v125, v124, v239
    v_alignbit_b32 v125, v126, v125, v239
    v_alignbit_b32 v128, v129, v128, v239
    v_alignbit_b32 v129, v130, v129, v239
    v_alignbit_b32 v130, v131, v130, v239
    v_alignbit_b32 v131, v132, v131, v239
    v_alignbit_b32 v134, v135, v134, v239
    v_alignbit_b32 v135, v136, v135, v239
    v_alignbit_b32 v136, v137, v136, v239
    v_alignbit_b32 v137, v138, v137, v239
    v_alignbit_b32 v140, v141, v140, v239
    v_alignbit_b32 v141, v142, v141, v239
    v_alignbit_b32 v142, v143, v142, v239
    v_alignbit_b32 v143, v144, v143, v239
    v_alignbit_b32 v146, v147, v146, v239
    v_alignbit_b32 v147, v148, v147, v239
    v_alignbit_b32 v148, v149, v148, v239
    v_alignbit_b32 v149, v150, v149, v239
    v_perm_b32 v8, v110, v104, s48
    v_perm_b32 v9, v122, v116, s48
    v_perm_b32 v10, v134, v128, s48
    v_perm_b32 v11, v146, v140, s48
    s_add_u32 s41, s43, 0x80
    buffer_store_dwordx4 v[8:11], v235, s[36:39], s41 offen sc1
    v_perm_b32 v12, v110, v104, s49
    v_perm_b32 v13, v122, v116, s49
    v_perm_b32 v14, v134, v128, s49
    v_perm_b32 v15, v146, v140, s49
    s_add_u32 s41, s43, 0x2080
    buffer_store_dwordx4 v[12:15], v235, s[36:39], s41 offen sc1
    v_perm_b32 v16, v111, v105, s48
    v_perm_b32 v17, v123, v117, s48
    v_perm_b32 v18, v135, v129, s48
    v_perm_b32 v19, v147, v141, s48
    s_add_u32 s41, s43, 0x4080
    buffer_store_dwordx4 v[16:19], v235, s[36:39], s41 offen sc1
    v_perm_b32 v20, v111, v105, s49
    v_perm_b32 v21, v123, v117, s49
    v_perm_b32 v22, v135, v129, s49
    v_perm_b32 v23, v147, v141, s49
    s_add_u32 s41, s43, 0x6080
    buffer_store_dwordx4 v[20:23], v235, s[36:39], s41 offen sc1
    v_perm_b32 v24, v112, v106, s48
    v_perm_b32 v25, v124, v118, s48
    v_perm_b32 v26, v136, v130, s48
    v_perm_b32 v27, v148, v142, s48
    s_add_u32 s41, s43, 0x8080
    buffer_store_dwordx4 v[24:27], v235, s[36:39], s41 offen sc1
    v_perm_b32 v28, v112, v106, s49
    v_perm_b32 v29, v124, v118, s49
    v_perm_b32 v30, v136, v130, s49
    v_perm_b32 v31, v148, v142, s49
    s_add_u32 s41, s43, 0xa080
    buffer_store_dwordx4 v[28:31], v235, s[36:39], s41 offen sc1
    v_perm_b32 v32, v113, v107, s48
    v_perm_b32 v33, v125, v119, s48
    v_perm_b32 v34, v137, v131, s48
    v_perm_b32 v35, v149, v143, s48
    s_add_u32 s41, s43, 0xc080
    buffer_store_dwordx4 v[32:35], v235, s[36:39], s41 offen sc1
    v_perm_b32 v36, v113, v107, s49
    v_perm_b32 v37, v125, v119, s49
    v_perm_b32 v38, v137, v131, s49
    v_perm_b32 v39, v149, v143, s49
    s_add_u32 s41, s43, 0xe080
    buffer_store_dwordx4 v[36:39], v235, s[36:39], s41 offen sc1
    s_waitcnt lgkmcnt(0)
    v_alignbit_b32 v152, v153, v152, v239
    v_alignbit_b32 v153, v154, v153, v239
    v_alignbit_b32 v154, v155, v154, v239
    v_alignbit_b32 v155, v156, v155, v239
    v_alignbit_b32 v158, v159, v158, v239
    v_alignbit_b32 v159, v160, v159, v239
    v_alignbit_b32 v160, v161, v160, v239
    v_alignbit_b32 v161, v162, v161, v239
    v_alignbit_b32 v164, v165, v164, v239
    v_alignbit_b32 v165, v166, v165, v239
    v_alignbit_b32 v166, v167, v166, v239
    v_alignbit_b32 v167, v168, v167, v239
    v_alignbit_b32 v170, v171, v170, v239
    v_alignbit_b32 v171, v172, v171, v239
    v_alignbit_b32 v172, v173, v172, v239
    v_alignbit_b32 v173, v174, v173, v239
    v_alignbit_b32 v176, v177, v176, v239
    v_alignbit_b32 v177, v178, v177, v239
    v_alignbit_b32 v178, v179, v178, v239
    v_alignbit_b32 v179, v180, v179, v239
    v_alignbit_b32 v182, v183, v182, v239
    v_alignbit_b32 v183, v184, v183, v239
    v_alignbit_b32 v184, v185, v184, v239
    v_alignbit_b32 v185, v186, v185, v239
    v_alignbit_b32 v188, v189, v188, v239
    v_alignbit_b32 v189, v190, v189, v239
    v_alignbit_b32 v190, v191, v190, v239
    v_alignbit_b32 v191, v192, v191, v239
    v_alignbit_b32 v194, v195, v194, v239
    v_alignbit_b32 v195, v196, v195, v239
    v_alignbit_b32 v196, v197, v196, v239
    v_alignbit_b32 v197, v198, v197, v239
    v_perm_b32 v8, v158, v152, s48
    v_perm_b32 v9, v170, v164, s48
    v_perm_b32 v10, v182, v176, s48
    v_perm_b32 v11, v194, v188, s48
    s_add_u32 s41, s43, 0x200080
    buffer_store_dwordx4 v[8:11], v235, s[36:39], s41 offen sc1
    v_perm_b32 v12, v158, v152, s49
    v_perm_b32 v13, v170, v164, s49
    v_perm_b32 v14, v182, v176, s49
    v_perm_b32 v15, v194, v188, s49
    s_add_u32 s41, s43, 0x202080
    buffer_store_dwordx4 v[12:15], v235, s[36:39], s41 offen sc1
    v_perm_b32 v16, v159, v153, s48
    v_perm_b32 v17, v171, v165, s48
    v_perm_b32 v18, v183, v177, s48
    v_perm_b32 v19, v195, v189, s48
    s_add_u32 s41, s43, 0x204080
    buffer_store_dwordx4 v[16:19], v235, s[36:39], s41 offen sc1
    v_perm_b32 v20, v159, v153, s49
    v_perm_b32 v21, v171, v165, s49
    v_perm_b32 v22, v183, v177, s49
    v_perm_b32 v23, v195, v189, s49
    s_add_u32 s41, s43, 0x206080
    buffer_store_dwordx4 v[20:23], v235, s[36:39], s41 offen sc1
    v_perm_b32 v24, v160, v154, s48
    v_perm_b32 v25, v172, v166, s48
    v_perm_b32 v26, v184, v178, s48
    v_perm_b32 v27, v196, v190, s48
    s_add_u32 s41, s43, 0x208080
    buffer_store_dwordx4 v[24:27], v235, s[36:39], s41 offen sc1
    v_perm_b32 v28, v160, v154, s49
    v_perm_b32 v29, v172, v166, s49
    v_perm_b32 v30, v184, v178, s49
    v_perm_b32 v31, v196, v190, s49
    s_add_u32 s41, s43, 0x20a080
    buffer_store_dwordx4 v[28:31], v235, s[36:39], s41 offen sc1
    v_perm_b32 v32, v161, v155, s48
    v_perm_b32 v33, v173, v167, s48
    v_perm_b32 v34, v185, v179, s48
    v_perm_b32 v35, v197, v191, s48
    s_add_u32 s41, s43, 0x20c080
    buffer_store_dwordx4 v[32:35], v235, s[36:39], s41 offen sc1
    v_perm_b32 v36, v161, v155, s49
    v_perm_b32 v37, v173, v167, s49
    v_perm_b32 v38, v185, v179, s49
    v_perm_b32 v39, v197, v191, s49
    s_add_u32 s41, s43, 0x20e080
    buffer_store_dwordx4 v[36:39], v235, s[36:39], s41 offen sc1
    s_cmp_lg_u32 s3, 0
    s_cbranch_scc1 r_noab
    s_waitcnt vmcnt(32)
    v_lshlrev_b32 v208, 16, v208
    v_lshlrev_b32 v209, 16, v209
    v_lshlrev_b32 v210, 16, v210
    v_lshlrev_b32 v211, 16, v211
    v_lshlrev_b32 v212, 16, v212
    v_lshlrev_b32 v213, 16, v213
    v_lshlrev_b32 v214, 16, v214
    v_lshlrev_b32 v215, 16, v215
    v_add_f32 v216, v208, v210
    v_sub_f32 v217, v209, v211
    v_add_f32 v218, v212, v214
    v_sub_f32 v219, v213, v215
    v_add_f32 v220, v216, v218
    v_add_f32 v221, v217, v219
    v_sub_f32 v222, v216, v218
    v_sub_f32 v223, v217, v219
    v_mul_f32 v220, 0x3e800000, v220
    v_mul_f32 v221, 0x3e800000, v221
    v_mul_f32 v222, 0x3e800000, v222
    v_mul_f32 v223, 0x3e800000, v223
    v_cvt_pk_bf16_f32 v220, v220, v221
    v_cvt_pk_bf16_f32 v222, v222, v223
    v_and_b32 v216, 15, v200
    v_lshlrev_b32 v216, 4, v216
    v_bfe_u32 v217, v200, 4, 2
    v_lshl_add_u32 v216, v217, 2, v216
    v_lshrrev_b32 v217, 6, v200
    v_lshl_add_u32 v216, v217, 8, v216
    s_mov_b32 s40, 0x400000
    s_mov_b32 s41, 0x402000
    buffer_store_dword v220, v216, s[36:39], s40 offen sc1
    buffer_store_dword v222, v216, s[36:39], s41 offen sc1
r_noab:
    buffer_load_dword v244, v242, s[24:27], s44 offen sc1
    v_and_b32 v4, 15, v1
    v_lshrrev_b32 v5, 4, v1
    v_lshlrev_b32 v6, 6, v4
    v_lshl_add_u32 v6, v5, 4, v6
    v_add_u32 v7, 0, v5
    v_xor_b32 v7, v7, v4
    v_lshlrev_b32 v7, 4, v7
    v_lshl_add_u32 v232, v5, 8, v7
    v_add_u32 v7, 4, v5
    v_xor_b32 v7, v7, v4
    v_lshlrev_b32 v7, 4, v7
    v_lshl_add_u32 v233, v5, 8, v7
    v_add_u32 v7, 8, v5
    v_xor_b32 v7, v7, v4
    v_lshlrev_b32 v7, 4, v7
    v_lshl_add_u32 v234, v5, 8, v7
    v_add_u32 v7, 12, v5
    v_xor_b32 v7, v7, v4
    v_lshlrev_b32 v7, 4, v7
    v_lshl_add_u32 v235, v5, 8, v7
    v_lshrrev_b32 v7, 5, v1
    v_lshlrev_b32 v7, 3, v7
    v_bfe_u32 v236, v1, 4, 1
    v_or_b32 v7, v7, v236
    v_xor_b32 v7, v7, v4
    v_lshlrev_b32 v7, 4, v7
    v_lshl_add_u32 v236, v4, 8, v7
    v_lshl_add_u32 v236, v2, 15, v236
    v_add_u32 v4, 0x1000, v3
    s_lshl_b32 s51, s2, 2
    s_add_u32 s51, s51, s3
    s_and_b32 s41, s51, 15
    s_bfe_u32 s42, s51, 0x20004
    s_lshl_b32 s42, s42, 7
    s_add_u32 s40, s41, s42
    s_sub_u32 s43, 32, s41
    s_cmp_eq_u32 s41, 0
    s_cselect_b32 s43, 16, s43
    s_add_u32 s43, s43, 480
    s_sub_u32 s43, s43, s42
    s_cmp_ge_u32 s51, 64
    s_cselect_b32 s40, s43, s40
    s_cselect_b32 s50, -1, 1
    s_lshl_b32 s50, s50, 18
    s_lshl_b32 s40, s40, 13
    s_add_u32 s52, s22, 0x400000
    s_addc_u32 s53, s23, 0
    s_and_b32 s53, s53, 0xffff
    s_mov_b32 s54, 0x400000
    s_mov_b32 s55, 0x20000
    s_add_u32 s56, s22, 0xd00000
    s_addc_u32 s57, s23, 0
    s_and_b32 s57, s57, 0xffff
    s_mov_b32 s58, 0x400000
    s_mov_b32 s59, 0x20000
    s_waitcnt vmcnt(0)
    v_cmp_ne_u32 vcc, s70, v244
    s_nop 4
    s_cbranch_vccz pd_f2
    s_mov_b32 s68, 0x20000
pl_f2:
    buffer_load_dword v244, v242, s[24:27], s44 offen sc1
    s_waitcnt vmcnt(0)
    v_cmp_ne_u32 vcc, s70, v244
    s_nop 3
    s_cbranch_vccz pd_f2
    s_sleep 4
    s_sub_u32 s68, s68, 1
    s_cmp_lg_u32 s68, 0
    s_cbranch_scc1 pl_f2
pd_f2:
    s_barrier
    s_add_u32 s63, s63, 131072
    s_cmp_lg_u32 s3, 0
    s_cbranch_scc1 sf_f2fb
    v_mov_b32 v241, s70
    s_mov_b64 exec, 1
    buffer_store_dword v241, v240, s[24:27], s63 offen sc1
    s_mov_b64 exec, -1
sf_f2fb:
    s_lshl_b32 s41, s51, 15
    s_lshl_b32 s42, s3, 15
    s_add_u32 m0, s42, 0
    s_nop 0
    buffer_load_dwordx4 v232, s[52:55], s41 offen offset:0 sc1 lds
    buffer_load_dwordx4 v233, s[52:55], s41 offen offset:1024 sc1 lds
    buffer_load_dwordx4 v234, s[52:55], s41 offen offset:2048 sc1 lds
    buffer_load_dwordx4 v235, s[52:55], s41 offen offset:3072 sc1 lds
    s_add_u32 s41, s41, 4096
    s_add_u32 m0, s42, 4096
    s_nop 0
    buffer_load_dwordx4 v232, s[52:55], s41 offen offset:0 sc1 lds
    buffer_load_dwordx4 v233, s[52:55], s41 offen offset:1024 sc1 lds
    buffer_load_dwordx4 v234, s[52:55], s41 offen offset:2048 sc1 lds
    buffer_load_dwordx4 v235, s[52:55], s41 offen offset:3072 sc1 lds
    s_add_u32 s41, s41, 4096
    s_add_u32 m0, s42, 8192
    s_nop 0
    buffer_load_dwordx4 v232, s[52:55], s41 offen offset:0 sc1 lds
    buffer_load_dwordx4 v233, s[52:55], s41 offen offset:1024 sc1 lds
    buffer_load_dwordx4 v234, s[52:55], s41 offen offset:2048 sc1 lds
    buffer_load_dwordx4 v235, s[52:55], s41 offen offset:3072 sc1 lds
    s_add_u32 s41, s41, 4096
    s_add_u32 m0, s42, 12288
    s_nop 0
    buffer_load_dwordx4 v232, s[52:55], s41 offen offset:0 sc1 lds
    buffer_load_dwordx4 v233, s[52:55], s41 offen offset:1024 sc1 lds
    buffer_load_dwordx4 v234, s[52:55], s41 offen offset:2048 sc1 lds
    buffer_load_dwordx4 v235, s[52:55], s41 offen offset:3072 sc1 lds
    s_add_u32 s41, s41, 4096
    s_add_u32 m0, s42, 16384
    s_nop 0
    buffer_load_dwordx4 v232, s[52:55], s41 offen offset:0 sc1 lds
    buffer_load_dwordx4 v233, s[52:55], s41 offen offset:1024 sc1 lds
    buffer_load_dwordx4 v234, s[52:55], s41 offen offset:2048 sc1 lds
    buffer_load_dwordx4 v235, s[52:55], s41 offen offset:3072 sc1 lds
    s_add_u32 s41, s41, 4096
    s_add_u32 m0, s42, 20480
    s_nop 0
    buffer_load_dwordx4 v232, s[52:55], s41 offen offset:0 sc1 lds
    buffer_load_dwordx4 v233, s[52:55], s41 offen offset:1024 sc1 lds
    buffer_load_dwordx4 v234, s[52:55], s41 offen offset:2048 sc1 lds
    buffer_load_dwordx4 v235, s[52:55], s41 offen offset:3072 sc1 lds
    s_add_u32 s41, s41, 4096
    s_add_u32 m0, s42, 24576
    s_nop 0
    buffer_load_dwordx4 v232, s[52:55], s41 offen offset:0 sc1 lds
    buffer_load_dwordx4 v233, s[52:55], s41 offen offset:1024 sc1 lds
    buffer_load_dwordx4 v234, s[52:55], s41 offen offset:2048 sc1 lds
    buffer_load_dwordx4 v235, s[52:55], s41 offen offset:3072 sc1 lds
    s_add_u32 s41, s41, 4096
    s_add_u32 m0, s42, 28672
    s_nop 0
    buffer_load_dwordx4 v232, s[52:55], s41 offen offset:0 sc1 lds
    buffer_load_dwordx4 v233, s[52:55], s41 offen offset:1024 sc1 lds
    buffer_load_dwordx4 v234, s[52:55], s41 offen offset:2048 sc1 lds
    buffer_load_dwordx4 v235, s[52:55], s41 offen offset:3072 sc1 lds
    s_add_u32 s41, s41, 4096
    s_mov_b32 s48, 0
    s_mov_b32 s49, 0xffff0000
    v_mov_b32 v237, v236
    s_cmp_eq_u32 s51, 0
    s_cselect_b32 s62, 0x400000, s40
    s_mov_b32 s44, 163840
    s_mov_b32 s68, 0x20000
    s_bfm_b64 exec, 32, 0
    buffer_load_dword v244, v242, s[24:27], s44 offen sc1
    s_mov_b64 exec, -1
    s_waitcnt vmcnt(0)
    ds_read_b128 a[128:131], v237 offset:0
    ds_read_b128 a[132:135], v237 offset:4096
    ds_read_b128 a[136:139], v237 offset:8192
    ds_read_b128 a[140:143], v237 offset:12288
    ds_read_b128 a[144:147], v237 offset:16384
    ds_read_b128 a[148:151], v237 offset:20480
    ds_read_b128 a[152:155], v237 offset:24576
    ds_read_b128 a[156:159], v237 offset:28672
    v_cmp_ne_u32 vcc, s70, v244
    s_nop 1
    s_bfm_b64 s[66:67], 32, 0
    s_and_b64 vcc, vcc, s[66:67]
    s_nop 3
    s_cbranch_vccz pd_f2b
pl_f2b:
    s_bfm_b64 exec, 32, 0
    buffer_load_dword v244, v242, s[24:27], s44 offen sc1
    s_mov_b64 exec, -1
    s_waitcnt vmcnt(0)
    v_cmp_ne_u32 vcc, s70, v244
    s_nop 1
    s_bfm_b64 s[66:67], 32, 0
    s_and_b64 vcc, vcc, s[66:67]
    s_nop 3
    s_cbranch_vccz pd_f2b
    s_sleep 2
    s_sub_u32 s68, s68, 1
    s_cmp_lg_u32 s68, 0
    s_cbranch_scc1 pl_f2b
pd_f2b:
    buffer_load_dwordx4 v[8:11], v3, s[36:39], s62 offen offset:0 sc1
    buffer_load_dwordx4 v[12:15], v3, s[36:39], s62 offen offset:1024 sc1
    buffer_load_dwordx4 v[16:19], v3, s[36:39], s62 offen offset:2048 sc1
    buffer_load_dwordx4 v[20:23], v3, s[36:39], s62 offen offset:3072 sc1
    buffer_load_dwordx4 v[24:27], v4, s[36:39], s62 offen offset:0 sc1
    buffer_load_dwordx4 v[28:31], v4, s[36:39], s62 offen offset:1024 sc1
    buffer_load_dwordx4 v[32:35], v4, s[36:39], s62 offen offset:2048 sc1
    buffer_load_dwordx4 v[36:39], v4, s[36:39], s62 offen offset:3072 sc1
    s_cmp_lg_u32 s51, 0
    s_cbranch_scc1 cf_nb
    s_mov_b32 s43, 0x402000
    buffer_load_dwordx4 a[208:211], v3, s[36:39], s43 offen offset:0 sc1
    buffer_load_dwordx4 a[212:215], v3, s[36:39], s43 offen offset:1024 sc1
    buffer_load_dwordx4 a[216:219], v3, s[36:39], s43 offen offset:2048 sc1
    buffer_load_dwordx4 a[220:223], v3, s[36:39], s43 offen offset:3072 sc1
    buffer_load_dwordx4 a[224:227], v4, s[36:39], s43 offen offset:0 sc1
    buffer_load_dwordx4 a[228:231], v4, s[36:39], s43 offen offset:1024 sc1
    buffer_load_dwordx4 a[232:235], v4, s[36:39], s43 offen offset:2048 sc1
    buffer_load_dwordx4 a[236:239], v4, s[36:39], s43 offen offset:3072 sc1
cf_nb:
cf_loop:
    s_waitcnt lgkmcnt(0)
    v_mfma_f32_16x16x32_bf16 v[104:107], a[128:131], a[160:163], 0
    v_mfma_f32_16x16x32_bf16 v[108:111], a[128:131], a[164:167], 0
    v_mfma_f32_16x16x32_bf16 v[112:115], a[132:135], a[160:163], 0
    v_mfma_f32_16x16x32_bf16 v[116:119], a[132:135], a[164:167], 0
    v_mfma_f32_16x16x32_bf16 v[120:123], a[136:139], a[160:163], 0
    v_mfma_f32_16x16x32_bf16 v[124:127], a[136:139], a[164:167], 0
    v_mfma_f32_16x16x32_bf16 v[128:131], a[140:143], a[160:163], 0
    v_mfma_f32_16x16x32_bf16 v[132:135], a[140:143], a[164:167], 0
    v_mfma_f32_16x16x32_bf16 v[136:139], a[144:147], a[160:163], 0
    v_mfma_f32_16x16x32_bf16 v[140:143], a[144:147], a[164:167], 0
    v_mfma_f32_16x16x32_bf16 v[144:147], a[148:151], a[160:163], 0
    v_mfma_f32_16x16x32_bf16 v[148:151], a[148:151], a[164:167], 0
    v_mfma_f32_16x16x32_bf16 v[152:155], a[152:155], a[160:163], 0
    v_mfma_f32_16x16x32_bf16 v[156:159], a[152:155], a[164:167], 0
    v_mfma_f32_16x16x32_bf16 v[160:163], a[156:159], a[160:163], 0
    v_mfma_f32_16x16x32_bf16 v[164:167], a[156:159], a[164:167], 0
    s_add_u32 s40, s40, s50
    s_add_u32 s43, s48, 1
    s_and_b32 s43, s43, 3
    s_lshl_b32 s43, s43, 5
    v_xor_b32 v237, s43, v236
    ds_read_b128 a[128:131], v237 offset:0
    ds_read_b128 a[132:135], v237 offset:4096
    ds_read_b128 a[136:139], v237 offset:8192
    ds_read_b128 a[140:143], v237 offset:12288
    ds_read_b128 a[144:147], v237 offset:16384
    ds_read_b128 a[148:151], v237 offset:20480
    ds_read_b128 a[152:155], v237 offset:24576
    ds_read_b128 a[156:159], v237 offset:28672
    v_pk_mul_f32 v[246:247], v[104:105], v[40:41]
    v_pk_mul_f32 v[248:249], v[106:107], v[42:43]
    v_pk_mul_f32 v[104:105], v[104:105], v[44:45]
    v_pk_mul_f32 v[106:107], v[106:107], v[46:47]
    v_pk_fma_f32 v[104:105], v[108:109], v[40:41], v[104:105] neg_lo:[0,0,1] neg_hi:[0,0,1]
    v_pk_fma_f32 v[106:107], v[110:111], v[42:43], v[106:107] neg_lo:[0,0,1] neg_hi:[0,0,1]
    v_pk_fma_f32 v[108:109], v[108:109], v[44:45], v[246:247]
    v_pk_fma_f32 v[110:111], v[110:111], v[46:47], v[248:249]
    v_pk_mul_f32 v[250:251], v[112:113], v[40:41]
    v_pk_mul_f32 v[252:253], v[114:115], v[42:43]
    v_pk_mul_f32 v[112:113], v[112:113], v[44:45]
    v_pk_mul_f32 v[114:115], v[114:115], v[46:47]
    v_pk_fma_f32 v[112:113], v[116:117], v[40:41], v[112:113] neg_lo:[0,0,1] neg_hi:[0,0,1]
    v_pk_fma_f32 v[114:115], v[118:119], v[42:43], v[114:115] neg_lo:[0,0,1] neg_hi:[0,0,1]
    v_pk_fma_f32 v[116:117], v[116:117], v[44:45], v[250:251]
    v_pk_fma_f32 v[118:119], v[118:119], v[46:47], v[252:253]
    v_pk_mul_f32 v[246:247], v[120:121], v[40:41]
    v_pk_mul_f32 v[248:249], v[122:123], v[42:43]
    v_pk_mul_f32 v[120:121], v[120:121], v[44:45]
    v_pk_mul_f32 v[122:123], v[122:123], v[46:47]
    v_pk_fma_f32 v[120:121], v[124:125], v[40:41], v[120:121] neg_lo:[0,0,1] neg_hi:[0,0,1]
    v_pk_fma_f32 v[122:123], v[126:127], v[42:43], v[122:123] neg_lo:[0,0,1] neg_hi:[0,0,1]
    v_pk_fma_f32 v[124:125], v[124:125], v[44:45], v[246:247]
    v_pk_fma_f32 v[126:127], v[126:127], v[46:47], v[248:249]
    v_pk_mul_f32 v[250:251], v[128:129], v[40:41]
    v_pk_mul_f32 v[252:253], v[130:131], v[42:43]
    v_pk_mul_f32 v[128:129], v[128:129], v[44:45]
    v_pk_mul_f32 v[130:131], v[130:131], v[46:47]
    v_pk_fma_f32 v[128:129], v[132:133], v[40:41], v[128:129] neg_lo:[0,0,1] neg_hi:[0,0,1]
    v_pk_fma_f32 v[130:131], v[134:135], v[42:43], v[130:131] neg_lo:[0,0,1] neg_hi:[0,0,1]
    v_pk_fma_f32 v[132:133], v[132:133], v[44:45], v[250:251]
    v_pk_fma_f32 v[134:135], v[134:135], v[46:47], v[252:253]
    v_pk_mul_f32 v[246:247], v[136:137], v[40:41]
    v_pk_mul_f32 v[248:249], v[138:139], v[42:43]
    v_pk_mul_f32 v[136:137], v[136:137], v[44:45]
    v_pk_mul_f32 v[138:139], v[138:139], v[46:47]
    v_pk_fma_f32 v[136:137], v[140:141], v[40:41], v[136:137] neg_lo:[0,0,1] neg_hi:[0,0,1]
    v_pk_fma_f32 v[138:139], v[142:143], v[42:43], v[138:139] neg_lo:[0,0,1] neg_hi:[0,0,1]
    v_pk_fma_f32 v[140:141], v[140:141], v[44:45], v[246:247]
    v_pk_fma_f32 v[142:143], v[142:143], v[46:47], v[248:249]
    v_pk_mul_f32 v[250:251], v[144:145], v[40:41]
    v_pk_mul_f32 v[252:253], v[146:147], v[42:43]
    v_pk_mul_f32 v[144:145], v[144:145], v[44:45]
    v_pk_mul_f32 v[146:147], v[146:147], v[46:47]
    v_pk_fma_f32 v[144:145], v[148:149], v[40:41], v[144:145] neg_lo:[0,0,1] neg_hi:[0,0,1]
    v_pk_fma_f32 v[146:147], v[150:151], v[42:43], v[146:147] neg_lo:[0,0,1] neg_hi:[0,0,1]
    v_pk_fma_f32 v[148:149], v[148:149], v[44:45], v[250:251]
    v_pk_fma_f32 v[150:151], v[150:151], v[46:47], v[252:253]
    v_pk_mul_f32 v[246:247], v[152:153], v[40:41]
    v_pk_mul_f32 v[248:249], v[154:155], v[42:43]
    v_pk_mul_f32 v[152:153], v[152:153], v[44:45]
    v_pk_mul_f32 v[154:155], v[154:155], v[46:47]
    v_pk_fma_f32 v[152:153], v[156:157], v[40:41], v[152:153] neg_lo:[0,0,1] neg_hi:[0,0,1]
    v_pk_fma_f32 v[154:155], v[158:159], v[42:43], v[154:155] neg_lo:[0,0,1] neg_hi:[0,0,1]
    v_pk_fma_f32 v[156:157], v[156:157], v[44:45], v[246:247]
    v_pk_fma_f32 v[158:159], v[158:159], v[46:47], v[248:249]
    v_pk_mul_f32 v[250:251], v[160:161], v[40:41]
    v_pk_mul_f32 v[252:253], v[162:163], v[42:43]
    v_pk_mul_f32 v[160:161], v[160:161], v[44:45]
    v_pk_mul_f32 v[162:163], v[162:163], v[46:47]
    v_pk_fma_f32 v[160:161], v[164:165], v[40:41], v[160:161] neg_lo:[0,0,1] neg_hi:[0,0,1]
    v_pk_fma_f32 v[162:163], v[166:167], v[42:43], v[162:163] neg_lo:[0,0,1] neg_hi:[0,0,1]
    v_pk_fma_f32 v[164:165], v[164:165], v[44:45], v[250:251]
    v_pk_fma_f32 v[166:167], v[166:167], v[46:47], v[252:253]
    v_cvt_pk_bf16_f32 v168, v108, v104
    v_cvt_pk_bf16_f32 v169, v109, v105
    v_cvt_pk_bf16_f32 v170, v110, v106
    v_cvt_pk_bf16_f32 v171, v111, v107
    v_cvt_pk_bf16_f32 v172, v116, v112
    v_cvt_pk_bf16_f32 v173, v117, v113
    v_mfma_f32_16x16x32_bf16 v[104:107], a[160:163], v[168:171], 0
    v_cvt_pk_bf16_f32 v174, v118, v114
    v_cvt_pk_bf16_f32 v175, v119, v115
    v_mfma_f32_16x16x32_bf16 v[108:111], a[164:167], v[168:171], 0
    v_cvt_pk_bf16_f32 v176, v124, v120
    v_cvt_pk_bf16_f32 v177, v125, v121
    v_mfma_f32_16x16x32_bf16 v[112:115], a[160:163], v[172:175], 0
    v_cvt_pk_bf16_f32 v178, v126, v122
    v_cvt_pk_bf16_f32 v179, v127, v123
    v_mfma_f32_16x16x32_bf16 v[116:119], a[164:167], v[172:175], 0
    v_cvt_pk_bf16_f32 v180, v132, v128
    v_cvt_pk_bf16_f32 v181, v133, v129
    v_mfma_f32_16x16x32_bf16 v[120:123], a[160:163], v[176:179], 0
    v_cvt_pk_bf16_f32 v182, v134, v130
    v_cvt_pk_bf16_f32 v183, v135, v131
    v_mfma_f32_16x16x32_bf16 v[124:127], a[164:167], v[176:179], 0
    v_cvt_pk_bf16_f32 v184, v140, v136
    v_cvt_pk_bf16_f32 v185, v141, v137
    v_mfma_f32_16x16x32_bf16 v[128:131], a[160:163], v[180:183], 0
    v_cvt_pk_bf16_f32 v186, v142, v138
    v_cvt_pk_bf16_f32 v187, v143, v139
    v_mfma_f32_16x16x32_bf16 v[132:135], a[164:167], v[180:183], 0
    v_cvt_pk_bf16_f32 v188, v148, v144
    v_cvt_pk_bf16_f32 v189, v149, v145
    v_mfma_f32_16x16x32_bf16 v[136:139], a[160:163], v[184:187], 0
    v_cvt_pk_bf16_f32 v190, v150, v146
    v_cvt_pk_bf16_f32 v191, v151, v147
    v_mfma_f32_16x16x32_bf16 v[140:143], a[164:167], v[184:187], 0
    v_cvt_pk_bf16_f32 v192, v156, v152
    v_cvt_pk_bf16_f32 v193, v157, v153
    v_mfma_f32_16x16x32_bf16 v[144:147], a[160:163], v[188:191], 0
    v_cvt_pk_bf16_f32 v194, v158, v154
    v_cvt_pk_bf16_f32 v195, v159, v155
    v_mfma_f32_16x16x32_bf16 v[148:151], a[164:167], v[188:191], 0
    v_cvt_pk_bf16_f32 v196, v164, v160
    v_cvt_pk_bf16_f32 v197, v165, v161
    v_mfma_f32_16x16x32_bf16 v[152:155], a[160:163], v[192:195], 0
    v_cvt_pk_bf16_f32 v198, v166, v162
    v_cvt_pk_bf16_f32 v199, v167, v163
    v_mfma_f32_16x16x32_bf16 v[156:159], a[164:167], v[192:195], 0
    s_nop 0
    v_mfma_f32_16x16x32_bf16 v[160:163], a[160:163], v[196:199], 0
    v_mfma_f32_16x16x32_bf16 v[164:167], a[164:167], v[196:199], 0
    v_cvt_pk_bf16_f32 v168, v104, v108
    v_cvt_pk_bf16_f32 v176, v105, v109
    v_cvt_pk_bf16_f32 v184, v106, v110
    v_cvt_pk_bf16_f32 v192, v107, v111
    v_pk_mul_f32 v[200:201], v[112:113], v[48:49]
    v_pk_mul_f32 v[202:203], v[114:115], v[50:51]
    v_pk_mul_f32 v[204:205], v[116:117], v[48:49]
    v_pk_mul_f32 v[206:207], v[118:119], v[50:51]
    v_pk_fma_f32 v[200:201], v[116:117], v[52:53], v[200:201]
    v_pk_fma_f32 v[202:203], v[118:119], v[54:55], v[202:203]
    v_pk_fma_f32 v[204:205], v[112:113], v[52:53], v[204:205] neg_lo:[1,0,0] neg_hi:[1,0,0]
    v_pk_fma_f32 v[206:207], v[114:115], v[54:55], v[206:207] neg_lo:[1,0,0] neg_hi:[1,0,0]
    v_cvt_pk_bf16_f32 v169, v200, v204
    v_cvt_pk_bf16_f32 v177, v201, v205
    v_cvt_pk_bf16_f32 v185, v202, v206
    v_cvt_pk_bf16_f32 v193, v203, v207
    v_pk_mul_f32 v[208:209], v[120:121], v[56:57]
    v_pk_mul_f32 v[210:211], v[122:123], v[58:59]
    v_pk_mul_f32 v[212:213], v[124:125], v[56:57]
    v_pk_mul_f32 v[214:215], v[126:127], v[58:59]
    v_pk_fma_f32 v[208:209], v[124:125], v[60:61], v[208:209]
    v_pk_fma_f32 v[210:211], v[126:127], v[62:63], v[210:211]
    v_pk_fma_f32 v[212:213], v[120:121], v[60:61], v[212:213] neg_lo:[1,0,0] neg_hi:[1,0,0]
    v_pk_fma_f32 v[214:215], v[122:123], v[62:63], v[214:215] neg_lo:[1,0,0] neg_hi:[1,0,0]
    v_cvt_pk_bf16_f32 v170, v208, v212
    v_cvt_pk_bf16_f32 v178, v209, v213
    v_cvt_pk_bf16_f32 v186, v210, v214
    v_cvt_pk_bf16_f32 v194, v211, v215
    v_pk_mul_f32 v[216:217], v[128:129], v[64:65]
    v_pk_mul_f32 v[218:219], v[130:131], v[66:67]
    v_pk_mul_f32 v[220:221], v[132:133], v[64:65]
    v_pk_mul_f32 v[222:223], v[134:135], v[66:67]
    v_pk_fma_f32 v[216:217], v[132:133], v[68:69], v[216:217]
    v_pk_fma_f32 v[218:219], v[134:135], v[70:71], v[218:219]
    v_pk_fma_f32 v[220:221], v[128:129], v[68:69], v[220:221] neg_lo:[1,0,0] neg_hi:[1,0,0]
    v_pk_fma_f32 v[222:223], v[130:131], v[70:71], v[222:223] neg_lo:[1,0,0] neg_hi:[1,0,0]
    v_cvt_pk_bf16_f32 v171, v216, v220
    v_cvt_pk_bf16_f32 v179, v217, v221
    v_cvt_pk_bf16_f32 v187, v218, v222
    v_cvt_pk_bf16_f32 v195, v219, v223
    v_pk_mul_f32 v[224:225], v[136:137], v[72:73]
    v_pk_mul_f32 v[226:227], v[138:139], v[74:75]
    v_pk_mul_f32 v[228:229], v[140:141], v[72:73]
    v_pk_mul_f32 v[230:231], v[142:143], v[74:75]
    v_pk_fma_f32 v[224:225], v[140:141], v[76:77], v[224:225]
    v_pk_fma_f32 v[226:227], v[142:143], v[78:79], v[226:227]
    v_pk_fma_f32 v[228:229], v[136:137], v[76:77], v[228:229] neg_lo:[1,0,0] neg_hi:[1,0,0]
    v_pk_fma_f32 v[230:231], v[138:139], v[78:79], v[230:231] neg_lo:[1,0,0] neg_hi:[1,0,0]
    v_cvt_pk_bf16_f32 v172, v224, v228
    v_cvt_pk_bf16_f32 v180, v225, v229
    v_cvt_pk_bf16_f32 v188, v226, v230
    v_cvt_pk_bf16_f32 v196, v227, v231
    v_pk_mul_f32 v[200:201], v[144:145], v[80:81]
    v_pk_mul_f32 v[202:203], v[146:147], v[82:83]
    v_pk_mul_f32 v[204:205], v[148:149], v[80:81]
    v_pk_mul_f32 v[206:207], v[150:151], v[82:83]
    v_pk_fma_f32 v[200:201], v[148:149], v[84:85], v[200:201]
    v_pk_fma_f32 v[202:203], v[150:151], v[86:87], v[202:203]
    v_pk_fma_f32 v[204:205], v[144:145], v[84:85], v[204:205] neg_lo:[1,0,0] neg_hi:[1,0,0]
    v_pk_fma_f32 v[206:207], v[146:147], v[86:87], v[206:207] neg_lo:[1,0,0] neg_hi:[1,0,0]
    v_cvt_pk_bf16_f32 v173, v200, v204
    v_cvt_pk_bf16_f32 v181, v201, v205
    v_cvt_pk_bf16_f32 v189, v202, v206
    v_cvt_pk_bf16_f32 v197, v203, v207
    v_pk_mul_f32 v[208:209], v[152:153], v[88:89]
    v_pk_mul_f32 v[210:211], v[154:155], v[90:91]
    v_pk_mul_f32 v[212:213], v[156:157], v[88:89]
    v_pk_mul_f32 v[214:215], v[158:159], v[90:91]
    v_pk_fma_f32 v[208:209], v[156:157], v[92:93], v[208:209]
    v_pk_fma_f32 v[210:211], v[158:159], v[94:95], v[210:211]
    v_pk_fma_f32 v[212:213], v[152:153], v[92:93], v[212:213] neg_lo:[1,0,0] neg_hi:[1,0,0]
    v_pk_fma_f32 v[214:215], v[154:155], v[94:95], v[214:215] neg_lo:[1,0,0] neg_hi:[1,0,0]
    v_cvt_pk_bf16_f32 v174, v208, v212
    v_cvt_pk_bf16_f32 v182, v209, v213
    v_cvt_pk_bf16_f32 v190, v210, v214
    v_cvt_pk_bf16_f32 v198, v211, v215
    v_pk_mul_f32 v[216:217], v[160:161], v[96:97]
    v_pk_mul_f32 v[218:219], v[162:163], v[98:99]
    v_pk_mul_f32 v[220:221], v[164:165], v[96:97]
    v_pk_mul_f32 v[222:223], v[166:167], v[98:99]
    v_pk_fma_f32 v[216:217], v[164:165], v[100:101], v[216:217]
    v_pk_fma_f32 v[218:219], v[166:167], v[102:103], v[218:219]
    v_pk_fma_f32 v[220:221], v[160:161], v[100:101], v[220:221] neg_lo:[1,0,0] neg_hi:[1,0,0]
    v_pk_fma_f32 v[222:223], v[162:163], v[102:103], v[222:223] neg_lo:[1,0,0] neg_hi:[1,0,0]
    v_cvt_pk_bf16_f32 v175, v216, v220
    v_cvt_pk_bf16_f32 v183, v217, v221
    v_cvt_pk_bf16_f32 v191, v218, v222
    v_cvt_pk_bf16_f32 v199, v219, v223
    s_waitcnt vmcnt(0)
    v_mfma_f32_32x32x16_bf16 v[104:119], a[176:179], v[168:171], 0
    v_lshlrev_b32 v200, 16, v8
    v_and_b32 v8, s49, v8
    v_lshlrev_b32 v204, 16, v12
    v_and_b32 v12, s49, v12
    v_lshlrev_b32 v208, 16, v16
    v_and_b32 v16, s49, v16
    v_lshlrev_b32 v212, 16, v20
    v_and_b32 v20, s49, v20
    v_mfma_f32_32x32x16_bf16 v[104:119], a[180:183], v[172:175], v[104:119]
    v_lshlrev_b32 v216, 16, v24
    v_and_b32 v24, s49, v24
    v_lshlrev_b32 v220, 16, v28
    v_and_b32 v28, s49, v28
    v_lshlrev_b32 v224, 16, v32
    v_and_b32 v32, s49, v32
    v_lshlrev_b32 v228, 16, v36
    v_and_b32 v36, s49, v36
    v_mfma_f32_32x32x16_bf16 v[120:135], a[176:179], v[176:179], 0
    v_lshlrev_b32 v201, 16, v9
    v_and_b32 v9, s49, v9
    v_lshlrev_b32 v205, 16, v13
    v_and_b32 v13, s49, v13
    v_lshlrev_b32 v209, 16, v17
    v_and_b32 v17, s49, v17
    v_lshlrev_b32 v213, 16, v21
    v_and_b32 v21, s49, v21
    v_mfma_f32_32x32x16_bf16 v[120:135], a[180:183], v[180:183], v[120:135]
    v_lshlrev_b32 v217, 16, v25
    v_and_b32 v25, s49, v25
    v_lshlrev_b32 v221, 16, v29
    v_and_b32 v29, s49, v29
    v_lshlrev_b32 v225, 16, v33
    v_and_b32 v33, s49, v33
    v_lshlrev_b32 v229, 16, v37
    v_and_b32 v37, s49, v37
    v_mfma_f32_32x32x16_bf16 v[136:151], a[176:179], v[184:187], 0
    v_lshlrev_b32 v202, 16, v10
    v_and_b32 v10, s49, v10
    v_lshlrev_b32 v206, 16, v14
    v_and_b32 v14, s49, v14
    v_lshlrev_b32 v210, 16, v18
    v_and_b32 v18, s49, v18
    v_lshlrev_b32 v214, 16, v22
    v_and_b32 v22, s49, v22
    v_mfma_f32_32x32x16_bf16 v[136:151], a[180:183], v[188:191], v[136:151]
    v_lshlrev_b32 v218, 16, v26
    v_and_b32 v26, s49, v26
    v_lshlrev_b32 v222, 16, v30
    v_and_b32 v30, s49, v30
    v_lshlrev_b32 v226, 16, v34
    v_and_b32 v34, s49, v34
    v_lshlrev_b32 v230, 16, v38
    v_and_b32 v38, s49, v38
    v_mfma_f32_32x32x16_bf16 v[152:167], a[176:179], v[192:195], 0
    v_lshlrev_b32 v203, 16, v11
    v_and_b32 v11, s49, v11
    v_lshlrev_b32 v207, 16, v15
    v_and_b32 v15, s49, v15
    v_lshlrev_b32 v211, 16, v19
    v_and_b32 v19, s49, v19
    v_lshlrev_b32 v215, 16, v23
    v_and_b32 v23, s49, v23
    v_mfma_f32_32x32x16_bf16 v[152:167], a[180:183], v[196:199], v[152:167]
    v_lshlrev_b32 v219, 16, v27
    v_and_b32 v27, s49, v27
    v_lshlrev_b32 v223, 16, v31
    v_and_b32 v31, s49, v31
    v_lshlrev_b32 v227, 16, v35
    v_and_b32 v35, s49, v35
    v_lshlrev_b32 v231, 16, v39
    v_and_b32 v39, s49, v39
    s_or_b32 s43, s51, s48
    s_cmp_eq_u32 s43, 0
    s_cbranch_scc1 cf_pack
cf_mul:
    v_pk_mul_f32 v[246:247], v[104:105], v[200:201] op_sel:[0,0] op_sel_hi:[1,0]
    v_pk_mul_f32 v[248:249], v[106:107], v[204:205] op_sel:[0,0] op_sel_hi:[1,0]
    v_pk_mul_f32 v[250:251], v[108:109], v[208:209] op_sel:[0,0] op_sel_hi:[1,0]
    v_pk_mul_f32 v[252:253], v[110:111], v[212:213] op_sel:[0,0] op_sel_hi:[1,0]
    v_pk_fma_f32 v[104:105], v[104:105], v[8:9], v[246:247] op_sel:[1,0,0] op_sel_hi:[0,0,1] neg_lo:[1,0,0]
    v_pk_fma_f32 v[106:107], v[106:107], v[12:13], v[248:249] op_sel:[1,0,0] op_sel_hi:[0,0,1] neg_lo:[1,0,0]
    v_pk_fma_f32 v[108:109], v[108:109], v[16:17], v[250:251] op_sel:[1,0,0] op_sel_hi:[0,0,1] neg_lo:[1,0,0]
    v_pk_fma_f32 v[110:111], v[110:111], v[20:21], v[252:253] op_sel:[1,0,0] op_sel_hi:[0,0,1] neg_lo:[1,0,0]
    v_pk_mul_f32 v[246:247], v[112:113], v[216:217] op_sel:[0,0] op_sel_hi:[1,0]
    v_pk_mul_f32 v[248:249], v[114:115], v[220:221] op_sel:[0,0] op_sel_hi:[1,0]
    v_pk_mul_f32 v[250:251], v[116:117], v[224:225] op_sel:[0,0] op_sel_hi:[1,0]
    v_pk_mul_f32 v[252:253], v[118:119], v[228:229] op_sel:[0,0] op_sel_hi:[1,0]
    v_pk_fma_f32 v[112:113], v[112:113], v[24:25], v[246:247] op_sel:[1,0,0] op_sel_hi:[0,0,1] neg_lo:[1,0,0]
    v_pk_fma_f32 v[114:115], v[114:115], v[28:29], v[248:249] op_sel:[1,0,0] op_sel_hi:[0,0,1] neg_lo:[1,0,0]
    v_pk_fma_f32 v[116:117], v[116:117], v[32:33], v[250:251] op_sel:[1,0,0] op_sel_hi:[0,0,1] neg_lo:[1,0,0]
    v_pk_fma_f32 v[118:119], v[118:119], v[36:37], v[252:253] op_sel:[1,0,0] op_sel_hi:[0,0,1] neg_lo:[1,0,0]
    v_pk_mul_f32 v[246:247], v[120:121], v[200:201] op_sel:[0,1] op_sel_hi:[1,1]
    v_pk_mul_f32 v[248:249], v[122:123], v[204:205] op_sel:[0,1] op_sel_hi:[1,1]
    v_pk_mul_f32 v[250:251], v[124:125], v[208:209] op_sel:[0,1] op_sel_hi:[1,1]
    v_pk_mul_f32 v[252:253], v[126:127], v[212:213] op_sel:[0,1] op_sel_hi:[1,1]
    v_pk_fma_f32 v[120:121], v[120:121], v[8:9], v[246:247] op_sel:[1,1,0] op_sel_hi:[0,1,1] neg_lo:[1,0,0]
    v_pk_fma_f32 v[122:123], v[122:123], v[12:13], v[248:249] op_sel:[1,1,0] op_sel_hi:[0,1,1] neg_lo:[1,0,0]
    v_pk_fma_f32 v[124:125], v[124:125], v[16:17], v[250:251] op_sel:[1,1,0] op_sel_hi:[0,1,1] neg_lo:[1,0,0]
    v_pk_fma_f32 v[126:127], v[126:127], v[20:21], v[252:253] op_sel:[1,1,0] op_sel_hi:[0,1,1] neg_lo:[1,0,0]
    v_pk_mul_f32 v[246:247], v[128:129], v[216:217] op_sel:[0,1] op_sel_hi:[1,1]
    v_pk_mul_f32 v[248:249], v[130:131], v[220:221] op_sel:[0,1] op_sel_hi:[1,1]
    v_pk_mul_f32 v[250:251], v[132:133], v[224:225] op_sel:[0,1] op_sel_hi:[1,1]
    v_pk_mul_f32 v[252:253], v[134:135], v[228:229] op_sel:[0,1] op_sel_hi:[1,1]
    v_pk_fma_f32 v[128:129], v[128:129], v[24:25], v[246:247] op_sel:[1,1,0] op_sel_hi:[0,1,1] neg_lo:[1,0,0]
    v_pk_fma_f32 v[130:131], v[130:131], v[28:29], v[248:249] op_sel:[1,1,0] op_sel_hi:[0,1,1] neg_lo:[1,0,0]
    v_pk_fma_f32 v[132:133], v[132:133], v[32:33], v[250:251] op_sel:[1,1,0] op_sel_hi:[0,1,1] neg_lo:[1,0,0]
    v_pk_fma_f32 v[134:135], v[134:135], v[36:37], v[252:253] op_sel:[1,1,0] op_sel_hi:[0,1,1] neg_lo:[1,0,0]
    v_pk_mul_f32 v[246:247], v[136:137], v[202:203] op_sel:[0,0] op_sel_hi:[1,0]
    v_pk_mul_f32 v[248:249], v[138:139], v[206:207] op_sel:[0,0] op_sel_hi:[1,0]
    v_pk_mul_f32 v[250:251], v[140:141], v[210:211] op_sel:[0,0] op_sel_hi:[1,0]
    v_pk_mul_f32 v[252:253], v[142:143], v[214:215] op_sel:[0,0] op_sel_hi:[1,0]
    v_pk_fma_f32 v[136:137], v[136:137], v[10:11], v[246:247] op_sel:[1,0,0] op_sel_hi:[0,0,1] neg_lo:[1,0,0]
    v_pk_fma_f32 v[138:139], v[138:139], v[14:15], v[248:249] op_sel:[1,0,0] op_sel_hi:[0,0,1] neg_lo:[1,0,0]
    v_pk_fma_f32 v[140:141], v[140:141], v[18:19], v[250:251] op_sel:[1,0,0] op_sel_hi:[0,0,1] neg_lo:[1,0,0]
    v_pk_fma_f32 v[142:143], v[142:143], v[22:23], v[252:253] op_sel:[1,0,0] op_sel_hi:[0,0,1] neg_lo:[1,0,0]
    v_pk_mul_f32 v[246:247], v[144:145], v[218:219] op_sel:[0,0] op_sel_hi:[1,0]
    v_pk_mul_f32 v[248:249], v[146:147], v[222:223] op_sel:[0,0] op_sel_hi:[1,0]
    v_pk_mul_f32 v[250:251], v[148:149], v[226:227] op_sel:[0,0] op_sel_hi:[1,0]
    v_pk_mul_f32 v[252:253], v[150:151], v[230:231] op_sel:[0,0] op_sel_hi:[1,0]
    v_pk_fma_f32 v[144:145], v[144:145], v[26:27], v[246:247] op_sel:[1,0,0] op_sel_hi:[0,0,1] neg_lo:[1,0,0]
    v_pk_fma_f32 v[146:147], v[146:147], v[30:31], v[248:249] op_sel:[1,0,0] op_sel_hi:[0,0,1] neg_lo:[1,0,0]
    v_pk_fma_f32 v[148:149], v[148:149], v[34:35], v[250:251] op_sel:[1,0,0] op_sel_hi:[0,0,1] neg_lo:[1,0,0]
    v_pk_fma_f32 v[150:151], v[150:151], v[38:39], v[252:253] op_sel:[1,0,0] op_sel_hi:[0,0,1] neg_lo:[1,0,0]
    v_pk_mul_f32 v[246:247], v[152:153], v[202:203] op_sel:[0,1] op_sel_hi:[1,1]
    v_pk_mul_f32 v[248:249], v[154:155], v[206:207] op_sel:[0,1] op_sel_hi:[1,1]
    v_pk_mul_f32 v[250:251], v[156:157], v[210:211] op_sel:[0,1] op_sel_hi:[1,1]
    v_pk_mul_f32 v[252:253], v[158:159], v[214:215] op_sel:[0,1] op_sel_hi:[1,1]
    v_pk_fma_f32 v[152:153], v[152:153], v[10:11], v[246:247] op_sel:[1,1,0] op_sel_hi:[0,1,1] neg_lo:[1,0,0]
    v_pk_fma_f32 v[154:155], v[154:155], v[14:15], v[248:249] op_sel:[1,1,0] op_sel_hi:[0,1,1] neg_lo:[1,0,0]
    v_pk_fma_f32 v[156:157], v[156:157], v[18:19], v[250:251] op_sel:[1,1,0] op_sel_hi:[0,1,1] neg_lo:[1,0,0]
    v_pk_fma_f32 v[158:159], v[158:159], v[22:23], v[252:253] op_sel:[1,1,0] op_sel_hi:[0,1,1] neg_lo:[1,0,0]
    v_pk_mul_f32 v[246:247], v[160:161], v[218:219] op_sel:[0,1] op_sel_hi:[1,1]
    v_pk_mul_f32 v[248:249], v[162:163], v[222:223] op_sel:[0,1] op_sel_hi:[1,1]
    v_pk_mul_f32 v[250:251], v[164:165], v[226:227] op_sel:[0,1] op_sel_hi:[1,1]
    v_pk_mul_f32 v[252:253], v[166:167], v[230:231] op_sel:[0,1] op_sel_hi:[1,1]
    v_pk_fma_f32 v[160:161], v[160:161], v[26:27], v[246:247] op_sel:[1,1,0] op_sel_hi:[0,1,1] neg_lo:[1,0,0]
    v_pk_fma_f32 v[162:163], v[162:163], v[30:31], v[248:249] op_sel:[1,1,0] op_sel_hi:[0,1,1] neg_lo:[1,0,0]
    v_pk_fma_f32 v[164:165], v[164:165], v[34:35], v[250:251] op_sel:[1,1,0] op_sel_hi:[0,1,1] neg_lo:[1,0,0]
    v_pk_fma_f32 v[166:167], v[166:167], v[38:39], v[252:253] op_sel:[1,1,0] op_sel_hi:[0,1,1] neg_lo:[1,0,0]
    s_cbranch_scc1 cf_pack2
cf_mul_done:
    v_cvt_pk_bf16_f32 v168, v104, v105
    v_cvt_pk_bf16_f32 v169, v106, v107
    v_cvt_pk_bf16_f32 v170, v108, v109
    v_cvt_pk_bf16_f32 v171, v110, v111
    v_cvt_pk_bf16_f32 v172, v112, v113
    v_cvt_pk_bf16_f32 v173, v114, v115
    v_cvt_pk_bf16_f32 v174, v116, v117
    v_cvt_pk_bf16_f32 v175, v118, v119
    v_cvt_pk_bf16_f32 v176, v120, v121
    v_cvt_pk_bf16_f32 v177, v122, v123
    v_cvt_pk_bf16_f32 v178, v124, v125
    v_cvt_pk_bf16_f32 v179, v126, v127
    v_mfma_f32_32x32x16_bf16 v[104:119], a[176:179], v[168:171], 0
    buffer_load_dwordx4 v[8:11], v3, s[36:39], s40 offen offset:0 sc1
    v_cvt_pk_bf16_f32 v180, v128, v129
    v_cvt_pk_bf16_f32 v181, v130, v131
    v_cvt_pk_bf16_f32 v182, v132, v133
    v_cvt_pk_bf16_f32 v183, v134, v135
    v_mfma_f32_32x32x16_bf16 v[104:119], a[180:183], v[172:175], v[104:119]
    buffer_load_dwordx4 v[12:15], v3, s[36:39], s40 offen offset:1024 sc1
    v_cvt_pk_bf16_f32 v184, v136, v137
    v_cvt_pk_bf16_f32 v185, v138, v139
    v_cvt_pk_bf16_f32 v186, v140, v141
    v_cvt_pk_bf16_f32 v187, v142, v143
    v_mfma_f32_32x32x16_bf16 v[120:135], a[176:179], v[176:179], 0
    buffer_load_dwordx4 v[16:19], v3, s[36:39], s40 offen offset:2048 sc1
    v_cvt_pk_bf16_f32 v188, v144, v145
    v_cvt_pk_bf16_f32 v189, v146, v147
    v_cvt_pk_bf16_f32 v190, v148, v149
    v_cvt_pk_bf16_f32 v191, v150, v151
    v_mfma_f32_32x32x16_bf16 v[120:135], a[180:183], v[180:183], v[120:135]
    buffer_load_dwordx4 v[20:23], v3, s[36:39], s40 offen offset:3072 sc1
    v_cvt_pk_bf16_f32 v192, v152, v153
    v_cvt_pk_bf16_f32 v193, v154, v155
    v_cvt_pk_bf16_f32 v194, v156, v157
    v_cvt_pk_bf16_f32 v195, v158, v159
    v_mfma_f32_32x32x16_bf16 v[136:151], a[176:179], v[184:187], 0
    buffer_load_dwordx4 v[24:27], v4, s[36:39], s40 offen offset:0 sc1
    v_cvt_pk_bf16_f32 v196, v160, v161
    v_cvt_pk_bf16_f32 v197, v162, v163
    v_cvt_pk_bf16_f32 v198, v164, v165
    v_cvt_pk_bf16_f32 v199, v166, v167
    v_mfma_f32_32x32x16_bf16 v[136:151], a[180:183], v[188:191], v[136:151]
    buffer_load_dwordx4 v[28:31], v4, s[36:39], s40 offen offset:1024 sc1
    v_mfma_f32_32x32x16_bf16 v[152:167], a[176:179], v[192:195], 0
    buffer_load_dwordx4 v[32:35], v4, s[36:39], s40 offen offset:2048 sc1
    v_mfma_f32_32x32x16_bf16 v[152:167], a[180:183], v[196:199], v[152:167]
    buffer_load_dwordx4 v[36:39], v4, s[36:39], s40 offen offset:3072 sc1
    v_cvt_pk_bf16_f32 v168, v104, v105
    v_pk_mul_f32 v[214:215], v[106:107], v[96:97] op_sel:[0,0] op_sel_hi:[1,0]
    v_pk_mul_f32 v[200:201], v[108:109], v[88:89] op_sel:[0,0] op_sel_hi:[1,0]
    v_pk_mul_f32 v[202:203], v[110:111], v[80:81] op_sel:[0,0] op_sel_hi:[1,0]
    v_pk_mul_f32 v[204:205], v[112:113], v[72:73] op_sel:[0,0] op_sel_hi:[1,0]
    v_pk_fma_f32 v[214:215], v[106:107], v[100:101], v[214:215] op_sel:[1,0,0] op_sel_hi:[0,0,1] neg_lo:[1,0,0]
    v_pk_fma_f32 v[200:201], v[108:109], v[92:93], v[200:201] op_sel:[1,0,0] op_sel_hi:[0,0,1] neg_lo:[1,0,0]
    v_pk_fma_f32 v[202:203], v[110:111], v[84:85], v[202:203] op_sel:[1,0,0] op_sel_hi:[0,0,1] neg_lo:[1,0,0]
    v_pk_fma_f32 v[204:205], v[112:113], v[76:77], v[204:205] op_sel:[1,0,0] op_sel_hi:[0,0,1] neg_lo:[1,0,0]
    v_cvt_pk_bf16_f32 v196, v214, v215
    v_cvt_pk_bf16_f32 v192, v200, v201
    v_cvt_pk_bf16_f32 v188, v202, v203
    v_cvt_pk_bf16_f32 v184, v204, v205
    v_pk_mul_f32 v[206:207], v[114:115], v[64:65] op_sel:[0,0] op_sel_hi:[1,0]
    v_pk_mul_f32 v[208:209], v[116:117], v[56:57] op_sel:[0,0] op_sel_hi:[1,0]
    v_pk_mul_f32 v[210:211], v[118:119], v[48:49] op_sel:[0,0] op_sel_hi:[1,0]
    v_pk_fma_f32 v[206:207], v[114:115], v[68:69], v[206:207] op_sel:[1,0,0] op_sel_hi:[0,0,1] neg_lo:[1,0,0]
    v_pk_fma_f32 v[208:209], v[116:117], v[60:61], v[208:209] op_sel:[1,0,0] op_sel_hi:[0,0,1] neg_lo:[1,0,0]
    v_pk_fma_f32 v[210:211], v[118:119], v[52:53], v[210:211] op_sel:[1,0,0] op_sel_hi:[0,0,1] neg_lo:[1,0,0]
    v_cvt_pk_bf16_f32 v180, v206, v207
    v_cvt_pk_bf16_f32 v176, v208, v209
    v_cvt_pk_bf16_f32 v172, v210, v211
    v_cvt_pk_bf16_f32 v169, v120, v121
    v_pk_mul_f32 v[212:213], v[122:123], v[96:97] op_sel:[0,1] op_sel_hi:[1,1]
    v_pk_mul_f32 v[214:215], v[124:125], v[88:89] op_sel:[0,1] op_sel_hi:[1,1]
    v_pk_mul_f32 v[200:201], v[126:127], v[80:81] op_sel:[0,1] op_sel_hi:[1,1]
    v_pk_mul_f32 v[202:203], v[128:129], v[72:73] op_sel:[0,1] op_sel_hi:[1,1]
    v_pk_fma_f32 v[212:213], v[122:123], v[100:101], v[212:213] op_sel:[1,1,0] op_sel_hi:[0,1,1] neg_lo:[1,0,0]
    v_pk_fma_f32 v[214:215], v[124:125], v[92:93], v[214:215] op_sel:[1,1,0] op_sel_hi:[0,1,1] neg_lo:[1,0,0]
    v_pk_fma_f32 v[200:201], v[126:127], v[84:85], v[200:201] op_sel:[1,1,0] op_sel_hi:[0,1,1] neg_lo:[1,0,0]
    v_pk_fma_f32 v[202:203], v[128:129], v[76:77], v[202:203] op_sel:[1,1,0] op_sel_hi:[0,1,1] neg_lo:[1,0,0]
    v_cvt_pk_bf16_f32 v197, v212, v213
    v_cvt_pk_bf16_f32 v193, v214, v215
    v_cvt_pk_bf16_f32 v189, v200, v201
    v_cvt_pk_bf16_f32 v185, v202, v203
    v_pk_mul_f32 v[204:205], v[130:131], v[64:65] op_sel:[0,1] op_sel_hi:[1,1]
    v_pk_mul_f32 v[206:207], v[132:133], v[56:57] op_sel:[0,1] op_sel_hi:[1,1]
    v_pk_mul_f32 v[208:209], v[134:135], v[48:49] op_sel:[0,1] op_sel_hi:[1,1]
    v_pk_fma_f32 v[204:205], v[130:131], v[68:69], v[204:205] op_sel:[1,1,0] op_sel_hi:[0,1,1] neg_lo:[1,0,0]
    v_pk_fma_f32 v[206:207], v[132:133], v[60:61], v[206:207] op_sel:[1,1,0] op_sel_hi:[0,1,1] neg_lo:[1,0,0]
    v_pk_fma_f32 v[208:209], v[134:135], v[52:53], v[208:209] op_sel:[1,1,0] op_sel_hi:[0,1,1] neg_lo:[1,0,0]
    v_cvt_pk_bf16_f32 v181, v204, v205
    v_cvt_pk_bf16_f32 v177, v206, v207
    v_cvt_pk_bf16_f32 v173, v208, v209
    v_cvt_pk_bf16_f32 v170, v136, v137
    v_pk_mul_f32 v[210:211], v[138:139], v[98:99] op_sel:[0,0] op_sel_hi:[1,0]
    v_pk_mul_f32 v[212:213], v[140:141], v[90:91] op_sel:[0,0] op_sel_hi:[1,0]
    v_pk_mul_f32 v[214:215], v[142:143], v[82:83] op_sel:[0,0] op_sel_hi:[1,0]
    v_pk_mul_f32 v[200:201], v[144:145], v[74:75] op_sel:[0,0] op_sel_hi:[1,0]
    v_pk_fma_f32 v[210:211], v[138:139], v[102:103], v[210:211] op_sel:[1,0,0] op_sel_hi:[0,0,1] neg_lo:[1,0,0]
    v_pk_fma_f32 v[212:213], v[140:141], v[94:95], v[212:213] op_sel:[1,0,0] op_sel_hi:[0,0,1] neg_lo:[1,0,0]
    v_pk_fma_f32 v[214:215], v[142:143], v[86:87], v[214:215] op_sel:[1,0,0] op_sel_hi:[0,0,1] neg_lo:[1,0,0]
    v_pk_fma_f32 v[200:201], v[144:145], v[78:79], v[200:201] op_sel:[1,0,0] op_sel_hi:[0,0,1] neg_lo:[1,0,0]
    v_cvt_pk_bf16_f32 v198, v210, v211
    v_cvt_pk_bf16_f32 v194, v212, v213
    v_cvt_pk_bf16_f32 v190, v214, v215
    v_cvt_pk_bf16_f32 v186, v200, v201
    v_pk_mul_f32 v[202:203], v[146:147], v[66:67] op_sel:[0,0] op_sel_hi:[1,0]
    v_pk_mul_f32 v[204:205], v[148:149], v[58:59] op_sel:[0,0] op_sel_hi:[1,0]
    v_pk_mul_f32 v[206:207], v[150:151], v[50:51] op_sel:[0,0] op_sel_hi:[1,0]
    v_pk_fma_f32 v[202:203], v[146:147], v[70:71], v[202:203] op_sel:[1,0,0] op_sel_hi:[0,0,1] neg_lo:[1,0,0]
    v_pk_fma_f32 v[204:205], v[148:149], v[62:63], v[204:205] op_sel:[1,0,0] op_sel_hi:[0,0,1] neg_lo:[1,0,0]
    v_pk_fma_f32 v[206:207], v[150:151], v[54:55], v[206:207] op_sel:[1,0,0] op_sel_hi:[0,0,1] neg_lo:[1,0,0]
    v_cvt_pk_bf16_f32 v182, v202, v203
    v_cvt_pk_bf16_f32 v178, v204, v205
    v_cvt_pk_bf16_f32 v174, v206, v207
    v_cvt_pk_bf16_f32 v171, v152, v153
    v_pk_mul_f32 v[208:209], v[154:155], v[98:99] op_sel:[0,1] op_sel_hi:[1,1]
    v_pk_mul_f32 v[210:211], v[156:157], v[90:91] op_sel:[0,1] op_sel_hi:[1,1]
    v_pk_mul_f32 v[212:213], v[158:159], v[82:83] op_sel:[0,1] op_sel_hi:[1,1]
    v_pk_mul_f32 v[214:215], v[160:161], v[74:75] op_sel:[0,1] op_sel_hi:[1,1]
    v_pk_fma_f32 v[208:209], v[154:155], v[102:103], v[208:209] op_sel:[1,1,0] op_sel_hi:[0,1,1] neg_lo:[1,0,0]
    v_pk_fma_f32 v[210:211], v[156:157], v[94:95], v[210:211] op_sel:[1,1,0] op_sel_hi:[0,1,1] neg_lo:[1,0,0]
    v_pk_fma_f32 v[212:213], v[158:159], v[86:87], v[212:213] op_sel:[1,1,0] op_sel_hi:[0,1,1] neg_lo:[1,0,0]
    v_pk_fma_f32 v[214:215], v[160:161], v[78:79], v[214:215] op_sel:[1,1,0] op_sel_hi:[0,1,1] neg_lo:[1,0,0]
    v_cvt_pk_bf16_f32 v199, v208, v209
    v_cvt_pk_bf16_f32 v195, v210, v211
    v_cvt_pk_bf16_f32 v191, v212, v213
    v_cvt_pk_bf16_f32 v187, v214, v215
    v_pk_mul_f32 v[200:201], v[162:163], v[66:67] op_sel:[0,1] op_sel_hi:[1,1]
    v_pk_mul_f32 v[202:203], v[164:165], v[58:59] op_sel:[0,1] op_sel_hi:[1,1]
    v_pk_mul_f32 v[204:205], v[166:167], v[50:51] op_sel:[0,1] op_sel_hi:[1,1]
    v_pk_fma_f32 v[200:201], v[162:163], v[70:71], v[200:201] op_sel:[1,1,0] op_sel_hi:[0,1,1] neg_lo:[1,0,0]
    v_pk_fma_f32 v[202:203], v[164:165], v[62:63], v[202:203] op_sel:[1,1,0] op_sel_hi:[0,1,1] neg_lo:[1,0,0]
    v_pk_fma_f32 v[204:205], v[166:167], v[54:55], v[204:205] op_sel:[1,1,0] op_sel_hi:[0,1,1] neg_lo:[1,0,0]
    v_cvt_pk_bf16_f32 v183, v200, v201
    v_cvt_pk_bf16_f32 v179, v202, v203
    v_cvt_pk_bf16_f32 v175, v204, v205
    v_mfma_f32_16x16x32_bf16 v[104:107], v[168:171], a[168:171], 0
    v_mfma_f32_16x16x32_bf16 v[108:111], v[168:171], a[172:175], 0
    v_mfma_f32_16x16x32_bf16 v[112:115], v[172:175], a[168:171], 0
    v_mfma_f32_16x16x32_bf16 v[116:119], v[172:175], a[172:175], 0
    v_mfma_f32_16x16x32_bf16 v[120:123], v[176:179], a[168:171], 0
    v_mfma_f32_16x16x32_bf16 v[124:127], v[176:179], a[172:175], 0
    v_mfma_f32_16x16x32_bf16 v[128:131], v[180:183], a[168:171], 0
    v_mfma_f32_16x16x32_bf16 v[132:135], v[180:183], a[172:175], 0
    v_mfma_f32_16x16x32_bf16 v[136:139], v[184:187], a[168:171], 0
    v_mfma_f32_16x16x32_bf16 v[140:143], v[184:187], a[172:175], 0
    v_mfma_f32_16x16x32_bf16 v[144:147], v[188:191], a[168:171], 0
    v_mfma_f32_16x16x32_bf16 v[148:151], v[188:191], a[172:175], 0
    v_mfma_f32_16x16x32_bf16 v[152:155], v[192:195], a[168:171], 0
    v_mfma_f32_16x16x32_bf16 v[156:159], v[192:195], a[172:175], 0
    v_mfma_f32_16x16x32_bf16 v[160:163], v[196:199], a[168:171], 0
    v_mfma_f32_16x16x32_bf16 v[164:167], v[196:199], a[172:175], 0
    v_pk_mul_f32 v[246:247], v[104:105], v[40:41]
    v_pk_mul_f32 v[248:249], v[106:107], v[42:43]
    v_pk_mul_f32 v[104:105], v[104:105], v[44:45]
    v_pk_mul_f32 v[106:107], v[106:107], v[46:47]
    v_pk_fma_f32 v[104:105], v[108:109], v[40:41], v[104:105]
    v_pk_fma_f32 v[106:107], v[110:111], v[42:43], v[106:107]
    v_pk_fma_f32 v[108:109], v[108:109], v[44:45], v[246:247] neg_lo:[1,0,0] neg_hi:[1,0,0]
    v_pk_fma_f32 v[110:111], v[110:111], v[46:47], v[248:249] neg_lo:[1,0,0] neg_hi:[1,0,0]
    v_pk_mul_f32 v[250:251], v[112:113], v[40:41]
    v_pk_mul_f32 v[252:253], v[114:115], v[42:43]
    v_pk_mul_f32 v[112:113], v[112:113], v[44:45]
    v_pk_mul_f32 v[114:115], v[114:115], v[46:47]
    v_pk_fma_f32 v[112:113], v[116:117], v[40:41], v[112:113]
    v_pk_fma_f32 v[114:115], v[118:119], v[42:43], v[114:115]
    v_pk_fma_f32 v[116:117], v[116:117], v[44:45], v[250:251] neg_lo:[1,0,0] neg_hi:[1,0,0]
    v_pk_fma_f32 v[118:119], v[118:119], v[46:47], v[252:253] neg_lo:[1,0,0] neg_hi:[1,0,0]
    v_pk_mul_f32 v[246:247], v[120:121], v[40:41]
    v_pk_mul_f32 v[248:249], v[122:123], v[42:43]
    v_pk_mul_f32 v[120:121], v[120:121], v[44:45]
    v_pk_mul_f32 v[122:123], v[122:123], v[46:47]
    v_pk_fma_f32 v[120:121], v[124:125], v[40:41], v[120:121]
    v_pk_fma_f32 v[122:123], v[126:127], v[42:43], v[122:123]
    v_pk_fma_f32 v[124:125], v[124:125], v[44:45], v[246:247] neg_lo:[1,0,0] neg_hi:[1,0,0]
    v_pk_fma_f32 v[126:127], v[126:127], v[46:47], v[248:249] neg_lo:[1,0,0] neg_hi:[1,0,0]
    v_pk_mul_f32 v[250:251], v[128:129], v[40:41]
    v_pk_mul_f32 v[252:253], v[130:131], v[42:43]
    v_pk_mul_f32 v[128:129], v[128:129], v[44:45]
    v_pk_mul_f32 v[130:131], v[130:131], v[46:47]
    v_pk_fma_f32 v[128:129], v[132:133], v[40:41], v[128:129]
    v_pk_fma_f32 v[130:131], v[134:135], v[42:43], v[130:131]
    v_pk_fma_f32 v[132:133], v[132:133], v[44:45], v[250:251] neg_lo:[1,0,0] neg_hi:[1,0,0]
    v_pk_fma_f32 v[134:135], v[134:135], v[46:47], v[252:253] neg_lo:[1,0,0] neg_hi:[1,0,0]
    v_pk_mul_f32 v[246:247], v[136:137], v[40:41]
    v_pk_mul_f32 v[248:249], v[138:139], v[42:43]
    v_pk_mul_f32 v[136:137], v[136:137], v[44:45]
    v_pk_mul_f32 v[138:139], v[138:139], v[46:47]
    v_pk_fma_f32 v[136:137], v[140:141], v[40:41], v[136:137]
    v_pk_fma_f32 v[138:139], v[142:143], v[42:43], v[138:139]
    v_pk_fma_f32 v[140:141], v[140:141], v[44:45], v[246:247] neg_lo:[1,0,0] neg_hi:[1,0,0]
    v_pk_fma_f32 v[142:143], v[142:143], v[46:47], v[248:249] neg_lo:[1,0,0] neg_hi:[1,0,0]
    v_pk_mul_f32 v[250:251], v[144:145], v[40:41]
    v_pk_mul_f32 v[252:253], v[146:147], v[42:43]
    v_pk_mul_f32 v[144:145], v[144:145], v[44:45]
    v_pk_mul_f32 v[146:147], v[146:147], v[46:47]
    v_pk_fma_f32 v[144:145], v[148:149], v[40:41], v[144:145]
    v_pk_fma_f32 v[146:147], v[150:151], v[42:43], v[146:147]
    v_pk_fma_f32 v[148:149], v[148:149], v[44:45], v[250:251] neg_lo:[1,0,0] neg_hi:[1,0,0]
    v_pk_fma_f32 v[150:151], v[150:151], v[46:47], v[252:253] neg_lo:[1,0,0] neg_hi:[1,0,0]
    v_pk_mul_f32 v[246:247], v[152:153], v[40:41]
    v_pk_mul_f32 v[248:249], v[154:155], v[42:43]
    v_pk_mul_f32 v[152:153], v[152:153], v[44:45]
    v_pk_mul_f32 v[154:155], v[154:155], v[46:47]
    v_pk_fma_f32 v[152:153], v[156:157], v[40:41], v[152:153]
    v_pk_fma_f32 v[154:155], v[158:159], v[42:43], v[154:155]
    v_pk_fma_f32 v[156:157], v[156:157], v[44:45], v[246:247] neg_lo:[1,0,0] neg_hi:[1,0,0]
    v_pk_fma_f32 v[158:159], v[158:159], v[46:47], v[248:249] neg_lo:[1,0,0] neg_hi:[1,0,0]
    v_pk_mul_f32 v[250:251], v[160:161], v[40:41]
    v_pk_mul_f32 v[252:253], v[162:163], v[42:43]
    v_pk_mul_f32 v[160:161], v[160:161], v[44:45]
    v_pk_mul_f32 v[162:163], v[162:163], v[46:47]
    v_pk_fma_f32 v[160:161], v[164:165], v[40:41], v[160:161]
    v_pk_fma_f32 v[162:163], v[166:167], v[42:43], v[162:163]
    v_pk_fma_f32 v[164:165], v[164:165], v[44:45], v[250:251] neg_lo:[1,0,0] neg_hi:[1,0,0]
    v_pk_fma_f32 v[166:167], v[166:167], v[46:47], v[252:253] neg_lo:[1,0,0] neg_hi:[1,0,0]
    v_cvt_pk_bf16_f32 v168, v108, v104
    v_cvt_pk_bf16_f32 v169, v109, v105
    v_cvt_pk_bf16_f32 v170, v110, v106
    v_cvt_pk_bf16_f32 v171, v111, v107
    v_cvt_pk_bf16_f32 v172, v116, v112
    v_cvt_pk_bf16_f32 v173, v117, v113
    v_mfma_f32_16x16x32_bf16 v[104:107], v[168:171], a[168:171], 0
    v_cvt_pk_bf16_f32 v174, v118, v114
    v_cvt_pk_bf16_f32 v175, v119, v115
    v_mfma_f32_16x16x32_bf16 v[108:111], v[168:171], a[172:175], 0
    v_cvt_pk_bf16_f32 v176, v124, v120
    v_cvt_pk_bf16_f32 v177, v125, v121
    v_mfma_f32_16x16x32_bf16 v[112:115], v[172:175], a[168:171], 0
    v_cvt_pk_bf16_f32 v178, v126, v122
    v_cvt_pk_bf16_f32 v179, v127, v123
    v_mfma_f32_16x16x32_bf16 v[116:119], v[172:175], a[172:175], 0
    v_cvt_pk_bf16_f32 v180, v132, v128
    v_cvt_pk_bf16_f32 v181, v133, v129
    v_mfma_f32_16x16x32_bf16 v[120:123], v[176:179], a[168:171], 0
    v_cvt_pk_bf16_f32 v182, v134, v130
    v_cvt_pk_bf16_f32 v183, v135, v131
    v_mfma_f32_16x16x32_bf16 v[124:127], v[176:179], a[172:175], 0
    v_cvt_pk_bf16_f32 v184, v140, v136
    v_cvt_pk_bf16_f32 v185, v141, v137
    v_mfma_f32_16x16x32_bf16 v[128:131], v[180:183], a[168:171], 0
    v_cvt_pk_bf16_f32 v186, v142, v138
    v_cvt_pk_bf16_f32 v187, v143, v139
    v_mfma_f32_16x16x32_bf16 v[132:135], v[180:183], a[172:175], 0
    v_cvt_pk_bf16_f32 v188, v148, v144
    v_cvt_pk_bf16_f32 v189, v149, v145
    v_mfma_f32_16x16x32_bf16 v[136:139], v[184:187], a[168:171], 0
    v_cvt_pk_bf16_f32 v190, v150, v146
    v_cvt_pk_bf16_f32 v191, v151, v147
    v_mfma_f32_16x16x32_bf16 v[140:143], v[184:187], a[172:175], 0
    v_cvt_pk_bf16_f32 v192, v156, v152
    v_cvt_pk_bf16_f32 v193, v157, v153
    v_mfma_f32_16x16x32_bf16 v[144:147], v[188:191], a[168:171], 0
    v_cvt_pk_bf16_f32 v194, v158, v154
    v_cvt_pk_bf16_f32 v195, v159, v155
    v_mfma_f32_16x16x32_bf16 v[148:151], v[188:191], a[172:175], 0
    v_cvt_pk_bf16_f32 v196, v164, v160
    v_cvt_pk_bf16_f32 v197, v165, v161
    v_mfma_f32_16x16x32_bf16 v[152:155], v[192:195], a[168:171], 0
    v_cvt_pk_bf16_f32 v198, v166, v162
    v_cvt_pk_bf16_f32 v199, v167, v163
    v_mfma_f32_16x16x32_bf16 v[156:159], v[192:195], a[172:175], 0
    s_nop 0
    v_mfma_f32_16x16x32_bf16 v[160:163], v[196:199], a[168:171], 0
    v_mfma_f32_16x16x32_bf16 v[164:167], v[196:199], a[172:175], 0
    v_cvt_pk_bf16_f32 v168, v104, v108
    v_cvt_pk_bf16_f32 v169, v105, v109
    v_cvt_pk_bf16_f32 v170, v106, v110
    v_cvt_pk_bf16_f32 v171, v107, v111
    v_cvt_pk_bf16_f32 v172, v112, v116
    v_cvt_pk_bf16_f32 v173, v113, v117
    v_cvt_pk_bf16_f32 v174, v114, v118
    v_cvt_pk_bf16_f32 v175, v115, v119
    v_cvt_pk_bf16_f32 v176, v120, v124
    v_cvt_pk_bf16_f32 v177, v121, v125
    v_cvt_pk_bf16_f32 v178, v122, v126
    v_cvt_pk_bf16_f32 v179, v123, v127
    v_cvt_pk_bf16_f32 v180, v128, v132
    v_cvt_pk_bf16_f32 v181, v129, v133
    v_cvt_pk_bf16_f32 v182, v130, v134
    v_cvt_pk_bf16_f32 v183, v131, v135
    v_cvt_pk_bf16_f32 v184, v136, v140
    v_cvt_pk_bf16_f32 v185, v137, v141
    v_cvt_pk_bf16_f32 v186, v138, v142
    v_cvt_pk_bf16_f32 v187, v139, v143
    v_cvt_pk_bf16_f32 v188, v144, v148
    v_cvt_pk_bf16_f32 v189, v145, v149
    v_cvt_pk_bf16_f32 v190, v146, v150
    v_cvt_pk_bf16_f32 v191, v147, v151
    v_cvt_pk_bf16_f32 v192, v152, v156
    v_cvt_pk_bf16_f32 v193, v153, v157
    v_cvt_pk_bf16_f32 v194, v154, v158
    v_cvt_pk_bf16_f32 v195, v155, v159
    v_cvt_pk_bf16_f32 v196, v160, v164
    v_cvt_pk_bf16_f32 v197, v161, v165
    v_cvt_pk_bf16_f32 v198, v162, v166
    v_cvt_pk_bf16_f32 v199, v163, v167
    s_cmp_eq_u32 s48, 0
    s_cbranch_scc0 cf_o0
    v_accvgpr_write_b32 a0, v168
    v_accvgpr_write_b32 a4, v169
    v_accvgpr_write_b32 a8, v170
    v_accvgpr_write_b32 a12, v171
    v_accvgpr_write_b32 a16, v172
    v_accvgpr_write_b32 a20, v173
    v_accvgpr_write_b32 a24, v174
    v_accvgpr_write_b32 a28, v175
    v_accvgpr_write_b32 a32, v176
    v_accvgpr_write_b32 a36, v177
    v_accvgpr_write_b32 a40, v178
    v_accvgpr_write_b32 a44, v179
    v_accvgpr_write_b32 a48, v180
    v_accvgpr_write_b32 a52, v181
    v_accvgpr_write_b32 a56, v182
    v_accvgpr_write_b32 a60, v183
    v_accvgpr_write_b32 a64, v184
    v_accvgpr_write_b32 a68, v185
    v_accvgpr_write_b32 a72, v186
    v_accvgpr_write_b32 a76, v187
    v_accvgpr_write_b32 a80, v188
    v_accvgpr_write_b32 a84, v189
    v_accvgpr_write_b32 a88, v190
    v_accvgpr_write_b32 a92, v191
    v_accvgpr_write_b32 a96, v192
    v_accvgpr_write_b32 a100, v193
    v_accvgpr_write_b32 a104, v194
    v_accvgpr_write_b32 a108, v195
    v_accvgpr_write_b32 a112, v196
    v_accvgpr_write_b32 a116, v197
    v_accvgpr_write_b32 a120, v198
    v_accvgpr_write_b32 a124, v199
cf_o0:
    s_cmp_eq_u32 s48, 1
    s_cbranch_scc0 cf_o1
    v_accvgpr_write_b32 a1, v168
    v_accvgpr_write_b32 a5, v169
    v_accvgpr_write_b32 a9, v170
    v_accvgpr_write_b32 a13, v171
    v_accvgpr_write_b32 a17, v172
    v_accvgpr_write_b32 a21, v173
    v_accvgpr_write_b32 a25, v174
    v_accvgpr_write_b32 a29, v175
    v_accvgpr_write_b32 a33, v176
    v_accvgpr_write_b32 a37, v177
    v_accvgpr_write_b32 a41, v178
    v_accvgpr_write_b32 a45, v179
    v_accvgpr_write_b32 a49, v180
    v_accvgpr_write_b32 a53, v181
    v_accvgpr_write_b32 a57, v182
    v_accvgpr_write_b32 a61, v183
    v_accvgpr_write_b32 a65, v184
    v_accvgpr_write_b32 a69, v185
    v_accvgpr_write_b32 a73, v186
    v_accvgpr_write_b32 a77, v187
    v_accvgpr_write_b32 a81, v188
    v_accvgpr_write_b32 a85, v189
    v_accvgpr_write_b32 a89, v190
    v_accvgpr_write_b32 a93, v191
    v_accvgpr_write_b32 a97, v192
    v_accvgpr_write_b32 a101, v193
    v_accvgpr_write_b32 a105, v194
    v_accvgpr_write_b32 a109, v195
    v_accvgpr_write_b32 a113, v196
    v_accvgpr_write_b32 a117, v197
    v_accvgpr_write_b32 a121, v198
    v_accvgpr_write_b32 a125, v199
cf_o1:
    s_cmp_eq_u32 s48, 2
    s_cbranch_scc0 cf_o2
    v_accvgpr_write_b32 a2, v168
    v_accvgpr_write_b32 a6, v169
    v_accvgpr_write_b32 a10, v170
    v_accvgpr_write_b32 a14, v171
    v_accvgpr_write_b32 a18, v172
    v_accvgpr_write_b32 a22, v173
    v_accvgpr_write_b32 a26, v174
    v_accvgpr_write_b32 a30, v175
    v_accvgpr_write_b32 a34, v176
    v_accvgpr_write_b32 a38, v177
    v_accvgpr_write_b32 a42, v178
    v_accvgpr_write_b32 a46, v179
    v_accvgpr_write_b32 a50, v180
    v_accvgpr_write_b32 a54, v181
    v_accvgpr_write_b32 a58, v182
    v_accvgpr_write_b32 a62, v183
    v_accvgpr_write_b32 a66, v184
    v_accvgpr_write_b32 a70, v185
    v_accvgpr_write_b32 a74, v186
    v_accvgpr_write_b32 a78, v187
    v_accvgpr_write_b32 a82, v188
    v_accvgpr_write_b32 a86, v189
    v_accvgpr_write_b32 a90, v190
    v_accvgpr_write_b32 a94, v191
    v_accvgpr_write_b32 a98, v192
    v_accvgpr_write_b32 a102, v193
    v_accvgpr_write_b32 a106, v194
    v_accvgpr_write_b32 a110, v195
    v_accvgpr_write_b32 a114, v196
    v_accvgpr_write_b32 a118, v197
    v_accvgpr_write_b32 a122, v198
    v_accvgpr_write_b32 a126, v199
cf_o2:
    s_cmp_eq_u32 s48, 3
    s_cbranch_scc0 cf_o3
    v_accvgpr_write_b32 a3, v168
    v_accvgpr_write_b32 a7, v169
    v_accvgpr_write_b32 a11, v170
    v_accvgpr_write_b32 a15, v171
    v_accvgpr_write_b32 a19, v172
    v_accvgpr_write_b32 a23, v173
    v_accvgpr_write_b32 a27, v174
    v_accvgpr_write_b32 a31, v175
    v_accvgpr_write_b32 a35, v176
    v_accvgpr_write_b32 a39, v177
    v_accvgpr_write_b32 a43, v178
    v_accvgpr_write_b32 a47, v179
    v_accvgpr_write_b32 a51, v180
    v_accvgpr_write_b32 a55, v181
    v_accvgpr_write_b32 a59, v182
    v_accvgpr_write_b32 a63, v183
    v_accvgpr_write_b32 a67, v184
    v_accvgpr_write_b32 a71, v185
    v_accvgpr_write_b32 a75, v186
    v_accvgpr_write_b32 a79, v187
    v_accvgpr_write_b32 a83, v188
    v_accvgpr_write_b32 a87, v189
    v_accvgpr_write_b32 a91, v190
    v_accvgpr_write_b32 a95, v191
    v_accvgpr_write_b32 a99, v192
    v_accvgpr_write_b32 a103, v193
    v_accvgpr_write_b32 a107, v194
    v_accvgpr_write_b32 a111, v195
    v_accvgpr_write_b32 a115, v196
    v_accvgpr_write_b32 a119, v197
    v_accvgpr_write_b32 a123, v198
    v_accvgpr_write_b32 a127, v199
cf_o3:
    s_add_u32 s48, s48, 1
    s_cmp_lt_u32 s48, 4
    s_cbranch_scc1 cf_loop
    v_and_b32 v238, 15, v1
    v_lshlrev_b32 v238, 4, v238
    v_lshl_add_u32 v238, v5, 20, v238
    s_lshl_b32 s41, s51, 8
    s_add_u32 s42, s41, 0x0
    buffer_store_dwordx4 a[0:3], v238, s[56:59], s42 offen sc1
    s_add_u32 s42, s41, 0x8000
    buffer_store_dwordx4 a[16:19], v238, s[56:59], s42 offen sc1
    s_add_u32 s42, s41, 0x10000
    buffer_store_dwordx4 a[32:35], v238, s[56:59], s42 offen sc1
    s_add_u32 s42, s41, 0x18000
    buffer_store_dwordx4 a[48:51], v238, s[56:59], s42 offen sc1
    s_add_u32 s42, s41, 0x20000
    buffer_store_dwordx4 a[64:67], v238, s[56:59], s42 offen sc1
    s_add_u32 s42, s41, 0x28000
    buffer_store_dwordx4 a[80:83], v238, s[56:59], s42 offen sc1
    s_add_u32 s42, s41, 0x30000
    buffer_store_dwordx4 a[96:99], v238, s[56:59], s42 offen sc1
    s_add_u32 s42, s41, 0x38000
    buffer_store_dwordx4 a[112:115], v238, s[56:59], s42 offen sc1
    s_add_u32 s42, s41, 0x40000
    buffer_store_dwordx4 a[4:7], v238, s[56:59], s42 offen sc1
    s_add_u32 s42, s41, 0x48000
    buffer_store_dwordx4 a[20:23], v238, s[56:59], s42 offen sc1
    s_add_u32 s42, s41, 0x50000
    buffer_store_dwordx4 a[36:39], v238, s[56:59], s42 offen sc1
    s_add_u32 s42, s41, 0x58000
    buffer_store_dwordx4 a[52:55], v238, s[56:59], s42 offen sc1
    s_add_u32 s42, s41, 0x60000
    buffer_store_dwordx4 a[68:71], v238, s[56:59], s42 offen sc1
    s_add_u32 s42, s41, 0x68000
    buffer_store_dwordx4 a[84:87], v238, s[56:59], s42 offen sc1
    s_add_u32 s42, s41, 0x70000
    buffer_store_dwordx4 a[100:103], v238, s[56:59], s42 offen sc1
    s_add_u32 s42, s41, 0x78000
    buffer_store_dwordx4 a[116:119], v238, s[56:59], s42 offen sc1
    s_add_u32 s42, s41, 0x80000
    buffer_store_dwordx4 a[8:11], v238, s[56:59], s42 offen sc1
    s_add_u32 s42, s41, 0x88000
    buffer_store_dwordx4 a[24:27], v238, s[56:59], s42 offen sc1
    s_add_u32 s42, s41, 0x90000
    buffer_store_dwordx4 a[40:43], v238, s[56:59], s42 offen sc1
    s_add_u32 s42, s41, 0x98000
    buffer_store_dwordx4 a[56:59], v238, s[56:59], s42 offen sc1
    s_add_u32 s42, s41, 0xa0000
    buffer_store_dwordx4 a[72:75], v238, s[56:59], s42 offen sc1
    s_add_u32 s42, s41, 0xa8000
    buffer_store_dwordx4 a[88:91], v238, s[56:59], s42 offen sc1
    s_add_u32 s42, s41, 0xb0000
    buffer_store_dwordx4 a[104:107], v238, s[56:59], s42 offen sc1
    s_add_u32 s42, s41, 0xb8000
    buffer_store_dwordx4 a[120:123], v238, s[56:59], s42 offen sc1
    s_add_u32 s42, s41, 0xc0000
    buffer_store_dwordx4 a[12:15], v238, s[56:59], s42 offen sc1
    s_add_u32 s42, s41, 0xc8000
    buffer_store_dwordx4 a[28:31], v238, s[56:59], s42 offen sc1
    s_add_u32 s42, s41, 0xd0000
    buffer_store_dwordx4 a[44:47], v238, s[56:59], s42 offen sc1
    s_add_u32 s42, s41, 0xd8000
    buffer_store_dwordx4 a[60:63], v238, s[56:59], s42 offen sc1
    s_add_u32 s42, s41, 0xe0000
    buffer_store_dwordx4 a[76:79], v238, s[56:59], s42 offen sc1
    s_add_u32 s42, s41, 0xe8000
    buffer_store_dwordx4 a[92:95], v238, s[56:59], s42 offen sc1
    s_add_u32 s42, s41, 0xf0000
    buffer_store_dwordx4 a[108:111], v238, s[56:59], s42 offen sc1
    s_add_u32 s42, s41, 0xf8000
    buffer_store_dwordx4 a[124:127], v238, s[56:59], s42 offen sc1
    s_waitcnt vmcnt(0) lgkmcnt(0)
    s_lshl_b32 s44, s2, 7
    s_add_u32 s44, s44, 65536
    s_barrier
    s_cmp_lg_u32 s3, 0
    s_cbranch_scc1 sf_f3
    v_mov_b32 v241, s70
    s_mov_b64 exec, 1
    buffer_store_dword v241, v240, s[24:27], s44 offen sc1
    s_mov_b64 exec, -1
sf_f3:
    s_lshl_b32 s71, s3, 12
    s_add_u32 m0, s71, 0x18000
    s_add_u32 s71, s71, 0x6000
    buffer_load_dwordx4 v3, s[28:31], s71 offen lds
    buffer_load_dwordx4 v3, s[28:31], s71 offen offset:1024 lds
    buffer_load_dwordx4 v3, s[28:31], s71 offen offset:2048 lds
    buffer_load_dwordx4 v3, s[28:31], s71 offen offset:3072 lds
    s_lshl_b32 s71, s3, 10
    s_add_u32 m0, s71, 0x1c000
    s_add_u32 s71, s71, 0xa000
    buffer_load_dwordx4 v3, s[28:31], s71 offen lds
    s_bfe_u32 s44, s2, 0x20001
    s_and_b32 s42, s2, 1
    s_lshl_b32 s42, s42, 2
    s_bfe_u32 s43, s2, 0x20003
    s_add_u32 s42, s42, s43
    s_lshr_b32 s43, s2, 5
    v_lshrrev_b32 v7, 4, v1
    v_lshlrev_b32 v13, 11, v7
    v_lshlrev_b32 v7, 1, v7
    v_and_b32 v5, 15, v1
    v_xor_b32 v7, v7, v5
    v_lshl_add_u32 v5, v7, 4, v13
    v_xor_b32 v6, 0x80, v5
    v_add_u32 v14, 0x3800, v5
    v_add_u32 v15, 0x5400, v6
    v_add_u32 v6, 0x1c00, v6
    s_add_u32 s48, s16, 0x0
    s_addc_u32 s49, s17, 0
    s_and_b32 s49, s49, 0xffff
    s_mov_b32 s50, 0x700000
    s_mov_b32 s51, 0x20000
    s_mul_i32 s45, s44, 1835008
    s_lshl_b32 s61, s43, 8
    s_add_u32 s61, s61, s45
    s_add_u32 s62, s61, 1835008
    s_lshl_b32 s45, s3, 17
    s_add_u32 s61, s61, s45
    s_lshl_b32 s64, s3, 13
    s_add_u32 m0, s64, 0x0
    s_nop 0
    buffer_load_dwordx4 v5, s[48:51], s61 offen lds
    buffer_load_dwordx4 v6, s[48:51], s61 offen offset:1024 lds
    buffer_load_dwordx4 v14, s[48:51], s61 offen offset:2048 lds
    buffer_load_dwordx4 v15, s[48:51], s61 offen offset:3072 lds
    s_add_u32 s61, s61, 0x8000
    s_add_u32 m0, s64, 0x1000
    s_nop 0
    buffer_load_dwordx4 v5, s[48:51], s61 offen lds
    buffer_load_dwordx4 v6, s[48:51], s61 offen offset:1024 lds
    buffer_load_dwordx4 v14, s[48:51], s61 offen offset:2048 lds
    buffer_load_dwordx4 v15, s[48:51], s61 offen offset:3072 lds
    s_add_u32 s61, s61, 0x78000
    s_cmp_ge_u32 s61, s62
    s_cselect_b32 s65, 1769472, 0
    s_cselect_b32 s62, -1, s62
    s_sub_u32 s61, s61, s65
    s_add_u32 m0, s64, 0x8000
    s_nop 0
    buffer_load_dwordx4 v5, s[48:51], s61 offen lds
    buffer_load_dwordx4 v6, s[48:51], s61 offen offset:1024 lds
    buffer_load_dwordx4 v14, s[48:51], s61 offen offset:2048 lds
    buffer_load_dwordx4 v15, s[48:51], s61 offen offset:3072 lds
    s_add_u32 s61, s61, 0x8000
    s_add_u32 m0, s64, 0x9000
    s_nop 0
    buffer_load_dwordx4 v5, s[48:51], s61 offen lds
    buffer_load_dwordx4 v6, s[48:51], s61 offen offset:1024 lds
    buffer_load_dwordx4 v14, s[48:51], s61 offen offset:2048 lds
    buffer_load_dwordx4 v15, s[48:51], s61 offen offset:3072 lds
    s_add_u32 s61, s61, 0x78000
    s_cmp_ge_u32 s61, s62
    s_cselect_b32 s65, 1769472, 0
    s_cselect_b32 s62, -1, s62
    s_sub_u32 s61, s61, s65
    s_xor_b32 s64, s64, 0x10000
    s_add_u32 m0, s64, 0x0
    s_nop 0
    buffer_load_dwordx4 v5, s[48:51], s61 offen lds
    buffer_load_dwordx4 v6, s[48:51], s61 offen offset:1024 lds
    buffer_load_dwordx4 v14, s[48:51], s61 offen offset:2048 lds
    buffer_load_dwordx4 v15, s[48:51], s61 offen offset:3072 lds
    s_add_u32 s61, s61, 0x8000
    v_lshrrev_b32 v21, 2, v1
    v_lshlrev_b32 v21, 18, v21
    v_lshl_add_u32 v21, v2, 13, v21
    v_and_b32 v22, 3, v1
    v_lshl_add_u32 v21, v22, 4, v21
    s_and_b32 s8, s2, 1
    s_lshl_b32 s8, s8, 17
    s_bfe_u32 s9, s2, 0x20003
    s_lshl_b32 s9, s9, 15
    s_add_u32 s8, s8, s9
    s_lshr_b32 s9, s2, 5
    s_lshl_b32 s9, s9, 8
    s_add_u32 s8, s8, s9
    s_bfe_u32 s9, s2, 0x20001
    s_lshl_b32 s9, s9, 6
    s_add_u32 s8, s8, s9
    s_add_u32 s9, s8, 0x1000
    s_add_u32 s12, s4, 0x0
    s_addc_u32 s13, s5, 0
    s_and_b32 s13, s13, 0xffff
    s_mov_b32 s14, 0x400000
    s_mov_b32 s15, 0x20000
    buffer_load_dwordx4 a[240:243], v21, s[12:15], s8 offen offset:0
    buffer_load_dwordx4 a[244:247], v21, s[12:15], s8 offen offset:2048
    buffer_load_dwordx4 a[248:251], v21, s[12:15], s9 offen offset:0
    buffer_load_dwordx4 a[252:255], v21, s[12:15], s9 offen offset:2048
    s_mov_b32 s46, 65536
    s_mov_b32 s68, 0x20000
pl_f3:
    s_bfm_b64 exec, 32, 0
    buffer_load_dword v244, v242, s[24:27], s46 offen sc1
    s_mov_b64 exec, -1
    s_waitcnt vmcnt(0)
    v_cmp_ne_u32 vcc, s70, v244
    s_nop 1
    s_bfm_b64 s[66:67], 32, 0
    s_and_b64 vcc, vcc, s[66:67]
    s_nop 3
    s_cbranch_vccz pd_f3
    s_sleep 4
    s_sub_u32 s68, s68, 1
    s_cmp_lg_u32 s68, 0
    s_cbranch_scc1 pl_f3
pd_f3:
    s_add_u32 s56, s22, 0xd00000
    s_addc_u32 s57, s23, 0
    s_and_b32 s57, s57, 0xffff
    s_mov_b32 s58, 0x400000
    s_mov_b32 s59, 0x20000
    v_lshrrev_b32 v7, 4, v1
    v_and_b32 v13, 7, v1
    v_xor_b32 v7, v7, v13
    v_lshlrev_b32 v7, 4, v7
    v_lshrrev_b32 v13, 3, v1
    v_lshl_add_u32 v7, v13, 8, v7
    v_xor_b32 v13, 64, v7
    s_lshr_b32 s40, s2, 1
    s_lshl_b32 s40, s40, 15
    s_and_b32 s41, s2, 1
    s_lshl_b32 s41, s41, 7
    s_add_u32 s40, s40, s41
    s_lshl_b32 s41, s3, 13
    s_add_u32 s40, s40, s41
    s_lshl_b32 s41, s3, 12
    s_add_u32 m0, s41, 0x20000
    s_nop 0
    buffer_load_dwordx4 v7, s[56:59], s40 offen sc1 lds
    s_add_u32 s40, s40, 1024
    buffer_load_dwordx4 v13, s[56:59], s40 offen offset:1024 sc1 lds
    s_add_u32 s40, s40, 1024
    buffer_load_dwordx4 v7, s[56:59], s40 offen offset:2048 sc1 lds
    s_add_u32 s40, s40, 1024
    buffer_load_dwordx4 v13, s[56:59], s40 offen offset:3072 sc1 lds
    s_add_u32 s40, s40, 1024
    s_mov_b32 s58, 0
    s_mov_b32 s55, 0
    s_mov_b32 s52, 0
    s_mov_b32 s53, 0
    s_waitcnt vmcnt(0)
    s_branch cf_end
cf_pack:
    s_nop 11
    v_and_b32 v238, 15, v1
    v_lshl_add_u32 v238, v5, 6, v238
    v_sub_u32 v239, 208, v238
    v_lshlrev_b32 v238, 3, v238
    v_lshlrev_b32 v239, 3, v239
    v_add_u32 v238, 0x20000, v238
    v_add_u32 v239, 0x20000, v239
    ds_write_b64 v238, v[104:105] offset:0
    ds_write_b64 v238, v[106:107] offset:2048
    ds_write_b64 v238, v[108:109] offset:4096
    ds_write_b64 v238, v[110:111] offset:6144
    ds_write_b64 v238, v[112:113] offset:8192
    ds_write_b64 v238, v[114:115] offset:10240
    ds_write_b64 v238, v[116:117] offset:12288
    ds_write_b64 v238, v[118:119] offset:14336
    ds_write_b64 v238, v[120:121] offset:128
    ds_write_b64 v238, v[122:123] offset:2176
    ds_write_b64 v238, v[124:125] offset:4224
    ds_write_b64 v238, v[126:127] offset:6272
    ds_write_b64 v238, v[128:129] offset:8320
    ds_write_b64 v238, v[130:131] offset:10368
    ds_write_b64 v238, v[132:133] offset:12416
    ds_write_b64 v238, v[134:135] offset:14464
    ds_write_b64 v238, v[136:137] offset:256
    ds_write_b64 v238, v[138:139] offset:2304
    ds_write_b64 v238, v[140:141] offset:4352
    ds_write_b64 v238, v[142:143] offset:6400
    ds_write_b64 v238, v[144:145] offset:8448
    ds_write_b64 v238, v[146:147] offset:10496
    ds_write_b64 v238, v[148:149] offset:12544
    ds_write_b64 v238, v[150:151] offset:14592
    ds_write_b64 v238, v[152:153] offset:384
    ds_write_b64 v238, v[154:155] offset:2432
    ds_write_b64 v238, v[156:157] offset:4480
    ds_write_b64 v238, v[158:159] offset:6528
    ds_write_b64 v238, v[160:161] offset:8576
    ds_write_b64 v238, v[162:163] offset:10624
    ds_write_b64 v238, v[164:165] offset:12672
    ds_write_b64 v238, v[166:167] offset:14720
    s_mov_b64 exec, 1
    ds_write_b64 v238, v[104:105] offset:16384
    s_mov_b64 exec, -1
    ds_read_b64 a[0:1], v239 offset:14720
    ds_read_b64 a[2:3], v239 offset:12672
    ds_read_b64 a[4:5], v239 offset:10624
    ds_read_b64 a[6:7], v239 offset:8576
    ds_read_b64 a[8:9], v239 offset:6528
    ds_read_b64 a[10:11], v239 offset:4480
    ds_read_b64 a[12:13], v239 offset:2432
    ds_read_b64 a[14:15], v239 offset:384
    ds_read_b64 a[16:17], v239 offset:14592
    ds_read_b64 a[18:19], v239 offset:12544
    ds_read_b64 a[20:21], v239 offset:10496
    ds_read_b64 a[22:23], v239 offset:8448
    ds_read_b64 a[24:25], v239 offset:6400
    ds_read_b64 a[26:27], v239 offset:4352
    ds_read_b64 a[28:29], v239 offset:2304
    ds_read_b64 a[30:31], v239 offset:256
    ds_read_b64 a[32:33], v239 offset:14464
    ds_read_b64 a[34:35], v239 offset:12416
    ds_read_b64 a[36:37], v239 offset:10368
    ds_read_b64 a[38:39], v239 offset:8320
    ds_read_b64 a[40:41], v239 offset:6272
    ds_read_b64 a[42:43], v239 offset:4224
    ds_read_b64 a[44:45], v239 offset:2176
    ds_read_b64 a[46:47], v239 offset:128
    ds_read_b64 a[48:49], v239 offset:14336
    ds_read_b64 a[50:51], v239 offset:12288
    ds_read_b64 a[52:53], v239 offset:10240
    ds_read_b64 a[54:55], v239 offset:8192
    ds_read_b64 a[56:57], v239 offset:6144
    ds_read_b64 a[58:59], v239 offset:4096
    ds_read_b64 a[60:61], v239 offset:2048
    ds_read_b64 a[62:63], v239 offset:0
    s_branch cf_mul
cf_pack2:
    s_waitcnt lgkmcnt(0)
    v_accvgpr_read_b32 v217, a208
    v_accvgpr_read_b32 v200, a0
    v_accvgpr_read_b32 v201, a1
    v_accvgpr_read_b32 v219, a212
    v_accvgpr_read_b32 v202, a2
    v_accvgpr_read_b32 v203, a3
    v_accvgpr_read_b32 v221, a216
    v_accvgpr_read_b32 v204, a4
    v_accvgpr_read_b32 v205, a5
    v_accvgpr_read_b32 v223, a220
    v_accvgpr_read_b32 v206, a6
    v_accvgpr_read_b32 v207, a7
    v_lshlrev_b32 v216, 16, v217
    v_and_b32 v217, s49, v217
    v_lshlrev_b32 v218, 16, v219
    v_and_b32 v219, s49, v219
    v_lshlrev_b32 v220, 16, v221
    v_and_b32 v221, s49, v221
    v_lshlrev_b32 v222, 16, v223
    v_and_b32 v223, s49, v223
    v_pk_fma_f32 v[104:105], v[200:201], v[216:217], v[104:105] op_sel:[0,0,0] op_sel_hi:[1,0,1] neg_hi:[1,0,0]
    v_pk_fma_f32 v[106:107], v[202:203], v[218:219], v[106:107] op_sel:[0,0,0] op_sel_hi:[1,0,1] neg_hi:[1,0,0]
    v_pk_fma_f32 v[108:109], v[204:205], v[220:221], v[108:109] op_sel:[0,0,0] op_sel_hi:[1,0,1] neg_hi:[1,0,0]
    v_pk_fma_f32 v[110:111], v[206:207], v[222:223], v[110:111] op_sel:[0,0,0] op_sel_hi:[1,0,1] neg_hi:[1,0,0]
    v_pk_fma_f32 v[104:105], v[200:201], v[216:217], v[104:105] op_sel:[1,1,0] op_sel_hi:[0,1,1]
    v_pk_fma_f32 v[106:107], v[202:203], v[218:219], v[106:107] op_sel:[1,1,0] op_sel_hi:[0,1,1]
    v_pk_fma_f32 v[108:109], v[204:205], v[220:221], v[108:109] op_sel:[1,1,0] op_sel_hi:[0,1,1]
    v_pk_fma_f32 v[110:111], v[206:207], v[222:223], v[110:111] op_sel:[1,1,0] op_sel_hi:[0,1,1]
    v_accvgpr_read_b32 v217, a224
    v_accvgpr_read_b32 v200, a8
    v_accvgpr_read_b32 v201, a9
    v_accvgpr_read_b32 v219, a228
    v_accvgpr_read_b32 v202, a10
    v_accvgpr_read_b32 v203, a11
    v_accvgpr_read_b32 v221, a232
    v_accvgpr_read_b32 v204, a12
    v_accvgpr_read_b32 v205, a13
    v_accvgpr_read_b32 v223, a236
    v_accvgpr_read_b32 v206, a14
    v_accvgpr_read_b32 v207, a15
    v_lshlrev_b32 v216, 16, v217
    v_and_b32 v217, s49, v217
    v_lshlrev_b32 v218, 16, v219
    v_and_b32 v219, s49, v219
    v_lshlrev_b32 v220, 16, v221
    v_and_b32 v221, s49, v221
    v_lshlrev_b32 v222, 16, v223
    v_and_b32 v223, s49, v223
    v_pk_fma_f32 v[112:113], v[200:201], v[216:217], v[112:113] op_sel:[0,0,0] op_sel_hi:[1,0,1] neg_hi:[1,0,0]
    v_pk_fma_f32 v[114:115], v[202:203], v[218:219], v[114:115] op_sel:[0,0,0] op_sel_hi:[1,0,1] neg_hi:[1,0,0]
    v_pk_fma_f32 v[116:117], v[204:205], v[220:221], v[116:117] op_sel:[0,0,0] op_sel_hi:[1,0,1] neg_hi:[1,0,0]
    v_pk_fma_f32 v[118:119], v[206:207], v[222:223], v[118:119] op_sel:[0,0,0] op_sel_hi:[1,0,1] neg_hi:[1,0,0]
    v_pk_fma_f32 v[112:113], v[200:201], v[216:217], v[112:113] op_sel:[1,1,0] op_sel_hi:[0,1,1]
    v_pk_fma_f32 v[114:115], v[202:203], v[218:219], v[114:115] op_sel:[1,1,0] op_sel_hi:[0,1,1]
    v_pk_fma_f32 v[116:117], v[204:205], v[220:221], v[116:117] op_sel:[1,1,0] op_sel_hi:[0,1,1]
    v_pk_fma_f32 v[118:119], v[206:207], v[222:223], v[118:119] op_sel:[1,1,0] op_sel_hi:[0,1,1]
    v_accvgpr_read_b32 v217, a209
    v_accvgpr_read_b32 v200, a16
    v_accvgpr_read_b32 v201, a17
    v_accvgpr_read_b32 v219, a213
    v_accvgpr_read_b32 v202, a18
    v_accvgpr_read_b32 v203, a19
    v_accvgpr_read_b32 v221, a217
    v_accvgpr_read_b32 v204, a20
    v_accvgpr_read_b32 v205, a21
    v_accvgpr_read_b32 v223, a221
    v_accvgpr_read_b32 v206, a22
    v_accvgpr_read_b32 v207, a23
    v_lshlrev_b32 v216, 16, v217
    v_and_b32 v217, s49, v217
    v_lshlrev_b32 v218, 16, v219
    v_and_b32 v219, s49, v219
    v_lshlrev_b32 v220, 16, v221
    v_and_b32 v221, s49, v221
    v_lshlrev_b32 v222, 16, v223
    v_and_b32 v223, s49, v223
    v_pk_fma_f32 v[120:121], v[200:201], v[216:217], v[120:121] op_sel:[0,0,0] op_sel_hi:[1,0,1] neg_hi:[1,0,0]
    v_pk_fma_f32 v[122:123], v[202:203], v[218:219], v[122:123] op_sel:[0,0,0] op_sel_hi:[1,0,1] neg_hi:[1,0,0]
    v_pk_fma_f32 v[124:125], v[204:205], v[220:221], v[124:125] op_sel:[0,0,0] op_sel_hi:[1,0,1] neg_hi:[1,0,0]
    v_pk_fma_f32 v[126:127], v[206:207], v[222:223], v[126:127] op_sel:[0,0,0] op_sel_hi:[1,0,1] neg_hi:[1,0,0]
    v_pk_fma_f32 v[120:121], v[200:201], v[216:217], v[120:121] op_sel:[1,1,0] op_sel_hi:[0,1,1]
    v_pk_fma_f32 v[122:123], v[202:203], v[218:219], v[122:123] op_sel:[1,1,0] op_sel_hi:[0,1,1]
    v_pk_fma_f32 v[124:125], v[204:205], v[220:221], v[124:125] op_sel:[1,1,0] op_sel_hi:[0,1,1]
    v_pk_fma_f32 v[126:127], v[206:207], v[222:223], v[126:127] op_sel:[1,1,0] op_sel_hi:[0,1,1]
    v_accvgpr_read_b32 v217, a225
    v_accvgpr_read_b32 v200, a24
    v_accvgpr_read_b32 v201, a25
    v_accvgpr_read_b32 v219, a229
    v_accvgpr_read_b32 v202, a26
    v_accvgpr_read_b32 v203, a27
    v_accvgpr_read_b32 v221, a233
    v_accvgpr_read_b32 v204, a28
    v_accvgpr_read_b32 v205, a29
    v_accvgpr_read_b32 v223, a237
    v_accvgpr_read_b32 v206, a30
    v_accvgpr_read_b32 v207, a31
    v_lshlrev_b32 v216, 16, v217
    v_and_b32 v217, s49, v217
    v_lshlrev_b32 v218, 16, v219
    v_and_b32 v219, s49, v219
    v_lshlrev_b32 v220, 16, v221
    v_and_b32 v221, s49, v221
    v_lshlrev_b32 v222, 16, v223
    v_and_b32 v223, s49, v223
    v_pk_fma_f32 v[128:129], v[200:201], v[216:217], v[128:129] op_sel:[0,0,0] op_sel_hi:[1,0,1] neg_hi:[1,0,0]
    v_pk_fma_f32 v[130:131], v[202:203], v[218:219], v[130:131] op_sel:[0,0,0] op_sel_hi:[1,0,1] neg_hi:[1,0,0]
    v_pk_fma_f32 v[132:133], v[204:205], v[220:221], v[132:133] op_sel:[0,0,0] op_sel_hi:[1,0,1] neg_hi:[1,0,0]
    v_pk_fma_f32 v[134:135], v[206:207], v[222:223], v[134:135] op_sel:[0,0,0] op_sel_hi:[1,0,1] neg_hi:[1,0,0]
    v_pk_fma_f32 v[128:129], v[200:201], v[216:217], v[128:129] op_sel:[1,1,0] op_sel_hi:[0,1,1]
    v_pk_fma_f32 v[130:131], v[202:203], v[218:219], v[130:131] op_sel:[1,1,0] op_sel_hi:[0,1,1]
    v_pk_fma_f32 v[132:133], v[204:205], v[220:221], v[132:133] op_sel:[1,1,0] op_sel_hi:[0,1,1]
    v_pk_fma_f32 v[134:135], v[206:207], v[222:223], v[134:135] op_sel:[1,1,0] op_sel_hi:[0,1,1]
    v_accvgpr_read_b32 v217, a210
    v_accvgpr_read_b32 v200, a32
    v_accvgpr_read_b32 v201, a33
    v_accvgpr_read_b32 v219, a214
    v_accvgpr_read_b32 v202, a34
    v_accvgpr_read_b32 v203, a35
    v_accvgpr_read_b32 v221, a218
    v_accvgpr_read_b32 v204, a36
    v_accvgpr_read_b32 v205, a37
    v_accvgpr_read_b32 v223, a222
    v_accvgpr_read_b32 v206, a38
    v_accvgpr_read_b32 v207, a39
    v_lshlrev_b32 v216, 16, v217
    v_and_b32 v217, s49, v217
    v_lshlrev_b32 v218, 16, v219
    v_and_b32 v219, s49, v219
    v_lshlrev_b32 v220, 16, v221
    v_and_b32 v221, s49, v221
    v_lshlrev_b32 v222, 16, v223
    v_and_b32 v223, s49, v223
    v_pk_fma_f32 v[136:137], v[200:201], v[216:217], v[136:137] op_sel:[0,0,0] op_sel_hi:[1,0,1] neg_hi:[1,0,0]
    v_pk_fma_f32 v[138:139], v[202:203], v[218:219], v[138:139] op_sel:[0,0,0] op_sel_hi:[1,0,1] neg_hi:[1,0,0]
    v_pk_fma_f32 v[140:141], v[204:205], v[220:221], v[140:141] op_sel:[0,0,0] op_sel_hi:[1,0,1] neg_hi:[1,0,0]
    v_pk_fma_f32 v[142:143], v[206:207], v[222:223], v[142:143] op_sel:[0,0,0] op_sel_hi:[1,0,1] neg_hi:[1,0,0]
    v_pk_fma_f32 v[136:137], v[200:201], v[216:217], v[136:137] op_sel:[1,1,0] op_sel_hi:[0,1,1]
    v_pk_fma_f32 v[138:139], v[202:203], v[218:219], v[138:139] op_sel:[1,1,0] op_sel_hi:[0,1,1]
    v_pk_fma_f32 v[140:141], v[204:205], v[220:221], v[140:141] op_sel:[1,1,0] op_sel_hi:[0,1,1]
    v_pk_fma_f32 v[142:143], v[206:207], v[222:223], v[142:143] op_sel:[1,1,0] op_sel_hi:[0,1,1]
    v_accvgpr_read_b32 v217, a226
    v_accvgpr_read_b32 v200, a40
    v_accvgpr_read_b32 v201, a41
    v_accvgpr_read_b32 v219, a230
    v_accvgpr_read_b32 v202, a42
    v_accvgpr_read_b32 v203, a43
    v_accvgpr_read_b32 v221, a234
    v_accvgpr_read_b32 v204, a44
    v_accvgpr_read_b32 v205, a45
    v_accvgpr_read_b32 v223, a238
    v_accvgpr_read_b32 v206, a46
    v_accvgpr_read_b32 v207, a47
    v_lshlrev_b32 v216, 16, v217
    v_and_b32 v217, s49, v217
    v_lshlrev_b32 v218, 16, v219
    v_and_b32 v219, s49, v219
    v_lshlrev_b32 v220, 16, v221
    v_and_b32 v221, s49, v221
    v_lshlrev_b32 v222, 16, v223
    v_and_b32 v223, s49, v223
    v_pk_fma_f32 v[144:145], v[200:201], v[216:217], v[144:145] op_sel:[0,0,0] op_sel_hi:[1,0,1] neg_hi:[1,0,0]
    v_pk_fma_f32 v[146:147], v[202:203], v[218:219], v[146:147] op_sel:[0,0,0] op_sel_hi:[1,0,1] neg_hi:[1,0,0]
    v_pk_fma_f32 v[148:149], v[204:205], v[220:221], v[148:149] op_sel:[0,0,0] op_sel_hi:[1,0,1] neg_hi:[1,0,0]
    v_pk_fma_f32 v[150:151], v[206:207], v[222:223], v[150:151] op_sel:[0,0,0] op_sel_hi:[1,0,1] neg_hi:[1,0,0]
    v_pk_fma_f32 v[144:145], v[200:201], v[216:217], v[144:145] op_sel:[1,1,0] op_sel_hi:[0,1,1]
    v_pk_fma_f32 v[146:147], v[202:203], v[218:219], v[146:147] op_sel:[1,1,0] op_sel_hi:[0,1,1]
    v_pk_fma_f32 v[148:149], v[204:205], v[220:221], v[148:149] op_sel:[1,1,0] op_sel_hi:[0,1,1]
    v_pk_fma_f32 v[150:151], v[206:207], v[222:223], v[150:151] op_sel:[1,1,0] op_sel_hi:[0,1,1]
    v_accvgpr_read_b32 v217, a211
    v_accvgpr_read_b32 v200, a48
    v_accvgpr_read_b32 v201, a49
    v_accvgpr_read_b32 v219, a215
    v_accvgpr_read_b32 v202, a50
    v_accvgpr_read_b32 v203, a51
    v_accvgpr_read_b32 v221, a219
    v_accvgpr_read_b32 v204, a52
    v_accvgpr_read_b32 v205, a53
    v_accvgpr_read_b32 v223, a223
    v_accvgpr_read_b32 v206, a54
    v_accvgpr_read_b32 v207, a55
    v_lshlrev_b32 v216, 16, v217
    v_and_b32 v217, s49, v217
    v_lshlrev_b32 v218, 16, v219
    v_and_b32 v219, s49, v219
    v_lshlrev_b32 v220, 16, v221
    v_and_b32 v221, s49, v221
    v_lshlrev_b32 v222, 16, v223
    v_and_b32 v223, s49, v223
    v_pk_fma_f32 v[152:153], v[200:201], v[216:217], v[152:153] op_sel:[0,0,0] op_sel_hi:[1,0,1] neg_hi:[1,0,0]
    v_pk_fma_f32 v[154:155], v[202:203], v[218:219], v[154:155] op_sel:[0,0,0] op_sel_hi:[1,0,1] neg_hi:[1,0,0]
    v_pk_fma_f32 v[156:157], v[204:205], v[220:221], v[156:157] op_sel:[0,0,0] op_sel_hi:[1,0,1] neg_hi:[1,0,0]
    v_pk_fma_f32 v[158:159], v[206:207], v[222:223], v[158:159] op_sel:[0,0,0] op_sel_hi:[1,0,1] neg_hi:[1,0,0]
    v_pk_fma_f32 v[152:153], v[200:201], v[216:217], v[152:153] op_sel:[1,1,0] op_sel_hi:[0,1,1]
    v_pk_fma_f32 v[154:155], v[202:203], v[218:219], v[154:155] op_sel:[1,1,0] op_sel_hi:[0,1,1]
    v_pk_fma_f32 v[156:157], v[204:205], v[220:221], v[156:157] op_sel:[1,1,0] op_sel_hi:[0,1,1]
    v_pk_fma_f32 v[158:159], v[206:207], v[222:223], v[158:159] op_sel:[1,1,0] op_sel_hi:[0,1,1]
    v_accvgpr_read_b32 v217, a227
    v_accvgpr_read_b32 v200, a56
    v_accvgpr_read_b32 v201, a57
    v_accvgpr_read_b32 v219, a231
    v_accvgpr_read_b32 v202, a58
    v_accvgpr_read_b32 v203, a59
    v_accvgpr_read_b32 v221, a235
    v_accvgpr_read_b32 v204, a60
    v_accvgpr_read_b32 v205, a61
    v_accvgpr_read_b32 v223, a239
    v_accvgpr_read_b32 v206, a62
    v_accvgpr_read_b32 v207, a63
    v_lshlrev_b32 v216, 16, v217
    v_and_b32 v217, s49, v217
    v_lshlrev_b32 v218, 16, v219
    v_and_b32 v219, s49, v219
    v_lshlrev_b32 v220, 16, v221
    v_and_b32 v221, s49, v221
    v_lshlrev_b32 v222, 16, v223
    v_and_b32 v223, s49, v223
    v_pk_fma_f32 v[160:161], v[200:201], v[216:217], v[160:161] op_sel:[0,0,0] op_sel_hi:[1,0,1] neg_hi:[1,0,0]
    v_pk_fma_f32 v[162:163], v[202:203], v[218:219], v[162:163] op_sel:[0,0,0] op_sel_hi:[1,0,1] neg_hi:[1,0,0]
    v_pk_fma_f32 v[164:165], v[204:205], v[220:221], v[164:165] op_sel:[0,0,0] op_sel_hi:[1,0,1] neg_hi:[1,0,0]
    v_pk_fma_f32 v[166:167], v[206:207], v[222:223], v[166:167] op_sel:[0,0,0] op_sel_hi:[1,0,1] neg_hi:[1,0,0]
    v_pk_fma_f32 v[160:161], v[200:201], v[216:217], v[160:161] op_sel:[1,1,0] op_sel_hi:[0,1,1]
    v_pk_fma_f32 v[162:163], v[202:203], v[218:219], v[162:163] op_sel:[1,1,0] op_sel_hi:[0,1,1]
    v_pk_fma_f32 v[164:165], v[204:205], v[220:221], v[164:165] op_sel:[1,1,0] op_sel_hi:[0,1,1]
    v_pk_fma_f32 v[166:167], v[206:207], v[222:223], v[166:167] op_sel:[1,1,0] op_sel_hi:[0,1,1]
    s_nop 1
    s_branch cf_mul_done
cf_end:
    s_branch k_g2
k_done:
    s_endpgm
.section .rodata,"a"
.p2align 6
.amdhsa_kernel recurrent_scan__spectral_gfnet__geglu_ffn__prompt_kernel
  .amdhsa_next_free_vgpr 512
  .amdhsa_next_free_sgpr 100
  .amdhsa_accum_offset 256
  .amdhsa_group_segment_fixed_size 0
  .amdhsa_kernarg_size 80
  .amdhsa_user_sgpr_count 2
  .amdhsa_user_sgpr_kernarg_segment_ptr 1
  .amdhsa_system_sgpr_workgroup_id_x 1
  .amdhsa_float_denorm_mode_32 3
.end_amdhsa_kernel
.section .rodata,"a"
.p2align 8
.type gf_tab,@object
gf_tab:
.long 0x3f803f80,0x3f803f80,0x3f803f80,0x3f803f80,0x3f7b3f80,0x3f553f6d,0xbf7bbf80,0xbf55bf6d
.long 0x3f6d3f80,0x3ec43f35,0x3f6d3f80,0x3ec43f35,0x3f553f80,0xbe483ec4,0xbf55bf80,0x3e48bec4
.long 0x3f353f80,0xbf350000,0x3f353f80,0xbf350000,0x3f0e3f80,0xbf7bbec4,0xbf0ebf80,0x3f7b3ec4
.long 0x3ec43f80,0xbf6dbf35,0x3ec43f80,0xbf6dbf35,0x3e483f80,0xbf0ebf6d,0xbe48bf80,0x3f0e3f6d
.long 0x3f80,0xbf80,0x3f80,0xbf80,0xbe483f80,0x3f0ebf6d,0x3e48bf80,0xbf0e3f6d
.long 0xbec43f80,0x3f6dbf35,0xbec43f80,0x3f6dbf35,0xbf0e3f80,0x3f7bbec4,0x3f0ebf80,0xbf7b3ec4
.long 0xbf353f80,0x3f350000,0xbf353f80,0x3f350000,0xbf553f80,0x3e483ec4,0x3f55bf80,0xbe48bec4
.long 0xbf6d3f80,0xbec43f35,0xbf6d3f80,0xbec43f35,0xbf7b3f80,0xbf553f6d,0x3f7bbf80,0x3f55bf6d
.long 0x3f803f80,0x3f803f80,0x3f803f80,0x3f803f80,0x3f0e3f35,0x3e483ec4,0xbf0ebf35,0xbe48bec4
.long 0xbec40000,0xbf6dbf35,0xbec40000,0xbf6dbf35,0xbf7bbf35,0xbf0ebf6d,0x3f7b3f35,0x3f0e3f6d
.long 0xbf35bf80,0x3f350000,0xbf35bf80,0x3f350000,0x3e48bf35,0x3f553f6d,0xbe483f35,0xbf55bf6d
.long 0x3f6d0000,0xbec43f35,0x3f6d0000,0xbec43f35,0x3f553f35,0xbf7bbec4,0xbf55bf35,0x3f7b3ec4
.long 0x3f80,0xbf80,0x3f80,0xbf80,0xbf553f35,0x3f7bbec4,0x3f55bf35,0xbf7b3ec4
.long 0xbf6d0000,0x3ec43f35,0xbf6d0000,0x3ec43f35,0xbe48bf35,0xbf553f6d,0x3e483f35,0x3f55bf6d
.long 0x3f35bf80,0xbf350000,0x3f35bf80,0xbf350000,0x3f7bbf35,0x3f0ebf6d,0xbf7b3f35,0xbf0e3f6d
.long 0x3ec40000,0x3f6dbf35,0x3ec40000,0x3f6dbf35,0xbf0e3f35,0xbe483ec4,0x3f0ebf35,0x3e48bec4
.long 0x3f803f80,0x3f803f80,0x3f803f80,0x3f803f80,0xbe480000,0xbf0ebec4,0x3e480000,0x3f0e3ec4
.long 0xbf6dbf80,0xbec4bf35,0xbf6dbf80,0xbec4bf35,0x3f0e0000,0x3f7b3f6d,0xbf0e0000,0xbf7bbf6d
.long 0x3f353f80,0xbf350000,0x3f353f80,0xbf350000,0xbf550000,0xbe48bf6d,0x3f550000,0x3e483f6d
.long 0xbec4bf80,0x3f6d3f35,0xbec4bf80,0x3f6d3f35,0x3f7b0000,0xbf553ec4,0xbf7b0000,0x3f55bec4
.long 0x3f80,0xbf80,0x3f80,0xbf80,0xbf7b0000,0x3f553ec4,0x3f7b0000,0xbf55bec4
.long 0x3ec4bf80,0xbf6d3f35,0x3ec4bf80,0xbf6d3f35,0x3f550000,0x3e48bf6d,0xbf550000,0xbe483f6d
.long 0xbf353f80,0x3f350000,0xbf353f80,0x3f350000,0xbf0e0000,0xbf7b3f6d,0x3f0e0000,0x3f7bbf6d
.long 0x3f6dbf80,0x3ec4bf35,0x3f6dbf80,0x3ec4bf35,0x3e480000,0x3f0ebec4,0xbe480000,0xbf0e3ec4
.long 0x3f803f80,0x3f803f80,0x3f803f80,0x3f803f80,0xbf55bf35,0xbf7bbf6d,0x3f553f35,0x3f7b3f6d
.long 0x3ec40000,0x3f6d3f35,0x3ec40000,0x3f6d3f35,0x3e483f35,0xbf55bec4,0xbe48bf35,0x3f553ec4
.long 0xbf35bf80,0x3f350000,0xbf35bf80,0x3f350000,0x3f7b3f35,0xbf0e3ec4,0xbf7bbf35,0x3f0ebec4
.long 0xbf6d0000,0x3ec4bf35,0xbf6d0000,0x3ec4bf35,0x3f0ebf35,0xbe483f6d,0xbf0e3f35,0x3e48bf6d
.long 0x3f80,0xbf80,0x3f80,0xbf80,0xbf0ebf35,0x3e483f6d,0x3f0e3f35,0xbe48bf6d
.long 0x3f6d0000,0xbec4bf35,0x3f6d0000,0xbec4bf35,0xbf7b3f35,0x3f0e3ec4,0x3f7bbf35,0xbf0ebec4
.long 0x3f35bf80,0xbf350000,0x3f35bf80,0xbf350000,0xbe483f35,0x3f55bec4,0x3e48bf35,0xbf553ec4
.long 0xbec40000,0xbf6d3f35,0xbec40000,0xbf6d3f35,0x3f55bf35,0x3f7bbf6d,0xbf553f35,0xbf7b3f6d
.long 0xbf803f80,0xbf803f80,0xbf803f80,0xbf803f80,0xbe488000,0xbf0ebec4,0x3e488000,0x3f0e3ec4
.long 0xbec48000,0xbf6dbf35,0xbec48000,0xbf6dbf35,0xbf0e8000,0xbf7bbf6d,0x3f0e8000,0x3f7b3f6d
.long 0xbf358000,0xbf35bf80,0xbf358000,0xbf35bf80,0xbf558000,0xbe48bf6d,0x3f558000,0x3e483f6d
.long 0xbf6d8000,0x3ec4bf35,0xbf6d8000,0x3ec4bf35,0xbf7b8000,0x3f55bec4,0x3f7b8000,0xbf553ec4
.long 0xbf808000,0x3f808000,0xbf808000,0x3f808000,0xbf7b8000,0x3f553ec4,0x3f7b8000,0xbf55bec4
.long 0xbf6d8000,0x3ec43f35,0xbf6d8000,0x3ec43f35,0xbf558000,0xbe483f6d,0x3f558000,0x3e48bf6d
.long 0xbf358000,0xbf353f80,0xbf358000,0xbf353f80,0xbf0e8000,0xbf7b3f6d,0x3f0e8000,0x3f7bbf6d
.long 0xbec48000,0xbf6d3f35,0xbec48000,0xbf6d3f35,0xbe488000,0xbf0e3ec4,0x3e488000,0x3f0ebec4
.long 0xbf803f80,0xbf803f80,0xbf803f80,0xbf803f80,0xbf55bf35,0xbf7bbf6d,0x3f553f35,0x3f7b3f6d
.long 0xbf6dbf80,0xbec4bf35,0xbf6dbf80,0xbec4bf35,0xbe48bf35,0x3f553ec4,0x3e483f35,0xbf55bec4
.long 0x3f358000,0x3f353f80,0x3f358000,0x3f353f80,0x3f7b3f35,0xbf0e3ec4,0xbf7bbf35,0x3f0ebec4
.long 0x3ec43f80,0xbf6dbf35,0x3ec43f80,0xbf6dbf35,0xbf0e3f35,0x3e48bf6d,0x3f0ebf35,0xbe483f6d
.long 0xbf808000,0x3f808000,0xbf808000,0x3f808000,0xbf0ebf35,0x3e483f6d,0x3f0e3f35,0xbe48bf6d
.long 0x3ec4bf80,0xbf6d3f35,0x3ec4bf80,0xbf6d3f35,0x3f7bbf35,0xbf0ebec4,0xbf7b3f35,0x3f0e3ec4
.long 0x3f358000,0x3f35bf80,0x3f358000,0x3f35bf80,0xbe483f35,0x3f55bec4,0x3e48bf35,0xbf553ec4
.long 0xbf6d3f80,0xbec43f35,0xbf6d3f80,0xbec43f35,0xbf553f35,0xbf7b3f6d,0x3f55bf35,0x3f7bbf6d
.long 0xbf803f80,0xbf803f80,0xbf803f80,0xbf803f80,0xbf7bbf80,0xbf55bf6d,0x3f7b3f80,0x3f553f6d
.long 0x3ec48000,0x3f6d3f35,0x3ec48000,0x3f6d3f35,0x3f553f80,0xbe483ec4,0xbf55bf80,0x3e48bec4
.long 0xbf358000,0xbf35bf80,0xbf358000,0xbf35bf80,0xbf0ebf80,0x3f7b3ec4,0x3f0e3f80,0xbf7bbec4
.long 0x3f6d8000,0xbec43f35,0x3f6d8000,0xbec43f35,0x3e483f80,0xbf0ebf6d,0xbe48bf80,0x3f0e3f6d
.long 0xbf808000,0x3f808000,0xbf808000,0x3f808000,0x3e48bf80,0xbf0e3f6d,0xbe483f80,0x3f0ebf6d
.long 0x3f6d8000,0xbec4bf35,0x3f6d8000,0xbec4bf35,0xbf0e3f80,0x3f7bbec4,0x3f0ebf80,0xbf7b3ec4
.long 0xbf358000,0xbf353f80,0xbf358000,0xbf353f80,0x3f55bf80,0xbe48bec4,0xbf553f80,0x3e483ec4
.long 0x3ec48000,0x3f6dbf35,0x3ec48000,0x3f6dbf35,0xbf7b3f80,0xbf553f6d,0x3f7bbf80,0x3f55bf6d
.long 0xbf803f80,0xbf803f80,0xbf803f80,0xbf803f80,0xbf0ebf35,0xbe48bec4,0x3f0e3f35,0x3e483ec4
.long 0x3f6d3f80,0x3ec43f35,0x3f6d3f80,0x3ec43f35,0xbf7bbf35,0xbf0ebf6d,0x3f7b3f35,0x3f0e3f6d
.long 0x3f358000,0x3f353f80,0x3f358000,0x3f353f80,0xbe483f35,0xbf55bf6d,0x3e48bf35,0x3f553f6d
.long 0xbec4bf80,0x3f6d3f35,0xbec4bf80,0x3f6d3f35,0x3f553f35,0xbf7bbec4,0xbf55bf35,0x3f7b3ec4
.long 0xbf808000,0x3f808000,0xbf808000,0x3f808000,0x3f55bf35,0xbf7b3ec4,0xbf553f35,0x3f7bbec4
.long 0xbec43f80,0x3f6dbf35,0xbec43f80,0x3f6dbf35,0xbe48bf35,0xbf553f6d,0x3e483f35,0x3f55bf6d
.long 0x3f358000,0x3f35bf80,0x3f358000,0x3f35bf80,0xbf7b3f35,0xbf0e3f6d,0x3f7bbf35,0x3f0ebf6d
.long 0x3f6dbf80,0x3ec4bf35,0x3f6dbf80,0x3ec4bf35,0xbf0e3f35,0xbe483ec4,0x3f0ebf35,0x3e48bec4
.long 0x3f800000,0x3f800000,0x3f800000,0x3f800000,0x3f800000,0x3f7ffec4,0x3f7ffb11,0x3f7ff4e6
.long 0x3f800000,0x3f7ffb11,0x3f7fec43,0x3f7fd397,0x3f800000,0x3f7ff4e6,0x3f7fd397,0x3f7f9c18
.long 0x3f800000,0x3f7fec43,0x3f7fb10f,0x3f7f4e6d,0x3f800000,0x3f7fe129,0x3f7f84ab,0x3f7eea9d
.long 0x3f800000,0x3f7fd397,0x3f7f4e6d,0x3f7e70b0,0x3f800000,0x3f7fc38f,0x3f7f0e58,0x3f7de0b1
.long 0x3f800000,0x3f7fb10f,0x3f7ec46d,0x3f7d3aac,0x3f800000,0x3f7f9c18,0x3f7e70b0,0x3f7c7eb0
.long 0x3f800000,0x3f7f84ab,0x3f7e1324,0x3f7baccd,0x3f800000,0x3f7f6ac7,0x3f7dabcc,0x3f7ac516
.long 0x3f800000,0x3f7f4e6d,0x3f7d3aac,0x3f79c79d,0x3f800000,0x3f7f2f9d,0x3f7cbfc9,0x3f78b47b
.long 0x3f800000,0x3f7f0e58,0x3f7c3b28,0x3f778bc5,0x3f800000,0x3f7eea9d,0x3f7baccd,0x3f764d97
.long 0x3f800000,0x3f800000,0x3f800000,0x3f800000,0x3f7fec43,0x3f7fe129,0x3f7fd397,0x3f7fc38f
.long 0x3f7fb10f,0x3f7f84ab,0x3f7f4e6d,0x3f7f0e58,0x3f7f4e6d,0x3f7eea9d,0x3f7e70b0,0x3f7de0b1
.long 0x3f7ec46d,0x3f7e1324,0x3f7d3aac,0x3f7c3b28,0x3f7e1324,0x3f7cfe73,0x3f7baccd,0x3f7a1e84
.long 0x3f7d3aac,0x3f7baccd,0x3f79c79d,0x3f778bc5,0x3f7c3b28,0x3f7a1e84,0x3f778bc5,0x3f748422
.long 0x3f7b14be,0x3f7853f8,0x3f74fa0b,0x3f710908,0x3f79c79d,0x3f764d97,0x3f721352,0x3f6d1c1d
.long 0x3f7853f8,0x3f740bdd,0x3f6ed89e,0x3f68bf3c,0x3f76ba07,0x3f718f57,0x3f6b4b0c,0x3f63f473
.long 0x3f74fa0b,0x3f6ed89e,0x3f676bd8,0x3f5ebe05,0x3f731447,0x3f6be858,0x3f633c5a,0x3f591e6a
.long 0x3f710908,0x3f68bf3c,0x3f5ebe05,0x3f531849,0x3f6ed89e,0x3f655e0b,0x3f59f26a,0x3f4cae79
.long 0x3f800000,0x3f800000,0x3f800000,0x3f800000,0x3f7fb10f,0x3f7f9c18,0x3f7f84ab,0x3f7f6ac7
.long 0x3f7ec46d,0x3f7e70b0,0x3f7e1324,0x3f7dabcc,0x3f7d3aac,0x3f7c7eb0,0x3f7baccd,0x3f7ac516
.long 0x3f7b14be,0x3f79c79d,0x3f7853f8,0x3f76ba07,0x3f7853f8,0x3f764d97,0x3f740bdd,0x3f718f57
.long 0x3f74fa0b,0x3f721352,0x3f6ed89e,0x3f6b4b0c,0x3f710908,0x3f6d1c1d,0x3f68bf3c,0x3f63f473
.long 0x3f6c835e,0x3f676bd8,0x3f61c598,0x3f5b941a,0x3f676bd8,0x3f6106f2,0x3f59f26a,0x3f5233c6
.long 0x3f61c598,0x3f59f26a,0x3f514d3d,0x3f47de65,0x3f5b941a,0x3f5233c6,0x3f47de65,0x3f3ca003
.long 0x3f54db31,0x3f49d112,0x3f3daef9,0x3f3085bb,0x3f4d9f02,0x3f40d0da,0x3f32c8c9,0x3f239da9
.long 0x3f45e403,0x3f373a23,0x3f273656,0x3f15f6d9,0x3f3daef9,0x3f2d1469,0x3f1b02c6,0x3f07a136
.long 0x3f800000,0x3f800000,0x3f800000,0x3f800000,0x3f7f4e6d,0x3f7f2f9d,0x3f7f0e58,0x3f7eea9d
.long 0x3f7d3aac,0x3f7cbfc9,0x3f7c3b28,0x3f7baccd,0x3f79c79d,0x3f78b47b,0x3f778bc5,0x3f764d97
.long 0x3f74fa0b,0x3f731447,0x3f710908,0x3f6ed89e,0x3f6ed89e,0x3f6be858,0x3f68bf3c,0x3f655e0b
.long 0x3f676bd8,0x3f633c5a,0x3f5ebe05,0x3f59f26a,0x3f5ebe05,0x3f591e6a,0x3f531849,0x3f4cae79
.long 0x3f54db31,0x3f4d9f02,0x3f45e403,0x3f3daef9,0x3f49d112,0x3f40d0da,0x3f373a23,0x3f2d1469
.long 0x3f3daef9,0x3f32c8c9,0x3f273656,0x3f1b02c6,0x3f3085bb,0x3f239da9,0x3f15f6d9,0x3f07a136
.long 0x3f226799,0x3f13682a,0x3f039c3d,0x3ee63375,0x3f13682a,0x3f0242b1,0x3ee0924f,0x3ebb31a0
.long 0x3f039c3d,0x3ee0924f,0x3eb8442a,0x3e8e9a22,0x3ee63375,0x3ebb31a0,0x3e8e9a22,0x3e419b37
.long 0x0,0x0,0x0,0x0,0x0,0x3bc90f88,0x3c490e90,0x3c96c9b6
.long 0x0,0x3c490e90,0x3cc90ab0,0x3d16c32c,0x0,0x3c96c9b6,0x3d16c32c,0x3d621469
.long 0x0,0x3cc90ab0,0x3d48fb30,0x3d96a905,0x0,0x3cfb49ba,0x3d7b2b74,0x3dbc3ac3
.long 0x0,0x3d16c32c,0x3d96a905,0x3de1bc2e,0x0,0x3d2fe007,0x3dafb680,0x3e039502
.long 0x0,0x3d48fb30,0x3dc8bd36,0x3e164083,0x0,0x3d621469,0x3de1bc2e,0x3e28defc
.long 0x0,0x3d7b2b74,0x3dfab273,0x3e3b6ecf,0x0,0x3d8a200a,0x3e09cf86,0x3e4dee60
.long 0x0,0x3d96a905,0x3e164083,0x3e605c13,0x0,0x3da3308c,0x3e22abb6,0x3e72b651
.long 0x0,0x3dafb680,0x3e2f10a2,0x3e827dc0,0x0,0x3dbc3ac3,0x3e3b6ecf,0x3e8b9507
.long 0x0,0x0,0x0,0x0,0x3cc90ab0,0x3cfb49ba,0x3d16c32c,0x3d2fe007
.long 0x3d48fb30,0x3d7b2b74,0x3d96a905,0x3dafb680,0x3d96a905,0x3dbc3ac3,0x3de1bc2e,0x3e039502
.long 0x3dc8bd36,0x3dfab273,0x3e164083,0x3e2f10a2,0x3dfab273,0x3e1c76de,0x3e3b6ecf,0x3e5a3997
.long 0x3e164083,0x3e3b6ecf,0x3e605c13,0x3e827dc0,0x3e2f10a2,0x3e5a3997,0x3e827dc0,0x3e97a117
.long 0x3e47c5c2,0x3e78cfcc,0x3e94a031,0x3eac7cd4,0x3e605c13,0x3e8b9507,0x3ea68f12,0x3ec1071e
.long 0x3e78cfcc,0x3e9aa086,0x3eb8442a,0x3ed53641,0x3e888e93,0x3ea986c4,0x3ec9b953,0x3ee900b7
.long 0x3e94a031,0x3eb8442a,0x3edae880,0x3efc5d27,0x3ea09ae5,0x3ec6d529,0x3eebcbbb,0x3f07a136
.long 0x3eac7cd4,0x3ed53641,0x3efc5d27,0x3f10d3cd,0x3eb8442a,0x3ee363fa,0x3f064b82,0x3f19c200
.long 0x0,0x0,0x0,0x0,0x3d48fb30,0x3d621469,0x3d7b2b74,0x3d8a200a
.long 0x3dc8bd36,0x3de1bc2e,0x3dfab273,0x3e09cf86,0x3e164083,0x3e28defc,0x3e3b6ecf,0x3e4dee60
.long 0x3e47c5c2,0x3e605c13,0x3e78cfcc,0x3e888e93,0x3e78cfcc,0x3e8b9507,0x3e9aa086,0x3ea986c4
.long 0x3e94a031,0x3ea68f12,0x3eb8442a,0x3ec9b953,0x3eac7cd4,0x3ec1071e,0x3ed53641,0x3ee900b7
.long 0x3ec3ef15,0x3edae880,0x3ef15aea,0x3f039c3d,0x3edae880,0x3ef41f07,0x3f064b82,0x3f121eb0
.long 0x3ef15aea,0x3f064b82,0x3f13682a,0x3f1ff6cb,0x3f039c3d,0x3f121eb0,0x3f1ff6cb,0x3f2d1469
.long 0x3f0e39da,0x3f1d7fd1,0x3f2beb4a,0x3f396842,0x3f187fc0,0x3f286605,0x3f373a23,0x3f44e3f5
.long 0x3f226799,0x3f32c8c9,0x3f41d870,0x3f4f7a1f,0x3f2beb4a,0x3f3ca003,0x3f4bbbf8,0x3f591e6a
.long 0x0,0x0,0x0,0x0,0x3d96a905,0x3da3308c,0x3dafb680,0x3dbc3ac3
.long 0x3e164083,0x3e22abb6,0x3e2f10a2,0x3e3b6ecf,0x3e605c13,0x3e72b651,0x3e827dc0,0x3e8b9507
.long 0x3e94a031,0x3ea09ae5,0x3eac7cd4,0x3eb8442a,0x3eb8442a,0x3ec6d529,0x3ed53641,0x3ee363fa
.long 0x3edae880,0x3eebcbbb,0x3efc5d27,0x3f064b82,0x3efc5d27,0x3f07a136,0x3f10d3cd,0x3f19c200
.long 0x3f0e39da,0x3f187fc0,0x3f226799,0x3f2beb4a,0x3f1d7fd1,0x3f286605,0x3f32c8c9,0x3f3ca003
.long 0x3f2beb4a,0x3f373a23,0x3f41d870,0x3f4bbbf8,0x3f396842,0x3f44e3f5,0x3f4f7a1f,0x3f591e6a
.long 0x3f45e403,0x3f514d3d,0x3f5b941a,0x3f64aa59,0x3f514d3d,0x3f5c61c7,0x3f660f88,0x3f6e46be
.long 0x3f5b941a,0x3f660f88,0x3f6ed89e,0x3f75dec6,0x3f64aa59,0x3f6e46be,0x3f75dec6,0x3f7b61fc
.long 0x3f800000,0x3f800000,0x3f800000,0x3f800000,0x3f7ec46d,0x3f7e9bc9,0x3f7e70b0,0x3f7e4323
.long 0x3f7b14be,0x3f7a7302,0x3f79c79d,0x3f791298,0x3f74fa0b,0x3f73913f,0x3f721352,0x3f708066
.long 0x3f6c835e,0x3f6a09a7,0x3f676bd8,0x3f64aa59,0x3f61c598,0x3f5df6be,0x3f59f26a,0x3f55b993
.long 0x3f54db31,0x3f4f7a1f,0x3f49d112,0x3f43e200,0x3f45e403,0x3f3ebc1b,0x3f373a23,0x3f2f61a5
.long 0x3f3504f3,0x3f2beb4a,0x3f226799,0x3f187fc0,0x3f226799,0x3f173c07,0x3f0b9a6b,0x3eff17b2
.long 0x3f0e39da,0x3f00e7e4,0x3ee63375,0x3ec9b953,0x3ef15aea,0x3ed25a09,0x3eb263ef,0x3e919ddd
.long 0x3ec3ef15,0x3ea09ae5,0x3e78cfcc,0x3e2f10a2,0x3e94a031,0x3e5a3997,0x3e09cf86,0x3d621469
.long 0x3e47c5c2,0x3de1bc2e,0x3cc90ab0,0xbd7b2b74,0x3dc8bd36,0x3bc90f88,0xbdafb680,0xbe354098
.long 0x3f800000,0x3f800000,0x3f800000,0x3f800000,0x3f7e1324,0x3f7de0b1,0x3f7dabcc,0x3f7d7474
.long 0x3f7853f8,0x3f778bc5,0x3f76ba07,0x3f75dec6,0x3f6ed89e,0x3f6d1c1d,0x3f6b4b0c,0x3f696591
.long 0x3f61c598,0x3f5ebe05,0x3f5b941a,0x3f584853,0x3f514d3d,0x3f4cae79,0x3f47de65,0x3f42de29
.long 0x3f3daef9,0x3f373a23,0x3f3085bb,0x3f299415,0x3f273656,0x3f1ebc12,0x3f15f6d9,0x3f0cead0
.long 0x3f0e39da,0x3f039c3d,0x3ef15aea,0x3edae880,0x3ee63375,0x3ecc9b8b,0x3eb263ef,0x3e97a117
.long 0x3eac7cd4,0x3e8e9a22,0x3e605c13,0x3e22abb6,0x3e605c13,0x3e1c76de,0x3dafb680,0x3c96c9b6
.long 0x3dc8bd36,0x3cc90ab0,0xbd48fb30,0xbdfab273,0xbcc90ab0,0xbdd53db9,0xbe3b6ecf,0xbe8586ce
.long 0xbe164083,0xbe6c9a7f,0xbea09ae5,0xbec9b953,0xbe888e93,0xbeb554ec,0xbee0924f,0xbf04f484
.long 0x3f800000,0x3f800000,0x3f800000,0x3f800000,0x3f7d3aac,0x3f7cfe73,0x3f7cbfc9,0x3f7c7eb0
.long 0x3f74fa0b,0x3f740bdd,0x3f731447,0x3f721352,0x3f676bd8,0x3f655e0b,0x3f633c5a,0x3f6106f2
.long 0x3f54db31,0x3f514d3d,0x3f4d9f02,0x3f49d112,0x3f3daef9,0x3f385216,0x3f32c8c9,0x3f2d1469
.long 0x3f226799,0x3f1b02c6,0x3f13682a,0x3f0b9a6b,0x3f039c3d,0x3ef41f07,0x3ee0924f,0x3ecc9b8b
.long 0x3ec3ef15,0x3eac7cd4,0x3e94a031,0x3e78cfcc,0x3e78cfcc,0x3e419b37,0x3e09cf86,0x3da3308c
.long 0x3dc8bd36,0x3d16c32c,0xbcc90ab0,0xbdafb680,0xbd48fb30,0xbdee3876,0xbe3b6ecf,0xbe7ee6e1
.long 0xbe47c5c2,0xbe888e93,0xbeac7cd4,0xbecf7bca,0xbeac7cd4,0xbed25a09,0xbef6e0cb,0xbf0cead0
.long 0xbef15aea,0xbf0b9a6b,0xbf1d7fd1,0xbf2e3bde,0xbf187fc0,0xbf2ac082,0xbf3b8f3b,0xbf4ac77f
.long 0x3f800000,0x3f800000,0x3f800000,0x3f800000,0x3f7c3b28,0x3f7bf531,0x3f7baccd,0x3f7b61fc
.long 0x3f710908,0x3f6ff573,0x3f6ed89e,0x3f6db293,0x3f5ebe05,0x3f5c61c7,0x3f59f26a,0x3f577026
.long 0x3f45e403,0x3f41d870,0x3f3daef9,0x3f396842,0x3f273656,0x3f212ff9,0x3f1b02c6,0x3f14b039
.long 0x3f039c3d,0x3ef6e0cb,0x3ee63375,0x3ed53641,0x3eb8442a,0x3ea395c5,0x3e8e9a22,0x3e72b651
.long 0x3e47c5c2,0x3e164083,0x3dc8bd36,0x3d48fb30,0x3cc90ab0,0xbcfb49ba,0xbdafb680,0xbe1008b7
.long 0xbe164083,0xbe541501,0xbe888e93,0xbea68f12,0xbea09ae5,0xbec1071e,0xbee0924f,0xbeff17b2
.long 0xbef15aea,0xbf08f59b,0xbf187fc0,0xbf273656,0xbf1d7fd1,0xbf2d1469,0xbf3b8f3b,0xbf48d8b3
.long 0xbf3daef9,0xbf4bbbf8,0xbf584853,0xbf633c5a,0xbf584853,0xbf63f473,0xbf6db293,0xbf756d97
.long 0x0,0x0,0x0,0x0,0x3dc8bd36,0x3dd53db9,0x3de1bc2e,0x3dee3876
.long 0x3e47c5c2,0x3e541501,0x3e605c13,0x3e6c9a7f,0x3e94a031,0x3e9d9e78,0x3ea68f12,0x3eaf713a
.long 0x3ec3ef15,0x3ecf7bca,0x3edae880,0x3ee63375,0x3ef15aea,0x3eff17b2,0x3f064b82,0x3f0cead0
.long 0x3f0e39da,0x3f15f6d9,0x3f1d7fd1,0x3f24d225,0x3f226799,0x3f2ac082,0x3f32c8c9,0x3f3a7ca4
.long 0x3f3504f3,0x3f3daef9,0x3f45e403,0x3f4d9f02,0x3f45e403,0x3f4e8d90,0x3f5695e5,0x3f5df6be
.long 0x3f54db31,0x3f5d2d53,0x3f64aa59,0x3f6b4b0c,0x3f61c598,0x3f696591,0x3f6ff573,0x3f756d97
.long 0x3f6c835e,0x3f731447,0x3f7853f8,0x3f7c3b28,0x3f74fa0b,0x3f7a1e84,0x3f7dabcc,0x3f7f9c18
.long 0x3f7b14be,0x3f7e70b0,0x3f7fec43,0x3f7f84ab,0x3f7ec46d,0x3f7ffec4,0x3f7f0e58,0x3f7bf531
.long 0x0,0x0,0x0,0x0,0x3dfab273,0x3e039502,0x3e09cf86,0x3e1008b7
.long 0x3e78cfcc,0x3e827dc0,0x3e888e93,0x3e8e9a22,0x3eb8442a,0x3ec1071e,0x3ec9b953,0x3ed25a09
.long 0x3ef15aea,0x3efc5d27,0x3f039c3d,0x3f08f59b,0x3f13682a,0x3f19c200,0x3f1ff6cb,0x3f26050a
.long 0x3f2beb4a,0x3f32c8c9,0x3f396842,0x3f3fc767,0x3f41d870,0x3f48d8b3,0x3f4f7a1f,0x3f55b993
.long 0x3f54db31,0x3f5b941a,0x3f61c598,0x3f676bd8,0x3f64aa59,0x3f6aab7b,0x3f6ff573,0x3f748422
.long 0x3f710908,0x3f75dec6,0x3f79c79d,0x3f7cbfc9,0x3f79c79d,0x3f7cfe73,0x3f7f0e58,0x3f7ff4e6
.long 0x3f7ec46d,0x3f7fec43,0x3f7fb10f,0x3f7e1324,0x3f7fec43,0x3f7e9bc9,0x3f7baccd,0x3f772417
.long 0x3f7d3aac,0x3f791298,0x3f731447,0x3f6b4b0c,0x3f76ba07,0x3f6f6830,0x3f660f88,0x3f5ac450
.long 0x0,0x0,0x0,0x0,0x3e164083,0x3e1c76de,0x3e22abb6,0x3e28defc
.long 0x3e94a031,0x3e9aa086,0x3ea09ae5,0x3ea68f12,0x3edae880,0x3ee363fa,0x3eebcbbb,0x3ef41f07
.long 0x3f0e39da,0x3f13682a,0x3f187fc0,0x3f1d7fd1,0x3f2beb4a,0x3f31a81d,0x3f373a23,0x3f3ca003
.long 0x3f45e403,0x3f4bbbf8,0x3f514d3d,0x3f5695e5,0x3f5b941a,0x3f6106f2,0x3f660f88,0x3f6aab7b
.long 0x3f6c835e,0x3f710908,0x3f74fa0b,0x3f7853f8,0x3f7853f8,0x3f7b61fc,0x3f7dabcc,0x3f7f2f9d
.long 0x3f7ec46d,0x3f7fd397,0x3f7fec43,0x3f7f0e58,0x3f7fb10f,0x3f7e4323,0x3f7baccd,0x3f77f110
.long 0x3f7b14be,0x3f76ba07,0x3f710908,0x3f6a09a7,0x3f710908,0x3f696591,0x3f604621,0x3f55b993
.long 0x3f61c598,0x3f5695e5,0x3f49d112,0x3f3b8f3b,0x3f4d9f02,0x3f3ebc1b,0x3f2e3bde,0x3f1c420c
.long 0x0,0x0,0x0,0x0,0x3e2f10a2,0x3e354098,0x3e3b6ecf,0x3e419b37
.long 0x3eac7cd4,0x3eb263ef,0x3eb8442a,0x3ebe1d4a,0x3efc5d27,0x3f0242b1,0x3f064b82,0x3f0a48ad
.long 0x3f226799,0x3f273656,0x3f2beb4a,0x3f3085bb,0x3f41d870,0x3f46e22a,0x3f4bbbf8,0x3f5064af
.long 0x3f5b941a,0x3f604621,0x3f64aa59,0x3f68bf3c,0x3f6ed89e,0x3f7294f8,0x3f75dec6,0x3f78b47b
.long 0x3f7b14be,0x3f7d3aac,0x3f7ec46d,0x3f7fb10f,0x3f7fec43,0x3f7fe129,0x3f7f0e58,0x3f7d7474
.long 0x3f7d3aac,0x3f7a7302,0x3f76ba07,0x3f721352,0x3f731447,0x3f6d1c1d,0x3f660f88,0x3f5df6be
.long 0x3f61c598,0x3f584853,0x3f4d9f02,0x3f41d870,0x3f49d112,0x3f3ca003,0x3f2e3bde,0x3f1ebc12
.long 0x3f2beb4a,0x3f1b02c6,0x3f08f59b,0x3eebcbbb,0x3f08f59b,0x3ee900b7,0x3ebe1d4a,0x3e919ddd
.long 0x3f80,0x3f80,0x3f80,0x3f80,0x3f80,0x3e483f7b,0x3ec43f6d,0x3f0e3f55
.long 0x3f80,0x3ec43f6d,0x3f353f35,0x3f6d3ec4,0x3f80,0x3f0e3f55,0x3f6d3ec4,0x3f7bbe48
.long 0x3f80,0x3f353f35,0x3f800000,0x3f35bf35,0x3f80,0x3f553f0e,0x3f6dbec4,0x3e48bf7b
.long 0x3f80,0x3f6d3ec4,0x3f35bf35,0xbec4bf6d,0x3f80,0x3f7b3e48,0x3ec4bf6d,0xbf55bf0e
.long 0x3f80,0x3f800000,0xbf80,0xbf800000,0x3f80,0x3f7bbe48,0xbec4bf6d,0xbf553f0e
.long 0x3f80,0x3f6dbec4,0xbf35bf35,0xbec43f6d,0x3f80,0x3f55bf0e,0xbf6dbec4,0x3e483f7b
.long 0x3f80,0x3f35bf35,0xbf800000,0x3f353f35,0x3f80,0x3f0ebf55,0xbf6d3ec4,0x3f7b3e48
.long 0x3f80,0x3ec4bf6d,0xbf353f35,0x3f6dbec4,0x3f80,0x3e48bf7b,0xbec43f6d,0x3f0ebf55
.long 0x3f80,0x3f80,0x3f80,0x3f80,0x3f353f35,0x3f553f0e,0x3f6d3ec4,0x3f7b3e48
.long 0x3f800000,0x3f6dbec4,0x3f35bf35,0x3ec4bf6d,0x3f35bf35,0x3e48bf7b,0xbec4bf6d,0xbf55bf0e
.long 0xbf80,0xbf35bf35,0xbf800000,0xbf353f35,0xbf35bf35,0xbf7b3e48,0xbec43f6d,0x3f0e3f55
.long 0xbf800000,0xbec43f6d,0x3f353f35,0x3f6dbec4,0xbf353f35,0x3f0e3f55,0x3f6dbec4,0xbe48bf7b
.long 0x3f80,0x3f800000,0xbf80,0xbf800000,0x3f353f35,0x3f0ebf55,0xbf6dbec4,0xbe483f7b
.long 0x3f800000,0xbec4bf6d,0xbf353f35,0x3f6d3ec4,0x3f35bf35,0xbf7bbe48,0x3ec43f6d,0x3f0ebf55
.long 0xbf80,0xbf353f35,0x3f800000,0xbf35bf35,0xbf35bf35,0x3e483f7b,0x3ec4bf6d,0xbf553f0e
.long 0xbf800000,0x3f6d3ec4,0xbf35bf35,0x3ec43f6d,0xbf353f35,0x3f55bf0e,0xbf6d3ec4,0x3f7bbe48
.long 0x3f80,0x3f80,0x3f80,0x3f80,0x3f800000,0x3f7bbe48,0x3f6dbec4,0x3f55bf0e
.long 0xbf80,0xbec4bf6d,0xbf35bf35,0xbf6dbec4,0xbf800000,0xbf553f0e,0xbec43f6d,0x3e483f7b
.long 0x3f80,0x3f353f35,0x3f800000,0x3f35bf35,0x3f800000,0x3f0ebf55,0xbec4bf6d,0xbf7bbe48
.long 0xbf80,0xbf6dbec4,0xbf353f35,0x3ec43f6d,0xbf800000,0xbe483f7b,0x3f6d3ec4,0x3f0ebf55
.long 0x3f80,0x3f800000,0xbf80,0xbf800000,0x3f800000,0xbe48bf7b,0xbf6d3ec4,0x3f0e3f55
.long 0xbf80,0xbf6d3ec4,0x3f353f35,0x3ec4bf6d,0xbf800000,0x3f0e3f55,0x3ec4bf6d,0xbf7b3e48
.long 0x3f80,0x3f35bf35,0xbf800000,0x3f353f35,0x3f800000,0xbf55bf0e,0x3ec43f6d,0x3e48bf7b
.long 0xbf80,0xbec43f6d,0x3f35bf35,0xbf6d3ec4,0xbf800000,0x3f7b3e48,0xbf6dbec4,0x3f553f0e
.long 0x3f80,0x3f80,0x3f80,0x3f80,0x3f35bf35,0x3f0ebf55,0x3ec4bf6d,0x3e48bf7b
.long 0xbf800000,0xbf6d3ec4,0xbf353f35,0xbec43f6d,0x3f353f35,0x3f7b3e48,0x3f6dbec4,0x3f0ebf55
.long 0xbf80,0xbf35bf35,0xbf800000,0xbf353f35,0xbf353f35,0x3e483f7b,0x3f6d3ec4,0x3f55bf0e
.long 0x3f800000,0x3ec4bf6d,0xbf35bf35,0xbf6d3ec4,0xbf35bf35,0xbf553f0e,0x3ec43f6d,0x3f7bbe48
.long 0x3f80,0x3f800000,0xbf80,0xbf800000,0x3f35bf35,0xbf55bf0e,0xbec43f6d,0x3f7b3e48
.long 0xbf800000,0x3ec43f6d,0x3f35bf35,0xbf6dbec4,0x3f353f35,0x3e48bf7b,0xbf6d3ec4,0x3f553f0e
.long 0xbf80,0xbf353f35,0x3f800000,0xbf35bf35,0xbf353f35,0x3f7bbe48,0xbf6dbec4,0x3f0e3f55
.long 0x3f800000,0xbf6dbec4,0x3f353f35,0xbec4bf6d,0xbf35bf35,0x3f0e3f55,0xbec4bf6d,0x3e483f7b
.long 0x3f80,0x3f80,0x3f80,0x3f80,0xbf80,0xbe48bf7b,0xbec4bf6d,0xbf0ebf55
.long 0x3f80,0x3ec43f6d,0x3f353f35,0x3f6d3ec4,0xbf80,0xbf0ebf55,0xbf6dbec4,0xbf7b3e48
.long 0x3f80,0x3f353f35,0x3f800000,0x3f35bf35,0xbf80,0xbf55bf0e,0xbf6d3ec4,0xbe483f7b
.long 0x3f80,0x3f6d3ec4,0x3f35bf35,0xbec4bf6d,0xbf80,0xbf7bbe48,0xbec43f6d,0x3f553f0e
.long 0x3f80,0x3f800000,0xbf80,0xbf800000,0xbf80,0xbf7b3e48,0x3ec43f6d,0x3f55bf0e
.long 0x3f80,0x3f6dbec4,0xbf35bf35,0xbec43f6d,0xbf80,0xbf553f0e,0x3f6d3ec4,0xbe48bf7b
.long 0x3f80,0x3f35bf35,0xbf800000,0x3f353f35,0xbf80,0xbf0e3f55,0x3f6dbec4,0xbf7bbe48
.long 0x3f80,0x3ec4bf6d,0xbf353f35,0x3f6dbec4,0xbf80,0xbe483f7b,0x3ec4bf6d,0xbf0e3f55
.long 0x3f80,0x3f80,0x3f80,0x3f80,0xbf35bf35,0xbf55bf0e,0xbf6dbec4,0xbf7bbe48
.long 0x3f800000,0x3f6dbec4,0x3f35bf35,0x3ec4bf6d,0xbf353f35,0xbe483f7b,0x3ec43f6d,0x3f553f0e
.long 0xbf80,0xbf35bf35,0xbf800000,0xbf353f35,0x3f353f35,0x3f7bbe48,0x3ec4bf6d,0xbf0ebf55
.long 0xbf800000,0xbec43f6d,0x3f353f35,0x3f6dbec4,0x3f35bf35,0xbf0ebf55,0xbf6d3ec4,0x3e483f7b
.long 0x3f80,0x3f800000,0xbf80,0xbf800000,0xbf35bf35,0xbf0e3f55,0x3f6d3ec4,0x3e48bf7b
.long 0x3f800000,0xbec4bf6d,0xbf353f35,0x3f6d3ec4,0xbf353f35,0x3f7b3e48,0xbec4bf6d,0xbf0e3f55
.long 0xbf80,0xbf353f35,0x3f800000,0xbf35bf35,0x3f353f35,0xbe48bf7b,0xbec43f6d,0x3f55bf0e
.long 0xbf800000,0x3f6d3ec4,0xbf35bf35,0x3ec43f6d,0x3f35bf35,0xbf553f0e,0x3f6dbec4,0xbf7b3e48
.long 0x3f80,0x3f80,0x3f80,0x3f80,0xbf800000,0xbf7b3e48,0xbf6d3ec4,0xbf553f0e
.long 0xbf80,0xbec4bf6d,0xbf35bf35,0xbf6dbec4,0x3f800000,0x3f55bf0e,0x3ec4bf6d,0xbe48bf7b
.long 0x3f80,0x3f353f35,0x3f800000,0x3f35bf35,0xbf800000,0xbf0e3f55,0x3ec43f6d,0x3f7b3e48
.long 0xbf80,0xbf6dbec4,0xbf353f35,0x3ec43f6d,0x3f800000,0x3e48bf7b,0xbf6dbec4,0xbf0e3f55
.long 0x3f80,0x3f800000,0xbf80,0xbf800000,0xbf800000,0x3e483f7b,0x3f6dbec4,0xbf0ebf55
.long 0xbf80,0xbf6d3ec4,0x3f353f35,0x3ec4bf6d,0x3f800000,0xbf0ebf55,0xbec43f6d,0x3f7bbe48
.long 0x3f80,0x3f35bf35,0xbf800000,0x3f353f35,0xbf800000,0x3f553f0e,0xbec4bf6d,0xbe483f7b
.long 0xbf80,0xbec43f6d,0x3f35bf35,0xbf6d3ec4,0x3f800000,0xbf7bbe48,0x3f6d3ec4,0xbf55bf0e
.long 0x3f80,0x3f80,0x3f80,0x3f80,0xbf353f35,0xbf0e3f55,0xbec43f6d,0xbe483f7b
.long 0xbf800000,0xbf6d3ec4,0xbf353f35,0xbec43f6d,0xbf35bf35,0xbf7bbe48,0xbf6d3ec4,0xbf0e3f55
.long 0xbf80,0xbf35bf35,0xbf800000,0xbf353f35,0x3f35bf35,0xbe48bf7b,0xbf6dbec4,0xbf553f0e
.long 0x3f800000,0x3ec4bf6d,0xbf35bf35,0xbf6d3ec4,0x3f353f35,0x3f55bf0e,0xbec4bf6d,0xbf7b3e48
.long 0x3f80,0x3f800000,0xbf80,0xbf800000,0xbf353f35,0x3f553f0e,0x3ec4bf6d,0xbf7bbe48
.long 0xbf800000,0x3ec43f6d,0x3f35bf35,0xbf6dbec4,0xbf35bf35,0xbe483f7b,0x3f6dbec4,0xbf55bf0e
.long 0xbf80,0xbf353f35,0x3f800000,0xbf35bf35,0x3f35bf35,0xbf7b3e48,0x3f6d3ec4,0xbf0ebf55
.long 0x3f800000,0xbf6dbec4,0x3f353f35,0xbec4bf6d,0x3f353f35,0xbf0ebf55,0x3ec43f6d,0xbe48bf7b
.long 0x3f808000,0x3f808000,0x3f808000,0x3f808000,0x3f808000,0x3f7bbe48,0x3f6dbec4,0x3f55bf0e
.long 0x3f808000,0x3f6dbec4,0x3f35bf35,0x3ec4bf6d,0x3f808000,0x3f55bf0e,0x3ec4bf6d,0xbe48bf7b
.long 0x3f808000,0x3f35bf35,0xbf80,0xbf35bf35,0x3f808000,0x3f0ebf55,0xbec4bf6d,0xbf7bbe48
.long 0x3f808000,0x3ec4bf6d,0xbf35bf35,0xbf6d3ec4,0x3f808000,0x3e48bf7b,0xbf6dbec4,0xbf0e3f55
.long 0x3f808000,0xbf80,0xbf808000,0x3f80,0x3f808000,0xbe48bf7b,0xbf6d3ec4,0x3f0e3f55
.long 0x3f808000,0xbec4bf6d,0xbf353f35,0x3f6d3ec4,0x3f808000,0xbf0ebf55,0xbec43f6d,0x3f7bbe48
.long 0x3f808000,0xbf35bf35,0x3f80,0x3f35bf35,0x3f808000,0xbf55bf0e,0x3ec43f6d,0x3e48bf7b
.long 0x3f808000,0xbf6dbec4,0x3f353f35,0xbec4bf6d,0x3f808000,0xbf7bbe48,0x3f6d3ec4,0xbf55bf0e
.long 0x3f808000,0x3f808000,0x3f808000,0x3f808000,0x3f35bf35,0x3f0ebf55,0x3ec4bf6d,0x3e48bf7b
.long 0xbf80,0xbec4bf6d,0xbf35bf35,0xbf6dbec4,0xbf35bf35,0xbf7bbe48,0xbf6d3ec4,0xbf0e3f55
.long 0xbf808000,0xbf353f35,0x3f80,0x3f353f35,0xbf353f35,0x3e483f7b,0x3f6d3ec4,0x3f55bf0e
.long 0x3f80,0x3f6d3ec4,0x3f35bf35,0xbec4bf6d,0x3f353f35,0x3f55bf0e,0xbec4bf6d,0xbf7b3e48
.long 0x3f808000,0xbf80,0xbf808000,0x3f80,0x3f35bf35,0xbf55bf0e,0xbec43f6d,0x3f7b3e48
.long 0xbf80,0xbf6d3ec4,0x3f353f35,0x3ec4bf6d,0xbf35bf35,0xbe483f7b,0x3f6dbec4,0xbf55bf0e
.long 0xbf808000,0x3f353f35,0xbf80,0xbf353f35,0xbf353f35,0x3f7bbe48,0xbf6dbec4,0x3f0e3f55
.long 0x3f80,0x3ec4bf6d,0xbf353f35,0x3f6dbec4,0x3f353f35,0xbf0ebf55,0x3ec43f6d,0xbe48bf7b
.long 0x3f808000,0x3f808000,0x3f808000,0x3f808000,0xbf80,0xbe48bf7b,0xbec4bf6d,0xbf0ebf55
.long 0xbf808000,0xbf6d3ec4,0xbf353f35,0xbec43f6d,0x3f80,0x3f0e3f55,0x3f6d3ec4,0x3f7bbe48
.long 0x3f808000,0x3f35bf35,0xbf80,0xbf35bf35,0xbf80,0xbf55bf0e,0xbf6d3ec4,0xbe483f7b
.long 0xbf808000,0xbec43f6d,0x3f353f35,0x3f6dbec4,0x3f80,0x3f7b3e48,0x3ec4bf6d,0xbf55bf0e
.long 0x3f808000,0xbf80,0xbf808000,0x3f80,0xbf80,0xbf7b3e48,0x3ec43f6d,0x3f55bf0e
.long 0xbf808000,0x3ec43f6d,0x3f35bf35,0xbf6dbec4,0x3f80,0x3f55bf0e,0xbf6dbec4,0x3e483f7b
.long 0x3f808000,0xbf35bf35,0x3f80,0x3f35bf35,0xbf80,0xbf0e3f55,0x3f6dbec4,0xbf7bbe48
.long 0xbf808000,0x3f6d3ec4,0xbf35bf35,0x3ec43f6d,0x3f80,0x3e48bf7b,0xbec43f6d,0x3f0ebf55
.long 0x3f808000,0x3f808000,0x3f808000,0x3f808000,0xbf35bf35,0xbf55bf0e,0xbf6dbec4,0xbf7bbe48
.long 0x3f80,0x3ec43f6d,0x3f353f35,0x3f6d3ec4,0x3f35bf35,0x3e48bf7b,0xbec4bf6d,0xbf55bf0e
.long 0xbf808000,0xbf353f35,0x3f80,0x3f353f35,0x3f353f35,0x3f7bbe48,0x3ec4bf6d,0xbf0ebf55
.long 0xbf80,0xbf6dbec4,0xbf353f35,0x3ec43f6d,0xbf353f35,0x3f0e3f55,0x3f6dbec4,0xbe48bf7b
.long 0x3f808000,0xbf80,0xbf808000,0x3f80,0xbf35bf35,0xbf0e3f55,0x3f6d3ec4,0x3e48bf7b
.long 0x3f80,0x3f6dbec4,0xbf35bf35,0xbec43f6d,0x3f35bf35,0xbf7bbe48,0x3ec43f6d,0x3f0ebf55
.long 0xbf808000,0x3f353f35,0xbf80,0xbf353f35,0x3f353f35,0xbe48bf7b,0xbec43f6d,0x3f55bf0e
.long 0xbf80,0xbec43f6d,0x3f35bf35,0xbf6d3ec4,0xbf353f35,0x3f55bf0e,0xbf6d3ec4,0x3f7bbe48
.long 0x3f808000,0x3f808000,0x3f808000,0x3f808000,0xbf808000,0xbf7b3e48,0xbf6d3ec4,0xbf553f0e
.long 0x3f808000,0x3f6dbec4,0x3f35bf35,0x3ec4bf6d,0xbf808000,0xbf553f0e,0xbec43f6d,0x3e483f7b
.long 0x3f808000,0x3f35bf35,0xbf80,0xbf35bf35,0xbf808000,0xbf0e3f55,0x3ec43f6d,0x3f7b3e48
.long 0x3f808000,0x3ec4bf6d,0xbf35bf35,0xbf6d3ec4,0xbf808000,0xbe483f7b,0x3f6d3ec4,0x3f0ebf55
.long 0x3f808000,0xbf80,0xbf808000,0x3f80,0xbf808000,0x3e483f7b,0x3f6dbec4,0xbf0ebf55
.long 0x3f808000,0xbec4bf6d,0xbf353f35,0x3f6d3ec4,0xbf808000,0x3f0e3f55,0x3ec4bf6d,0xbf7b3e48
.long 0x3f808000,0xbf35bf35,0x3f80,0x3f35bf35,0xbf808000,0x3f553f0e,0xbec4bf6d,0xbe483f7b
.long 0x3f808000,0xbf6dbec4,0x3f353f35,0xbec4bf6d,0xbf808000,0x3f7b3e48,0xbf6dbec4,0x3f553f0e
.long 0x3f808000,0x3f808000,0x3f808000,0x3f808000,0xbf353f35,0xbf0e3f55,0xbec43f6d,0xbe483f7b
.long 0xbf80,0xbec4bf6d,0xbf35bf35,0xbf6dbec4,0x3f353f35,0x3f7b3e48,0x3f6dbec4,0x3f0ebf55
.long 0xbf808000,0xbf353f35,0x3f80,0x3f353f35,0x3f35bf35,0xbe48bf7b,0xbf6dbec4,0xbf553f0e
.long 0x3f80,0x3f6d3ec4,0x3f35bf35,0xbec4bf6d,0xbf35bf35,0xbf553f0e,0x3ec43f6d,0x3f7bbe48
.long 0x3f808000,0xbf80,0xbf808000,0x3f80,0xbf353f35,0x3f553f0e,0x3ec4bf6d,0xbf7bbe48
.long 0xbf80,0xbf6d3ec4,0x3f353f35,0x3ec4bf6d,0x3f353f35,0x3e48bf7b,0xbf6d3ec4,0x3f553f0e
.long 0xbf808000,0x3f353f35,0xbf80,0xbf353f35,0x3f35bf35,0xbf7b3e48,0x3f6d3ec4,0xbf0ebf55
.long 0x3f80,0x3ec4bf6d,0xbf353f35,0x3f6dbec4,0xbf35bf35,0x3f0e3f55,0xbec4bf6d,0x3e483f7b
.long 0x3f808000,0x3f808000,0x3f808000,0x3f808000,0x3f80,0x3e483f7b,0x3ec43f6d,0x3f0e3f55
.long 0xbf808000,0xbf6d3ec4,0xbf353f35,0xbec43f6d,0xbf80,0xbf0ebf55,0xbf6dbec4,0xbf7b3e48
.long 0x3f808000,0x3f35bf35,0xbf80,0xbf35bf35,0x3f80,0x3f553f0e,0x3f6dbec4,0x3e48bf7b
.long 0xbf808000,0xbec43f6d,0x3f353f35,0x3f6dbec4,0xbf80,0xbf7bbe48,0xbec43f6d,0x3f553f0e
.long 0x3f808000,0xbf80,0xbf808000,0x3f80,0x3f80,0x3f7bbe48,0xbec4bf6d,0xbf553f0e
.long 0xbf808000,0x3ec43f6d,0x3f35bf35,0xbf6dbec4,0xbf80,0xbf553f0e,0x3f6d3ec4,0xbe48bf7b
.long 0x3f808000,0xbf35bf35,0x3f80,0x3f35bf35,0x3f80,0x3f0ebf55,0xbf6d3ec4,0x3f7b3e48
.long 0xbf808000,0x3f6d3ec4,0xbf35bf35,0x3ec43f6d,0xbf80,0xbe483f7b,0x3ec4bf6d,0xbf0e3f55
.long 0x3f808000,0x3f808000,0x3f808000,0x3f808000,0x3f353f35,0x3f553f0e,0x3f6d3ec4,0x3f7b3e48
.long 0x3f80,0x3ec43f6d,0x3f353f35,0x3f6d3ec4,0xbf353f35,0xbe483f7b,0x3ec43f6d,0x3f553f0e
.long 0xbf808000,0xbf353f35,0x3f80,0x3f353f35,0xbf35bf35,0xbf7b3e48,0xbec43f6d,0x3f0e3f55
.long 0xbf80,0xbf6dbec4,0xbf353f35,0x3ec43f6d,0x3f35bf35,0xbf0ebf55,0xbf6d3ec4,0x3e483f7b
.long 0x3f808000,0xbf80,0xbf808000,0x3f80,0x3f353f35,0x3f0ebf55,0xbf6dbec4,0xbe483f7b
.long 0x3f80,0x3f6dbec4,0xbf35bf35,0xbec43f6d,0xbf353f35,0x3f7b3e48,0xbec4bf6d,0xbf0e3f55
.long 0xbf808000,0x3f353f35,0xbf80,0xbf353f35,0xbf35bf35,0x3e483f7b,0x3ec4bf6d,0xbf553f0e
.long 0xbf80,0xbec43f6d,0x3f35bf35,0xbf6d3ec4,0x3f35bf35,0xbf553f0e,0x3f6dbec4,0xbf7b3e48
.long 0x3f80,0xbf80,0x3f80,0xbf80,0x3f80,0xbe48bf7b,0x3ec43f6d,0xbf0ebf55
.long 0x3f80,0xbec4bf6d,0x3f353f35,0xbf6dbec4,0x3f80,0xbf0ebf55,0x3f6d3ec4,0xbf7b3e48
.long 0x3f80,0xbf35bf35,0x3f800000,0xbf353f35,0x3f80,0xbf55bf0e,0x3f6dbec4,0xbe483f7b
.long 0x3f80,0xbf6dbec4,0x3f35bf35,0x3ec43f6d,0x3f80,0xbf7bbe48,0x3ec4bf6d,0x3f553f0e
.long 0x3f80,0xbf800000,0xbf80,0x3f800000,0x3f80,0xbf7b3e48,0xbec4bf6d,0x3f55bf0e
.long 0x3f80,0xbf6d3ec4,0xbf35bf35,0x3ec4bf6d,0x3f80,0xbf553f0e,0xbf6dbec4,0xbe48bf7b
.long 0x3f80,0xbf353f35,0xbf800000,0xbf35bf35,0x3f80,0xbf0e3f55,0xbf6d3ec4,0xbf7bbe48
.long 0x3f80,0xbec43f6d,0xbf353f35,0xbf6d3ec4,0x3f80,0xbe483f7b,0xbec43f6d,0xbf0e3f55
.long 0x3f80,0xbf80,0x3f80,0xbf80,0x3f353f35,0xbf55bf0e,0x3f6d3ec4,0xbf7bbe48
.long 0x3f800000,0xbf6d3ec4,0x3f35bf35,0xbec43f6d,0x3f35bf35,0xbe483f7b,0xbec4bf6d,0x3f553f0e
.long 0xbf80,0x3f353f35,0xbf800000,0x3f35bf35,0xbf35bf35,0x3f7bbe48,0xbec43f6d,0xbf0ebf55
.long 0xbf800000,0x3ec4bf6d,0x3f353f35,0xbf6d3ec4,0xbf353f35,0xbf0ebf55,0x3f6dbec4,0x3e483f7b
.long 0x3f80,0xbf800000,0xbf80,0x3f800000,0x3f353f35,0xbf0e3f55,0xbf6dbec4,0x3e48bf7b
.long 0x3f800000,0x3ec43f6d,0xbf353f35,0xbf6dbec4,0x3f35bf35,0x3f7b3e48,0x3ec43f6d,0xbf0e3f55
.long 0xbf80,0x3f35bf35,0x3f800000,0x3f353f35,0xbf35bf35,0xbe48bf7b,0x3ec4bf6d,0x3f55bf0e
.long 0xbf800000,0xbf6dbec4,0xbf35bf35,0xbec4bf6d,0xbf353f35,0xbf553f0e,0xbf6d3ec4,0xbf7b3e48
.long 0x3f80,0xbf80,0x3f80,0xbf80,0x3f800000,0xbf7b3e48,0x3f6dbec4,0xbf553f0e
.long 0xbf80,0x3ec43f6d,0xbf35bf35,0x3f6d3ec4,0xbf800000,0x3f55bf0e,0xbec43f6d,0xbe48bf7b
.long 0x3f80,0xbf35bf35,0x3f800000,0xbf353f35,0x3f800000,0xbf0e3f55,0xbec4bf6d,0x3f7b3e48
.long 0xbf80,0x3f6d3ec4,0xbf353f35,0xbec4bf6d,0xbf800000,0x3e48bf7b,0x3f6d3ec4,0xbf0e3f55
.long 0x3f80,0xbf800000,0xbf80,0x3f800000,0x3f800000,0x3e483f7b,0xbf6d3ec4,0xbf0ebf55
.long 0xbf80,0x3f6dbec4,0x3f353f35,0xbec43f6d,0xbf800000,0xbf0ebf55,0x3ec4bf6d,0x3f7bbe48
.long 0x3f80,0xbf353f35,0xbf800000,0xbf35bf35,0x3f800000,0x3f553f0e,0x3ec43f6d,0xbe483f7b
.long 0xbf80,0x3ec4bf6d,0x3f35bf35,0x3f6dbec4,0xbf800000,0xbf7bbe48,0xbf6dbec4,0xbf55bf0e
.long 0x3f80,0xbf80,0x3f80,0xbf80,0x3f35bf35,0xbf0e3f55,0x3ec4bf6d,0xbe483f7b
.long 0xbf800000,0x3f6dbec4,0xbf353f35,0x3ec4bf6d,0x3f353f35,0xbf7bbe48,0x3f6dbec4,0xbf0e3f55
.long 0xbf80,0x3f353f35,0xbf800000,0x3f35bf35,0xbf353f35,0xbe48bf7b,0x3f6d3ec4,0xbf553f0e
.long 0x3f800000,0xbec43f6d,0xbf35bf35,0x3f6dbec4,0xbf35bf35,0x3f55bf0e,0x3ec43f6d,0xbf7b3e48
.long 0x3f80,0xbf800000,0xbf80,0x3f800000,0x3f35bf35,0x3f553f0e,0xbec43f6d,0xbf7bbe48
.long 0xbf800000,0xbec4bf6d,0x3f35bf35,0x3f6d3ec4,0x3f353f35,0xbe483f7b,0xbf6d3ec4,0xbf55bf0e
.long 0xbf80,0x3f35bf35,0x3f800000,0x3f353f35,0xbf353f35,0xbf7b3e48,0xbf6dbec4,0xbf0ebf55
.long 0x3f800000,0x3f6d3ec4,0x3f353f35,0x3ec43f6d,0xbf35bf35,0xbf0ebf55,0xbec4bf6d,0xbe48bf7b
.long 0x3f80,0xbf80,0x3f80,0xbf80,0xbf80,0x3e483f7b,0xbec4bf6d,0x3f0e3f55
.long 0x3f80,0xbec4bf6d,0x3f353f35,0xbf6dbec4,0xbf80,0x3f0e3f55,0xbf6dbec4,0x3f7bbe48
.long 0x3f80,0xbf35bf35,0x3f800000,0xbf353f35,0xbf80,0x3f553f0e,0xbf6d3ec4,0x3e48bf7b
.long 0x3f80,0xbf6dbec4,0x3f35bf35,0x3ec43f6d,0xbf80,0x3f7b3e48,0xbec43f6d,0xbf55bf0e
.long 0x3f80,0xbf800000,0xbf80,0x3f800000,0xbf80,0x3f7bbe48,0x3ec43f6d,0xbf553f0e
.long 0x3f80,0xbf6d3ec4,0xbf35bf35,0x3ec4bf6d,0xbf80,0x3f55bf0e,0x3f6d3ec4,0x3e483f7b
.long 0x3f80,0xbf353f35,0xbf800000,0xbf35bf35,0xbf80,0x3f0ebf55,0x3f6dbec4,0x3f7b3e48
.long 0x3f80,0xbec43f6d,0xbf353f35,0xbf6d3ec4,0xbf80,0x3e48bf7b,0x3ec4bf6d,0x3f0ebf55
.long 0x3f80,0xbf80,0x3f80,0xbf80,0xbf35bf35,0x3f553f0e,0xbf6dbec4,0x3f7b3e48
.long 0x3f800000,0xbf6d3ec4,0x3f35bf35,0xbec43f6d,0xbf353f35,0x3e48bf7b,0x3ec43f6d,0xbf55bf0e
.long 0xbf80,0x3f353f35,0xbf800000,0x3f35bf35,0x3f353f35,0xbf7b3e48,0x3ec4bf6d,0x3f0e3f55
.long 0xbf800000,0x3ec4bf6d,0x3f353f35,0xbf6d3ec4,0x3f35bf35,0x3f0e3f55,0xbf6d3ec4,0xbe48bf7b
.long 0x3f80,0xbf800000,0xbf80,0x3f800000,0xbf35bf35,0x3f0ebf55,0x3f6d3ec4,0xbe483f7b
.long 0x3f800000,0x3ec43f6d,0xbf353f35,0xbf6dbec4,0xbf353f35,0xbf7bbe48,0xbec4bf6d,0x3f0ebf55
.long 0xbf80,0x3f35bf35,0x3f800000,0x3f353f35,0x3f353f35,0x3e483f7b,0xbec43f6d,0xbf553f0e
.long 0xbf800000,0xbf6dbec4,0xbf35bf35,0xbec4bf6d,0x3f35bf35,0x3f55bf0e,0x3f6dbec4,0x3f7bbe48
.long 0x3f80,0xbf80,0x3f80,0xbf80,0xbf800000,0x3f7bbe48,0xbf6d3ec4,0x3f55bf0e
.long 0xbf80,0x3ec43f6d,0xbf35bf35,0x3f6d3ec4,0x3f800000,0xbf553f0e,0x3ec4bf6d,0x3e483f7b
.long 0x3f80,0xbf35bf35,0x3f800000,0xbf353f35,0xbf800000,0x3f0ebf55,0x3ec43f6d,0xbf7bbe48
.long 0xbf80,0x3f6d3ec4,0xbf353f35,0xbec4bf6d,0x3f800000,0xbe483f7b,0xbf6dbec4,0x3f0ebf55
.long 0x3f80,0xbf800000,0xbf80,0x3f800000,0xbf800000,0xbe48bf7b,0x3f6dbec4,0x3f0e3f55
.long 0xbf80,0x3f6dbec4,0x3f353f35,0xbec43f6d,0x3f800000,0x3f0e3f55,0xbec43f6d,0xbf7b3e48
.long 0x3f80,0xbf353f35,0xbf800000,0xbf35bf35,0xbf800000,0xbf55bf0e,0xbec4bf6d,0x3e48bf7b
.long 0xbf80,0x3ec4bf6d,0x3f35bf35,0x3f6dbec4,0x3f800000,0x3f7b3e48,0x3f6d3ec4,0x3f553f0e
.long 0x3f80,0xbf80,0x3f80,0xbf80,0xbf353f35,0x3f0ebf55,0xbec43f6d,0x3e48bf7b
.long 0xbf800000,0x3f6dbec4,0xbf353f35,0x3ec4bf6d,0xbf35bf35,0x3f7b3e48,0xbf6d3ec4,0x3f0ebf55
.long 0xbf80,0x3f353f35,0xbf800000,0x3f35bf35,0x3f35bf35,0x3e483f7b,0xbf6dbec4,0x3f55bf0e
.long 0x3f800000,0xbec43f6d,0xbf35bf35,0x3f6dbec4,0x3f353f35,0xbf553f0e,0xbec4bf6d,0x3f7bbe48
.long 0x3f80,0xbf800000,0xbf80,0x3f800000,0xbf353f35,0xbf55bf0e,0x3ec4bf6d,0x3f7b3e48
.long 0xbf800000,0xbec4bf6d,0x3f35bf35,0x3f6d3ec4,0xbf35bf35,0x3e48bf7b,0x3f6dbec4,0x3f553f0e
.long 0xbf80,0x3f35bf35,0x3f800000,0x3f353f35,0x3f35bf35,0x3f7bbe48,0x3f6d3ec4,0x3f0e3f55
.long 0x3f800000,0x3f6d3ec4,0x3f353f35,0x3ec43f6d,0x3f353f35,0x3f0e3f55,0x3ec43f6d,0x3e483f7b
.long 0xbf800000,0x3f800000,0xbf800000,0x3f800000,0xbf800000,0x3f7bbe48,0xbf6d3ec4,0x3f55bf0e
.long 0xbf800000,0x3f6dbec4,0xbf353f35,0x3ec4bf6d,0xbf800000,0x3f55bf0e,0xbec43f6d,0xbe48bf7b
.long 0xbf800000,0x3f35bf35,0x80003f80,0xbf35bf35,0xbf800000,0x3f0ebf55,0x3ec43f6d,0xbf7bbe48
.long 0xbf800000,0x3ec4bf6d,0x3f353f35,0xbf6d3ec4,0xbf800000,0x3e48bf7b,0x3f6d3ec4,0xbf0e3f55
.long 0xbf800000,0x8000bf80,0x3f800000,0x80003f80,0xbf800000,0xbe48bf7b,0x3f6dbec4,0x3f0e3f55
.long 0xbf800000,0xbec4bf6d,0x3f35bf35,0x3f6d3ec4,0xbf800000,0xbf0ebf55,0x3ec4bf6d,0x3f7bbe48
.long 0xbf800000,0xbf35bf35,0x8000bf80,0x3f35bf35,0xbf800000,0xbf55bf0e,0xbec4bf6d,0x3e48bf7b
.long 0xbf800000,0xbf6dbec4,0xbf35bf35,0xbec4bf6d,0xbf800000,0xbf7bbe48,0xbf6dbec4,0xbf55bf0e
.long 0xbf800000,0x3f800000,0xbf800000,0x3f800000,0xbf353f35,0x3f0ebf55,0xbec43f6d,0x3e48bf7b
.long 0x80003f80,0xbec4bf6d,0x3f353f35,0xbf6dbec4,0x3f353f35,0xbf7bbe48,0x3f6dbec4,0xbf0e3f55
.long 0x3f800000,0xbf353f35,0x8000bf80,0x3f353f35,0x3f35bf35,0x3e483f7b,0xbf6dbec4,0x3f55bf0e
.long 0x8000bf80,0x3f6d3ec4,0xbf353f35,0xbec4bf6d,0xbf35bf35,0x3f55bf0e,0x3ec43f6d,0xbf7b3e48
.long 0xbf800000,0x8000bf80,0x3f800000,0x80003f80,0xbf353f35,0xbf55bf0e,0x3ec4bf6d,0x3f7b3e48
.long 0x80003f80,0xbf6d3ec4,0xbf35bf35,0x3ec4bf6d,0x3f353f35,0xbe483f7b,0xbf6d3ec4,0xbf55bf0e
.long 0x3f800000,0x3f353f35,0x80003f80,0xbf353f35,0x3f35bf35,0x3f7bbe48,0x3f6d3ec4,0x3f0e3f55
.long 0x8000bf80,0x3ec4bf6d,0x3f35bf35,0x3f6dbec4,0xbf35bf35,0xbf0ebf55,0xbec4bf6d,0xbe48bf7b
.long 0xbf800000,0x3f800000,0xbf800000,0x3f800000,0x80003f80,0xbe48bf7b,0x3ec43f6d,0xbf0ebf55
.long 0x3f800000,0xbf6d3ec4,0x3f35bf35,0xbec43f6d,0x8000bf80,0x3f0e3f55,0xbf6dbec4,0x3f7bbe48
.long 0xbf800000,0x3f35bf35,0x80003f80,0xbf35bf35,0x80003f80,0xbf55bf0e,0x3f6dbec4,0xbe483f7b
.long 0x3f800000,0xbec43f6d,0xbf35bf35,0x3f6dbec4,0x8000bf80,0x3f7b3e48,0xbec43f6d,0xbf55bf0e
.long 0xbf800000,0x8000bf80,0x3f800000,0x80003f80,0x80003f80,0xbf7b3e48,0xbec4bf6d,0x3f55bf0e
.long 0x3f800000,0x3ec43f6d,0xbf353f35,0xbf6dbec4,0x8000bf80,0x3f55bf0e,0x3f6d3ec4,0x3e483f7b
.long 0xbf800000,0xbf35bf35,0x8000bf80,0x3f35bf35,0x80003f80,0xbf0e3f55,0xbf6d3ec4,0xbf7bbe48
.long 0x3f800000,0x3f6d3ec4,0x3f353f35,0x3ec43f6d,0x8000bf80,0x3e48bf7b,0x3ec4bf6d,0x3f0ebf55
.long 0xbf800000,0x3f800000,0xbf800000,0x3f800000,0x3f353f35,0xbf55bf0e,0x3f6d3ec4,0xbf7bbe48
.long 0x8000bf80,0x3ec43f6d,0xbf35bf35,0x3f6d3ec4,0xbf353f35,0x3e48bf7b,0x3ec43f6d,0xbf55bf0e
.long 0x3f800000,0xbf353f35,0x8000bf80,0x3f353f35,0xbf35bf35,0x3f7bbe48,0xbec43f6d,0xbf0ebf55
.long 0x80003f80,0xbf6dbec4,0x3f35bf35,0x3ec43f6d,0x3f35bf35,0x3f0e3f55,0xbf6d3ec4,0xbe48bf7b
.long 0xbf800000,0x8000bf80,0x3f800000,0x80003f80,0x3f353f35,0xbf0e3f55,0xbf6dbec4,0x3e48bf7b
.long 0x8000bf80,0x3f6dbec4,0x3f353f35,0xbec43f6d,0xbf353f35,0xbf7bbe48,0xbec4bf6d,0x3f0ebf55
.long 0x3f800000,0x3f353f35,0x80003f80,0xbf353f35,0xbf35bf35,0xbe48bf7b,0x3ec4bf6d,0x3f55bf0e
.long 0x80003f80,0xbec43f6d,0xbf353f35,0xbf6d3ec4,0x3f35bf35,0x3f55bf0e,0x3f6dbec4,0x3f7bbe48
.long 0xbf800000,0x3f800000,0xbf800000,0x3f800000,0x3f800000,0xbf7b3e48,0x3f6dbec4,0xbf553f0e
.long 0xbf800000,0x3f6dbec4,0xbf353f35,0x3ec4bf6d,0x3f800000,0xbf553f0e,0x3ec4bf6d,0x3e483f7b
.long 0xbf800000,0x3f35bf35,0x80003f80,0xbf35bf35,0x3f800000,0xbf0e3f55,0xbec4bf6d,0x3f7b3e48
.long 0xbf800000,0x3ec4bf6d,0x3f353f35,0xbf6d3ec4,0x3f800000,0xbe483f7b,0xbf6dbec4,0x3f0ebf55
.long 0xbf800000,0x8000bf80,0x3f800000,0x80003f80,0x3f800000,0x3e483f7b,0xbf6d3ec4,0xbf0ebf55
.long 0xbf800000,0xbec4bf6d,0x3f35bf35,0x3f6d3ec4,0x3f800000,0x3f0e3f55,0xbec43f6d,0xbf7b3e48
.long 0xbf800000,0xbf35bf35,0x8000bf80,0x3f35bf35,0x3f800000,0x3f553f0e,0x3ec43f6d,0xbe483f7b
.long 0xbf800000,0xbf6dbec4,0xbf35bf35,0xbec4bf6d,0x3f800000,0x3f7b3e48,0x3f6d3ec4,0x3f553f0e
.long 0xbf800000,0x3f800000,0xbf800000,0x3f800000,0x3f35bf35,0xbf0e3f55,0x3ec4bf6d,0xbe483f7b
.long 0x80003f80,0xbec4bf6d,0x3f353f35,0xbf6dbec4,0xbf35bf35,0x3f7b3e48,0xbf6d3ec4,0x3f0ebf55
.long 0x3f800000,0xbf353f35,0x8000bf80,0x3f353f35,0xbf353f35,0xbe48bf7b,0x3f6d3ec4,0xbf553f0e
.long 0x8000bf80,0x3f6d3ec4,0xbf353f35,0xbec4bf6d,0x3f353f35,0xbf553f0e,0xbec4bf6d,0x3f7bbe48
.long 0xbf800000,0x8000bf80,0x3f800000,0x80003f80,0x3f35bf35,0x3f553f0e,0xbec43f6d,0xbf7bbe48
.long 0x80003f80,0xbf6d3ec4,0xbf35bf35,0x3ec4bf6d,0xbf35bf35,0x3e48bf7b,0x3f6dbec4,0x3f553f0e
.long 0x3f800000,0x3f353f35,0x80003f80,0xbf353f35,0xbf353f35,0xbf7b3e48,0xbf6dbec4,0xbf0ebf55
.long 0x8000bf80,0x3ec4bf6d,0x3f35bf35,0x3f6dbec4,0x3f353f35,0x3f0e3f55,0x3ec43f6d,0x3e483f7b
.long 0xbf800000,0x3f800000,0xbf800000,0x3f800000,0x8000bf80,0x3e483f7b,0xbec4bf6d,0x3f0e3f55
.long 0x3f800000,0xbf6d3ec4,0x3f35bf35,0xbec43f6d,0x80003f80,0xbf0ebf55,0x3f6d3ec4,0xbf7b3e48
.long 0xbf800000,0x3f35bf35,0x80003f80,0xbf35bf35,0x8000bf80,0x3f553f0e,0xbf6d3ec4,0x3e48bf7b
.long 0x3f800000,0xbec43f6d,0xbf35bf35,0x3f6dbec4,0x80003f80,0xbf7bbe48,0x3ec4bf6d,0x3f553f0e
.long 0xbf800000,0x8000bf80,0x3f800000,0x80003f80,0x8000bf80,0x3f7bbe48,0x3ec43f6d,0xbf553f0e
.long 0x3f800000,0x3ec43f6d,0xbf353f35,0xbf6dbec4,0x80003f80,0xbf553f0e,0xbf6dbec4,0xbe48bf7b
.long 0xbf800000,0xbf35bf35,0x8000bf80,0x3f35bf35,0x8000bf80,0x3f0ebf55,0x3f6dbec4,0x3f7b3e48
.long 0x3f800000,0x3f6d3ec4,0x3f353f35,0x3ec43f6d,0x80003f80,0xbe483f7b,0xbec43f6d,0xbf0e3f55
.long 0xbf800000,0x3f800000,0xbf800000,0x3f800000,0xbf35bf35,0x3f553f0e,0xbf6dbec4,0x3f7b3e48
.long 0x8000bf80,0x3ec43f6d,0xbf35bf35,0x3f6d3ec4,0x3f35bf35,0xbe483f7b,0xbec4bf6d,0x3f553f0e
.long 0x3f800000,0xbf353f35,0x8000bf80,0x3f353f35,0x3f353f35,0xbf7b3e48,0x3ec4bf6d,0x3f0e3f55
.long 0x80003f80,0xbf6dbec4,0x3f35bf35,0x3ec43f6d,0xbf353f35,0xbf0ebf55,0x3f6dbec4,0x3e483f7b
.long 0xbf800000,0x8000bf80,0x3f800000,0x80003f80,0xbf35bf35,0x3f0ebf55,0x3f6d3ec4,0xbe483f7b
.long 0x8000bf80,0x3f6dbec4,0x3f353f35,0xbec43f6d,0x3f35bf35,0x3f7b3e48,0x3ec43f6d,0xbf0e3f55
.long 0x3f800000,0x3f353f35,0x80003f80,0xbf353f35,0x3f353f35,0x3e483f7b,0xbec43f6d,0xbf553f0e
.long 0x80003f80,0xbec43f6d,0xbf353f35,0xbf6d3ec4,0xbf353f35,0xbf553f0e,0xbf6d3ec4,0xbf7b3e48
.long 0x3f803f80,0xbf7f3f80,0x3f7b3f80,0xbf753f80,0x3f803f80,0xbf753f7b,0x3f553f6d,0xbf223f55
.long 0x3f803f80,0xbf623f6d,0x3f0e3f35,0xbdc93ec4,0x3f803f80,0xbf463f55,0x3e483ec4,0x3ef1be48
.long 0x3f803f80,0xbf223f35,0xbe480000,0x3f62bf35,0x3f803f80,0xbef13f0e,0xbf0ebec4,0x3f7fbf7b
.long 0x3f803f80,0xbe953ec4,0xbf55bf35,0x3f46bf6d,0x3f803f80,0xbdc93e48,0xbf7bbf6d,0x3e95bf0e
.long 0x3f803f80,0x3dc90000,0xbf7bbf80,0xbe950000,0x3f803f80,0x3e95be48,0xbf55bf6d,0xbf463f0e
.long 0x3f803f80,0x3ef1bec4,0xbf0ebf35,0xbf7f3f6d,0x3f803f80,0x3f22bf0e,0xbe48bec4,0xbf623f7b
.long 0x3f803f80,0x3f46bf35,0x3e480000,0xbef13f35,0x3f803f80,0x3f62bf55,0x3f0e3ec4,0x3dc93e48
.long 0x3f803f80,0x3f75bf6d,0x3f553f35,0x3f22bec4,0x3f803f80,0x3f7fbf7b,0x3f7b3f6d,0x3f75bf55
.long 0x3f6d3f80,0xbf623f80,0x3f553f80,0xbf463f80,0x3ec43f35,0xbdc93f0e,0xbe483ec4,0x3ef13e48
.long 0xbec40000,0x3f46bec4,0xbf7bbf35,0x3f75bf6d,0xbf6dbf35,0x3f75bf7b,0xbf0ebf6d,0xbdc9bf0e
.long 0xbf6dbf80,0x3e95bf35,0x3f0e0000,0xbf7f3f35,0xbec4bf35,0xbf223e48,0x3f7b3f6d,0xbe953f55
.long 0x3ec40000,0xbf7f3f6d,0x3e483f35,0x3f62bec4,0x3f6d3f35,0xbef13f55,0xbf55bec4,0x3f22bf7b
.long 0x3f6d3f80,0x3ef10000,0xbf55bf80,0xbf220000,0x3ec43f35,0x3f7fbf55,0x3e48bec4,0xbf623f7b
.long 0xbec40000,0x3f22bf6d,0x3f7b3f35,0x3e953ec4,0xbf6dbf35,0xbe95be48,0x3f0e3f6d,0x3f7fbf55
.long 0xbf6dbf80,0xbf753f35,0xbf0e0000,0x3dc9bf35,0xbec4bf35,0xbf463f7b,0xbf7bbf6d,0xbf753f0e
.long 0x3ec40000,0x3dc93ec4,0xbe48bf35,0xbef13f6d,0x3f6d3f35,0x3f62bf0e,0x3f553ec4,0x3f46be48
.long 0x3f353f80,0xbf223f80,0x3f0e3f80,0xbef13f80,0xbf350000,0x3f62be48,0xbf7bbec4,0x3f7fbf0e
.long 0xbf35bf80,0x3e95bf6d,0x3e48bf35,0xbf22bec4,0x3f350000,0xbf7f3f0e,0x3f553f6d,0xbe953f7b
.long 0x3f353f80,0x3dc93f35,0xbf550000,0x3f75bf35,0xbf350000,0x3f75bf55,0xbe48bf6d,0xbf46be48
.long 0xbf35bf80,0xbef1bec4,0x3f7b3f35,0xbdc93f6d,0x3f350000,0xbf463f7b,0xbf0e3ec4,0x3f62bf55
.long 0x3f353f80,0x3f460000,0xbf0ebf80,0xbf620000,0xbf350000,0x3ef1bf7b,0x3f7b3ec4,0x3dc93f55
.long 0xbf35bf80,0xbf753ec4,0xbe483f35,0x3f46bf6d,0x3f350000,0xbdc93f55,0xbf55bf6d,0xbf753e48
.long 0x3f353f80,0x3f7fbf35,0x3f550000,0x3e953f35,0xbf350000,0xbe95bf0e,0x3e483f6d,0x3f22bf7b
.long 0xbf35bf80,0xbf623f6d,0xbf7bbf35,0xbf7f3ec4,0x3f350000,0x3f223e48,0x3f0ebec4,0x3ef13f0e
.long 0x3ec43f80,0xbe953f80,0x3e483f80,0xbdc93f80,0xbf6dbf35,0x3f46bf55,0xbf0ebf6d,0x3e95bf7b
.long 0x3f6d0000,0xbf7f3ec4,0x3f553f35,0xbef13f6d,0xbec43f35,0x3f623e48,0xbf7bbec4,0x3f22bf55
.long 0xbec4bf80,0xbef1bf35,0x3f7b0000,0xbf463f35,0x3f6d3f35,0xbdc93f7b,0xbf553ec4,0x3f62bf0e
.long 0xbf6d0000,0x3f22bf6d,0x3f0ebf35,0xbf753ec4,0x3ec4bf35,0xbf753f0e,0xbe483f6d,0x3f7fbe48
.long 0x3ec43f80,0x3f750000,0xbe48bf80,0xbf7f0000,0xbf6dbf35,0xbf22bf0e,0x3f0e3f6d,0x3f753e48
.long 0x3f6d0000,0x3dc93f6d,0xbf55bf35,0xbf62bec4,0xbec43f35,0x3ef1bf7b,0x3f7b3ec4,0x3f463f0e
.long 0xbec4bf80,0xbf623f35,0xbf7b0000,0xbf22bf35,0x3f6d3f35,0x3f7fbe48,0x3f55bec4,0x3ef13f55
.long 0xbf6d0000,0xbf46bec4,0xbf0e3f35,0xbe95bf6d,0x3ec4bf35,0x3e953f55,0x3e48bf6d,0x3dc93f7b
.long 0x3f80,0x3dc93f80,0xbe483f80,0x3e953f80,0xbf80,0xbe95bf7b,0x3f0ebf6d,0xbf46bf55
.long 0x3f80,0x3ef13f6d,0xbf553f35,0x3f7f3ec4,0xbf80,0xbf22bf55,0x3f7bbec4,0xbf623e48
.long 0x3f80,0x3f463f35,0xbf7b0000,0x3ef1bf35,0xbf80,0xbf62bf0e,0x3f553ec4,0x3dc93f7b
.long 0x3f80,0x3f753ec4,0xbf0ebf35,0xbf22bf6d,0xbf80,0xbf7fbe48,0x3e483f6d,0x3f753f0e
.long 0x3f80,0x3f7f0000,0x3e48bf80,0xbf750000,0xbf80,0xbf753e48,0xbf0e3f6d,0x3f22bf0e
.long 0x3f80,0x3f62bec4,0x3f55bf35,0xbdc93f6d,0xbf80,0xbf463f0e,0xbf7b3ec4,0xbef1bf7b
.long 0x3f80,0x3f22bf35,0x3f7b0000,0x3f623f35,0xbf80,0xbef13f55,0xbf55bec4,0xbf7fbe48
.long 0x3f80,0x3e95bf6d,0x3f0e3f35,0x3f46bec4,0xbf80,0xbdc93f7b,0xbe48bf6d,0xbe953f55
.long 0xbec43f80,0x3ef13f80,0xbf0e3f80,0x3f223f80,0x3f6dbf35,0xbf7fbf0e,0x3f7bbec4,0xbf62be48
.long 0xbf6d0000,0x3f22bec4,0xbe48bf35,0xbe95bf6d,0x3ec43f35,0x3e953f7b,0xbf553f6d,0x3f7f3f0e
.long 0x3ec4bf80,0xbf75bf35,0x3f550000,0xbdc93f35,0xbf6d3f35,0x3f46be48,0x3e48bf6d,0xbf75bf55
.long 0x3f6d0000,0x3dc93f6d,0xbf7b3f35,0x3ef1bec4,0xbec4bf35,0xbf62bf55,0x3f0e3ec4,0x3f463f7b
.long 0xbec43f80,0x3f620000,0x3f0ebf80,0xbf460000,0x3f6dbf35,0xbdc93f55,0xbf7b3ec4,0xbef1bf7b
.long 0xbf6d0000,0xbf46bf6d,0x3e483f35,0x3f753ec4,0x3ec43f35,0x3f753e48,0x3f55bf6d,0x3dc93f55
.long 0x3ec4bf80,0xbe953f35,0xbf550000,0xbf7fbf35,0xbf6d3f35,0xbf22bf7b,0xbe483f6d,0x3e95bf0e
.long 0x3f6d0000,0x3f7f3ec4,0x3f7bbf35,0x3f623f6d,0xbec4bf35,0xbef13f0e,0xbf0ebec4,0xbf223e48
.long 0xbf353f80,0x3f463f80,0xbf553f80,0x3f623f80,0x3f350000,0xbef13e48,0x3e483ec4,0x3dc93f0e
.long 0x3f35bf80,0xbf75bf6d,0x3f7bbf35,0xbf46bec4,0xbf350000,0x3dc9bf0e,0x3f0ebf6d,0xbf75bf7b
.long 0xbf353f80,0x3f7f3f35,0xbf0e0000,0xbe95bf35,0x3f350000,0x3e953f55,0xbf7b3f6d,0x3f223e48
.long 0x3f35bf80,0xbf62bec4,0xbe483f35,0x3f7f3f6d,0xbf350000,0xbf22bf7b,0x3f55bec4,0x3ef13f55
.long 0xbf353f80,0x3f220000,0x3f55bf80,0xbef10000,0x3f350000,0x3f623f7b,0xbe48bec4,0xbf7fbf55
.long 0x3f35bf80,0xbe953ec4,0xbf7b3f35,0xbf22bf6d,0xbf350000,0xbf7fbf55,0xbf0e3f6d,0x3e95be48
.long 0xbf353f80,0xbdc9bf35,0x3f0e0000,0x3f753f35,0x3f350000,0x3f753f0e,0x3f7bbf6d,0x3f463f7b
.long 0x3f35bf80,0x3ef13f6d,0x3e48bf35,0xbdc93ec4,0xbf350000,0xbf46be48,0xbf553ec4,0xbf62bf0e
.long 0xbf6d3f80,0x3f753f80,0xbf7b3f80,0x3f7f3f80,0xbec43f35,0x3f223f55,0xbf553f6d,0x3f753f7b
.long 0x3ec40000,0x3dc93ec4,0xbf0e3f35,0x3f623f6d,0x3f6dbf35,0xbef1be48,0xbe483ec4,0x3f463f55
.long 0x3f6dbf80,0xbf62bf35,0x3e480000,0x3f223f35,0x3ec4bf35,0xbf7fbf7b,0x3f0ebec4,0x3ef13f0e
.long 0xbec40000,0xbf46bf6d,0x3f55bf35,0x3e953ec4,0xbf6d3f35,0xbe95bf0e,0x3f7bbf6d,0x3dc93e48
.long 0xbf6d3f80,0x3e950000,0x3f7bbf80,0xbdc90000,0xbec43f35,0x3f463f0e,0x3f55bf6d,0xbe95be48
.long 0x3ec40000,0x3f7f3f6d,0x3f0ebf35,0xbef1bec4,0x3f6dbf35,0x3f623f7b,0x3e48bec4,0xbf22bf0e
.long 0x3f6dbf80,0x3ef13f35,0xbe480000,0xbf46bf35,0x3ec4bf35,0xbdc93e48,0xbf0e3ec4,0xbf62bf55
.long 0xbec40000,0xbf22bec4,0xbf553f35,0xbf75bf6d,0xbf6d3f35,0xbf75bf55,0xbf7b3f6d,0xbf7fbf7b
.long 0x80003f80,0xbdc9bf80,0x3e483f80,0xbe95bf80,0x80008000,0xbe95be48,0x3f0ebec4,0xbf46bf0e
.long 0x80008000,0xbef1bec4,0x3f55bf35,0xbf7fbf6d,0x80008000,0xbf22bf0e,0x3f7bbf6d,0xbf62bf7b
.long 0x80008000,0xbf46bf35,0x3f7bbf80,0xbef1bf35,0x80008000,0xbf62bf55,0x3f55bf6d,0x3dc9be48
.long 0x80008000,0xbf75bf6d,0x3f0ebf35,0x3f223ec4,0x80008000,0xbf7fbf7b,0x3e48bec4,0x3f753f55
.long 0x80008000,0xbf7fbf80,0xbe488000,0x3f753f80,0x80008000,0xbf75bf7b,0xbf0e3ec4,0x3f223f55
.long 0x80008000,0xbf62bf6d,0xbf553f35,0x3dc93ec4,0x80008000,0xbf46bf55,0xbf7b3f6d,0xbef1be48
.long 0x80008000,0xbf22bf35,0xbf7b3f80,0xbf62bf35,0x80008000,0xbef1bf0e,0xbf553f6d,0xbf7fbf7b
.long 0x80008000,0xbe95bec4,0xbf0e3f35,0xbf46bf6d,0x80008000,0xbdc9be48,0xbe483ec4,0xbe95bf0e
.long 0x3ec43f80,0xbef1bf80,0x3f0e3f80,0xbf22bf80,0x3f6dbf35,0xbf7fbf55,0x3f7bbf6d,0xbf62bf7b
.long 0x3f6dbf80,0xbf22bf6d,0x3e48bf35,0x3e95bec4,0x3ec4bf35,0x3e95be48,0xbf553ec4,0x3f7f3f55
.long 0xbec48000,0x3f753f35,0xbf553f80,0x3dc93f35,0xbf6d3f35,0x3f463f7b,0x3e483ec4,0xbf75bf0e
.long 0xbf6d3f80,0xbdc93ec4,0x3f7bbf35,0xbef1bf6d,0xbec43f35,0xbf62bf0e,0x3f0ebf6d,0x3f463e48
.long 0x3ec48000,0xbf62bf80,0xbf0e8000,0x3f463f80,0x3f6dbf35,0xbdc9bf0e,0xbf7b3f6d,0xbef13e48
.long 0x3f6dbf80,0x3f463ec4,0xbe483f35,0xbf75bf6d,0x3ec4bf35,0x3f753f7b,0x3f55bec4,0x3dc9bf0e
.long 0xbec48000,0x3e953f35,0x3f55bf80,0x3f7f3f35,0xbf6d3f35,0xbf22be48,0xbe48bec4,0x3e953f55
.long 0xbf6d3f80,0xbf7fbf6d,0xbf7b3f35,0xbf62bec4,0xbec43f35,0xbef1bf55,0xbf0e3f6d,0xbf22bf7b
.long 0x3f353f80,0xbf46bf80,0x3f553f80,0xbf62bf80,0x3f35bf80,0xbef1bf7b,0x3e48bf6d,0x3dc9bf55
.long 0xbf358000,0x3f753ec4,0xbf7b3f35,0x3f463f6d,0xbf353f80,0x3dc93f55,0x3f0e3ec4,0xbf75be48
.long 0x3f358000,0xbf7fbf35,0x3f0ebf80,0x3e95bf35,0x3f35bf80,0x3e95bf0e,0xbf7b3ec4,0x3f223f7b
.long 0xbf358000,0x3f623f6d,0x3e483f35,0xbf7fbec4,0xbf353f80,0xbf223e48,0x3f55bf6d,0x3ef1bf0e
.long 0x3f358000,0xbf22bf80,0xbf558000,0x3ef13f80,0x3f35bf80,0x3f623e48,0xbe483f6d,0xbf7fbf0e
.long 0xbf358000,0x3e953f6d,0x3f7bbf35,0x3f22bec4,0xbf353f80,0xbf7fbf0e,0xbf0ebec4,0x3e953f7b
.long 0x3f358000,0x3dc9bf35,0xbf0e3f80,0xbf75bf35,0x3f35bf80,0x3f753f55,0x3f7bbec4,0x3f46be48
.long 0xbf358000,0xbef13ec4,0xbe48bf35,0x3dc93f6d,0xbf353f80,0xbf46bf7b,0xbf553f6d,0xbf62bf55
.long 0x3f6d3f80,0xbf75bf80,0x3f7b3f80,0xbf7fbf80,0xbec4bf35,0x3f22bf0e,0xbf55bec4,0x3f75be48
.long 0xbec43f80,0xbdc93f6d,0x3f0e3f35,0xbf623ec4,0x3f6dbf35,0xbef1bf7b,0xbe48bf6d,0x3f46bf0e
.long 0xbf6d8000,0x3f623f35,0xbe483f80,0xbf223f35,0x3ec43f35,0xbf7fbe48,0x3f0ebf6d,0x3ef1bf55
.long 0x3ec4bf80,0x3f46bec4,0xbf553f35,0xbe953f6d,0xbf6d3f35,0xbe953f55,0x3f7bbec4,0x3dc9bf7b
.long 0x3f6d8000,0xbe95bf80,0xbf7b8000,0x3dc93f80,0xbec4bf35,0x3f463f55,0x3f553ec4,0xbe95bf7b
.long 0xbec43f80,0xbf7fbec4,0xbf0ebf35,0x3ef13f6d,0x3f6dbf35,0x3f62be48,0x3e483f6d,0xbf22bf55
.long 0xbf6d8000,0xbef13f35,0x3e48bf80,0x3f463f35,0x3ec43f35,0xbdc9bf7b,0xbf0e3f6d,0xbf62bf0e
.long 0x3ec4bf80,0x3f223f6d,0x3f55bf35,0x3f753ec4,0xbf6d3f35,0xbf75bf0e,0xbf7b3ec4,0xbf7fbe48
.long 0x3f803f80,0xbf7fbf80,0x3f7b3f80,0xbf75bf80,0xbf808000,0x3f753e48,0xbf553ec4,0x3f223f0e
.long 0x3f808000,0xbf62bec4,0x3f0ebf35,0xbdc9bf6d,0xbf808000,0x3f463f0e,0xbe483f6d,0xbef13f7b
.long 0x3f808000,0xbf22bf35,0xbe48bf80,0x3f62bf35,0xbf808000,0x3ef13f55,0x3f0e3f6d,0xbf7f3e48
.long 0x3f808000,0xbe95bf6d,0xbf55bf35,0x3f463ec4,0xbf808000,0x3dc93f7b,0x3f7b3ec4,0xbe95bf55
.long 0x3f808000,0x3dc9bf80,0xbf7b8000,0xbe953f80,0xbf808000,0xbe953f7b,0x3f55bec4,0x3f46bf55
.long 0x3f808000,0x3ef1bf6d,0xbf0e3f35,0xbf7f3ec4,0xbf808000,0xbf223f55,0x3e48bf6d,0x3f623e48
.long 0x3f808000,0x3f46bf35,0x3e483f80,0xbef1bf35,0xbf808000,0xbf623f0e,0xbf0ebf6d,0xbdc93f7b
.long 0x3f808000,0x3f75bec4,0x3f553f35,0x3f22bf6d,0xbf808000,0xbf7f3e48,0xbf7bbec4,0xbf753f0e
.long 0x3f6d3f80,0xbf62bf80,0x3f553f80,0xbf46bf80,0xbec43f35,0x3dc93f55,0x3e483f6d,0xbef13f7b
.long 0xbec4bf80,0x3f46bf6d,0xbf7bbf35,0x3f75bec4,0x3f6d3f35,0xbf753e48,0x3f0ebec4,0x3dc9bf55
.long 0xbf6d8000,0x3e953f35,0x3f0e3f80,0xbf7f3f35,0x3ec4bf35,0x3f22bf7b,0xbf7bbec4,0x3e953f0e
.long 0x3ec43f80,0xbf7f3ec4,0x3e48bf35,0x3f62bf6d,0xbf6dbf35,0x3ef13f0e,0x3f553f6d,0xbf22be48
.long 0x3f6d8000,0x3ef1bf80,0xbf558000,0xbf223f80,0xbec43f35,0xbf7f3f0e,0xbe48bf6d,0x3f62be48
.long 0xbec4bf80,0x3f223ec4,0x3f7b3f35,0x3e95bf6d,0x3f6d3f35,0x3e95bf7b,0xbf0e3ec4,0xbf7f3f0e
.long 0xbf6d8000,0xbf753f35,0xbf0ebf80,0x3dc93f35,0x3ec4bf35,0x3f463e48,0x3f7b3ec4,0x3f75bf55
.long 0x3ec43f80,0x3dc9bf6d,0xbe483f35,0xbef1bec4,0xbf6dbf35,0xbf623f55,0xbf55bf6d,0xbf463f7b
.long 0x3f353f80,0xbf22bf80,0x3f0e3f80,0xbef1bf80,0x3f353f80,0xbf623f7b,0x3f7b3f6d,0xbf7f3f55
.long 0xbf358000,0x3e953ec4,0x3e483f35,0xbf223f6d,0xbf35bf80,0x3f7fbf55,0xbf55bec4,0x3e953e48
.long 0x3f358000,0x3dc9bf35,0xbf55bf80,0x3f75bf35,0x3f353f80,0xbf753f0e,0x3e48bec4,0x3f46bf7b
.long 0xbf358000,0xbef13f6d,0x3f7b3f35,0xbdc9bec4,0xbf35bf80,0x3f46be48,0x3f0e3f6d,0xbf623f0e
.long 0x3f358000,0x3f46bf80,0xbf0e8000,0xbf623f80,0x3f353f80,0xbef1be48,0xbf7bbf6d,0xbdc93f0e
.long 0xbf358000,0xbf753f6d,0xbe48bf35,0x3f46bec4,0xbf35bf80,0x3dc93f0e,0x3f553ec4,0x3f75bf7b
.long 0x3f358000,0x3f7fbf35,0x3f553f80,0x3e95bf35,0x3f353f80,0x3e95bf55,0xbe483ec4,0xbf223e48
.long 0xbf358000,0xbf623ec4,0xbf7bbf35,0xbf7f3f6d,0xbf35bf80,0xbf223f7b,0xbf0ebf6d,0xbef13f55
.long 0x3ec43f80,0xbe95bf80,0x3e483f80,0xbdc9bf80,0x3f6d3f35,0xbf463f0e,0x3f0e3ec4,0xbe953e48
.long 0x3f6d3f80,0xbf7f3f6d,0x3f553f35,0xbef13ec4,0x3ec43f35,0xbf623f7b,0x3f7b3f6d,0xbf223f0e
.long 0xbec48000,0xbef13f35,0x3f7b3f80,0xbf463f35,0xbf6dbf35,0x3dc93e48,0x3f553f6d,0xbf623f55
.long 0xbf6dbf80,0x3f22bec4,0x3f0e3f35,0xbf753f6d,0xbec4bf35,0x3f75bf55,0x3e483ec4,0xbf7f3f7b
.long 0x3ec48000,0x3f75bf80,0xbe488000,0xbf7f3f80,0x3f6d3f35,0x3f22bf55,0xbf0ebec4,0xbf753f7b
.long 0x3f6d3f80,0x3dc9bec4,0xbf55bf35,0xbf623f6d,0x3ec43f35,0xbef13e48,0xbf7bbf6d,0xbf463f55
.long 0xbec48000,0xbf623f35,0xbf7bbf80,0xbf223f35,0xbf6dbf35,0xbf7f3f7b,0xbf55bf6d,0xbef13f0e
.long 0xbf6dbf80,0xbf463f6d,0xbf0ebf35,0xbe953ec4,0xbec4bf35,0xbe953f0e,0xbe48bec4,0xbdc93e48
.long 0x3f80,0x3f80,0x3f80,0x3f80,0x3f80,0x3ec43f6d,0x3f353f35,0x3f6d3ec4
.long 0x3f80,0x3f353f35,0x3f800000,0x3f35bf35,0x3f80,0x3f6d3ec4,0x3f35bf35,0xbec4bf6d
.long 0x3f80,0x3f800000,0xbf80,0xbf800000,0x3f80,0x3f6dbec4,0xbf35bf35,0xbec43f6d
.long 0x3f80,0x3f35bf35,0xbf800000,0x3f353f35,0x3f80,0x3ec4bf6d,0xbf353f35,0x3f6dbec4
.long 0x3f80,0xbf80,0x3f80,0xbf80,0x3f80,0xbec4bf6d,0x3f353f35,0xbf6dbec4
.long 0x3f80,0xbf35bf35,0x3f800000,0xbf353f35,0x3f80,0xbf6dbec4,0x3f35bf35,0x3ec43f6d
.long 0x3f80,0xbf800000,0xbf80,0x3f800000,0x3f80,0xbf6d3ec4,0xbf35bf35,0x3ec4bf6d
.long 0x3f80,0xbf353f35,0xbf800000,0xbf35bf35,0x3f80,0xbec43f6d,0xbf353f35,0xbf6d3ec4
.long 0x3f80,0x3f80,0x3f80,0x3f80,0x3f800000,0x3f6dbec4,0x3f35bf35,0x3ec4bf6d
.long 0xbf80,0xbf35bf35,0xbf800000,0xbf353f35,0xbf800000,0xbec43f6d,0x3f353f35,0x3f6dbec4
.long 0x3f80,0x3f800000,0xbf80,0xbf800000,0x3f800000,0xbec4bf6d,0xbf353f35,0x3f6d3ec4
.long 0xbf80,0xbf353f35,0x3f800000,0xbf35bf35,0xbf800000,0x3f6d3ec4,0xbf35bf35,0x3ec43f6d
.long 0x3f80,0xbf80,0x3f80,0xbf80,0x3f800000,0xbf6d3ec4,0x3f35bf35,0xbec43f6d
.long 0xbf80,0x3f353f35,0xbf800000,0x3f35bf35,0xbf800000,0x3ec4bf6d,0x3f353f35,0xbf6d3ec4
.long 0x3f80,0xbf800000,0xbf80,0x3f800000,0x3f800000,0x3ec43f6d,0xbf353f35,0xbf6dbec4
.long 0xbf80,0x3f35bf35,0x3f800000,0x3f353f35,0xbf800000,0xbf6dbec4,0xbf35bf35,0xbec4bf6d
.long 0x3f80,0x3f80,0x3f80,0x3f80,0xbf80,0xbec4bf6d,0xbf35bf35,0xbf6dbec4
.long 0x3f80,0x3f353f35,0x3f800000,0x3f35bf35,0xbf80,0xbf6dbec4,0xbf353f35,0x3ec43f6d
.long 0x3f80,0x3f800000,0xbf80,0xbf800000,0xbf80,0xbf6d3ec4,0x3f353f35,0x3ec4bf6d
.long 0x3f80,0x3f35bf35,0xbf800000,0x3f353f35,0xbf80,0xbec43f6d,0x3f35bf35,0xbf6d3ec4
.long 0x3f80,0xbf80,0x3f80,0xbf80,0xbf80,0x3ec43f6d,0xbf35bf35,0x3f6d3ec4
.long 0x3f80,0xbf35bf35,0x3f800000,0xbf353f35,0xbf80,0x3f6d3ec4,0xbf353f35,0xbec4bf6d
.long 0x3f80,0xbf800000,0xbf80,0x3f800000,0xbf80,0x3f6dbec4,0x3f353f35,0xbec43f6d
.long 0x3f80,0xbf353f35,0xbf800000,0xbf35bf35,0xbf80,0x3ec4bf6d,0x3f35bf35,0x3f6dbec4
.long 0x3f80,0x3f80,0x3f80,0x3f80,0xbf800000,0xbf6d3ec4,0xbf353f35,0xbec43f6d
.long 0xbf80,0xbf35bf35,0xbf800000,0xbf353f35,0x3f800000,0x3ec4bf6d,0xbf35bf35,0xbf6d3ec4
.long 0x3f80,0x3f800000,0xbf80,0xbf800000,0xbf800000,0x3ec43f6d,0x3f35bf35,0xbf6dbec4
.long 0xbf80,0xbf353f35,0x3f800000,0xbf35bf35,0x3f800000,0xbf6dbec4,0x3f353f35,0xbec4bf6d
.long 0x3f80,0xbf80,0x3f80,0xbf80,0xbf800000,0x3f6dbec4,0xbf353f35,0x3ec4bf6d
.long 0xbf80,0x3f353f35,0xbf800000,0x3f35bf35,0x3f800000,0xbec43f6d,0xbf35bf35,0x3f6dbec4
.long 0x3f80,0xbf800000,0xbf80,0x3f800000,0xbf800000,0xbec4bf6d,0x3f35bf35,0x3f6d3ec4
.long 0xbf80,0x3f35bf35,0x3f800000,0x3f353f35,0x3f800000,0x3f6d3ec4,0x3f353f35,0x3ec43f6d
.long 0x3f808000,0x3f808000,0x3f808000,0x3f808000,0x3f808000,0x3f6dbec4,0x3f35bf35,0x3ec4bf6d
.long 0x3f808000,0x3f35bf35,0xbf80,0xbf35bf35,0x3f808000,0x3ec4bf6d,0xbf35bf35,0xbf6d3ec4
.long 0x3f808000,0xbf80,0xbf808000,0x3f80,0x3f808000,0xbec4bf6d,0xbf353f35,0x3f6d3ec4
.long 0x3f808000,0xbf35bf35,0x3f80,0x3f35bf35,0x3f808000,0xbf6dbec4,0x3f353f35,0xbec4bf6d
.long 0x3f808000,0xbf808000,0x3f808000,0xbf808000,0x3f808000,0xbf6d3ec4,0x3f35bf35,0xbec43f6d
.long 0x3f808000,0xbf353f35,0xbf80,0x3f353f35,0x3f808000,0xbec43f6d,0xbf35bf35,0x3f6dbec4
.long 0x3f808000,0x3f80,0xbf808000,0xbf80,0x3f808000,0x3ec43f6d,0xbf353f35,0xbf6dbec4
.long 0x3f808000,0x3f353f35,0x3f80,0xbf353f35,0x3f808000,0x3f6d3ec4,0x3f353f35,0x3ec43f6d
.long 0x3f808000,0x3f808000,0x3f808000,0x3f808000,0xbf80,0xbec4bf6d,0xbf35bf35,0xbf6dbec4
.long 0xbf808000,0xbf353f35,0x3f80,0x3f353f35,0x3f80,0x3f6d3ec4,0x3f35bf35,0xbec4bf6d
.long 0x3f808000,0xbf80,0xbf808000,0x3f80,0xbf80,0xbf6d3ec4,0x3f353f35,0x3ec4bf6d
.long 0xbf808000,0x3f353f35,0xbf80,0xbf353f35,0x3f80,0x3ec4bf6d,0xbf353f35,0x3f6dbec4
.long 0x3f808000,0xbf808000,0x3f808000,0xbf808000,0xbf80,0x3ec43f6d,0xbf35bf35,0x3f6d3ec4
.long 0xbf808000,0x3f35bf35,0x3f80,0xbf35bf35,0x3f80,0xbf6dbec4,0x3f35bf35,0x3ec43f6d
.long 0x3f808000,0x3f80,0xbf808000,0xbf80,0xbf80,0x3f6dbec4,0x3f353f35,0xbec43f6d
.long 0xbf808000,0xbf35bf35,0xbf80,0x3f35bf35,0x3f80,0xbec43f6d,0xbf353f35,0xbf6d3ec4
.long 0x3f808000,0x3f808000,0x3f808000,0x3f808000,0xbf808000,0xbf6d3ec4,0xbf353f35,0xbec43f6d
.long 0x3f808000,0x3f35bf35,0xbf80,0xbf35bf35,0xbf808000,0xbec43f6d,0x3f353f35,0x3f6dbec4
.long 0x3f808000,0xbf80,0xbf808000,0x3f80,0xbf808000,0x3ec43f6d,0x3f35bf35,0xbf6dbec4
.long 0x3f808000,0xbf35bf35,0x3f80,0x3f35bf35,0xbf808000,0x3f6d3ec4,0xbf35bf35,0x3ec43f6d
.long 0x3f808000,0xbf808000,0x3f808000,0xbf808000,0xbf808000,0x3f6dbec4,0xbf353f35,0x3ec4bf6d
.long 0x3f808000,0xbf353f35,0xbf80,0x3f353f35,0xbf808000,0x3ec4bf6d,0x3f353f35,0xbf6d3ec4
.long 0x3f808000,0x3f80,0xbf808000,0xbf80,0xbf808000,0xbec4bf6d,0x3f35bf35,0x3f6d3ec4
.long 0x3f808000,0x3f353f35,0x3f80,0xbf353f35,0xbf808000,0xbf6dbec4,0xbf35bf35,0xbec4bf6d
.long 0x3f808000,0x3f808000,0x3f808000,0x3f808000,0x3f80,0x3ec43f6d,0x3f353f35,0x3f6d3ec4
.long 0xbf808000,0xbf353f35,0x3f80,0x3f353f35,0xbf80,0xbf6dbec4,0xbf353f35,0x3ec43f6d
.long 0x3f808000,0xbf80,0xbf808000,0x3f80,0x3f80,0x3f6dbec4,0xbf35bf35,0xbec43f6d
.long 0xbf808000,0x3f353f35,0xbf80,0xbf353f35,0xbf80,0xbec43f6d,0x3f35bf35,0xbf6d3ec4
.long 0x3f808000,0xbf808000,0x3f808000,0xbf808000,0x3f80,0xbec4bf6d,0x3f353f35,0xbf6dbec4
.long 0xbf808000,0x3f35bf35,0x3f80,0xbf35bf35,0xbf80,0x3f6d3ec4,0xbf353f35,0xbec4bf6d
.long 0x3f808000,0x3f80,0xbf808000,0xbf80,0x3f80,0xbf6d3ec4,0xbf35bf35,0x3ec4bf6d
.long 0xbf808000,0xbf35bf35,0xbf80,0x3f35bf35,0xbf80,0x3ec4bf6d,0x3f35bf35,0x3f6dbec4
.long 0x80003f80,0x80003f80,0x80003f80,0x80003f80,0x80003f80,0xbec43f6d,0xbf353f35,0xbf6d3ec4
.long 0x80003f80,0xbf353f35,0xbf800000,0xbf35bf35,0x80003f80,0xbf6d3ec4,0xbf35bf35,0x3ec4bf6d
.long 0x80003f80,0xbf800000,0x8000bf80,0x3f800000,0x80003f80,0xbf6dbec4,0x3f35bf35,0x3ec43f6d
.long 0x80003f80,0xbf35bf35,0x3f800000,0xbf353f35,0x80003f80,0xbec4bf6d,0x3f353f35,0xbf6dbec4
.long 0x80003f80,0x8000bf80,0x80003f80,0x8000bf80,0x80003f80,0x3ec4bf6d,0xbf353f35,0x3f6dbec4
.long 0x80003f80,0x3f35bf35,0xbf800000,0x3f353f35,0x80003f80,0x3f6dbec4,0xbf35bf35,0xbec43f6d
.long 0x80003f80,0x3f800000,0x8000bf80,0xbf800000,0x80003f80,0x3f6d3ec4,0x3f35bf35,0xbec4bf6d
.long 0x80003f80,0x3f353f35,0x3f800000,0x3f35bf35,0x80003f80,0x3ec43f6d,0x3f353f35,0x3f6d3ec4
.long 0x80003f80,0x80003f80,0x80003f80,0x80003f80,0xbf800000,0xbf6dbec4,0xbf35bf35,0xbec4bf6d
.long 0x8000bf80,0x3f35bf35,0x3f800000,0x3f353f35,0x3f800000,0x3ec43f6d,0xbf353f35,0xbf6dbec4
.long 0x80003f80,0xbf800000,0x8000bf80,0x3f800000,0xbf800000,0x3ec4bf6d,0x3f353f35,0xbf6d3ec4
.long 0x8000bf80,0x3f353f35,0xbf800000,0x3f35bf35,0x3f800000,0xbf6d3ec4,0x3f35bf35,0xbec43f6d
.long 0x80003f80,0x8000bf80,0x80003f80,0x8000bf80,0xbf800000,0x3f6d3ec4,0xbf35bf35,0x3ec43f6d
.long 0x8000bf80,0xbf353f35,0x3f800000,0xbf35bf35,0x3f800000,0xbec4bf6d,0xbf353f35,0x3f6d3ec4
.long 0x80003f80,0x3f800000,0x8000bf80,0xbf800000,0xbf800000,0xbec43f6d,0x3f353f35,0x3f6dbec4
.long 0x8000bf80,0xbf35bf35,0xbf800000,0xbf353f35,0x3f800000,0x3f6dbec4,0x3f35bf35,0x3ec4bf6d
.long 0x80003f80,0x80003f80,0x80003f80,0x80003f80,0x8000bf80,0x3ec4bf6d,0x3f35bf35,0x3f6dbec4
.long 0x80003f80,0xbf353f35,0xbf800000,0xbf35bf35,0x8000bf80,0x3f6dbec4,0x3f353f35,0xbec43f6d
.long 0x80003f80,0xbf800000,0x8000bf80,0x3f800000,0x8000bf80,0x3f6d3ec4,0xbf353f35,0xbec4bf6d
.long 0x80003f80,0xbf35bf35,0x3f800000,0xbf353f35,0x8000bf80,0x3ec43f6d,0xbf35bf35,0x3f6d3ec4
.long 0x80003f80,0x8000bf80,0x80003f80,0x8000bf80,0x8000bf80,0xbec43f6d,0x3f35bf35,0xbf6d3ec4
.long 0x80003f80,0x3f35bf35,0xbf800000,0x3f353f35,0x8000bf80,0xbf6d3ec4,0x3f353f35,0x3ec4bf6d
.long 0x80003f80,0x3f800000,0x8000bf80,0xbf800000,0x8000bf80,0xbf6dbec4,0xbf353f35,0x3ec43f6d
.long 0x80003f80,0x3f353f35,0x3f800000,0x3f35bf35,0x8000bf80,0xbec4bf6d,0xbf35bf35,0xbf6dbec4
.long 0x80003f80,0x80003f80,0x80003f80,0x80003f80,0x3f800000,0x3f6d3ec4,0x3f353f35,0x3ec43f6d
.long 0x8000bf80,0x3f35bf35,0x3f800000,0x3f353f35,0xbf800000,0xbec4bf6d,0x3f35bf35,0x3f6d3ec4
.long 0x80003f80,0xbf800000,0x8000bf80,0x3f800000,0x3f800000,0xbec43f6d,0xbf35bf35,0x3f6dbec4
.long 0x8000bf80,0x3f353f35,0xbf800000,0x3f35bf35,0xbf800000,0x3f6dbec4,0xbf353f35,0x3ec4bf6d
.long 0x80003f80,0x8000bf80,0x80003f80,0x8000bf80,0x3f800000,0xbf6dbec4,0x3f353f35,0xbec4bf6d
.long 0x8000bf80,0xbf353f35,0x3f800000,0xbf35bf35,0xbf800000,0x3ec43f6d,0x3f35bf35,0xbf6dbec4
.long 0x80003f80,0x3f800000,0x8000bf80,0xbf800000,0x3f800000,0x3ec4bf6d,0xbf35bf35,0xbf6d3ec4
.long 0x8000bf80,0xbf35bf35,0xbf800000,0xbf353f35,0xbf800000,0xbf6d3ec4,0xbf353f35,0xbec43f6d
.long 0x3f800000,0x3f800000,0x3f800000,0x3f800000,0x3f800000,0x3f6d3ec4,0x3f353f35,0x3ec43f6d
.long 0x3f800000,0x3f353f35,0x3f80,0xbf353f35,0x3f800000,0x3ec43f6d,0xbf353f35,0xbf6dbec4
.long 0x3f800000,0x3f80,0xbf800000,0xbf80,0x3f800000,0xbec43f6d,0xbf35bf35,0x3f6dbec4
.long 0x3f800000,0xbf353f35,0xbf80,0x3f353f35,0x3f800000,0xbf6d3ec4,0x3f35bf35,0xbec43f6d
.long 0x3f800000,0xbf800000,0x3f800000,0xbf800000,0x3f800000,0xbf6dbec4,0x3f353f35,0xbec4bf6d
.long 0x3f800000,0xbf35bf35,0x3f80,0x3f35bf35,0x3f800000,0xbec4bf6d,0xbf353f35,0x3f6d3ec4
.long 0x3f800000,0xbf80,0xbf800000,0x3f80,0x3f800000,0x3ec4bf6d,0xbf35bf35,0xbf6d3ec4
.long 0x3f800000,0x3f35bf35,0xbf80,0xbf35bf35,0x3f800000,0x3f6dbec4,0x3f35bf35,0x3ec4bf6d
.long 0x3f800000,0x3f800000,0x3f800000,0x3f800000,0x3f80,0xbec43f6d,0xbf353f35,0xbf6d3ec4
.long 0xbf800000,0xbf35bf35,0xbf80,0x3f35bf35,0xbf80,0x3f6dbec4,0x3f353f35,0xbec43f6d
.long 0x3f800000,0x3f80,0xbf800000,0xbf80,0x3f80,0xbf6dbec4,0x3f35bf35,0x3ec43f6d
.long 0xbf800000,0x3f35bf35,0x3f80,0xbf35bf35,0xbf80,0x3ec43f6d,0xbf35bf35,0x3f6d3ec4
.long 0x3f800000,0xbf800000,0x3f800000,0xbf800000,0x3f80,0x3ec4bf6d,0xbf353f35,0x3f6dbec4
.long 0xbf800000,0x3f353f35,0xbf80,0xbf353f35,0xbf80,0xbf6d3ec4,0x3f353f35,0x3ec4bf6d
.long 0x3f800000,0xbf80,0xbf800000,0x3f80,0x3f80,0x3f6d3ec4,0x3f35bf35,0xbec4bf6d
.long 0xbf800000,0xbf353f35,0x3f80,0x3f353f35,0xbf80,0xbec4bf6d,0xbf35bf35,0xbf6dbec4
.long 0x3f800000,0x3f800000,0x3f800000,0x3f800000,0xbf800000,0xbf6dbec4,0xbf35bf35,0xbec4bf6d
.long 0x3f800000,0x3f353f35,0x3f80,0xbf353f35,0xbf800000,0xbec4bf6d,0x3f35bf35,0x3f6d3ec4
.long 0x3f800000,0x3f80,0xbf800000,0xbf80,0xbf800000,0x3ec4bf6d,0x3f353f35,0xbf6d3ec4
.long 0x3f800000,0xbf353f35,0xbf80,0x3f353f35,0xbf800000,0x3f6dbec4,0xbf353f35,0x3ec4bf6d
.long 0x3f800000,0xbf800000,0x3f800000,0xbf800000,0xbf800000,0x3f6d3ec4,0xbf35bf35,0x3ec43f6d
.long 0x3f800000,0xbf35bf35,0x3f80,0x3f35bf35,0xbf800000,0x3ec43f6d,0x3f35bf35,0xbf6dbec4
.long 0x3f800000,0xbf80,0xbf800000,0x3f80,0xbf800000,0xbec43f6d,0x3f353f35,0x3f6dbec4
.long 0x3f800000,0x3f35bf35,0xbf80,0xbf35bf35,0xbf800000,0xbf6d3ec4,0xbf353f35,0xbec43f6d
.long 0x3f800000,0x3f800000,0x3f800000,0x3f800000,0xbf80,0x3ec4bf6d,0x3f35bf35,0x3f6dbec4
.long 0xbf800000,0xbf35bf35,0xbf80,0x3f35bf35,0x3f80,0xbf6d3ec4,0xbf35bf35,0x3ec4bf6d
.long 0x3f800000,0x3f80,0xbf800000,0xbf80,0xbf80,0x3f6d3ec4,0xbf353f35,0xbec4bf6d
.long 0xbf800000,0x3f35bf35,0x3f80,0xbf35bf35,0x3f80,0xbec4bf6d,0x3f353f35,0xbf6dbec4
.long 0x3f800000,0xbf800000,0x3f800000,0xbf800000,0xbf80,0xbec43f6d,0x3f35bf35,0xbf6d3ec4
.long 0xbf800000,0x3f353f35,0xbf80,0xbf353f35,0x3f80,0x3f6dbec4,0xbf35bf35,0xbec43f6d
.long 0x3f800000,0xbf80,0xbf800000,0x3f80,0xbf80,0xbf6dbec4,0xbf353f35,0x3ec43f6d
.long 0xbf800000,0xbf353f35,0x3f80,0x3f353f35,0x3f80,0x3ec43f6d,0x3f353f35,0x3f6d3ec4
.long 0x3f80,0x3f80,0x3f80,0x3f80,0x3f808000,0x3f808000,0x3f808000,0x3f808000
.long 0x3f80,0x3f353f35,0x3f800000,0x3f35bf35,0x3f808000,0x3f35bf35,0xbf80,0xbf35bf35
.long 0x0,0x0,0x0,0x0,0x0,0x0,0x0,0x0
.long 0x0,0x0,0x0,0x0,0x0,0x0,0x0,0x0
.long 0x3f80,0x3f800000,0xbf80,0xbf800000,0x3f808000,0xbf80,0xbf808000,0x3f80
.long 0x3f80,0x3f35bf35,0xbf800000,0x3f353f35,0x3f808000,0xbf35bf35,0x3f80,0x3f35bf35
.long 0x0,0x0,0x0,0x0,0x0,0x0,0x0,0x0
.long 0x0,0x0,0x0,0x0,0x0,0x0,0x0,0x0
.long 0x3f80,0xbf80,0x3f80,0xbf80,0x3f808000,0xbf808000,0x3f808000,0xbf808000
.long 0x3f80,0xbf35bf35,0x3f800000,0xbf353f35,0x3f808000,0xbf353f35,0xbf80,0x3f353f35
.long 0x0,0x0,0x0,0x0,0x0,0x0,0x0,0x0
.long 0x0,0x0,0x0,0x0,0x0,0x0,0x0,0x0
.long 0x3f80,0xbf800000,0xbf80,0x3f800000,0x3f808000,0x3f80,0xbf808000,0xbf80
.long 0x3f80,0xbf353f35,0xbf800000,0xbf35bf35,0x3f808000,0x3f353f35,0x3f80,0xbf353f35
.long 0x0,0x0,0x0,0x0,0x0,0x0,0x0,0x0
.long 0x0,0x0,0x0,0x0,0x0,0x0,0x0,0x0
.long 0x0,0x0,0x0,0x0,0x0,0x0,0x0,0x0
.long 0x0,0x0,0x0,0x0,0x0,0x0,0x0,0x0
.long 0x3f80,0x3f80,0x3f80,0x3f80,0x3f808000,0x3f808000,0x3f808000,0x3f808000
.long 0x3f80,0x3f353f35,0x3f800000,0x3f35bf35,0x3f808000,0x3f35bf35,0xbf80,0xbf35bf35
.long 0x0,0x0,0x0,0x0,0x0,0x0,0x0,0x0
.long 0x0,0x0,0x0,0x0,0x0,0x0,0x0,0x0
.long 0x3f80,0x3f800000,0xbf80,0xbf800000,0x3f808000,0xbf80,0xbf808000,0x3f80
.long 0x3f80,0x3f35bf35,0xbf800000,0x3f353f35,0x3f808000,0xbf35bf35,0x3f80,0x3f35bf35
.long 0x0,0x0,0x0,0x0,0x0,0x0,0x0,0x0
.long 0x0,0x0,0x0,0x0,0x0,0x0,0x0,0x0
.long 0x3f80,0xbf80,0x3f80,0xbf80,0x3f808000,0xbf808000,0x3f808000,0xbf808000
.long 0x3f80,0xbf35bf35,0x3f800000,0xbf353f35,0x3f808000,0xbf353f35,0xbf80,0x3f353f35
.long 0x0,0x0,0x0,0x0,0x0,0x0,0x0,0x0
.long 0x0,0x0,0x0,0x0,0x0,0x0,0x0,0x0
.long 0x3f80,0xbf800000,0xbf80,0x3f800000,0x3f808000,0x3f80,0xbf808000,0xbf80
.long 0x3f80,0xbf353f35,0xbf800000,0xbf35bf35,0x3f808000,0x3f353f35,0x3f80,0xbf353f35
.long 0x3f80,0x3f80,0x3f80,0x3f80,0x3f808000,0x3f808000,0x3f808000,0x3f808000
.long 0xbf80,0xbf35bf35,0xbf800000,0xbf353f35,0xbf808000,0xbf353f35,0x3f80,0x3f353f35
.long 0x0,0x0,0x0,0x0,0x0,0x0,0x0,0x0
.long 0x0,0x0,0x0,0x0,0x0,0x0,0x0,0x0
.long 0x3f80,0x3f800000,0xbf80,0xbf800000,0x3f808000,0xbf80,0xbf808000,0x3f80
.long 0xbf80,0xbf353f35,0x3f800000,0xbf35bf35,0xbf808000,0x3f353f35,0xbf80,0xbf353f35
.long 0x0,0x0,0x0,0x0,0x0,0x0,0x0,0x0
.long 0x0,0x0,0x0,0x0,0x0,0x0,0x0,0x0
.long 0x3f80,0xbf80,0x3f80,0xbf80,0x3f808000,0xbf808000,0x3f808000,0xbf808000
.long 0xbf80,0x3f353f35,0xbf800000,0x3f35bf35,0xbf808000,0x3f35bf35,0x3f80,0xbf35bf35
.long 0x0,0x0,0x0,0x0,0x0,0x0,0x0,0x0
.long 0x0,0x0,0x0,0x0,0x0,0x0,0x0,0x0
.long 0x3f80,0xbf800000,0xbf80,0x3f800000,0x3f808000,0x3f80,0xbf808000,0xbf80
.long 0xbf80,0x3f35bf35,0x3f800000,0x3f353f35,0xbf808000,0xbf35bf35,0xbf80,0x3f35bf35
.long 0x0,0x0,0x0,0x0,0x0,0x0,0x0,0x0
.long 0x0,0x0,0x0,0x0,0x0,0x0,0x0,0x0
.long 0x0,0x0,0x0,0x0,0x0,0x0,0x0,0x0
.long 0x0,0x0,0x0,0x0,0x0,0x0,0x0,0x0
.long 0x3f80,0x3f80,0x3f80,0x3f80,0x3f808000,0x3f808000,0x3f808000,0x3f808000
.long 0xbf80,0xbf35bf35,0xbf800000,0xbf353f35,0xbf808000,0xbf353f35,0x3f80,0x3f353f35
.long 0x0,0x0,0x0,0x0,0x0,0x0,0x0,0x0
.long 0x0,0x0,0x0,0x0,0x0,0x0,0x0,0x0
.long 0x3f80,0x3f800000,0xbf80,0xbf800000,0x3f808000,0xbf80,0xbf808000,0x3f80
.long 0xbf80,0xbf353f35,0x3f800000,0xbf35bf35,0xbf808000,0x3f353f35,0xbf80,0xbf353f35
.long 0x0,0x0,0x0,0x0,0x0,0x0,0x0,0x0
.long 0x0,0x0,0x0,0x0,0x0,0x0,0x0,0x0
.long 0x3f80,0xbf80,0x3f80,0xbf80,0x3f808000,0xbf808000,0x3f808000,0xbf808000
.long 0xbf80,0x3f353f35,0xbf800000,0x3f35bf35,0xbf808000,0x3f35bf35,0x3f80,0xbf35bf35
.long 0x0,0x0,0x0,0x0,0x0,0x0,0x0,0x0
.long 0x0,0x0,0x0,0x0,0x0,0x0,0x0,0x0
.long 0x3f80,0xbf800000,0xbf80,0x3f800000,0x3f808000,0x3f80,0xbf808000,0xbf80
.long 0xbf80,0x3f35bf35,0x3f800000,0x3f353f35,0xbf808000,0xbf35bf35,0xbf80,0x3f35bf35
.long 0x80003f80,0x80003f80,0x80003f80,0x80003f80,0x80003f80,0xbe483f7b,0xbec43f6d,0xbf0e3f55
.long 0x80003f80,0xbec43f6d,0xbf353f35,0xbf6d3ec4,0x80003f80,0xbf0e3f55,0xbf6d3ec4,0xbf7bbe48
.long 0x80003f80,0xbf800000,0x8000bf80,0x3f800000,0x80003f80,0xbf7bbe48,0x3ec4bf6d,0x3f553f0e
.long 0x80003f80,0xbf6dbec4,0x3f35bf35,0x3ec43f6d,0x80003f80,0xbf55bf0e,0x3f6dbec4,0xbe483f7b
.long 0x80003f80,0x8000bf80,0x80003f80,0x8000bf80,0x80003f80,0x3e48bf7b,0xbec43f6d,0x3f0ebf55
.long 0x80003f80,0x3ec4bf6d,0xbf353f35,0x3f6dbec4,0x80003f80,0x3f0ebf55,0xbf6d3ec4,0x3f7b3e48
.long 0x80003f80,0x3f800000,0x8000bf80,0xbf800000,0x80003f80,0x3f7b3e48,0x3ec4bf6d,0xbf55bf0e
.long 0x80003f80,0x3f6d3ec4,0x3f35bf35,0xbec4bf6d,0x80003f80,0x3f553f0e,0x3f6dbec4,0x3e48bf7b
.long 0x80003f80,0x80003f80,0x80003f80,0x80003f80,0xbf353f35,0xbf553f0e,0xbf6d3ec4,0xbf7b3e48
.long 0xbf800000,0xbf6dbec4,0xbf35bf35,0xbec4bf6d,0xbf35bf35,0xbe48bf7b,0x3ec4bf6d,0x3f55bf0e
.long 0x80003f80,0xbf800000,0x8000bf80,0x3f800000,0xbf353f35,0xbf0ebf55,0x3f6dbec4,0x3e483f7b
.long 0xbf800000,0x3ec4bf6d,0x3f353f35,0xbf6d3ec4,0xbf35bf35,0x3f7bbe48,0xbec43f6d,0xbf0ebf55
.long 0x80003f80,0x8000bf80,0x80003f80,0x8000bf80,0xbf353f35,0x3f55bf0e,0xbf6d3ec4,0x3f7bbe48
.long 0xbf800000,0x3f6d3ec4,0xbf35bf35,0x3ec43f6d,0xbf35bf35,0x3e483f7b,0x3ec4bf6d,0xbf553f0e
.long 0x80003f80,0x3f800000,0x8000bf80,0xbf800000,0xbf353f35,0x3f0e3f55,0x3f6dbec4,0xbe48bf7b
.long 0xbf800000,0xbec43f6d,0x3f353f35,0x3f6dbec4,0xbf35bf35,0xbf7b3e48,0xbec43f6d,0x3f0e3f55
.long 0x80003f80,0x80003f80,0x80003f80,0x80003f80,0xbf800000,0xbf7bbe48,0xbf6dbec4,0xbf55bf0e
.long 0x8000bf80,0x3ec4bf6d,0x3f35bf35,0x3f6dbec4,0x3f800000,0x3f553f0e,0x3ec43f6d,0xbe483f7b
.long 0x80003f80,0xbf800000,0x8000bf80,0x3f800000,0xbf800000,0x3e48bf7b,0x3f6d3ec4,0xbf0e3f55
.long 0x8000bf80,0x3f6d3ec4,0xbf353f35,0xbec4bf6d,0x3f800000,0xbf0e3f55,0xbec4bf6d,0x3f7b3e48
.long 0x80003f80,0x8000bf80,0x80003f80,0x8000bf80,0xbf800000,0x3f7b3e48,0xbf6dbec4,0x3f553f0e
.long 0x8000bf80,0xbec43f6d,0x3f35bf35,0xbf6d3ec4,0x3f800000,0xbf55bf0e,0x3ec43f6d,0x3e48bf7b
.long 0x80003f80,0x3f800000,0x8000bf80,0xbf800000,0xbf800000,0xbe483f7b,0x3f6d3ec4,0x3f0ebf55
.long 0x8000bf80,0xbf6dbec4,0xbf353f35,0x3ec43f6d,0x3f800000,0x3f0ebf55,0xbec4bf6d,0xbf7bbe48
.long 0x80003f80,0x80003f80,0x80003f80,0x80003f80,0xbf35bf35,0xbf0ebf55,0xbec4bf6d,0xbe48bf7b
.long 0x3f800000,0x3f6d3ec4,0x3f353f35,0x3ec43f6d,0xbf353f35,0xbf7b3e48,0xbf6dbec4,0xbf0ebf55
.long 0x80003f80,0xbf800000,0x8000bf80,0x3f800000,0xbf35bf35,0x3f55bf0e,0x3ec43f6d,0xbf7b3e48
.long 0x3f800000,0xbec43f6d,0xbf35bf35,0x3f6dbec4,0xbf353f35,0xbe48bf7b,0x3f6d3ec4,0xbf553f0e
.long 0x80003f80,0x8000bf80,0x80003f80,0x8000bf80,0xbf35bf35,0x3f0e3f55,0xbec4bf6d,0x3e483f7b
.long 0x3f800000,0xbf6dbec4,0x3f353f35,0xbec4bf6d,0xbf353f35,0x3f7bbe48,0xbf6dbec4,0x3f0e3f55
.long 0x80003f80,0x3f800000,0x8000bf80,0xbf800000,0xbf35bf35,0xbf553f0e,0x3ec43f6d,0x3f7bbe48
.long 0x3f800000,0x3ec4bf6d,0xbf35bf35,0xbf6d3ec4,0xbf353f35,0x3e483f7b,0x3f6d3ec4,0x3f55bf0e
.long 0x3f80,0x3f80,0x3f80,0x3f80,0xbf80,0xbe48bf7b,0xbec4bf6d,0xbf0ebf55
.long 0x3f80,0x3ec43f6d,0x3f353f35,0x3f6d3ec4,0xbf80,0xbf0ebf55,0xbf6dbec4,0xbf7b3e48
.long 0x3f80,0x3f800000,0xbf80,0xbf800000,0xbf80,0xbf7b3e48,0x3ec43f6d,0x3f55bf0e
.long 0x3f80,0x3f6dbec4,0xbf35bf35,0xbec43f6d,0xbf80,0xbf553f0e,0x3f6d3ec4,0xbe48bf7b
.long 0x3f80,0xbf80,0x3f80,0xbf80,0xbf80,0x3e483f7b,0xbec4bf6d,0x3f0e3f55
.long 0x3f80,0xbec4bf6d,0x3f353f35,0xbf6dbec4,0xbf80,0x3f0e3f55,0xbf6dbec4,0x3f7bbe48
.long 0x3f80,0xbf800000,0xbf80,0x3f800000,0xbf80,0x3f7bbe48,0x3ec43f6d,0xbf553f0e
.long 0x3f80,0xbf6d3ec4,0xbf35bf35,0x3ec4bf6d,0xbf80,0x3f55bf0e,0x3f6d3ec4,0x3e483f7b
.long 0x3f80,0x3f80,0x3f80,0x3f80,0xbf35bf35,0xbf55bf0e,0xbf6dbec4,0xbf7bbe48
.long 0x3f800000,0x3f6dbec4,0x3f35bf35,0x3ec4bf6d,0xbf353f35,0xbe483f7b,0x3ec43f6d,0x3f553f0e
.long 0x3f80,0x3f800000,0xbf80,0xbf800000,0xbf35bf35,0xbf0e3f55,0x3f6d3ec4,0x3e48bf7b
.long 0x3f800000,0xbec4bf6d,0xbf353f35,0x3f6d3ec4,0xbf353f35,0x3f7b3e48,0xbec4bf6d,0xbf0e3f55
.long 0x3f80,0xbf80,0x3f80,0xbf80,0xbf35bf35,0x3f553f0e,0xbf6dbec4,0x3f7b3e48
.long 0x3f800000,0xbf6d3ec4,0x3f35bf35,0xbec43f6d,0xbf353f35,0x3e48bf7b,0x3ec43f6d,0xbf55bf0e
.long 0x3f80,0xbf800000,0xbf80,0x3f800000,0xbf35bf35,0x3f0ebf55,0x3f6d3ec4,0xbe483f7b
.long 0x3f800000,0x3ec43f6d,0xbf353f35,0xbf6dbec4,0xbf353f35,0xbf7bbe48,0xbec4bf6d,0x3f0ebf55
.long 0x3f80,0x3f80,0x3f80,0x3f80,0xbf800000,0xbf7b3e48,0xbf6d3ec4,0xbf553f0e
.long 0xbf80,0xbec4bf6d,0xbf35bf35,0xbf6dbec4,0x3f800000,0x3f55bf0e,0x3ec4bf6d,0xbe48bf7b
.long 0x3f80,0x3f800000,0xbf80,0xbf800000,0xbf800000,0x3e483f7b,0x3f6dbec4,0xbf0ebf55
.long 0xbf80,0xbf6d3ec4,0x3f353f35,0x3ec4bf6d,0x3f800000,0xbf0ebf55,0xbec43f6d,0x3f7bbe48
.long 0x3f80,0xbf80,0x3f80,0xbf80,0xbf800000,0x3f7bbe48,0xbf6d3ec4,0x3f55bf0e
.long 0xbf80,0x3ec43f6d,0xbf35bf35,0x3f6d3ec4,0x3f800000,0xbf553f0e,0x3ec4bf6d,0x3e483f7b
.long 0x3f80,0xbf800000,0xbf80,0x3f800000,0xbf800000,0xbe48bf7b,0x3f6dbec4,0x3f0e3f55
.long 0xbf80,0x3f6dbec4,0x3f353f35,0xbec43f6d,0x3f800000,0x3f0e3f55,0xbec43f6d,0xbf7b3e48
.long 0x3f80,0x3f80,0x3f80,0x3f80,0xbf353f35,0xbf0e3f55,0xbec43f6d,0xbe483f7b
.long 0xbf800000,0xbf6d3ec4,0xbf353f35,0xbec43f6d,0xbf35bf35,0xbf7bbe48,0xbf6d3ec4,0xbf0e3f55
.long 0x3f80,0x3f800000,0xbf80,0xbf800000,0xbf353f35,0x3f553f0e,0x3ec4bf6d,0xbf7bbe48
.long 0xbf800000,0x3ec43f6d,0x3f35bf35,0xbf6dbec4,0xbf35bf35,0xbe483f7b,0x3f6dbec4,0xbf55bf0e
.long 0x3f80,0xbf80,0x3f80,0xbf80,0xbf353f35,0x3f0ebf55,0xbec43f6d,0x3e48bf7b
.long 0xbf800000,0x3f6dbec4,0xbf353f35,0x3ec4bf6d,0xbf35bf35,0x3f7b3e48,0xbf6d3ec4,0x3f0ebf55
.long 0x3f80,0xbf800000,0xbf80,0x3f800000,0xbf353f35,0xbf55bf0e,0x3ec4bf6d,0x3f7b3e48
.long 0xbf800000,0xbec4bf6d,0x3f35bf35,0x3f6d3ec4,0xbf35bf35,0x3e48bf7b,0x3f6dbec4,0x3f553f0e
.long 0x3f800000,0x3f800000,0x3f800000,0x3f800000,0x3f800000,0x3f7b3e48,0x3f6d3ec4,0x3f553f0e
.long 0x3f800000,0x3f6d3ec4,0x3f353f35,0x3ec43f6d,0x3f800000,0x3f553f0e,0x3ec43f6d,0xbe483f7b
.long 0x3f800000,0x3f80,0xbf800000,0xbf80,0x3f800000,0xbe483f7b,0xbf6dbec4,0x3f0ebf55
.long 0x3f800000,0xbec43f6d,0xbf35bf35,0x3f6dbec4,0x3f800000,0xbf0e3f55,0xbec4bf6d,0x3f7b3e48
.long 0x3f800000,0xbf800000,0x3f800000,0xbf800000,0x3f800000,0xbf7bbe48,0x3f6d3ec4,0xbf55bf0e
.long 0x3f800000,0xbf6dbec4,0x3f353f35,0xbec4bf6d,0x3f800000,0xbf55bf0e,0x3ec43f6d,0x3e48bf7b
.long 0x3f800000,0xbf80,0xbf800000,0x3f80,0x3f800000,0x3e48bf7b,0xbf6dbec4,0xbf0e3f55
.long 0x3f800000,0x3ec4bf6d,0xbf35bf35,0xbf6d3ec4,0x3f800000,0x3f0ebf55,0xbec4bf6d,0xbf7bbe48
.long 0x3f800000,0x3f800000,0x3f800000,0x3f800000,0x3f353f35,0x3f0e3f55,0x3ec43f6d,0x3e483f7b
.long 0x3f80,0xbec43f6d,0xbf353f35,0xbf6d3ec4,0xbf353f35,0xbf7b3e48,0xbf6dbec4,0xbf0ebf55
.long 0x3f800000,0x3f80,0xbf800000,0xbf80,0x3f353f35,0xbf553f0e,0xbec4bf6d,0x3f7bbe48
.long 0x3f80,0xbf6dbec4,0x3f35bf35,0x3ec43f6d,0xbf353f35,0xbe48bf7b,0x3f6d3ec4,0xbf553f0e
.long 0x3f800000,0xbf800000,0x3f800000,0xbf800000,0x3f353f35,0xbf0ebf55,0x3ec43f6d,0xbe48bf7b
.long 0x3f80,0x3ec4bf6d,0xbf353f35,0x3f6dbec4,0xbf353f35,0x3f7bbe48,0xbf6dbec4,0x3f0e3f55
.long 0x3f800000,0xbf80,0xbf800000,0x3f80,0x3f353f35,0x3f55bf0e,0xbec4bf6d,0xbf7b3e48
.long 0x3f80,0x3f6d3ec4,0x3f35bf35,0xbec4bf6d,0xbf353f35,0x3e483f7b,0x3f6d3ec4,0x3f55bf0e
.long 0x3f800000,0x3f800000,0x3f800000,0x3f800000,0x3f80,0xbe483f7b,0xbec43f6d,0xbf0e3f55
.long 0xbf800000,0xbf6dbec4,0xbf35bf35,0xbec4bf6d,0xbf80,0x3f0ebf55,0x3f6dbec4,0x3f7b3e48
.long 0x3f800000,0x3f80,0xbf800000,0xbf80,0x3f80,0xbf7bbe48,0x3ec4bf6d,0x3f553f0e
.long 0xbf800000,0x3ec4bf6d,0x3f353f35,0xbf6d3ec4,0xbf80,0x3f553f0e,0xbf6d3ec4,0x3e48bf7b
.long 0x3f800000,0xbf800000,0x3f800000,0xbf800000,0x3f80,0x3e48bf7b,0xbec43f6d,0x3f0ebf55
.long 0xbf800000,0x3f6d3ec4,0xbf35bf35,0x3ec43f6d,0xbf80,0xbf0e3f55,0x3f6dbec4,0xbf7bbe48
.long 0x3f800000,0xbf80,0xbf800000,0x3f80,0x3f80,0x3f7b3e48,0x3ec4bf6d,0xbf55bf0e
.long 0xbf800000,0xbec43f6d,0x3f353f35,0x3f6dbec4,0xbf80,0xbf55bf0e,0xbf6d3ec4,0xbe483f7b
.long 0x3f800000,0x3f800000,0x3f800000,0x3f800000,0xbf353f35,0xbf553f0e,0xbf6d3ec4,0xbf7b3e48
.long 0xbf80,0x3ec4bf6d,0x3f35bf35,0x3f6dbec4,0x3f353f35,0x3e483f7b,0xbec43f6d,0xbf553f0e
.long 0x3f800000,0x3f80,0xbf800000,0xbf80,0xbf353f35,0xbf0ebf55,0x3f6dbec4,0x3e483f7b
.long 0xbf80,0x3f6d3ec4,0xbf353f35,0xbec4bf6d,0x3f353f35,0xbf7b3e48,0x3ec4bf6d,0x3f0e3f55
.long 0x3f800000,0xbf800000,0x3f800000,0xbf800000,0xbf353f35,0x3f55bf0e,0xbf6d3ec4,0x3f7bbe48
.long 0xbf80,0xbec43f6d,0x3f35bf35,0xbf6d3ec4,0x3f353f35,0xbe48bf7b,0xbec43f6d,0x3f55bf0e
.long 0x3f800000,0xbf80,0xbf800000,0x3f80,0xbf353f35,0x3f0e3f55,0x3f6dbec4,0xbe48bf7b
.long 0xbf80,0xbf6dbec4,0xbf353f35,0x3ec43f6d,0x3f353f35,0x3f7bbe48,0x3ec4bf6d,0xbf0ebf55
.long 0xbf800000,0xbf800000,0xbf800000,0xbf800000,0x3f800000,0x3f7bbe48,0x3f6dbec4,0x3f55bf0e
.long 0xbf800000,0xbf6d3ec4,0xbf353f35,0xbec43f6d,0x3f800000,0x3f55bf0e,0x3ec4bf6d,0xbe48bf7b
.long 0xbf800000,0x80003f80,0x3f800000,0x8000bf80,0x3f800000,0xbe48bf7b,0xbf6d3ec4,0x3f0e3f55
.long 0xbf800000,0x3ec43f6d,0x3f35bf35,0xbf6dbec4,0x3f800000,0xbf0ebf55,0xbec43f6d,0x3f7bbe48
.long 0xbf800000,0x3f800000,0xbf800000,0x3f800000,0x3f800000,0xbf7b3e48,0x3f6dbec4,0xbf553f0e
.long 0xbf800000,0x3f6dbec4,0xbf353f35,0x3ec4bf6d,0x3f800000,0xbf553f0e,0x3ec4bf6d,0x3e483f7b
.long 0xbf800000,0x8000bf80,0x3f800000,0x80003f80,0x3f800000,0x3e483f7b,0xbf6d3ec4,0xbf0ebf55
.long 0xbf800000,0xbec4bf6d,0x3f35bf35,0x3f6d3ec4,0x3f800000,0x3f0e3f55,0xbec43f6d,0xbf7b3e48
.long 0xbf800000,0xbf800000,0xbf800000,0xbf800000,0x3f35bf35,0x3f0ebf55,0x3ec4bf6d,0x3e48bf7b
.long 0x80003f80,0x3ec43f6d,0x3f353f35,0x3f6d3ec4,0xbf35bf35,0xbf7bbe48,0xbf6d3ec4,0xbf0e3f55
.long 0xbf800000,0x80003f80,0x3f800000,0x8000bf80,0x3f35bf35,0xbf55bf0e,0xbec43f6d,0x3f7b3e48
.long 0x80003f80,0x3f6dbec4,0xbf35bf35,0xbec43f6d,0xbf35bf35,0xbe483f7b,0x3f6dbec4,0xbf55bf0e
.long 0xbf800000,0x3f800000,0xbf800000,0x3f800000,0x3f35bf35,0xbf0e3f55,0x3ec4bf6d,0xbe483f7b
.long 0x80003f80,0xbec4bf6d,0x3f353f35,0xbf6dbec4,0xbf35bf35,0x3f7b3e48,0xbf6d3ec4,0x3f0ebf55
.long 0xbf800000,0x8000bf80,0x3f800000,0x80003f80,0x3f35bf35,0x3f553f0e,0xbec43f6d,0xbf7bbe48
.long 0x80003f80,0xbf6d3ec4,0xbf35bf35,0x3ec4bf6d,0xbf35bf35,0x3e48bf7b,0x3f6dbec4,0x3f553f0e
.long 0xbf800000,0xbf800000,0xbf800000,0xbf800000,0x8000bf80,0xbe48bf7b,0xbec4bf6d,0xbf0ebf55
.long 0x3f800000,0x3f6dbec4,0x3f35bf35,0x3ec4bf6d,0x80003f80,0x3f0e3f55,0x3f6d3ec4,0x3f7bbe48
.long 0xbf800000,0x80003f80,0x3f800000,0x8000bf80,0x8000bf80,0xbf7b3e48,0x3ec43f6d,0x3f55bf0e
.long 0x3f800000,0xbec4bf6d,0xbf353f35,0x3f6d3ec4,0x80003f80,0x3f55bf0e,0xbf6dbec4,0x3e483f7b
.long 0xbf800000,0x3f800000,0xbf800000,0x3f800000,0x8000bf80,0x3e483f7b,0xbec4bf6d,0x3f0e3f55
.long 0x3f800000,0xbf6d3ec4,0x3f35bf35,0xbec43f6d,0x80003f80,0xbf0ebf55,0x3f6d3ec4,0xbf7b3e48
.long 0xbf800000,0x8000bf80,0x3f800000,0x80003f80,0x8000bf80,0x3f7bbe48,0x3ec43f6d,0xbf553f0e
.long 0x3f800000,0x3ec43f6d,0xbf353f35,0xbf6dbec4,0x80003f80,0xbf553f0e,0xbf6dbec4,0xbe48bf7b
.long 0xbf800000,0xbf800000,0xbf800000,0xbf800000,0xbf35bf35,0xbf55bf0e,0xbf6dbec4,0xbf7bbe48
.long 0x8000bf80,0xbec4bf6d,0xbf35bf35,0xbf6dbec4,0x3f35bf35,0x3e48bf7b,0xbec4bf6d,0xbf55bf0e
.long 0xbf800000,0x80003f80,0x3f800000,0x8000bf80,0xbf35bf35,0xbf0e3f55,0x3f6d3ec4,0x3e48bf7b
.long 0x8000bf80,0xbf6d3ec4,0x3f353f35,0x3ec4bf6d,0x3f35bf35,0xbf7bbe48,0x3ec43f6d,0x3f0ebf55
.long 0xbf800000,0x3f800000,0xbf800000,0x3f800000,0xbf35bf35,0x3f553f0e,0xbf6dbec4,0x3f7b3e48
.long 0x8000bf80,0x3ec43f6d,0xbf35bf35,0x3f6d3ec4,0x3f35bf35,0xbe483f7b,0xbec4bf6d,0x3f553f0e
.long 0xbf800000,0x8000bf80,0x3f800000,0x80003f80,0xbf35bf35,0x3f0ebf55,0x3f6d3ec4,0xbe483f7b
.long 0x8000bf80,0x3f6dbec4,0x3f353f35,0xbec43f6d,0x3f35bf35,0x3f7b3e48,0x3ec43f6d,0xbf0e3f55
.long 0x80003f80,0xbf353f35,0xbf800000,0xbf35bf35,0x80003f80,0xbf553f0e,0xbf6dbec4,0xbe48bf7b
.long 0x80003f80,0xbf6d3ec4,0xbf35bf35,0x3ec4bf6d,0x80003f80,0xbf7b3e48,0xbec4bf6d,0x3f55bf0e
.long 0x80003f80,0xbf35bf35,0x3f800000,0xbf353f35,0x80003f80,0xbf0ebf55,0x3f6d3ec4,0xbf7b3e48
.long 0x80003f80,0xbec4bf6d,0x3f353f35,0xbf6dbec4,0x80003f80,0xbe48bf7b,0x3ec43f6d,0xbf0ebf55
.long 0x80003f80,0x3f35bf35,0xbf800000,0x3f353f35,0x80003f80,0x3f55bf0e,0xbf6dbec4,0x3e483f7b
.long 0x80003f80,0x3f6dbec4,0xbf35bf35,0xbec43f6d,0x80003f80,0x3f7bbe48,0xbec4bf6d,0xbf553f0e
.long 0x80003f80,0x3f353f35,0x3f800000,0x3f35bf35,0x80003f80,0x3f0e3f55,0x3f6d3ec4,0x3f7bbe48
.long 0x80003f80,0x3ec43f6d,0x3f353f35,0x3f6d3ec4,0x80003f80,0x3e483f7b,0x3ec43f6d,0x3f0e3f55
.long 0x8000bf80,0x3f35bf35,0x3f800000,0x3f353f35,0x3f35bf35,0x3f7b3e48,0x3ec43f6d,0xbf0e3f55
.long 0x3f800000,0x3ec43f6d,0xbf353f35,0xbf6dbec4,0x3f353f35,0xbf0e3f55,0xbf6dbec4,0x3e48bf7b
.long 0x8000bf80,0x3f353f35,0xbf800000,0x3f35bf35,0x3f35bf35,0xbe483f7b,0xbec4bf6d,0x3f553f0e
.long 0x3f800000,0xbf6d3ec4,0x3f35bf35,0xbec43f6d,0x3f353f35,0xbf55bf0e,0x3f6d3ec4,0xbf7bbe48
.long 0x8000bf80,0xbf353f35,0x3f800000,0xbf35bf35,0x3f35bf35,0xbf7bbe48,0x3ec43f6d,0x3f0ebf55
.long 0x3f800000,0xbec4bf6d,0xbf353f35,0x3f6d3ec4,0x3f353f35,0x3f0ebf55,0xbf6dbec4,0xbe483f7b
.long 0x8000bf80,0xbf35bf35,0xbf800000,0xbf353f35,0x3f35bf35,0x3e48bf7b,0xbec4bf6d,0xbf55bf0e
.long 0x3f800000,0x3f6dbec4,0x3f35bf35,0x3ec4bf6d,0x3f353f35,0x3f553f0e,0x3f6d3ec4,0x3f7b3e48
.long 0x80003f80,0xbf353f35,0xbf800000,0xbf35bf35,0xbf800000,0xbf0ebf55,0x3ec4bf6d,0x3f7bbe48
.long 0x8000bf80,0x3f6dbec4,0x3f353f35,0xbec43f6d,0x3f800000,0x3e483f7b,0xbf6d3ec4,0xbf0ebf55
.long 0x80003f80,0xbf35bf35,0x3f800000,0xbf353f35,0xbf800000,0x3f55bf0e,0xbec43f6d,0xbe48bf7b
.long 0x8000bf80,0x3ec43f6d,0xbf35bf35,0x3f6d3ec4,0x3f800000,0xbf7b3e48,0x3f6dbec4,0xbf553f0e
.long 0x80003f80,0x3f35bf35,0xbf800000,0x3f353f35,0xbf800000,0x3f0e3f55,0x3ec4bf6d,0xbf7b3e48
.long 0x8000bf80,0xbf6d3ec4,0x3f353f35,0x3ec4bf6d,0x3f800000,0xbe48bf7b,0xbf6d3ec4,0x3f0e3f55
.long 0x80003f80,0x3f353f35,0x3f800000,0x3f35bf35,0xbf800000,0xbf553f0e,0xbec43f6d,0x3e483f7b
.long 0x8000bf80,0xbec4bf6d,0xbf35bf35,0xbf6dbec4,0x3f800000,0x3f7bbe48,0x3f6dbec4,0x3f55bf0e
.long 0x8000bf80,0x3f35bf35,0x3f800000,0x3f353f35,0x3f353f35,0xbe483f7b,0xbf6d3ec4,0xbf55bf0e
.long 0xbf800000,0xbec4bf6d,0x3f35bf35,0x3f6d3ec4,0x3f35bf35,0x3f553f0e,0xbec43f6d,0xbf7bbe48
.long 0x8000bf80,0x3f353f35,0xbf800000,0x3f35bf35,0x3f353f35,0xbf7bbe48,0x3f6dbec4,0xbf0e3f55
.long 0xbf800000,0x3f6dbec4,0xbf353f35,0x3ec4bf6d,0x3f35bf35,0xbf0e3f55,0x3ec4bf6d,0xbe483f7b
.long 0x8000bf80,0xbf353f35,0x3f800000,0xbf35bf35,0x3f353f35,0x3e48bf7b,0xbf6d3ec4,0x3f553f0e
.long 0xbf800000,0x3ec43f6d,0x3f35bf35,0xbf6dbec4,0x3f35bf35,0xbf55bf0e,0xbec43f6d,0x3f7b3e48
.long 0x8000bf80,0xbf35bf35,0xbf800000,0xbf353f35,0x3f353f35,0x3f7b3e48,0x3f6dbec4,0x3f0ebf55
.long 0xbf800000,0xbf6d3ec4,0xbf353f35,0xbec43f6d,0x3f35bf35,0x3f0ebf55,0x3ec4bf6d,0x3e48bf7b
.long 0x3f80,0x3f353f35,0x3f800000,0x3f35bf35,0xbf80,0xbf55bf0e,0xbf6d3ec4,0xbe483f7b
.long 0x3f80,0x3f6d3ec4,0x3f35bf35,0xbec4bf6d,0xbf80,0xbf7bbe48,0xbec43f6d,0x3f553f0e
.long 0x3f80,0x3f35bf35,0xbf800000,0x3f353f35,0xbf80,0xbf0e3f55,0x3f6dbec4,0xbf7bbe48
.long 0x3f80,0x3ec4bf6d,0xbf353f35,0x3f6dbec4,0xbf80,0xbe483f7b,0x3ec4bf6d,0xbf0e3f55
.long 0x3f80,0xbf35bf35,0x3f800000,0xbf353f35,0xbf80,0x3f553f0e,0xbf6d3ec4,0x3e48bf7b
.long 0x3f80,0xbf6dbec4,0x3f35bf35,0x3ec43f6d,0xbf80,0x3f7b3e48,0xbec43f6d,0xbf55bf0e
.long 0x3f80,0xbf353f35,0xbf800000,0xbf35bf35,0xbf80,0x3f0ebf55,0x3f6dbec4,0x3f7b3e48
.long 0x3f80,0xbec43f6d,0xbf353f35,0xbf6d3ec4,0xbf80,0x3e48bf7b,0x3ec4bf6d,0x3f0ebf55
.long 0xbf80,0xbf35bf35,0xbf800000,0xbf353f35,0x3f353f35,0x3f7bbe48,0x3ec4bf6d,0xbf0ebf55
.long 0xbf800000,0xbec43f6d,0x3f353f35,0x3f6dbec4,0x3f35bf35,0xbf0ebf55,0xbf6d3ec4,0x3e483f7b
.long 0xbf80,0xbf353f35,0x3f800000,0xbf35bf35,0x3f353f35,0xbe48bf7b,0xbec43f6d,0x3f55bf0e
.long 0xbf800000,0x3f6d3ec4,0xbf35bf35,0x3ec43f6d,0x3f35bf35,0xbf553f0e,0x3f6dbec4,0xbf7b3e48
.long 0xbf80,0x3f353f35,0xbf800000,0x3f35bf35,0x3f353f35,0xbf7b3e48,0x3ec4bf6d,0x3f0e3f55
.long 0xbf800000,0x3ec4bf6d,0x3f353f35,0xbf6d3ec4,0x3f35bf35,0x3f0e3f55,0xbf6d3ec4,0xbe48bf7b
.long 0xbf80,0x3f35bf35,0x3f800000,0x3f353f35,0x3f353f35,0x3e483f7b,0xbec43f6d,0xbf553f0e
.long 0xbf800000,0xbf6dbec4,0xbf35bf35,0xbec4bf6d,0x3f35bf35,0x3f55bf0e,0x3f6dbec4,0x3f7bbe48
.long 0x3f80,0x3f353f35,0x3f800000,0x3f35bf35,0xbf800000,0xbf0e3f55,0x3ec43f6d,0x3f7b3e48
.long 0xbf80,0xbf6dbec4,0xbf353f35,0x3ec43f6d,0x3f800000,0x3e48bf7b,0xbf6dbec4,0xbf0e3f55
.long 0x3f80,0x3f35bf35,0xbf800000,0x3f353f35,0xbf800000,0x3f553f0e,0xbec4bf6d,0xbe483f7b
.long 0xbf80,0xbec43f6d,0x3f35bf35,0xbf6d3ec4,0x3f800000,0xbf7bbe48,0x3f6d3ec4,0xbf55bf0e
.long 0x3f80,0xbf35bf35,0x3f800000,0xbf353f35,0xbf800000,0x3f0ebf55,0x3ec43f6d,0xbf7bbe48
.long 0xbf80,0x3f6d3ec4,0xbf353f35,0xbec4bf6d,0x3f800000,0xbe483f7b,0xbf6dbec4,0x3f0ebf55
.long 0x3f80,0xbf353f35,0xbf800000,0xbf35bf35,0xbf800000,0xbf55bf0e,0xbec4bf6d,0x3e48bf7b
.long 0xbf80,0x3ec4bf6d,0x3f35bf35,0x3f6dbec4,0x3f800000,0x3f7b3e48,0x3f6d3ec4,0x3f553f0e
.long 0xbf80,0xbf35bf35,0xbf800000,0xbf353f35,0x3f35bf35,0xbe48bf7b,0xbf6dbec4,0xbf553f0e
.long 0x3f800000,0x3ec4bf6d,0xbf35bf35,0xbf6d3ec4,0x3f353f35,0x3f55bf0e,0xbec4bf6d,0xbf7b3e48
.long 0xbf80,0xbf353f35,0x3f800000,0xbf35bf35,0x3f35bf35,0xbf7b3e48,0x3f6d3ec4,0xbf0ebf55
.long 0x3f800000,0xbf6dbec4,0x3f353f35,0xbec4bf6d,0x3f353f35,0xbf0ebf55,0x3ec43f6d,0xbe48bf7b
.long 0xbf80,0x3f353f35,0xbf800000,0x3f35bf35,0x3f35bf35,0x3e483f7b,0xbf6dbec4,0x3f55bf0e
.long 0x3f800000,0xbec43f6d,0xbf35bf35,0x3f6dbec4,0x3f353f35,0xbf553f0e,0xbec4bf6d,0x3f7bbe48
.long 0xbf80,0x3f35bf35,0x3f800000,0x3f353f35,0x3f35bf35,0x3f7bbe48,0x3f6d3ec4,0x3f0e3f55
.long 0x3f800000,0x3f6d3ec4,0x3f353f35,0x3ec43f6d,0x3f353f35,0x3f0e3f55,0x3ec43f6d,0x3e483f7b
.long 0x3f800000,0x3f353f35,0x3f80,0xbf353f35,0x3f800000,0x3f0e3f55,0xbec43f6d,0xbf7b3e48
.long 0x3f800000,0x3ec43f6d,0xbf353f35,0xbf6dbec4,0x3f800000,0x3e483f7b,0xbf6d3ec4,0xbf0ebf55
.long 0x3f800000,0xbf353f35,0xbf80,0x3f353f35,0x3f800000,0xbf553f0e,0x3ec4bf6d,0x3e483f7b
.long 0x3f800000,0xbf6d3ec4,0x3f35bf35,0xbec43f6d,0x3f800000,0xbf7b3e48,0x3f6dbec4,0xbf553f0e
.long 0x3f800000,0xbf35bf35,0x3f80,0x3f35bf35,0x3f800000,0xbf0ebf55,0xbec43f6d,0x3f7bbe48
.long 0x3f800000,0xbec4bf6d,0xbf353f35,0x3f6d3ec4,0x3f800000,0xbe48bf7b,0xbf6d3ec4,0x3f0e3f55
.long 0x3f800000,0x3f35bf35,0xbf80,0xbf35bf35,0x3f800000,0x3f55bf0e,0x3ec4bf6d,0xbe48bf7b
.long 0x3f800000,0x3f6dbec4,0x3f35bf35,0x3ec4bf6d,0x3f800000,0x3f7bbe48,0x3f6dbec4,0x3f55bf0e
.long 0xbf800000,0xbf35bf35,0xbf80,0x3f35bf35,0xbf35bf35,0x3e48bf7b,0x3f6dbec4,0x3f553f0e
.long 0xbf80,0x3f6dbec4,0x3f353f35,0xbec43f6d,0x3f35bf35,0x3f553f0e,0xbec43f6d,0xbf7bbe48
.long 0xbf800000,0x3f35bf35,0x3f80,0xbf35bf35,0xbf35bf35,0x3f7b3e48,0xbf6d3ec4,0x3f0ebf55
.long 0xbf80,0x3ec43f6d,0xbf35bf35,0x3f6d3ec4,0x3f35bf35,0xbf0e3f55,0x3ec4bf6d,0xbe483f7b
.long 0xbf800000,0x3f353f35,0xbf80,0xbf353f35,0xbf35bf35,0xbe483f7b,0x3f6dbec4,0xbf55bf0e
.long 0xbf80,0xbf6d3ec4,0x3f353f35,0x3ec4bf6d,0x3f35bf35,0xbf55bf0e,0xbec43f6d,0x3f7b3e48
.long 0xbf800000,0xbf353f35,0x3f80,0x3f353f35,0xbf35bf35,0xbf7bbe48,0xbf6d3ec4,0xbf0e3f55
.long 0xbf80,0xbec4bf6d,0xbf35bf35,0xbf6dbec4,0x3f35bf35,0x3f0ebf55,0x3ec4bf6d,0x3e48bf7b
.long 0x3f800000,0x3f353f35,0x3f80,0xbf353f35,0x3f80,0xbf553f0e,0xbf6dbec4,0xbe48bf7b
.long 0xbf800000,0xbec4bf6d,0x3f35bf35,0x3f6d3ec4,0xbf80,0x3f7bbe48,0x3ec43f6d,0xbf553f0e
.long 0x3f800000,0xbf353f35,0xbf80,0x3f353f35,0x3f80,0xbf0ebf55,0x3f6d3ec4,0xbf7b3e48
.long 0xbf800000,0x3f6dbec4,0xbf353f35,0x3ec4bf6d,0xbf80,0x3e483f7b,0xbec4bf6d,0x3f0e3f55
.long 0x3f800000,0xbf35bf35,0x3f80,0x3f35bf35,0x3f80,0x3f55bf0e,0xbf6dbec4,0x3e483f7b
.long 0xbf800000,0x3ec43f6d,0x3f35bf35,0xbf6dbec4,0xbf80,0xbf7b3e48,0x3ec43f6d,0x3f55bf0e
.long 0x3f800000,0x3f35bf35,0xbf80,0xbf35bf35,0x3f80,0x3f0e3f55,0x3f6d3ec4,0x3f7bbe48
.long 0xbf800000,0xbf6d3ec4,0xbf353f35,0xbec43f6d,0xbf80,0xbe48bf7b,0xbec4bf6d,0xbf0ebf55
.long 0xbf800000,0xbf35bf35,0xbf80,0x3f35bf35,0x3f35bf35,0x3f7b3e48,0x3ec43f6d,0xbf0e3f55
.long 0x3f80,0xbf6d3ec4,0xbf35bf35,0x3ec4bf6d,0xbf35bf35,0x3f0ebf55,0x3f6d3ec4,0xbe483f7b
.long 0xbf800000,0x3f35bf35,0x3f80,0xbf35bf35,0x3f35bf35,0xbe483f7b,0xbec4bf6d,0x3f553f0e
.long 0x3f80,0xbec4bf6d,0x3f353f35,0xbf6dbec4,0xbf35bf35,0x3f553f0e,0xbf6dbec4,0x3f7b3e48
.long 0xbf800000,0x3f353f35,0xbf80,0xbf353f35,0x3f35bf35,0xbf7bbe48,0x3ec43f6d,0x3f0ebf55
.long 0x3f80,0x3f6dbec4,0xbf35bf35,0xbec43f6d,0xbf35bf35,0xbf0e3f55,0x3f6d3ec4,0x3e48bf7b
.long 0xbf800000,0xbf353f35,0x3f80,0x3f353f35,0x3f35bf35,0x3e48bf7b,0xbec4bf6d,0xbf55bf0e
.long 0x3f80,0x3ec43f6d,0x3f353f35,0x3f6d3ec4,0xbf35bf35,0xbf55bf0e,0xbf6dbec4,0xbf7bbe48
.long 0xbf800000,0xbf353f35,0x80003f80,0x3f353f35,0x3f800000,0x3f0ebf55,0xbec4bf6d,0xbf7bbe48
.long 0xbf800000,0xbec43f6d,0x3f353f35,0x3f6dbec4,0x3f800000,0x3e48bf7b,0xbf6dbec4,0xbf0e3f55
.long 0xbf800000,0x3f353f35,0x8000bf80,0xbf353f35,0x3f800000,0xbf55bf0e,0x3ec43f6d,0x3e48bf7b
.long 0xbf800000,0x3f6d3ec4,0xbf35bf35,0x3ec43f6d,0x3f800000,0xbf7bbe48,0x3f6d3ec4,0xbf55bf0e
.long 0xbf800000,0x3f35bf35,0x80003f80,0xbf35bf35,0x3f800000,0xbf0e3f55,0xbec4bf6d,0x3f7b3e48
.long 0xbf800000,0x3ec4bf6d,0x3f353f35,0xbf6d3ec4,0x3f800000,0xbe483f7b,0xbf6dbec4,0x3f0ebf55
.long 0xbf800000,0xbf35bf35,0x8000bf80,0x3f35bf35,0x3f800000,0x3f553f0e,0x3ec43f6d,0xbe483f7b
.long 0xbf800000,0xbf6dbec4,0xbf35bf35,0xbec4bf6d,0x3f800000,0x3f7b3e48,0x3f6d3ec4,0x3f553f0e
.long 0x3f800000,0x3f35bf35,0x8000bf80,0xbf35bf35,0xbf353f35,0x3e483f7b,0x3f6d3ec4,0x3f55bf0e
.long 0x8000bf80,0xbf6dbec4,0xbf353f35,0x3ec43f6d,0x3f353f35,0x3f55bf0e,0xbec4bf6d,0xbf7b3e48
.long 0x3f800000,0xbf35bf35,0x80003f80,0x3f35bf35,0xbf353f35,0x3f7bbe48,0xbf6dbec4,0x3f0e3f55
.long 0x8000bf80,0xbec43f6d,0x3f35bf35,0xbf6d3ec4,0x3f353f35,0xbf0ebf55,0x3ec43f6d,0xbe48bf7b
.long 0x3f800000,0xbf353f35,0x8000bf80,0x3f353f35,0xbf353f35,0xbe48bf7b,0x3f6d3ec4,0xbf553f0e
.long 0x8000bf80,0x3f6d3ec4,0xbf353f35,0xbec4bf6d,0x3f353f35,0xbf553f0e,0xbec4bf6d,0x3f7bbe48
.long 0x3f800000,0x3f353f35,0x80003f80,0xbf353f35,0xbf353f35,0xbf7b3e48,0xbf6dbec4,0xbf0ebf55
.long 0x8000bf80,0x3ec4bf6d,0x3f35bf35,0x3f6dbec4,0x3f353f35,0x3f0e3f55,0x3ec43f6d,0x3e483f7b
.long 0xbf800000,0xbf353f35,0x80003f80,0x3f353f35,0x8000bf80,0xbf55bf0e,0xbf6d3ec4,0xbe483f7b
.long 0x3f800000,0x3ec4bf6d,0xbf35bf35,0xbf6d3ec4,0x80003f80,0x3f7b3e48,0x3ec4bf6d,0xbf55bf0e
.long 0xbf800000,0x3f353f35,0x8000bf80,0xbf353f35,0x8000bf80,0xbf0e3f55,0x3f6dbec4,0xbf7bbe48
.long 0x3f800000,0xbf6dbec4,0x3f353f35,0xbec4bf6d,0x80003f80,0x3e48bf7b,0xbec43f6d,0x3f0ebf55
.long 0xbf800000,0x3f35bf35,0x80003f80,0xbf35bf35,0x8000bf80,0x3f553f0e,0xbf6d3ec4,0x3e48bf7b
.long 0x3f800000,0xbec43f6d,0xbf35bf35,0x3f6dbec4,0x80003f80,0xbf7bbe48,0x3ec4bf6d,0x3f553f0e
.long 0xbf800000,0xbf35bf35,0x8000bf80,0x3f35bf35,0x8000bf80,0x3f0ebf55,0x3f6dbec4,0x3f7b3e48
.long 0x3f800000,0x3f6d3ec4,0x3f353f35,0x3ec43f6d,0x80003f80,0xbe483f7b,0xbec43f6d,0xbf0e3f55
.long 0x3f800000,0x3f35bf35,0x8000bf80,0xbf35bf35,0x3f353f35,0x3f7bbe48,0x3ec4bf6d,0xbf0ebf55
.long 0x80003f80,0x3f6d3ec4,0x3f35bf35,0xbec4bf6d,0xbf353f35,0x3f0e3f55,0x3f6dbec4,0xbe48bf7b
.long 0x3f800000,0xbf35bf35,0x80003f80,0x3f35bf35,0x3f353f35,0xbe48bf7b,0xbec43f6d,0x3f55bf0e
.long 0x80003f80,0x3ec4bf6d,0xbf353f35,0x3f6dbec4,0xbf353f35,0x3f55bf0e,0xbf6d3ec4,0x3f7bbe48
.long 0x3f800000,0xbf353f35,0x8000bf80,0x3f353f35,0x3f353f35,0xbf7b3e48,0x3ec4bf6d,0x3f0e3f55
.long 0x80003f80,0xbf6dbec4,0x3f35bf35,0x3ec43f6d,0xbf353f35,0xbf0ebf55,0x3f6dbec4,0x3e483f7b
.long 0x3f800000,0x3f353f35,0x80003f80,0xbf353f35,0x3f353f35,0x3e483f7b,0xbec43f6d,0xbf553f0e
.long 0x80003f80,0xbec43f6d,0xbf353f35,0xbf6d3ec4,0xbf353f35,0xbf553f0e,0xbf6d3ec4,0xbf7b3e48
.long 0x3f803f80,0x80004000,0x80004000,0x80004000,0xbf803f80,0xbec83ffb,0xbf443fed,0xbf8e3fd5
.long 0x3f803f80,0xbf443fed,0xbfb53fb5,0xbfed3f44,0xbf803f80,0xbf8e3fd5,0xbfed3f44,0xbffbbec8
.long 0x3f803f80,0xc0000000,0x8000c000,0x40000000,0xbf803f80,0xbffbbec8,0x3f44bfed,0x3fd53f8e
.long 0x3f803f80,0xbfedbf44,0x3fb5bfb5,0x3f443fed,0xbf803f80,0xbfd5bf8e,0x3fedbf44,0xbec83ffb
.long 0x3f803f80,0x8000c000,0x80004000,0x8000c000,0xbf803f80,0x3ec8bffb,0xbf443fed,0x3f8ebfd5
.long 0x3f803f80,0x3f44bfed,0xbfb53fb5,0x3fedbf44,0xbf803f80,0x3f8ebfd5,0xbfed3f44,0x3ffb3ec8
.long 0x3f803f80,0x40000000,0x8000c000,0xc0000000,0xbf803f80,0x3ffb3ec8,0x3f44bfed,0xbfd5bf8e
.long 0x3f803f80,0x3fed3f44,0x3fb5bfb5,0xbf44bfed,0xbf803f80,0x3fd53f8e,0x3fedbf44,0x3ec8bffb
.long 0x80004000,0x80004000,0x80004000,0x80004000,0xbfb53fb5,0xbfd53f8e,0xbfed3f44,0xbffb3ec8
.long 0xc0000000,0xbfedbf44,0xbfb5bfb5,0xbf44bfed,0xbfb5bfb5,0xbec8bffb,0x3f44bfed,0x3fd5bf8e
.long 0x80004000,0xc0000000,0x8000c000,0x40000000,0xbfb53fb5,0xbf8ebfd5,0x3fedbf44,0x3ec83ffb
.long 0xc0000000,0x3f44bfed,0x3fb53fb5,0xbfed3f44,0xbfb5bfb5,0x3ffbbec8,0xbf443fed,0xbf8ebfd5
.long 0x80004000,0x8000c000,0x80004000,0x8000c000,0xbfb53fb5,0x3fd5bf8e,0xbfed3f44,0x3ffbbec8
.long 0xc0000000,0x3fed3f44,0xbfb5bfb5,0x3f443fed,0xbfb5bfb5,0x3ec83ffb,0x3f44bfed,0xbfd53f8e
.long 0x80004000,0x40000000,0x8000c000,0xc0000000,0xbfb53fb5,0x3f8e3fd5,0x3fedbf44,0xbec8bffb
.long 0xc0000000,0xbf443fed,0x3fb53fb5,0x3fedbf44,0xbfb5bfb5,0xbffb3ec8,0xbf443fed,0x3f8e3fd5
.long 0x80004000,0x80004000,0x80004000,0x80004000,0xc0000000,0xbffbbec8,0xbfedbf44,0xbfd5bf8e
.long 0x8000c000,0x3f44bfed,0x3fb5bfb5,0x3fedbf44,0x40000000,0x3fd53f8e,0x3f443fed,0xbec83ffb
.long 0x80004000,0xc0000000,0x8000c000,0x40000000,0xc0000000,0x3ec8bffb,0x3fed3f44,0xbf8e3fd5
.long 0x8000c000,0x3fed3f44,0xbfb53fb5,0xbf44bfed,0x40000000,0xbf8e3fd5,0xbf44bfed,0x3ffb3ec8
.long 0x80004000,0x8000c000,0x80004000,0x8000c000,0xc0000000,0x3ffb3ec8,0xbfedbf44,0x3fd53f8e
.long 0x8000c000,0xbf443fed,0x3fb5bfb5,0xbfed3f44,0x40000000,0xbfd5bf8e,0x3f443fed,0x3ec8bffb
.long 0x80004000,0x40000000,0x8000c000,0xc0000000,0xc0000000,0xbec83ffb,0x3fed3f44,0x3f8ebfd5
.long 0x8000c000,0xbfedbf44,0xbfb53fb5,0x3f443fed,0x40000000,0x3f8ebfd5,0xbf44bfed,0xbffbbec8
.long 0x80004000,0x80004000,0x80004000,0x80004000,0xbfb5bfb5,0xbf8ebfd5,0xbf44bfed,0xbec8bffb
.long 0x40000000,0x3fed3f44,0x3fb53fb5,0x3f443fed,0xbfb53fb5,0xbffb3ec8,0xbfedbf44,0xbf8ebfd5
.long 0x80004000,0xc0000000,0x8000c000,0x40000000,0xbfb5bfb5,0x3fd5bf8e,0x3f443fed,0xbffb3ec8
.long 0x40000000,0xbf443fed,0xbfb5bfb5,0x3fedbf44,0xbfb53fb5,0xbec8bffb,0x3fed3f44,0xbfd53f8e
.long 0x80004000,0x8000c000,0x80004000,0x8000c000,0xbfb5bfb5,0x3f8e3fd5,0xbf44bfed,0x3ec83ffb
.long 0x40000000,0xbfedbf44,0x3fb53fb5,0xbf44bfed,0xbfb53fb5,0x3ffbbec8,0xbfedbf44,0x3f8e3fd5
.long 0x80004000,0x40000000,0x8000c000,0xc0000000,0xbfb5bfb5,0xbfd53f8e,0x3f443fed,0x3ffbbec8
.long 0x40000000,0x3f44bfed,0xbfb5bfb5,0xbfed3f44,0xbfb53fb5,0x3ec83ffb,0x3fed3f44,0x3fd5bf8e
.long 0x80004000,0x80004000,0x80004000,0x80004000,0xbe49bfff,0xbf15bff5,0xbf71bfe2,0xbfa2bfc6
.long 0x3ec83ffb,0x3f8e3fd5,0x3fd53f8e,0x3ffb3ec8,0xbf15bff5,0xbfc6bfa2,0xbfffbe49,0xbfe23f71
.long 0x3fb53fb5,0x3fb5bfb5,0xbfb5bfb5,0xbfb53fb5,0xbfc6bfa2,0xbf713fe2,0x3ff53f15,0x3e49bfff
.long 0x3fd53f8e,0x3ec8bffb,0xbffb3ec8,0x3f8e3fd5,0xbfe2bf71,0x3e493fff,0x3fc6bfa2,0xbff5bf15
.long 0x40000000,0xc0000000,0x40000000,0xc0000000,0xbfff3e49,0x3ff5bf15,0xbfe23f71,0x3fc6bfa2
.long 0x3ffbbec8,0xbfd53f8e,0x3f8ebfd5,0xbec83ffb,0xbff53f15,0x3fa2bfc6,0xbe493fff,0xbf71bfe2
.long 0x3fb5bfb5,0x3fb53fb5,0xbfb53fb5,0xbfb5bfb5,0xbfa23fc6,0xbfe2bf71,0x3f15bff5,0x3fff3e49
.long 0x3f8ebfd5,0x3ffb3ec8,0x3ec83ffb,0xbfd53f8e,0xbf713fe2,0xbfff3e49,0xbfa2bfc6,0x3f15bff5
.long 0x80004000,0x80004000,0x80004000,0x80004000,0xbfc6bfa2,0xbfe2bf71,0xbff5bf15,0xbfffbe49
.long 0x3ffbbec8,0x3fd5bf8e,0x3f8ebfd5,0x3ec8bffb,0xbf713fe2,0x3e493fff,0x3fa23fc6,0x3ff53f15
.long 0x3fb53fb5,0x3fb5bfb5,0xbfb5bfb5,0xbfb53fb5,0xbfff3e49,0x3f153ff5,0x3fe2bf71,0xbfa2bfc6
.long 0x3f8ebfd5,0xbffbbec8,0x3ec83ffb,0x3fd5bf8e,0x3f153ff5,0x3fa2bfc6,0xbfffbe49,0x3f713fe2
.long 0x40000000,0xc0000000,0x40000000,0xc0000000,0xbfa23fc6,0x3f71bfe2,0xbf153ff5,0x3e49bfff
.long 0xbec8bffb,0x3f8e3fd5,0xbfd5bf8e,0x3ffb3ec8,0x3fe23f71,0xbfff3e49,0x3fc6bfa2,0xbf153ff5
.long 0x3fb5bfb5,0x3fb53fb5,0xbfb53fb5,0xbfb5bfb5,0x3e493fff,0xbff53f15,0xbf71bfe2,0x3fc6bfa2
.long 0xbfd5bf8e,0x3ec8bffb,0x3ffbbec8,0x3f8e3fd5,0x3ff5bf15,0x3fc63fa2,0xbe493fff,0xbfe23f71
.long 0x80004000,0x80004000,0x80004000,0x80004000,0xbfff3e49,0xbff53f15,0xbfe23f71,0xbfc63fa2
.long 0xbec8bffb,0xbf8ebfd5,0xbfd5bf8e,0xbffbbec8,0x3ff5bf15,0x3fa2bfc6,0x3e49bfff,0xbf71bfe2
.long 0x3fb53fb5,0x3fb5bfb5,0xbfb5bfb5,0xbfb53fb5,0xbfa23fc6,0x3fe23f71,0x3f15bff5,0xbfffbe49
.long 0xbfd5bf8e,0xbec83ffb,0x3ffbbec8,0xbf8ebfd5,0x3f71bfe2,0xbfff3e49,0x3fa23fc6,0x3f15bff5
.long 0x40000000,0xc0000000,0x40000000,0xc0000000,0x3e493fff,0xbf15bff5,0x3f713fe2,0xbfa2bfc6
.long 0xbffb3ec8,0x3fd5bf8e,0xbf8e3fd5,0x3ec8bffb,0xbf15bff5,0x3fc63fa2,0xbfffbe49,0x3fe2bf71
.long 0x3fb5bfb5,0x3fb53fb5,0xbfb53fb5,0xbfb5bfb5,0x3fc63fa2,0xbf713fe2,0xbff5bf15,0x3e49bfff
.long 0xbf8e3fd5,0xbffbbec8,0xbec8bffb,0x3fd5bf8e,0xbfe2bf71,0xbe49bfff,0x3fc6bfa2,0x3ff53f15
.long 0x80004000,0x80004000,0x80004000,0x80004000,0xbfa23fc6,0xbf713fe2,0xbf153ff5,0xbe493fff
.long 0xbffb3ec8,0xbfd53f8e,0xbf8e3fd5,0xbec83ffb,0xbfe2bf71,0xbfff3e49,0xbfc63fa2,0xbf153ff5
.long 0x3fb53fb5,0x3fb5bfb5,0xbfb5bfb5,0xbfb53fb5,0x3e493fff,0x3ff5bf15,0xbf71bfe2,0xbfc63fa2
.long 0xbf8e3fd5,0x3ffb3ec8,0xbec8bffb,0xbfd53f8e,0xbff53f15,0x3fc63fa2,0x3e49bfff,0xbfe23f71
.long 0x40000000,0xc0000000,0x40000000,0xc0000000,0x3fc63fa2,0xbfe2bf71,0x3ff53f15,0xbfffbe49
.long 0x3ec83ffb,0xbf8ebfd5,0x3fd53f8e,0xbffbbec8,0xbf713fe2,0xbe49bfff,0x3fa23fc6,0xbff5bf15
.long 0x3fb5bfb5,0x3fb53fb5,0xbfb53fb5,0xbfb5bfb5,0x3fffbe49,0x3f153ff5,0xbfe23f71,0xbfa2bfc6
.long 0x3fd53f8e,0xbec83ffb,0xbffb3ec8,0xbf8ebfd5,0x3f153ff5,0xbfa23fc6,0xbfffbe49,0xbf71bfe2
.long 0x3f803f80,0xbfb53fb5,0xc0000000,0xbfb5bfb5,0xbf803f80,0xbfd53f8e,0xbfedbf44,0xbec8bffb
.long 0x3f803f80,0xbfed3f44,0xbfb5bfb5,0x3f44bfed,0xbf803f80,0xbffb3ec8,0xbf44bfed,0x3fd5bf8e
.long 0x3f803f80,0xbfb5bfb5,0x40000000,0xbfb53fb5,0xbf803f80,0xbf8ebfd5,0x3fed3f44,0xbffb3ec8
.long 0x3f803f80,0xbf44bfed,0x3fb53fb5,0xbfedbf44,0xbf803f80,0xbec8bffb,0x3f443fed,0xbf8ebfd5
.long 0x3f803f80,0x3fb5bfb5,0xc0000000,0x3fb53fb5,0xbf803f80,0x3fd5bf8e,0xbfedbf44,0x3ec83ffb
.long 0x3f803f80,0x3fedbf44,0xbfb5bfb5,0xbf443fed,0xbf803f80,0x3ffbbec8,0xbf44bfed,0xbfd53f8e
.long 0x3f803f80,0x3fb53fb5,0x40000000,0x3fb5bfb5,0xbf803f80,0x3f8e3fd5,0x3fed3f44,0x3ffbbec8
.long 0x3f803f80,0x3f443fed,0x3fb53fb5,0x3fed3f44,0xbf803f80,0x3ec83ffb,0x3f443fed,0x3f8e3fd5
.long 0x8000c000,0x3fb5bfb5,0x40000000,0x3fb53fb5,0x3fb5bfb5,0x3ffb3ec8,0x3f443fed,0xbf8e3fd5
.long 0x40000000,0x3f443fed,0xbfb53fb5,0xbfedbf44,0x3fb53fb5,0xbf8e3fd5,0xbfedbf44,0x3ec8bffb
.long 0x8000c000,0x3fb53fb5,0xc0000000,0x3fb5bfb5,0x3fb5bfb5,0xbec83ffb,0xbf44bfed,0x3fd53f8e
.long 0x40000000,0xbfed3f44,0x3fb5bfb5,0xbf443fed,0x3fb53fb5,0xbfd5bf8e,0x3fed3f44,0xbffbbec8
.long 0x8000c000,0xbfb53fb5,0x40000000,0xbfb5bfb5,0x3fb5bfb5,0xbffbbec8,0x3f443fed,0x3f8ebfd5
.long 0x40000000,0xbf44bfed,0xbfb53fb5,0x3fed3f44,0x3fb53fb5,0x3f8ebfd5,0xbfedbf44,0xbec83ffb
.long 0x8000c000,0xbfb5bfb5,0xc0000000,0xbfb53fb5,0x3fb5bfb5,0x3ec8bffb,0xbf44bfed,0xbfd5bf8e
.long 0x40000000,0x3fedbf44,0x3fb5bfb5,0x3f44bfed,0x3fb53fb5,0x3fd53f8e,0x3fed3f44,0x3ffb3ec8
.long 0x80004000,0xbfb53fb5,0xc0000000,0xbfb5bfb5,0xc0000000,0xbf8ebfd5,0x3f44bfed,0x3ffbbec8
.long 0x8000c000,0x3fedbf44,0x3fb53fb5,0xbf443fed,0x40000000,0x3ec83ffb,0xbfed3f44,0xbf8ebfd5
.long 0x80004000,0xbfb5bfb5,0x40000000,0xbfb53fb5,0xc0000000,0x3fd5bf8e,0xbf443fed,0xbec8bffb
.long 0x8000c000,0x3f443fed,0xbfb5bfb5,0x3fed3f44,0x40000000,0xbffb3ec8,0x3fedbf44,0xbfd53f8e
.long 0x80004000,0x3fb5bfb5,0xc0000000,0x3fb53fb5,0xc0000000,0x3f8e3fd5,0x3f44bfed,0xbffb3ec8
.long 0x8000c000,0xbfed3f44,0x3fb53fb5,0x3f44bfed,0x40000000,0xbec8bffb,0xbfed3f44,0x3f8e3fd5
.long 0x80004000,0x3fb53fb5,0x40000000,0x3fb5bfb5,0xc0000000,0xbfd53f8e,0xbf443fed,0x3ec83ffb
.long 0x8000c000,0xbf44bfed,0xbfb5bfb5,0xbfedbf44,0x40000000,0x3ffbbec8,0x3fedbf44,0x3fd5bf8e
.long 0x8000c000,0x3fb5bfb5,0x40000000,0x3fb53fb5,0x3fb53fb5,0xbec83ffb,0xbfed3f44,0xbfd5bf8e
.long 0xc0000000,0xbf44bfed,0x3fb5bfb5,0x3fed3f44,0x3fb5bfb5,0x3fd53f8e,0xbf443fed,0xbffbbec8
.long 0x8000c000,0x3fb53fb5,0xc0000000,0x3fb5bfb5,0x3fb53fb5,0xbffbbec8,0x3fedbf44,0xbf8e3fd5
.long 0xc0000000,0x3fedbf44,0xbfb53fb5,0x3f44bfed,0x3fb5bfb5,0xbf8e3fd5,0x3f44bfed,0xbec83ffb
.long 0x8000c000,0xbfb53fb5,0x40000000,0xbfb5bfb5,0x3fb53fb5,0x3ec8bffb,0xbfed3f44,0x3fd53f8e
.long 0xc0000000,0x3f443fed,0x3fb5bfb5,0xbfedbf44,0x3fb5bfb5,0xbfd5bf8e,0xbf443fed,0x3ffb3ec8
.long 0x8000c000,0xbfb5bfb5,0xc0000000,0xbfb53fb5,0x3fb53fb5,0x3ffb3ec8,0x3fedbf44,0x3f8ebfd5
.long 0xc0000000,0xbfed3f44,0xbfb53fb5,0xbf443fed,0x3fb5bfb5,0x3f8ebfd5,0x3f44bfed,0x3ec8bffb
.long 0x3f443fed,0x3fed3f44,0x3fedbf44,0x3f44bfed,0xbf71bfe2,0xbfffbe49,0xbfa23fc6,0x3f153ff5
.long 0x3f8e3fd5,0x3ffbbec8,0x3ec8bffb,0xbfd5bf8e,0xbfa2bfc6,0xbfe23f71,0x3f153ff5,0x3fffbe49
.long 0x3fed3f44,0xbf44bfed,0xbf443fed,0x3fedbf44,0xbff5bf15,0x3fa23fc6,0xbe49bfff,0xbf713fe2
.long 0x3ffb3ec8,0xbfd5bf8e,0x3f8e3fd5,0xbec8bffb,0xbfffbe49,0x3ff53f15,0xbfe2bf71,0x3fc63fa2
.long 0x3fedbf44,0xbf443fed,0xbf44bfed,0x3fed3f44,0xbfe23f71,0x3e49bfff,0x3fc63fa2,0xbff53f15
.long 0x3fd5bf8e,0x3ec83ffb,0xbffbbec8,0x3f8ebfd5,0xbfc63fa2,0xbf71bfe2,0x3ff5bf15,0x3e493fff
.long 0x3f44bfed,0x3fedbf44,0x3fed3f44,0x3f443fed,0xbf153ff5,0xbfc63fa2,0xbfff3e49,0xbfe2bf71
.long 0x3ec8bffb,0x3f8ebfd5,0x3fd5bf8e,0x3ffbbec8,0xbe493fff,0xbf153ff5,0xbf713fe2,0xbfa23fc6
.long 0xbf44bfed,0xbfedbf44,0xbfed3f44,0xbf443fed,0x3ff53f15,0x3fc6bfa2,0xbe49bfff,0xbfe2bf71
.long 0xbfd53f8e,0x3ec83ffb,0x3ffb3ec8,0x3f8ebfd5,0x3e49bfff,0xbff5bf15,0xbf713fe2,0x3fc63fa2
.long 0xbfedbf44,0x3f443fed,0x3f44bfed,0xbfed3f44,0x3fe2bf71,0xbfffbe49,0x3fc63fa2,0xbf15bff5
.long 0xbec83ffb,0x3f8ebfd5,0xbfd53f8e,0x3ffbbec8,0xbfa2bfc6,0x3f713fe2,0xbf15bff5,0x3e493fff
.long 0xbfed3f44,0x3f44bfed,0x3f443fed,0xbfedbf44,0x3f15bff5,0x3fa23fc6,0xbfff3e49,0x3f71bfe2
.long 0x3f8e3fd5,0xbffb3ec8,0x3ec8bffb,0x3fd53f8e,0xbfffbe49,0x3f15bff5,0x3fe23f71,0xbfa23fc6
.long 0xbf443fed,0xbfed3f44,0xbfedbf44,0xbf44bfed,0xbf71bfe2,0x3e49bfff,0x3fa2bfc6,0x3ff5bf15
.long 0x3ffb3ec8,0x3fd53f8e,0x3f8e3fd5,0x3ec83ffb,0xbfc63fa2,0xbfe23f71,0xbff53f15,0xbfff3e49
.long 0x3f443fed,0x3fed3f44,0x3fedbf44,0x3f44bfed,0xbfe23f71,0xbe493fff,0x3fc63fa2,0x3ff5bf15
.long 0xbf8ebfd5,0xbffb3ec8,0xbec83ffb,0x3fd53f8e,0x3fc6bfa2,0xbf71bfe2,0xbff53f15,0x3e493fff
.long 0x3fed3f44,0xbf44bfed,0xbf443fed,0x3fedbf44,0xbf153ff5,0x3fc6bfa2,0xbfff3e49,0x3fe23f71
.long 0xbffbbec8,0x3fd53f8e,0xbf8ebfd5,0x3ec83ffb,0x3e49bfff,0xbf153ff5,0x3f71bfe2,0xbfa23fc6
.long 0x3fedbf44,0xbf443fed,0xbf44bfed,0x3fed3f44,0x3f713fe2,0xbfffbe49,0x3fa2bfc6,0x3f153ff5
.long 0xbfd53f8e,0xbec8bffb,0x3ffb3ec8,0xbf8e3fd5,0xbfa2bfc6,0x3fe2bf71,0x3f153ff5,0xbfff3e49
.long 0x3f44bfed,0x3fedbf44,0x3fed3f44,0x3f443fed,0x3ff53f15,0x3fa23fc6,0x3e493fff,0xbf713fe2
.long 0xbec83ffb,0xbf8e3fd5,0xbfd53f8e,0xbffb3ec8,0xbfffbe49,0xbff5bf15,0xbfe2bf71,0xbfc6bfa2
.long 0xbf44bfed,0xbfedbf44,0xbfed3f44,0xbf443fed,0x3f15bff5,0xbfa2bfc6,0xbfff3e49,0xbf713fe2
.long 0x3fd5bf8e,0xbec8bffb,0xbffbbec8,0xbf8e3fd5,0x3fff3e49,0x3f15bff5,0xbfe2bf71,0xbfa23fc6
.long 0xbfedbf44,0x3f443fed,0x3f44bfed,0xbfed3f44,0xbf71bfe2,0xbe493fff,0x3fa2bfc6,0xbff53f15
.long 0x3ec8bffb,0xbf8e3fd5,0x3fd5bf8e,0xbffb3ec8,0x3fc6bfa2,0xbfe23f71,0x3ff5bf15,0xbfff3e49
.long 0xbfed3f44,0x3f44bfed,0x3f443fed,0xbfedbf44,0xbff5bf15,0x3fc6bfa2,0x3e493fff,0xbfe2bf71
.long 0xbf8ebfd5,0x3ffbbec8,0xbec83ffb,0xbfd5bf8e,0x3e49bfff,0x3ff53f15,0xbf713fe2,0xbfc6bfa2
.long 0xbf443fed,0xbfed3f44,0xbfedbf44,0xbf44bfed,0xbfe23f71,0xbfffbe49,0xbfc6bfa2,0xbf15bff5
.long 0xbffbbec8,0xbfd5bf8e,0xbf8ebfd5,0xbec8bffb,0xbfa2bfc6,0xbf71bfe2,0xbf15bff5,0xbe49bfff
.long 0x35003500,0x80003580,0x80003580,0x80003580,0xb5003500,0xb448357b,0xb4c4356d,0xb50e3555
.long 0x35003500,0xb4c4356d,0xb5353535,0xb56d34c4,0xb5003500,0xb50e3555,0xb56d34c4,0xb57bb448
.long 0x35003500,0xb5353535,0xb5800000,0xb535b535,0xb5003500,0xb555350e,0xb56db4c4,0xb448b57b
.long 0x35003500,0xb56d34c4,0xb535b535,0x34c4b56d,0xb5003500,0xb57b3448,0xb4c4b56d,0x3555b50e
.long 0x35003500,0xb5800000,0x8000b580,0x35800000,0xb5003500,0xb57bb448,0x34c4b56d,0x3555350e
.long 0x35003500,0xb56db4c4,0x3535b535,0x34c4356d,0xb5003500,0xb555b50e,0x356db4c4,0xb448357b
.long 0x35003500,0xb535b535,0x35800000,0xb5353535,0xb5003500,0xb50eb555,0x356d34c4,0xb57b3448
.long 0x35003500,0xb4c4b56d,0x35353535,0xb56db4c4,0xb5003500,0xb448b57b,0x34c4356d,0xb50eb555
.long 0x80003580,0x80003580,0x80003580,0x80003580,0xb5353535,0xb555350e,0xb56d34c4,0xb57b3448
.long 0xb5800000,0xb56db4c4,0xb535b535,0xb4c4b56d,0xb535b535,0xb448b57b,0x34c4b56d,0x3555b50e
.long 0x8000b580,0x3535b535,0x35800000,0x35353535,0x3535b535,0x357b3448,0x34c4356d,0xb50e3555
.long 0x35800000,0x34c4356d,0xb5353535,0xb56db4c4,0x35353535,0xb50e3555,0xb56db4c4,0x3448b57b
.long 0x80003580,0xb5800000,0x8000b580,0x35800000,0xb5353535,0xb50eb555,0x356db4c4,0x3448357b
.long 0xb5800000,0x34c4b56d,0x35353535,0xb56d34c4,0xb535b535,0x357bb448,0xb4c4356d,0xb50eb555
.long 0x8000b580,0x35353535,0xb5800000,0x3535b535,0x3535b535,0xb448357b,0xb4c4b56d,0x3555350e
.long 0x35800000,0xb56d34c4,0x3535b535,0xb4c4356d,0x35353535,0xb555b50e,0x356d34c4,0xb57bb448
.long 0x80003580,0x80003580,0x80003580,0x80003580,0xb5800000,0xb57bb448,0xb56db4c4,0xb555b50e
.long 0x8000b580,0x34c4b56d,0x3535b535,0x356db4c4,0x35800000,0x3555350e,0x34c4356d,0xb448357b
.long 0x80003580,0xb5353535,0xb5800000,0xb535b535,0xb5800000,0xb50eb555,0x34c4b56d,0x357bb448
.long 0x8000b580,0x356db4c4,0x35353535,0xb4c4356d,0x35800000,0x3448357b,0xb56d34c4,0xb50eb555
.long 0x80003580,0xb5800000,0x8000b580,0x35800000,0xb5800000,0x3448b57b,0x356d34c4,0xb50e3555
.long 0x8000b580,0x356d34c4,0xb5353535,0xb4c4b56d,0x35800000,0xb50e3555,0xb4c4b56d,0x357b3448
.long 0x80003580,0xb535b535,0x35800000,0xb5353535,0xb5800000,0x3555b50e,0xb4c4356d,0xb448b57b
.long 0x8000b580,0x34c4356d,0xb535b535,0x356d34c4,0x35800000,0xb57b3448,0x356db4c4,0xb555350e
.long 0x80003580,0x80003580,0x80003580,0x80003580,0xb535b535,0xb50eb555,0xb4c4b56d,0xb448b57b
.long 0x35800000,0x356d34c4,0x35353535,0x34c4356d,0xb5353535,0xb57b3448,0xb56db4c4,0xb50eb555
.long 0x8000b580,0x3535b535,0x35800000,0x35353535,0x35353535,0xb448357b,0xb56d34c4,0xb555b50e
.long 0xb5800000,0xb4c4b56d,0x3535b535,0x356d34c4,0x3535b535,0x3555350e,0xb4c4356d,0xb57bb448
.long 0x80003580,0xb5800000,0x8000b580,0x35800000,0xb535b535,0x3555b50e,0x34c4356d,0xb57b3448
.long 0x35800000,0xb4c4356d,0xb535b535,0x356db4c4,0xb5353535,0xb448b57b,0x356d34c4,0xb555350e
.long 0x8000b580,0x35353535,0xb5800000,0x3535b535,0x35353535,0xb57bb448,0x356db4c4,0xb50e3555
.long 0xb5800000,0x356db4c4,0xb5353535,0x34c4b56d,0x3535b535,0xb50e3555,0x34c4b56d,0xb448357b
.long 0x35003500,0x8000b580,0x80003580,0x8000b580,0xb5003500,0x3448b57b,0xb4c4356d,0x350eb555
.long 0x35003500,0x34c4b56d,0xb5353535,0x356db4c4,0xb5003500,0x350eb555,0xb56d34c4,0x357b3448
.long 0x35003500,0x3535b535,0xb5800000,0x35353535,0xb5003500,0x3555b50e,0xb56db4c4,0x3448357b
.long 0x35003500,0x356db4c4,0xb535b535,0xb4c4356d,0xb5003500,0x357bb448,0xb4c4b56d,0xb555350e
.long 0x35003500,0x35800000,0x8000b580,0xb5800000,0xb5003500,0x357b3448,0x34c4b56d,0xb555b50e
.long 0x35003500,0x356d34c4,0x3535b535,0xb4c4b56d,0xb5003500,0x3555350e,0x356db4c4,0x3448b57b
.long 0x35003500,0x35353535,0x35800000,0x3535b535,0xb5003500,0x350e3555,0x356d34c4,0x357bb448
.long 0x35003500,0x34c4356d,0x35353535,0x356d34c4,0xb5003500,0x3448357b,0x34c4356d,0x350e3555
.long 0x80003580,0x8000b580,0x80003580,0x8000b580,0xb5353535,0x3555b50e,0xb56d34c4,0x357bb448
.long 0xb5800000,0x356d34c4,0xb535b535,0x34c4356d,0xb535b535,0x3448357b,0x34c4b56d,0xb555350e
.long 0x8000b580,0xb5353535,0x35800000,0xb535b535,0x3535b535,0xb57bb448,0x34c4356d,0x350eb555
.long 0x35800000,0xb4c4b56d,0xb5353535,0x356d34c4,0x35353535,0x350eb555,0xb56db4c4,0xb448357b
.long 0x80003580,0x35800000,0x8000b580,0xb5800000,0xb5353535,0x350e3555,0x356db4c4,0xb448b57b
.long 0xb5800000,0xb4c4356d,0x35353535,0x356db4c4,0xb535b535,0xb57b3448,0xb4c4356d,0x350e3555
.long 0x8000b580,0xb535b535,0xb5800000,0xb5353535,0x3535b535,0x3448b57b,0xb4c4b56d,0xb555b50e
.long 0x35800000,0x356db4c4,0x3535b535,0x34c4b56d,0x35353535,0x3555350e,0x356d34c4,0x357b3448
.long 0x80003580,0x8000b580,0x80003580,0x8000b580,0xb5800000,0x357b3448,0xb56db4c4,0x3555350e
.long 0x8000b580,0xb4c4356d,0x3535b535,0xb56d34c4,0x35800000,0xb555b50e,0x34c4356d,0x3448b57b
.long 0x80003580,0x3535b535,0xb5800000,0x35353535,0xb5800000,0x350e3555,0x34c4b56d,0xb57b3448
.long 0x8000b580,0xb56d34c4,0x35353535,0x34c4b56d,0x35800000,0xb448b57b,0xb56d34c4,0x350e3555
.long 0x80003580,0x35800000,0x8000b580,0xb5800000,0xb5800000,0xb448357b,0x356d34c4,0x350eb555
.long 0x8000b580,0xb56db4c4,0xb5353535,0x34c4356d,0x35800000,0x350eb555,0xb4c4b56d,0xb57bb448
.long 0x80003580,0x35353535,0x35800000,0x3535b535,0xb5800000,0xb555350e,0xb4c4356d,0x3448357b
.long 0x8000b580,0xb4c4b56d,0xb535b535,0xb56db4c4,0x35800000,0x357bb448,0x356db4c4,0x3555b50e
.long 0x80003580,0x8000b580,0x80003580,0x8000b580,0xb535b535,0x350e3555,0xb4c4b56d,0x3448357b
.long 0x35800000,0xb56db4c4,0x35353535,0xb4c4b56d,0xb5353535,0x357bb448,0xb56db4c4,0x350e3555
.long 0x8000b580,0xb5353535,0x35800000,0xb535b535,0x35353535,0x3448b57b,0xb56d34c4,0x3555350e
.long 0xb5800000,0x34c4356d,0x3535b535,0xb56db4c4,0x3535b535,0xb555b50e,0xb4c4356d,0x357b3448
.long 0x80003580,0x35800000,0x8000b580,0xb5800000,0xb535b535,0xb555350e,0x34c4356d,0x357bb448
.long 0x35800000,0x34c4b56d,0xb535b535,0xb56d34c4,0xb5353535,0x3448357b,0x356d34c4,0x3555b50e
.long 0x8000b580,0xb535b535,0xb5800000,0xb5353535,0x35353535,0x357b3448,0x356db4c4,0x350eb555
.long 0xb5800000,0xb56d34c4,0xb5353535,0xb4c4356d,0x3535b535,0x350eb555,0x34c4b56d,0x3448b57b
.long 0x3f800000,0x3f800000,0x3f800000,0x3f800000,0x3f800000,0x3f7ffec4,0x3f7ffb11,0x3f7ff4e6
.long 0x3f800000,0x3f7ffb11,0x3f7fec43,0x3f7fd397,0x3f800000,0x3f7ff4e6,0x3f7fd397,0x3f7f9c18
.long 0x3f800000,0x3f7fb10f,0x3f7ec46d,0x3f7d3aac,0x3f800000,0x3f7f9c18,0x3f7e70b0,0x3f7c7eb0
.long 0x3f800000,0x3f7f84ab,0x3f7e1324,0x3f7baccd,0x3f800000,0x3f7f6ac7,0x3f7dabcc,0x3f7ac516
.long 0x3f800000,0x3f7ec46d,0x3f7b14be,0x3f74fa0b,0x3f800000,0x3f7e9bc9,0x3f7a7302,0x3f73913f
.long 0x3f800000,0x3f7e70b0,0x3f79c79d,0x3f721352,0x3f800000,0x3f7e4323,0x3f791298,0x3f708066
.long 0x3f800000,0x3f7d3aac,0x3f74fa0b,0x3f676bd8,0x3f800000,0x3f7cfe73,0x3f740bdd,0x3f655e0b
.long 0x3f800000,0x3f7cbfc9,0x3f731447,0x3f633c5a,0x3f800000,0x3f7c7eb0,0x3f721352,0x3f6106f2
.long 0x3f800000,0x3f800000,0x3f800000,0x3f800000,0x3f7fec43,0x3f7fe129,0x3f7fd397,0x3f7fc38f
.long 0x3f7fb10f,0x3f7f84ab,0x3f7f4e6d,0x3f7f0e58,0x3f7f4e6d,0x3f7eea9d,0x3f7e70b0,0x3f7de0b1
.long 0x3f7b14be,0x3f7853f8,0x3f74fa0b,0x3f710908,0x3f79c79d,0x3f764d97,0x3f721352,0x3f6d1c1d
.long 0x3f7853f8,0x3f740bdd,0x3f6ed89e,0x3f68bf3c,0x3f76ba07,0x3f718f57,0x3f6b4b0c,0x3f63f473
.long 0x3f6c835e,0x3f61c598,0x3f54db31,0x3f45e403,0x3f6a09a7,0x3f5df6be,0x3f4f7a1f,0x3f3ebc1b
.long 0x3f676bd8,0x3f59f26a,0x3f49d112,0x3f373a23,0x3f64aa59,0x3f55b993,0x3f43e200,0x3f2f61a5
.long 0x3f54db31,0x3f3daef9,0x3f226799,0x3f039c3d,0x3f514d3d,0x3f385216,0x3f1b02c6,0x3ef41f07
.long 0x3f4d9f02,0x3f32c8c9,0x3f13682a,0x3ee0924f,0x3f49d112,0x3f2d1469,0x3f0b9a6b,0x3ecc9b8b
.long 0x3f800000,0x3f800000,0x3f800000,0x3f800000,0x3f7fb10f,0x3f7f9c18,0x3f7f84ab,0x3f7f6ac7
.long 0x3f7ec46d,0x3f7e70b0,0x3f7e1324,0x3f7dabcc,0x3f7d3aac,0x3f7c7eb0,0x3f7baccd,0x3f7ac516
.long 0x3f6c835e,0x3f676bd8,0x3f61c598,0x3f5b941a,0x3f676bd8,0x3f6106f2,0x3f59f26a,0x3f5233c6
.long 0x3f61c598,0x3f59f26a,0x3f514d3d,0x3f47de65,0x3f5b941a,0x3f5233c6,0x3f47de65,0x3f3ca003
.long 0x3f3504f3,0x3f226799,0x3f0e39da,0x3ef15aea,0x3f2beb4a,0x3f173c07,0x3f00e7e4,0x3ed25a09
.long 0x3f226799,0x3f0b9a6b,0x3ee63375,0x3eb263ef,0x3f187fc0,0x3eff17b2,0x3ec9b953,0x3e919ddd
.long 0x3ec3ef15,0x3e78cfcc,0x3dc8bd36,0xbd48fb30,0x3eac7cd4,0x3e419b37,0x3d16c32c,0xbdee3876
.long 0x3e94a031,0x3e09cf86,0xbcc90ab0,0xbe3b6ecf,0x3e78cfcc,0x3da3308c,0xbdafb680,0xbe7ee6e1
.long 0x3f800000,0x3f800000,0x3f800000,0x3f800000,0x3f7f4e6d,0x3f7f2f9d,0x3f7f0e58,0x3f7eea9d
.long 0x3f7d3aac,0x3f7cbfc9,0x3f7c3b28,0x3f7baccd,0x3f79c79d,0x3f78b47b,0x3f778bc5,0x3f764d97
.long 0x3f54db31,0x3f4d9f02,0x3f45e403,0x3f3daef9,0x3f49d112,0x3f40d0da,0x3f373a23,0x3f2d1469
.long 0x3f3daef9,0x3f32c8c9,0x3f273656,0x3f1b02c6,0x3f3085bb,0x3f239da9,0x3f15f6d9,0x3f07a136
.long 0x3ec3ef15,0x3e94a031,0x3e47c5c2,0x3dc8bd36,0x3ea09ae5,0x3e5a3997,0x3de1bc2e,0x3bc90f88
.long 0x3e78cfcc,0x3e09cf86,0x3cc90ab0,0xbdafb680,0x3e2f10a2,0x3d621469,0xbd7b2b74,0xbe354098
.long 0xbe47c5c2,0xbeac7cd4,0xbef15aea,0xbf187fc0,0xbe888e93,0xbed25a09,0xbf0b9a6b,0xbf2ac082
.long 0xbeac7cd4,0xbef6e0cb,0xbf1d7fd1,0xbf3b8f3b,0xbecf7bca,0xbf0cead0,0xbf2e3bde,0xbf4ac77f
.long 0x0,0x0,0x0,0x0,0x0,0x3bc90f88,0x3c490e90,0x3c96c9b6
.long 0x0,0x3c490e90,0x3cc90ab0,0x3d16c32c,0x0,0x3c96c9b6,0x3d16c32c,0x3d621469
.long 0x0,0x3d48fb30,0x3dc8bd36,0x3e164083,0x0,0x3d621469,0x3de1bc2e,0x3e28defc
.long 0x0,0x3d7b2b74,0x3dfab273,0x3e3b6ecf,0x0,0x3d8a200a,0x3e09cf86,0x3e4dee60
.long 0x0,0x3dc8bd36,0x3e47c5c2,0x3e94a031,0x0,0x3dd53db9,0x3e541501,0x3e9d9e78
.long 0x0,0x3de1bc2e,0x3e605c13,0x3ea68f12,0x0,0x3dee3876,0x3e6c9a7f,0x3eaf713a
.long 0x0,0x3e164083,0x3e94a031,0x3edae880,0x0,0x3e1c76de,0x3e9aa086,0x3ee363fa
.long 0x0,0x3e22abb6,0x3ea09ae5,0x3eebcbbb,0x0,0x3e28defc,0x3ea68f12,0x3ef41f07
.long 0x0,0x0,0x0,0x0,0x3cc90ab0,0x3cfb49ba,0x3d16c32c,0x3d2fe007
.long 0x3d48fb30,0x3d7b2b74,0x3d96a905,0x3dafb680,0x3d96a905,0x3dbc3ac3,0x3de1bc2e,0x3e039502
.long 0x3e47c5c2,0x3e78cfcc,0x3e94a031,0x3eac7cd4,0x3e605c13,0x3e8b9507,0x3ea68f12,0x3ec1071e
.long 0x3e78cfcc,0x3e9aa086,0x3eb8442a,0x3ed53641,0x3e888e93,0x3ea986c4,0x3ec9b953,0x3ee900b7
.long 0x3ec3ef15,0x3ef15aea,0x3f0e39da,0x3f226799,0x3ecf7bca,0x3eff17b2,0x3f15f6d9,0x3f2ac082
.long 0x3edae880,0x3f064b82,0x3f1d7fd1,0x3f32c8c9,0x3ee63375,0x3f0cead0,0x3f24d225,0x3f3a7ca4
.long 0x3f0e39da,0x3f2beb4a,0x3f45e403,0x3f5b941a,0x3f13682a,0x3f31a81d,0x3f4bbbf8,0x3f6106f2
.long 0x3f187fc0,0x3f373a23,0x3f514d3d,0x3f660f88,0x3f1d7fd1,0x3f3ca003,0x3f5695e5,0x3f6aab7b
.long 0x0,0x0,0x0,0x0,0x3d48fb30,0x3d621469,0x3d7b2b74,0x3d8a200a
.long 0x3dc8bd36,0x3de1bc2e,0x3dfab273,0x3e09cf86,0x3e164083,0x3e28defc,0x3e3b6ecf,0x3e4dee60
.long 0x3ec3ef15,0x3edae880,0x3ef15aea,0x3f039c3d,0x3edae880,0x3ef41f07,0x3f064b82,0x3f121eb0
.long 0x3ef15aea,0x3f064b82,0x3f13682a,0x3f1ff6cb,0x3f039c3d,0x3f121eb0,0x3f1ff6cb,0x3f2d1469
.long 0x3f3504f3,0x3f45e403,0x3f54db31,0x3f61c598,0x3f3daef9,0x3f4e8d90,0x3f5d2d53,0x3f696591
.long 0x3f45e403,0x3f5695e5,0x3f64aa59,0x3f6ff573,0x3f4d9f02,0x3f5df6be,0x3f6b4b0c,0x3f756d97
.long 0x3f6c835e,0x3f7853f8,0x3f7ec46d,0x3f7fb10f,0x3f710908,0x3f7b61fc,0x3f7fd397,0x3f7e4323
.long 0x3f74fa0b,0x3f7dabcc,0x3f7fec43,0x3f7baccd,0x3f7853f8,0x3f7f2f9d,0x3f7f0e58,0x3f77f110
.long 0x0,0x0,0x0,0x0,0x3d96a905,0x3da3308c,0x3dafb680,0x3dbc3ac3
.long 0x3e164083,0x3e22abb6,0x3e2f10a2,0x3e3b6ecf,0x3e605c13,0x3e72b651,0x3e827dc0,0x3e8b9507
.long 0x3f0e39da,0x3f187fc0,0x3f226799,0x3f2beb4a,0x3f1d7fd1,0x3f286605,0x3f32c8c9,0x3f3ca003
.long 0x3f2beb4a,0x3f373a23,0x3f41d870,0x3f4bbbf8,0x3f396842,0x3f44e3f5,0x3f4f7a1f,0x3f591e6a
.long 0x3f6c835e,0x3f74fa0b,0x3f7b14be,0x3f7ec46d,0x3f731447,0x3f7a1e84,0x3f7e70b0,0x3f7ffec4
.long 0x3f7853f8,0x3f7dabcc,0x3f7fec43,0x3f7f0e58,0x3f7c3b28,0x3f7f9c18,0x3f7f84ab,0x3f7bf531
.long 0x3f7b14be,0x3f710908,0x3f61c598,0x3f4d9f02,0x3f76ba07,0x3f696591,0x3f5695e5,0x3f3ebc1b
.long 0x3f710908,0x3f604621,0x3f49d112,0x3f2e3bde,0x3f6a09a7,0x3f55b993,0x3f3b8f3b,0x3f1c420c
.long 0x3f800000,0x3f7fec43,0x3f7fb10f,0x3f7f4e6d,0x3f800000,0x3f7fe129,0x3f7f84ab,0x3f7eea9d
.long 0x3f800000,0x3f7fd397,0x3f7f4e6d,0x3f7e70b0,0x3f800000,0x3f7fc38f,0x3f7f0e58,0x3f7de0b1
.long 0x3f800000,0x3f7f4e6d,0x3f7d3aac,0x3f79c79d,0x3f800000,0x3f7f2f9d,0x3f7cbfc9,0x3f78b47b
.long 0x3f800000,0x3f7f0e58,0x3f7c3b28,0x3f778bc5,0x3f800000,0x3f7eea9d,0x3f7baccd,0x3f764d97
.long 0x3f800000,0x3f7e1324,0x3f7853f8,0x3f6ed89e,0x3f800000,0x3f7de0b1,0x3f778bc5,0x3f6d1c1d
.long 0x3f800000,0x3f7dabcc,0x3f76ba07,0x3f6b4b0c,0x3f800000,0x3f7d7474,0x3f75dec6,0x3f696591
.long 0x3f800000,0x3f7c3b28,0x3f710908,0x3f5ebe05,0x3f800000,0x3f7bf531,0x3f6ff573,0x3f5c61c7
.long 0x3f800000,0x3f7baccd,0x3f6ed89e,0x3f59f26a,0x3f800000,0x3f7b61fc,0x3f6db293,0x3f577026
.long 0x3f7ec46d,0x3f7e1324,0x3f7d3aac,0x3f7c3b28,0x3f7e1324,0x3f7cfe73,0x3f7baccd,0x3f7a1e84
.long 0x3f7d3aac,0x3f7baccd,0x3f79c79d,0x3f778bc5,0x3f7c3b28,0x3f7a1e84,0x3f778bc5,0x3f748422
.long 0x3f74fa0b,0x3f6ed89e,0x3f676bd8,0x3f5ebe05,0x3f731447,0x3f6be858,0x3f633c5a,0x3f591e6a
.long 0x3f710908,0x3f68bf3c,0x3f5ebe05,0x3f531849,0x3f6ed89e,0x3f655e0b,0x3f59f26a,0x3f4cae79
.long 0x3f61c598,0x3f514d3d,0x3f3daef9,0x3f273656,0x3f5ebe05,0x3f4cae79,0x3f373a23,0x3f1ebc12
.long 0x3f5b941a,0x3f47de65,0x3f3085bb,0x3f15f6d9,0x3f584853,0x3f42de29,0x3f299415,0x3f0cead0
.long 0x3f45e403,0x3f273656,0x3f039c3d,0x3eb8442a,0x3f41d870,0x3f212ff9,0x3ef6e0cb,0x3ea395c5
.long 0x3f3daef9,0x3f1b02c6,0x3ee63375,0x3e8e9a22,0x3f396842,0x3f14b039,0x3ed53641,0x3e72b651
.long 0x3f7b14be,0x3f79c79d,0x3f7853f8,0x3f76ba07,0x3f7853f8,0x3f764d97,0x3f740bdd,0x3f718f57
.long 0x3f74fa0b,0x3f721352,0x3f6ed89e,0x3f6b4b0c,0x3f710908,0x3f6d1c1d,0x3f68bf3c,0x3f63f473
.long 0x3f54db31,0x3f49d112,0x3f3daef9,0x3f3085bb,0x3f4d9f02,0x3f40d0da,0x3f32c8c9,0x3f239da9
.long 0x3f45e403,0x3f373a23,0x3f273656,0x3f15f6d9,0x3f3daef9,0x3f2d1469,0x3f1b02c6,0x3f07a136
.long 0x3f0e39da,0x3ee63375,0x3eac7cd4,0x3e605c13,0x3f039c3d,0x3ecc9b8b,0x3e8e9a22,0x3e1c76de
.long 0x3ef15aea,0x3eb263ef,0x3e605c13,0x3dafb680,0x3edae880,0x3e97a117,0x3e22abb6,0x3c96c9b6
.long 0x3e47c5c2,0x3cc90ab0,0xbe164083,0xbea09ae5,0x3e164083,0xbcfb49ba,0xbe541501,0xbec1071e
.long 0x3dc8bd36,0xbdafb680,0xbe888e93,0xbee0924f,0x3d48fb30,0xbe1008b7,0xbea68f12,0xbeff17b2
.long 0x3f74fa0b,0x3f731447,0x3f710908,0x3f6ed89e,0x3f6ed89e,0x3f6be858,0x3f68bf3c,0x3f655e0b
.long 0x3f676bd8,0x3f633c5a,0x3f5ebe05,0x3f59f26a,0x3f5ebe05,0x3f591e6a,0x3f531849,0x3f4cae79
.long 0x3f226799,0x3f13682a,0x3f039c3d,0x3ee63375,0x3f13682a,0x3f0242b1,0x3ee0924f,0x3ebb31a0
.long 0x3f039c3d,0x3ee0924f,0x3eb8442a,0x3e8e9a22,0x3ee63375,0x3ebb31a0,0x3e8e9a22,0x3e419b37
.long 0x3dc8bd36,0xbcc90ab0,0xbe164083,0xbe888e93,0x3cc90ab0,0xbdd53db9,0xbe6c9a7f,0xbeb554ec
.long 0xbd48fb30,0xbe3b6ecf,0xbea09ae5,0xbee0924f,0xbdfab273,0xbe8586ce,0xbec9b953,0xbf04f484
.long 0xbef15aea,0xbf1d7fd1,0xbf3daef9,0xbf584853,0xbf08f59b,0xbf2d1469,0xbf4bbbf8,0xbf63f473
.long 0xbf187fc0,0xbf3b8f3b,0xbf584853,0xbf6db293,0xbf273656,0xbf48d8b3,0xbf633c5a,0xbf756d97
.long 0x0,0x3cc90ab0,0x3d48fb30,0x3d96a905,0x0,0x3cfb49ba,0x3d7b2b74,0x3dbc3ac3
.long 0x0,0x3d16c32c,0x3d96a905,0x3de1bc2e,0x0,0x3d2fe007,0x3dafb680,0x3e039502
.long 0x0,0x3d96a905,0x3e164083,0x3e605c13,0x0,0x3da3308c,0x3e22abb6,0x3e72b651
.long 0x0,0x3dafb680,0x3e2f10a2,0x3e827dc0,0x0,0x3dbc3ac3,0x3e3b6ecf,0x3e8b9507
.long 0x0,0x3dfab273,0x3e78cfcc,0x3eb8442a,0x0,0x3e039502,0x3e827dc0,0x3ec1071e
.long 0x0,0x3e09cf86,0x3e888e93,0x3ec9b953,0x0,0x3e1008b7,0x3e8e9a22,0x3ed25a09
.long 0x0,0x3e2f10a2,0x3eac7cd4,0x3efc5d27,0x0,0x3e354098,0x3eb263ef,0x3f0242b1
.long 0x0,0x3e3b6ecf,0x3eb8442a,0x3f064b82,0x0,0x3e419b37,0x3ebe1d4a,0x3f0a48ad
.long 0x3dc8bd36,0x3dfab273,0x3e164083,0x3e2f10a2,0x3dfab273,0x3e1c76de,0x3e3b6ecf,0x3e5a3997
.long 0x3e164083,0x3e3b6ecf,0x3e605c13,0x3e827dc0,0x3e2f10a2,0x3e5a3997,0x3e827dc0,0x3e97a117
.long 0x3e94a031,0x3eb8442a,0x3edae880,0x3efc5d27,0x3ea09ae5,0x3ec6d529,0x3eebcbbb,0x3f07a136
.long 0x3eac7cd4,0x3ed53641,0x3efc5d27,0x3f10d3cd,0x3eb8442a,0x3ee363fa,0x3f064b82,0x3f19c200
.long 0x3ef15aea,0x3f13682a,0x3f2beb4a,0x3f41d870,0x3efc5d27,0x3f19c200,0x3f32c8c9,0x3f48d8b3
.long 0x3f039c3d,0x3f1ff6cb,0x3f396842,0x3f4f7a1f,0x3f08f59b,0x3f26050a,0x3f3fc767,0x3f55b993
.long 0x3f226799,0x3f41d870,0x3f5b941a,0x3f6ed89e,0x3f273656,0x3f46e22a,0x3f604621,0x3f7294f8
.long 0x3f2beb4a,0x3f4bbbf8,0x3f64aa59,0x3f75dec6,0x3f3085bb,0x3f5064af,0x3f68bf3c,0x3f78b47b
.long 0x3e47c5c2,0x3e605c13,0x3e78cfcc,0x3e888e93,0x3e78cfcc,0x3e8b9507,0x3e9aa086,0x3ea986c4
.long 0x3e94a031,0x3ea68f12,0x3eb8442a,0x3ec9b953,0x3eac7cd4,0x3ec1071e,0x3ed53641,0x3ee900b7
.long 0x3f0e39da,0x3f1d7fd1,0x3f2beb4a,0x3f396842,0x3f187fc0,0x3f286605,0x3f373a23,0x3f44e3f5
.long 0x3f226799,0x3f32c8c9,0x3f41d870,0x3f4f7a1f,0x3f2beb4a,0x3f3ca003,0x3f4bbbf8,0x3f591e6a
.long 0x3f54db31,0x3f64aa59,0x3f710908,0x3f79c79d,0x3f5b941a,0x3f6aab7b,0x3f75dec6,0x3f7cfe73
.long 0x3f61c598,0x3f6ff573,0x3f79c79d,0x3f7f0e58,0x3f676bd8,0x3f748422,0x3f7cbfc9,0x3f7ff4e6
.long 0x3f7b14be,0x3f7fec43,0x3f7d3aac,0x3f731447,0x3f7d3aac,0x3f7fe129,0x3f7a7302,0x3f6d1c1d
.long 0x3f7ec46d,0x3f7f0e58,0x3f76ba07,0x3f660f88,0x3f7fb10f,0x3f7d7474,0x3f721352,0x3f5df6be
.long 0x3e94a031,0x3ea09ae5,0x3eac7cd4,0x3eb8442a,0x3eb8442a,0x3ec6d529,0x3ed53641,0x3ee363fa
.long 0x3edae880,0x3eebcbbb,0x3efc5d27,0x3f064b82,0x3efc5d27,0x3f07a136,0x3f10d3cd,0x3f19c200
.long 0x3f45e403,0x3f514d3d,0x3f5b941a,0x3f64aa59,0x3f514d3d,0x3f5c61c7,0x3f660f88,0x3f6e46be
.long 0x3f5b941a,0x3f660f88,0x3f6ed89e,0x3f75dec6,0x3f64aa59,0x3f6e46be,0x3f75dec6,0x3f7b61fc
.long 0x3f7ec46d,0x3f7fec43,0x3f7d3aac,0x3f76ba07,0x3f7fec43,0x3f7e9bc9,0x3f791298,0x3f6f6830
.long 0x3f7fb10f,0x3f7baccd,0x3f731447,0x3f660f88,0x3f7e1324,0x3f772417,0x3f6b4b0c,0x3f5ac450
.long 0x3f61c598,0x3f49d112,0x3f2beb4a,0x3f08f59b,0x3f584853,0x3f3ca003,0x3f1b02c6,0x3ee900b7
.long 0x3f4d9f02,0x3f2e3bde,0x3f08f59b,0x3ebe1d4a,0x3f41d870,0x3f1ebc12,0x3eebcbbb,0x3e919ddd
.size gf_tab, 43008
```
